```python
import torch

def _softmax(x, axis=-1):
    return torch.softmax(x, dim=axis)

def _gelu(x):
    return torch.nn.functional.gelu(x, approximate='tanh')

def _silu(x):
    return torch.nn.functional.silu(x)

def _sigmoid(x):
    return torch.sigmoid(x)

def _layernorm(x, axis=-1, eps=1e-05):
    m = x.mean(dim=axis, keepdim=True)
    v = x.var(dim=axis, keepdim=True, unbiased=False)
    return (x - m) / torch.sqrt(v + eps)

def _scatter_add(tgt, idx, src, axis=0):
    return tgt.clone().index_add_(axis, idx, src)

def _segment_sum(src, seg, n):
    out = torch.zeros((n,) + src.shape[1:], dtype=src.dtype)
    return out.index_add_(0, seg, src)

def _pad(x, pw):
    flat = tuple((v for pair in reversed(pw) for v in pair))
    return torch.nn.functional.pad(x, flat)
kernel_name = 'sequential_preLN__memory_aug_recurrent_mem_tr__dense_activation_gelu__prompt'

def setup_inputs():

    _w = lambda a: (lambda t: t.to(torch.bfloat16) if t.is_floating_point() else t)(torch.as_tensor(a))

    def _A_setup():
        B, S, Dm = (1, 2048, 576)
        H, Dh = (32, 128)
        M, seg = (8, 32)
        seg = min(seg, S)
        S = S // seg * seg
        return {'x': _w((lambda *s: torch.randn(*s, dtype=torch.bfloat16) * 0.05)(B, S, Dm)), 'mem0': _w((lambda *s: torch.randn(*s, dtype=torch.bfloat16) * 0.2)(B, M, Dm)), 'Wq': _w((lambda *s: torch.randn(*s, dtype=torch.bfloat16) * 1.6)(Dm, H, Dh) * Dm ** (-0.5)), 'Wk': _w((lambda *s: torch.randn(*s, dtype=torch.bfloat16) * 1.6)(Dm, H, Dh) * Dm ** (-0.5)), 'Wv': _w((lambda *s: torch.randn(*s, dtype=torch.bfloat16) * 0.2)(Dm, H, Dh) * Dm ** (-0.5)), 'Wo': _w((lambda *s: torch.randn(*s, dtype=torch.bfloat16) * 0.2)(H, Dh, Dm) * (H * Dh) ** (-0.5)), 'seg_len': seg}
    _A_in = _A_setup()

    def _B_setup():
        B, S, D, F = (1, 2048, 576, 4608)
        return {'x': _w((lambda *s: torch.randn(*s, dtype=torch.bfloat16) * 0.05)(B, S, D)), 'w1': _w((lambda *s: torch.randn(*s, dtype=torch.bfloat16) * 0.4)(D, F) * D ** (-0.5)), 'b1': _w((lambda *s: torch.randn(*s, dtype=torch.bfloat16) * 12.8)(F) * 0.01), 'w2': _w((lambda *s: torch.randn(*s, dtype=torch.bfloat16) * 0.2)(F, D) * F ** (-0.5)), 'b2': _w((lambda *s: torch.randn(*s, dtype=torch.bfloat16) * 3.2)(D) * 0.01)}
    _B_in = _B_setup()
    return {'A_x': _A_in['x'], 'A_mem0': _A_in['mem0'], 'A_Wq': _A_in['Wq'], 'A_Wk': _A_in['Wk'], 'A_Wv': _A_in['Wv'], 'A_Wo': _A_in['Wo'], 'A_seg_len': _A_in['seg_len'], 'B_x': _B_in['x'], 'B_w1': _B_in['w1'], 'B_b1': _B_in['b1'], 'B_w2': _B_in['w2'], 'B_b2': _B_in['b2']}

def reference(A_x, A_mem0, A_Wq, A_Wk, A_Wv, A_Wo, A_seg_len, B_x, B_w1, B_b1, B_w2, B_b2):

    def _A_ref(x, mem0, Wq, Wk, Wv, Wo, seg_len):
        B, S, Dm = x.shape
        H, Dh = (Wq.shape[1], Wq.shape[2])
        M = mem0.shape[1]
        scale = Dh ** (-0.5)
        n_seg = S // seg_len
        L = M + seg_len
        idx = torch.arange(L)
        mask = (idx[:, None] < M) | (idx[:, None] >= idx[None, :])
        mem = mem0
        outs = []
        for s in range(n_seg):
            xs = x[:, s * seg_len:(s + 1) * seg_len, :].clone()
            h = torch.concatenate([mem, xs], axis=1)
            q = torch.einsum('btd,dhe->bhte', h, Wq)
            k = torch.einsum('btd,dhe->bhte', h, Wk)
            v = torch.einsum('btd,dhe->bhte', h, Wv)
            scores = torch.einsum('bhqe,bhke->bhqk', q, k) * scale
            scores = torch.where(mask[None, None], scores, -1000000000.0)
            p = _softmax(scores, axis=-1)
            o = torch.einsum('bhqk,bhke->bhqe', p, v)
            o = torch.einsum('bhte,hed->btd', o, Wo)
            mem = o[:, :M, :].clone()
            outs.append(o[:, M:, :])
        return torch.concatenate(outs, axis=1)

    def _B_ref(x, w1, b1, w2, b2):
        h = torch.einsum('bsd,df->bsf', x, w1) + b1
        h = _gelu(h)
        return torch.einsum('bsf,fd->bsd', h, w2) + b2
    x = A_x
    h = x + _A_ref(_layernorm(x, axis=-1), A_mem0, A_Wq, A_Wk, A_Wv, A_Wo, A_seg_len)
    h2 = h + _B_ref(_layernorm(h, axis=-1), B_w1, B_b1, B_w2, B_b2)
    return h2
```

```asm
; @launch kernel=sequential_preLN__memory_aug_recurrent_mem_tr__dense_activation_gelu__prompt_kernel grid=(256,1,1) block=(256,1,1) lds=163840
.amdgcn_target "amdgcn-amd-amdhsa--gfx950"
.text
.globl sequential_preLN__memory_aug_recurrent_mem_tr__dense_activation_gelu__prompt_kernel
.p2align 8
.type sequential_preLN__memory_aug_recurrent_mem_tr__dense_activation_gelu__prompt_kernel,@function
sequential_preLN__memory_aug_recurrent_mem_tr__dense_activation_gelu__prompt_kernel:
    s_cmp_ge_u32 s2, 256
    s_cbranch_scc1 exit_m_1
    s_and_b32 s3, s2, 7
    s_cmp_eq_u32 s3, 0
    s_cbranch_scc0 workers_m_3
    s_lshr_b32 s16, s2, 3
    s_load_dwordx2 s[56:57], s[0:1], 112
    s_load_dwordx2 s[58:59], s[0:1], 104
    s_load_dwordx8 s[68:75], s[0:1], 8
    s_load_dwordx2 s[76:77], s[0:1], 40
    v_lshrrev_b32 v25, 6, v0
    s_nop 0
    v_readfirstlane_b32 s17, v25
    v_and_b32 v20, 63, v0
    v_lshrrev_b32 v21, 4, v20
    v_and_b32 v22, 15, v20
    v_lshrrev_b32 v23, 2, v22
    v_and_b32 v24, 3, v22
    v_lshlrev_b32 v0, 4, v20
    s_mul_i32 s46, s17, 34816
    s_add_u32 s46, s46, 24576
    v_add_u32 v1, s46, v0
    v_and_b32 v25, 8, v20
    v_cmp_ne_u32 s[24:25], 0, v25
    v_cmp_eq_u32 s[62:63], 0, v25
    v_cmp_lt_u32 s[28:29], 31, v20
    v_mov_b32 v25, 17476
    v_mov_b32 v26, 61166
    v_cndmask_b32 v2, v25, v26, s[24:25]
    v_lshrrev_b32 v25, 5, v20
    v_lshl_add_u32 v25, v25, 4, v22
    s_lshl_b32 s20, s17, 5
    v_add_u32 v25, s20, v25
    v_and_b32 v26, 1, v21
    v_lshlrev_b32 v26, 3, v26
    v_lshl_add_u32 v3, v25, 4, v26
    v_lshrrev_b32 v25, 1, v21
    v_lshlrev_b32 v25, 4, v25
    v_and_b32 v26, 1, v21
    v_lshl_add_u32 v25, v26, 2, v25
    v_add_u32 v25, v25, v23
    v_and_b32 v26, 1, v24
    v_lshlrev_b32 v26, 3, v26
    v_lshl_add_u32 v4, v25, 4, v26
    v_and_b32 v25, 7, v20
    v_lshlrev_b32 v25, 4, v25
    v_lshl_add_u32 v5, v21, 7, v25
    s_lshl_b32 s21, s17, 11
    v_add_u32 v6, s21, v5
    s_and_b32 s20, s17, 1
    s_lshl_b32 s65, s20, 9
    s_add_u32 s20, s65, 8192
    v_add_u32 v7, s20, v5
    v_lshrrev_b32 v25, 2, v20
    v_and_b32 v26, 3, v20
    v_lshlrev_b32 v26, 4, v26
    v_lshl_add_u32 v56, v25, 13, v26
    s_mov_b32 s22, 1152
    v_mul_lo_u32 v25, v25, s22
    v_add_u32 v57, v25, v26
    v_and_b32 v25, 1, v23
    v_lshl_add_u32 v25, v21, 2, v25
    v_lshlrev_b32 v25, 6, v25
    v_lshrrev_b32 v26, 1, v23
    v_lshl_add_u32 v26, v26, 5, v25
    v_lshl_add_u32 v26, v24, 3, v26
    v_add_u32 v58, s46, v26
    s_lshl_b32 s20, s65, 2
    v_xor_b32 v26, s20, v26
    v_add_u32 v60, s46, v26
    v_xor_b32 v26, 2048, v26
    v_add_u32 v61, s46, v26
    v_and_b32 v25, 1, v21
    v_lshlrev_b32 v25, 4, v25
    v_lshrrev_b32 v26, 1, v21
    v_lshl_add_u32 v25, v26, 2, v25
    v_and_b32 v26, 1, v23
    v_add_u32 v25, v25, v26
    v_lshlrev_b32 v25, 6, v25
    v_lshrrev_b32 v26, 1, v23
    v_lshl_add_u32 v25, v26, 5, v25
    v_lshl_add_u32 v25, v24, 3, v25
    s_lshl_b32 s20, s65, 2
    v_xor_b32 v25, s20, v25
    v_add_u32 v59, s46, v25
    v_xor_b32 v25, 2048, v25
    v_add_u32 v62, s46, v25
    s_lshl_b32 s48, s17, 1
    s_lshl_b32 s20, s16, 8
    s_lshl_b32 s21, s17, 6
    s_add_u32 s47, s20, s21
    s_mov_b32 s26, 1040356334
    s_mov_b32 s27, 1040356334
    s_mov_b32 s30, 1065369472
    s_mov_b32 s31, 1065369472
    s_mov_b32 s49, 4294967294
    s_mov_b32 s98, 1056980736
    s_mov_b32 s99, 1056980736
    s_mov_b32 s19, 4194304
    s_lshl_b32 s20, s17, 5
    s_add_u32 s20, s20, s16
    s_mul_i32 s60, s20, 2560
    s_lshl_b32 s61, s17, 9
    s_lshr_b32 s21, s20, 4
    s_mul_i32 s50, s21, 81920
    s_and_b32 s22, s20, 15
    s_lshl_b32 s22, s22, 7
    s_add_u32 s50, s50, s22
    s_mov_b32 s51, 20480
    s_mov_b32 s3, 40960
    s_lshr_b32 s22, s20, 2
    s_mul_i32 s55, s22, 512
    s_and_b32 s22, s20, 2
    s_lshl_b32 s22, s22, 7
    s_add_u32 s55, s55, s22
    s_and_b32 s22, s20, 1
    s_lshl_b32 s22, s22, 6
    s_add_u32 s55, s55, s22
    s_mov_b32 s45, 1
    s_waitcnt lgkmcnt(0)
    s_cmp_lt_u32 s17, 2
    s_cbranch_scc1 rnorm_m_7
    s_mov_b32 s45, 0
    s_mov_b32 s50, 0
    s_mov_b32 s55, 0
    s_cmp_ge_u32 s20, 80
    s_cbranch_scc1 rnorm_m_7
    s_mov_b32 s45, 2
    s_lshr_b32 s21, s16, 3
    s_mul_i32 s50, s21, 81920
    s_and_b32 s22, s16, 7
    s_lshl_b32 s22, s22, 6
    s_add_u32 s50, s50, s22
    s_add_u32 s50, s50, 2048
    s_mov_b32 s51, 40960
    s_mov_b32 s3, 163840
    s_add_u32 s21, s21, 16
    s_mul_i32 s55, s21, 512
    s_and_b32 s22, s16, 4
    s_lshl_b32 s22, s22, 6
    s_add_u32 s55, s55, s22
    s_and_b32 s22, s16, 1
    s_lshl_b32 s22, s22, 7
    s_add_u32 s55, s55, s22
    s_and_b32 s22, s16, 2
    s_lshl_b32 s22, s22, 5
    s_add_u32 s55, s55, s22
rnorm_m_7:
    v_lshrrev_b32 v8, 7, v0
    v_mul_u32_u24 v8, 2560, v8
    v_and_b32 v25, 112, v0
    v_add_u32 v8, v8, v25
    v_lshrrev_b32 v26, 6, v0
    v_mul_u32_u24 v26, 2560, v26
    v_and_b32 v25, 48, v0
    v_add_u32 v26, v26, v25
    s_cmp_eq_u32 s45, 2
    s_cselect_b64 s[96:97], -1, 0
    v_cndmask_b32 v8, v8, v26, s[96:97]
    v_lshlrev_b32 v25, 2, v24
    v_lshl_add_u32 v25, v21, 4, v25
    v_bfe_u32 v26, v20, 2, 1
    v_lshl_add_u32 v26, v26, 7, v25
    v_cndmask_b32 v25, v26, v25, s[96:97]
    v_add_u32 v9, s55, v25
    s_waitcnt lgkmcnt(0)
    s_mov_b32 s4, s56
    s_and_b32 s5, s57, 65535
    s_mov_b32 s6, 268435456
    s_mov_b32 s7, 131072
    s_mov_b32 s12, s58
    s_and_b32 s13, s59, 65535
    s_mov_b32 s14, 256
    s_mov_b32 s15, 131072
    s_mov_b32 s80, s70
    s_and_b32 s81, s71, 65535
    s_mov_b32 s82, 4718592
    s_mov_b32 s83, 131072
    s_mov_b32 s84, s72
    s_and_b32 s85, s73, 65535
    s_mov_b32 s86, 4718592
    s_mov_b32 s87, 131072
    s_mov_b32 s88, s74
    s_and_b32 s89, s75, 65535
    s_mov_b32 s90, 4718592
    s_mov_b32 s91, 131072
    s_mov_b32 s92, s76
    s_and_b32 s93, s77, 65535
    s_mov_b32 s94, 4718592
    s_mov_b32 s95, 131072
    s_mov_b32 s8, s68
    s_and_b32 s9, s69, 65535
    s_mov_b32 s10, 9216
    s_mov_b32 s11, 131072
    v_mov_b32 v12, -1
    v_mov_b32 v13, -1
    v_mov_b32 v14, -1
    v_mov_b32 v15, -1
    s_add_u32 s20, s60, 182452224
    buffer_store_dwordx4 v[12:15], v0, s[4:7], s20 offen sc1
    buffer_store_dwordx4 v[12:15], v0, s[4:7], s20 offen offset:1024 sc1
    v_lshrrev_b32 v10, 1, v0
    buffer_store_dwordx2 v[12:13], v10, s[4:7], s20 offen offset:2048 sc1
    s_add_u32 s20, s60, 182779904
    buffer_store_dwordx4 v[12:15], v0, s[4:7], s20 offen sc1
    buffer_store_dwordx4 v[12:15], v0, s[4:7], s20 offen offset:1024 sc1
    v_lshrrev_b32 v10, 1, v0
    buffer_store_dwordx2 v[12:13], v10, s[4:7], s20 offen offset:2048 sc1
    s_cmp_lg_u32 s17, 3
    s_cbranch_scc1 nomem_m_8
    s_cmp_ge_u32 s16, 9
    s_cbranch_scc1 nomem_m_8
    s_mul_i32 s20, s16, 1024
    v_lshrrev_b32 v10, 9, v0
    v_mul_u32_u24 v10, 0, v10
    v_add_u32 v11, v10, v0
    s_add_u32 s21, s20, 183510016
    buffer_store_dwordx4 v[12:15], v11, s[4:7], s21 offen sc1
    s_add_u32 s21, s21, 9216
    buffer_store_dwordx4 v[12:15], v11, s[4:7], s21 offen sc1
    v_lshrrev_b32 v20, 4, v0
    v_and_b32 v21, 7, v20
    v_mul_u32_u24 v21, 1152, v21
    v_lshrrev_b32 v20, 3, v20
    v_lshl_add_u32 v20, v20, 4, v21
    s_lshl_b32 s21, s16, 7
    buffer_load_dwordx4 v[16:19], v20, s[8:11], s21 offen
    s_waitcnt vmcnt(0)
    v_min_u32 v16, s49, v16
    v_min_u32 v17, s49, v17
    v_min_u32 v18, s49, v18
    v_min_u32 v19, s49, v19
    s_add_u32 s21, s20, 183500800
    buffer_store_dwordx4 v[16:19], v11, s[4:7], s21 offen sc1
    s_nop 1
nomem_m_8:
    v_lshrrev_b32 v22, 4, v0
    v_lshrrev_b32 v20, 3, v22
    v_and_b32 v21, 7, v22
    v_lshlrev_b32 v21, 4, v21
    v_lshl_add_u32 v56, v20, 13, v21
    v_mul_u32_u24 v20, 1152, v20
    v_add_u32 v57, v20, v21
    s_and_b32 s20, s17, 2
    s_mul_i32 s101, s20, 34816
    s_add_u32 s101, s101, 24576
    s_lshl_b32 s100, s20, 1
    s_lshl_b32 s97, s16, 8
    s_lshl_b32 s20, s20, 6
    s_add_u32 s97, s97, s20
    s_mul_i32 s96, s16, 147456
    s_lshl_b32 s20, s17, 8
    s_add_u32 s96, s96, s20
    v_lshrrev_b32 v23, 4, v22
    v_bfe_u32 v24, v22, 2, 2
    v_and_b32 v25, 3, v22
    v_lshrrev_b32 v21, 1, v24
    v_lshlrev_b32 v21, 5, v21
    v_lshl_add_u32 v21, v25, 3, v21
    v_add_u32 v21, s101, v21
    v_and_b32 v24, 1, v24
    v_lshl_add_u32 v20, v23, 2, v24
    v_lshl_add_u32 v58, v20, 7, v21
    v_and_b32 v20, 1, v23
    v_lshlrev_b32 v20, 4, v20
    v_lshrrev_b32 v25, 1, v23
    v_lshl_add_u32 v20, v25, 2, v20
    v_add_u32 v20, v20, v24
    v_lshl_add_u32 v59, v20, 7, v21
    s_bitcmp1_b32 s17, 0
    s_cbranch_scc1 wodd_m_9
    s_xor_b32 s20, s17, 0
    s_mul_i32 s20, s20, 36864
    s_add_u32 s20, s20, s96
    s_add_u32 s20, s20, 0
    s_add_u32 m0, s46, 16384
    s_nop 0
    buffer_load_dwordx4 v57, s[92:95], s20 offen lds
    s_add_u32 m0, s46, 17408
    s_add_u32 s20, s20, 9216
    buffer_load_dwordx4 v57, s[92:95], s20 offen lds
    s_add_u32 m0, s46, 18432
    s_add_u32 s20, s20, 9216
    buffer_load_dwordx4 v57, s[92:95], s20 offen lds
    s_add_u32 m0, s46, 19456
    s_add_u32 s20, s20, 9216
    buffer_load_dwordx4 v57, s[92:95], s20 offen lds
    s_xor_b32 s20, s17, 0
    s_mul_i32 s20, s20, 36864
    s_add_u32 s20, s20, s96
    s_add_u32 s20, s20, 128
    s_add_u32 m0, s46, 0
    s_nop 0
    buffer_load_dwordx4 v57, s[92:95], s20 offen lds
    s_add_u32 m0, s46, 1024
    s_add_u32 s20, s20, 9216
    buffer_load_dwordx4 v57, s[92:95], s20 offen lds
    s_add_u32 m0, s46, 2048
    s_add_u32 s20, s20, 9216
    buffer_load_dwordx4 v57, s[92:95], s20 offen lds
    s_add_u32 m0, s46, 3072
    s_add_u32 s20, s20, 9216
    buffer_load_dwordx4 v57, s[92:95], s20 offen lds
    s_xor_b32 s20, s17, 1
    s_mul_i32 s20, s20, 36864
    s_add_u32 s20, s20, s96
    s_add_u32 s20, s20, 0
    s_add_u32 m0, s46, 4096
    s_nop 0
    buffer_load_dwordx4 v57, s[92:95], s20 offen lds
    s_add_u32 m0, s46, 5120
    s_add_u32 s20, s20, 9216
    buffer_load_dwordx4 v57, s[92:95], s20 offen lds
    s_add_u32 m0, s46, 6144
    s_add_u32 s20, s20, 9216
    buffer_load_dwordx4 v57, s[92:95], s20 offen lds
    s_add_u32 m0, s46, 7168
    s_add_u32 s20, s20, 9216
    buffer_load_dwordx4 v57, s[92:95], s20 offen lds
    s_xor_b32 s20, s17, 1
    s_mul_i32 s20, s20, 36864
    s_add_u32 s20, s20, s96
    s_add_u32 s20, s20, 128
    s_add_u32 m0, s46, 8192
    s_nop 0
    buffer_load_dwordx4 v57, s[92:95], s20 offen lds
    s_add_u32 m0, s46, 9216
    s_add_u32 s20, s20, 9216
    buffer_load_dwordx4 v57, s[92:95], s20 offen lds
    s_add_u32 m0, s46, 10240
    s_add_u32 s20, s20, 9216
    buffer_load_dwordx4 v57, s[92:95], s20 offen lds
    s_add_u32 m0, s46, 11264
    s_add_u32 s20, s20, 9216
    buffer_load_dwordx4 v57, s[92:95], s20 offen lds
    s_waitcnt vmcnt(12)
    s_barrier
    s_xor_b32 s20, s17, 2
    s_mul_i32 s20, s20, 36864
    s_add_u32 s20, s20, s96
    s_add_u32 s20, s20, 0
    s_add_u32 m0, s46, 12288
    s_nop 0
    buffer_load_dwordx4 v57, s[92:95], s20 offen lds
    s_add_u32 m0, s46, 13312
    s_add_u32 s20, s20, 9216
    buffer_load_dwordx4 v57, s[92:95], s20 offen lds
    s_add_u32 m0, s46, 14336
    s_add_u32 s20, s20, 9216
    buffer_load_dwordx4 v57, s[92:95], s20 offen lds
    s_add_u32 m0, s46, 15360
    s_add_u32 s20, s20, 9216
    buffer_load_dwordx4 v57, s[92:95], s20 offen lds
    s_cmp_lg_u32 s17, 0
    s_cbranch_scc1 noann_m_11
    s_getreg_b32 s20, hwreg(HW_REG_XCC_ID)
    s_and_b32 s20, s20, 15
    s_add_u32 s20, s20, 1
    v_mov_b32 v20, s20
    v_mov_b32 v21, s16
    buffer_store_byte v20, v21, s[12:15], 0 offen sc1
    s_waitcnt vmcnt(0)
noann_m_11:
    ds_read_b64_tr_b16 v[160:161], v59 offset:16384
    ds_read_b64_tr_b16 v[162:163], v59 offset:16640
    ds_read_b64_tr_b16 v[164:165], v59 offset:17408
    ds_read_b64_tr_b16 v[166:167], v59 offset:17664
    ds_read_b64_tr_b16 v[176:177], v59 offset:16448
    ds_read_b64_tr_b16 v[178:179], v59 offset:16704
    ds_read_b64_tr_b16 v[180:181], v59 offset:17472
    ds_read_b64_tr_b16 v[182:183], v59 offset:17728
    s_waitcnt lgkmcnt(0)
    s_waitcnt vmcnt(12)
    s_barrier
    s_xor_b32 s20, s17, 2
    s_mul_i32 s20, s20, 36864
    s_add_u32 s20, s20, s96
    s_add_u32 s20, s20, 128
    s_add_u32 m0, s46, 16384
    s_nop 0
    buffer_load_dwordx4 v57, s[92:95], s20 offen lds
    s_add_u32 m0, s46, 17408
    s_add_u32 s20, s20, 9216
    buffer_load_dwordx4 v57, s[92:95], s20 offen lds
    s_add_u32 m0, s46, 18432
    s_add_u32 s20, s20, 9216
    buffer_load_dwordx4 v57, s[92:95], s20 offen lds
    s_add_u32 m0, s46, 19456
    s_add_u32 s20, s20, 9216
    buffer_load_dwordx4 v57, s[92:95], s20 offen lds
    ds_read_b64_tr_b16 v[28:29], v59 offset:0
    ds_read_b64_tr_b16 v[30:31], v59 offset:256
    ds_read_b64_tr_b16 v[32:33], v59 offset:1024
    ds_read_b64_tr_b16 v[34:35], v59 offset:1280
    ds_read_b64_tr_b16 v[224:225], v59 offset:64
    ds_read_b64_tr_b16 v[226:227], v59 offset:320
    ds_read_b64_tr_b16 v[228:229], v59 offset:1088
    ds_read_b64_tr_b16 v[230:231], v59 offset:1344
    s_waitcnt lgkmcnt(0)
    s_waitcnt vmcnt(12)
    s_barrier
    s_xor_b32 s20, s17, 3
    s_mul_i32 s20, s20, 36864
    s_add_u32 s20, s20, s96
    s_add_u32 s20, s20, 0
    s_add_u32 m0, s46, 0
    s_nop 0
    buffer_load_dwordx4 v57, s[92:95], s20 offen lds
    s_add_u32 m0, s46, 1024
    s_add_u32 s20, s20, 9216
    buffer_load_dwordx4 v57, s[92:95], s20 offen lds
    s_add_u32 m0, s46, 2048
    s_add_u32 s20, s20, 9216
    buffer_load_dwordx4 v57, s[92:95], s20 offen lds
    s_add_u32 m0, s46, 3072
    s_add_u32 s20, s20, 9216
    buffer_load_dwordx4 v57, s[92:95], s20 offen lds
    ds_write_b128 v1, v[28:31] offset:24576
    ds_write_b128 v1, v[32:35] offset:25600
    ds_read_b64_tr_b16 v[168:169], v59 offset:4096
    ds_read_b64_tr_b16 v[170:171], v59 offset:4352
    ds_read_b64_tr_b16 v[172:173], v59 offset:5120
    ds_read_b64_tr_b16 v[174:175], v59 offset:5376
    ds_read_b64_tr_b16 v[184:185], v59 offset:4160
    ds_read_b64_tr_b16 v[186:187], v59 offset:4416
    ds_read_b64_tr_b16 v[188:189], v59 offset:5184
    ds_read_b64_tr_b16 v[190:191], v59 offset:5440
    s_waitcnt lgkmcnt(0)
    s_waitcnt vmcnt(12)
    s_barrier
    s_xor_b32 s20, s17, 3
    s_mul_i32 s20, s20, 36864
    s_add_u32 s20, s20, s96
    s_add_u32 s20, s20, 128
    s_add_u32 m0, s46, 4096
    s_nop 0
    buffer_load_dwordx4 v57, s[92:95], s20 offen lds
    s_add_u32 m0, s46, 5120
    s_add_u32 s20, s20, 9216
    buffer_load_dwordx4 v57, s[92:95], s20 offen lds
    s_add_u32 m0, s46, 6144
    s_add_u32 s20, s20, 9216
    buffer_load_dwordx4 v57, s[92:95], s20 offen lds
    s_add_u32 m0, s46, 7168
    s_add_u32 s20, s20, 9216
    buffer_load_dwordx4 v57, s[92:95], s20 offen lds
    ds_read_b64_tr_b16 v[28:29], v59 offset:8192
    ds_read_b64_tr_b16 v[30:31], v59 offset:8448
    ds_read_b64_tr_b16 v[32:33], v59 offset:9216
    ds_read_b64_tr_b16 v[34:35], v59 offset:9472
    ds_read_b64_tr_b16 v[232:233], v59 offset:8256
    ds_read_b64_tr_b16 v[234:235], v59 offset:8512
    ds_read_b64_tr_b16 v[236:237], v59 offset:9280
    ds_read_b64_tr_b16 v[238:239], v59 offset:9536
    s_waitcnt lgkmcnt(0)
    s_waitcnt vmcnt(12)
    s_barrier
    s_mul_i32 s20, s17, 36864
    s_mul_i32 s21, s16, 147456
    s_add_u32 s20, s20, s21
    s_add_u32 s20, s20, 1024
    s_add_u32 m0, s46, 8192
    s_nop 0
    buffer_load_dwordx4 v57, s[92:95], s20 offen lds
    s_add_u32 m0, s46, 9216
    s_add_u32 s20, s20, 9216
    buffer_load_dwordx4 v57, s[92:95], s20 offen lds
    s_add_u32 m0, s46, 10240
    s_add_u32 s20, s20, 9216
    buffer_load_dwordx4 v57, s[92:95], s20 offen lds
    s_add_u32 m0, s46, 11264
    s_add_u32 s20, s20, 9216
    buffer_load_dwordx4 v57, s[92:95], s20 offen lds
    ds_write_b128 v1, v[28:31] offset:26624
    ds_write_b128 v1, v[32:35] offset:27648
    ds_read_b64_tr_b16 v[12:13], v59 offset:12288
    ds_read_b64_tr_b16 v[14:15], v59 offset:12544
    ds_read_b64_tr_b16 v[16:17], v59 offset:13312
    ds_read_b64_tr_b16 v[18:19], v59 offset:13568
    ds_read_b64_tr_b16 v[192:193], v59 offset:12352
    ds_read_b64_tr_b16 v[194:195], v59 offset:12608
    ds_read_b64_tr_b16 v[196:197], v59 offset:13376
    ds_read_b64_tr_b16 v[198:199], v59 offset:13632
    s_waitcnt lgkmcnt(0)
    s_waitcnt vmcnt(12)
    s_barrier
    s_xor_b32 s20, s100, 4
    s_lshl_b32 s20, s20, 19
    s_add_u32 s20, s20, s97
    s_add_u32 m0, s46, 12288
    s_nop 0
    buffer_load_dwordx4 v56, s[80:83], s20 offen lds
    s_add_u32 m0, s46, 13312
    s_add_u32 s20, s20, 65536
    buffer_load_dwordx4 v56, s[80:83], s20 offen lds
    s_add_u32 m0, s46, 14336
    s_add_u32 s20, s20, 65536
    buffer_load_dwordx4 v56, s[80:83], s20 offen lds
    s_add_u32 m0, s46, 15360
    s_add_u32 s20, s20, 65536
    buffer_load_dwordx4 v56, s[80:83], s20 offen lds
    ds_write_b128 v1, v[12:15] offset:20480
    ds_write_b128 v1, v[16:19] offset:21504
    ds_read_b64_tr_b16 v[208:209], v59 offset:16384
    ds_read_b64_tr_b16 v[210:211], v59 offset:16640
    ds_read_b64_tr_b16 v[212:213], v59 offset:17408
    ds_read_b64_tr_b16 v[214:215], v59 offset:17664
    ds_read_b64_tr_b16 v[36:37], v59 offset:16448
    ds_read_b64_tr_b16 v[38:39], v59 offset:16704
    ds_read_b64_tr_b16 v[40:41], v59 offset:17472
    ds_read_b64_tr_b16 v[42:43], v59 offset:17728
    s_waitcnt lgkmcnt(0)
    s_waitcnt vmcnt(12)
    s_barrier
    s_xor_b32 s20, s100, 5
    s_lshl_b32 s20, s20, 19
    s_add_u32 s20, s20, s97
    s_add_u32 m0, s46, 16384
    s_nop 0
    buffer_load_dwordx4 v56, s[80:83], s20 offen lds
    s_add_u32 m0, s46, 17408
    s_add_u32 s20, s20, 65536
    buffer_load_dwordx4 v56, s[80:83], s20 offen lds
    s_add_u32 m0, s46, 18432
    s_add_u32 s20, s20, 65536
    buffer_load_dwordx4 v56, s[80:83], s20 offen lds
    s_add_u32 m0, s46, 19456
    s_add_u32 s20, s20, 65536
    buffer_load_dwordx4 v56, s[80:83], s20 offen lds
    ds_write_b128 v1, v[36:39] offset:28672
    ds_write_b128 v1, v[40:43] offset:29696
    ds_read_b64_tr_b16 v[12:13], v59 offset:0
    ds_read_b64_tr_b16 v[14:15], v59 offset:256
    ds_read_b64_tr_b16 v[16:17], v59 offset:1024
    ds_read_b64_tr_b16 v[18:19], v59 offset:1280
    ds_read_b64_tr_b16 v[200:201], v59 offset:64
    ds_read_b64_tr_b16 v[202:203], v59 offset:320
    ds_read_b64_tr_b16 v[204:205], v59 offset:1088
    ds_read_b64_tr_b16 v[206:207], v59 offset:1344
    s_waitcnt lgkmcnt(0)
    s_waitcnt vmcnt(12)
    s_barrier
    s_xor_b32 s20, s100, 6
    s_lshl_b32 s20, s20, 19
    s_add_u32 s20, s20, s97
    s_add_u32 m0, s46, 0
    s_nop 0
    buffer_load_dwordx4 v56, s[80:83], s20 offen lds
    s_add_u32 m0, s46, 1024
    s_add_u32 s20, s20, 65536
    buffer_load_dwordx4 v56, s[80:83], s20 offen lds
    s_add_u32 m0, s46, 2048
    s_add_u32 s20, s20, 65536
    buffer_load_dwordx4 v56, s[80:83], s20 offen lds
    s_add_u32 m0, s46, 3072
    s_add_u32 s20, s20, 65536
    buffer_load_dwordx4 v56, s[80:83], s20 offen lds
    ds_write_b128 v1, v[12:15] offset:22528
    ds_write_b128 v1, v[16:19] offset:23552
    ds_read_b64_tr_b16 v[216:217], v59 offset:4096
    ds_read_b64_tr_b16 v[218:219], v59 offset:4352
    ds_read_b64_tr_b16 v[220:221], v59 offset:5120
    ds_read_b64_tr_b16 v[222:223], v59 offset:5376
    ds_read_b64_tr_b16 v[36:37], v59 offset:4160
    ds_read_b64_tr_b16 v[38:39], v59 offset:4416
    ds_read_b64_tr_b16 v[40:41], v59 offset:5184
    ds_read_b64_tr_b16 v[42:43], v59 offset:5440
    s_waitcnt lgkmcnt(0)
    s_waitcnt vmcnt(12)
    s_barrier
    s_xor_b32 s20, s100, 7
    s_lshl_b32 s20, s20, 19
    s_add_u32 s20, s20, s97
    s_add_u32 m0, s46, 4096
    s_nop 0
    buffer_load_dwordx4 v56, s[80:83], s20 offen lds
    s_add_u32 m0, s46, 5120
    s_add_u32 s20, s20, 65536
    buffer_load_dwordx4 v56, s[80:83], s20 offen lds
    s_add_u32 m0, s46, 6144
    s_add_u32 s20, s20, 65536
    buffer_load_dwordx4 v56, s[80:83], s20 offen lds
    s_add_u32 m0, s46, 7168
    s_add_u32 s20, s20, 65536
    buffer_load_dwordx4 v56, s[80:83], s20 offen lds
    ds_write_b128 v1, v[36:39] offset:30720
    ds_write_b128 v1, v[40:43] offset:31744
    ds_read_b64_tr_b16 v[240:241], v59 offset:8192
    ds_read_b64_tr_b16 v[242:243], v59 offset:8448
    ds_read_b64_tr_b16 v[244:245], v59 offset:9216
    ds_read_b64_tr_b16 v[246:247], v59 offset:9472
    ds_read_b64_tr_b16 v[248:249], v59 offset:47104
    ds_read_b64_tr_b16 v[250:251], v59 offset:47360
    ds_read_b64_tr_b16 v[252:253], v59 offset:48128
    ds_read_b64_tr_b16 v[254:255], v59 offset:48384
    s_waitcnt lgkmcnt(0)
    s_waitcnt vmcnt(12)
    s_barrier
    s_add_u32 s20, s97, 4194304
    s_add_u32 m0, s46, 8192
    s_nop 0
    buffer_load_dwordx4 v56, s[80:83], s20 offen lds
    s_add_u32 m0, s46, 9216
    s_add_u32 s20, s20, 65536
    buffer_load_dwordx4 v56, s[80:83], s20 offen lds
    s_add_u32 m0, s46, 10240
    s_add_u32 s20, s20, 65536
    buffer_load_dwordx4 v56, s[80:83], s20 offen lds
    s_add_u32 m0, s46, 11264
    s_add_u32 s20, s20, 65536
    buffer_load_dwordx4 v56, s[80:83], s20 offen lds
    ds_read_b64_tr_b16 a[16:17], v58 offset:12288
    ds_read_b64_tr_b16 a[18:19], v58 offset:12544
    ds_read_b64_tr_b16 a[20:21], v58 offset:14336
    ds_read_b64_tr_b16 a[22:23], v58 offset:14592
    ds_read_b64_tr_b16 a[24:25], v58 offset:43008
    ds_read_b64_tr_b16 a[26:27], v58 offset:43264
    ds_read_b64_tr_b16 a[28:29], v58 offset:45056
    ds_read_b64_tr_b16 a[30:31], v58 offset:45312
    s_waitcnt lgkmcnt(0)
    s_waitcnt vmcnt(12)
    s_barrier
    s_xor_b32 s20, s100, 0
    s_lshl_b32 s20, s20, 19
    s_add_u32 s20, s20, s97
    s_add_u32 m0, s46, 12288
    s_nop 0
    buffer_load_dwordx4 v56, s[84:87], s20 offen lds
    s_add_u32 m0, s46, 13312
    s_add_u32 s20, s20, 65536
    buffer_load_dwordx4 v56, s[84:87], s20 offen lds
    s_add_u32 m0, s46, 14336
    s_add_u32 s20, s20, 65536
    buffer_load_dwordx4 v56, s[84:87], s20 offen lds
    s_add_u32 m0, s46, 15360
    s_add_u32 s20, s20, 65536
    buffer_load_dwordx4 v56, s[84:87], s20 offen lds
    ds_read_b64_tr_b16 a[32:33], v58 offset:16384
    ds_read_b64_tr_b16 a[34:35], v58 offset:16640
    ds_read_b64_tr_b16 a[36:37], v58 offset:18432
    ds_read_b64_tr_b16 a[38:39], v58 offset:18688
    ds_read_b64_tr_b16 a[40:41], v58 offset:51200
    ds_read_b64_tr_b16 a[42:43], v58 offset:51456
    ds_read_b64_tr_b16 a[44:45], v58 offset:53248
    ds_read_b64_tr_b16 a[46:47], v58 offset:53504
    s_waitcnt lgkmcnt(0)
    s_waitcnt vmcnt(12)
    s_barrier
    s_xor_b32 s20, s100, 1
    s_lshl_b32 s20, s20, 19
    s_add_u32 s20, s20, s97
    s_add_u32 m0, s46, 16384
    s_nop 0
    buffer_load_dwordx4 v56, s[84:87], s20 offen lds
    s_add_u32 m0, s46, 17408
    s_add_u32 s20, s20, 65536
    buffer_load_dwordx4 v56, s[84:87], s20 offen lds
    s_add_u32 m0, s46, 18432
    s_add_u32 s20, s20, 65536
    buffer_load_dwordx4 v56, s[84:87], s20 offen lds
    s_add_u32 m0, s46, 19456
    s_add_u32 s20, s20, 65536
    buffer_load_dwordx4 v56, s[84:87], s20 offen lds
    ds_read_b64_tr_b16 a[48:49], v58 offset:0
    ds_read_b64_tr_b16 a[50:51], v58 offset:256
    ds_read_b64_tr_b16 a[52:53], v58 offset:2048
    ds_read_b64_tr_b16 a[54:55], v58 offset:2304
    ds_read_b64_tr_b16 a[56:57], v58 offset:38912
    ds_read_b64_tr_b16 a[58:59], v58 offset:39168
    ds_read_b64_tr_b16 a[60:61], v58 offset:40960
    ds_read_b64_tr_b16 a[62:63], v58 offset:41216
    s_waitcnt lgkmcnt(0)
    s_waitcnt vmcnt(12)
    s_barrier
    s_xor_b32 s20, s100, 2
    s_lshl_b32 s20, s20, 19
    s_add_u32 s20, s20, s97
    s_add_u32 m0, s46, 0
    s_nop 0
    buffer_load_dwordx4 v56, s[84:87], s20 offen lds
    s_add_u32 m0, s46, 1024
    s_add_u32 s20, s20, 65536
    buffer_load_dwordx4 v56, s[84:87], s20 offen lds
    s_add_u32 m0, s46, 2048
    s_add_u32 s20, s20, 65536
    buffer_load_dwordx4 v56, s[84:87], s20 offen lds
    s_add_u32 m0, s46, 3072
    s_add_u32 s20, s20, 65536
    buffer_load_dwordx4 v56, s[84:87], s20 offen lds
    ds_read_b64_tr_b16 a[64:65], v58 offset:4096
    ds_read_b64_tr_b16 a[66:67], v58 offset:4352
    ds_read_b64_tr_b16 a[68:69], v58 offset:6144
    ds_read_b64_tr_b16 a[70:71], v58 offset:6400
    ds_read_b64_tr_b16 a[72:73], v58 offset:34816
    ds_read_b64_tr_b16 a[74:75], v58 offset:35072
    ds_read_b64_tr_b16 a[76:77], v58 offset:36864
    ds_read_b64_tr_b16 a[78:79], v58 offset:37120
    s_waitcnt lgkmcnt(0)
    s_waitcnt vmcnt(12)
    s_barrier
    s_xor_b32 s20, s100, 3
    s_lshl_b32 s20, s20, 19
    s_add_u32 s20, s20, s97
    s_add_u32 m0, s46, 4096
    s_nop 0
    buffer_load_dwordx4 v56, s[84:87], s20 offen lds
    s_add_u32 m0, s46, 5120
    s_add_u32 s20, s20, 65536
    buffer_load_dwordx4 v56, s[84:87], s20 offen lds
    s_add_u32 m0, s46, 6144
    s_add_u32 s20, s20, 65536
    buffer_load_dwordx4 v56, s[84:87], s20 offen lds
    s_add_u32 m0, s46, 7168
    s_add_u32 s20, s20, 65536
    buffer_load_dwordx4 v56, s[84:87], s20 offen lds
    ds_read_b64_tr_b16 a[0:1], v58 offset:8192
    ds_read_b64_tr_b16 a[2:3], v58 offset:8448
    ds_read_b64_tr_b16 a[4:5], v58 offset:10240
    ds_read_b64_tr_b16 a[6:7], v58 offset:10496
    ds_read_b64_tr_b16 a[8:9], v58 offset:47104
    ds_read_b64_tr_b16 a[10:11], v58 offset:47360
    ds_read_b64_tr_b16 a[12:13], v58 offset:49152
    ds_read_b64_tr_b16 a[14:15], v58 offset:49408
    s_waitcnt lgkmcnt(0)
    s_waitcnt vmcnt(12)
    s_barrier
    s_xor_b32 s20, s100, 4
    s_lshl_b32 s20, s20, 19
    s_add_u32 s20, s20, s97
    s_add_u32 m0, s46, 8192
    s_nop 0
    buffer_load_dwordx4 v56, s[84:87], s20 offen lds
    s_add_u32 m0, s46, 9216
    s_add_u32 s20, s20, 65536
    buffer_load_dwordx4 v56, s[84:87], s20 offen lds
    s_add_u32 m0, s46, 10240
    s_add_u32 s20, s20, 65536
    buffer_load_dwordx4 v56, s[84:87], s20 offen lds
    s_add_u32 m0, s46, 11264
    s_add_u32 s20, s20, 65536
    buffer_load_dwordx4 v56, s[84:87], s20 offen lds
    ds_read_b64_tr_b16 a[80:81], v58 offset:12288
    ds_read_b64_tr_b16 a[82:83], v58 offset:12544
    ds_read_b64_tr_b16 a[84:85], v58 offset:14336
    ds_read_b64_tr_b16 a[86:87], v58 offset:14592
    ds_read_b64_tr_b16 a[88:89], v58 offset:43008
    ds_read_b64_tr_b16 a[90:91], v58 offset:43264
    ds_read_b64_tr_b16 a[92:93], v58 offset:45056
    ds_read_b64_tr_b16 a[94:95], v58 offset:45312
    s_waitcnt lgkmcnt(0)
    s_waitcnt vmcnt(12)
    s_barrier
    s_xor_b32 s20, s100, 5
    s_lshl_b32 s20, s20, 19
    s_add_u32 s20, s20, s97
    s_add_u32 m0, s46, 12288
    s_nop 0
    buffer_load_dwordx4 v56, s[84:87], s20 offen lds
    s_add_u32 m0, s46, 13312
    s_add_u32 s20, s20, 65536
    buffer_load_dwordx4 v56, s[84:87], s20 offen lds
    s_add_u32 m0, s46, 14336
    s_add_u32 s20, s20, 65536
    buffer_load_dwordx4 v56, s[84:87], s20 offen lds
    s_add_u32 m0, s46, 15360
    s_add_u32 s20, s20, 65536
    buffer_load_dwordx4 v56, s[84:87], s20 offen lds
    ds_read_b64_tr_b16 a[96:97], v58 offset:16384
    ds_read_b64_tr_b16 a[98:99], v58 offset:16640
    ds_read_b64_tr_b16 a[100:101], v58 offset:18432
    ds_read_b64_tr_b16 a[102:103], v58 offset:18688
    ds_read_b64_tr_b16 a[104:105], v58 offset:51200
    ds_read_b64_tr_b16 a[106:107], v58 offset:51456
    ds_read_b64_tr_b16 a[108:109], v58 offset:53248
    ds_read_b64_tr_b16 a[110:111], v58 offset:53504
    s_waitcnt lgkmcnt(0)
    s_waitcnt vmcnt(12)
    s_barrier
    s_xor_b32 s20, s100, 6
    s_lshl_b32 s20, s20, 19
    s_add_u32 s20, s20, s97
    s_add_u32 m0, s46, 16384
    s_nop 0
    buffer_load_dwordx4 v56, s[84:87], s20 offen lds
    s_add_u32 m0, s46, 17408
    s_add_u32 s20, s20, 65536
    buffer_load_dwordx4 v56, s[84:87], s20 offen lds
    s_add_u32 m0, s46, 18432
    s_add_u32 s20, s20, 65536
    buffer_load_dwordx4 v56, s[84:87], s20 offen lds
    s_add_u32 m0, s46, 19456
    s_add_u32 s20, s20, 65536
    buffer_load_dwordx4 v56, s[84:87], s20 offen lds
    ds_read_b64_tr_b16 a[112:113], v58 offset:0
    ds_read_b64_tr_b16 a[114:115], v58 offset:256
    ds_read_b64_tr_b16 a[116:117], v58 offset:2048
    ds_read_b64_tr_b16 a[118:119], v58 offset:2304
    ds_read_b64_tr_b16 a[120:121], v58 offset:38912
    ds_read_b64_tr_b16 a[122:123], v58 offset:39168
    ds_read_b64_tr_b16 a[124:125], v58 offset:40960
    ds_read_b64_tr_b16 a[126:127], v58 offset:41216
    s_waitcnt lgkmcnt(0)
    s_waitcnt vmcnt(12)
    s_barrier
    s_xor_b32 s20, s100, 7
    s_lshl_b32 s20, s20, 19
    s_add_u32 s20, s20, s97
    s_add_u32 m0, s46, 0
    s_nop 0
    buffer_load_dwordx4 v56, s[84:87], s20 offen lds
    s_add_u32 m0, s46, 1024
    s_add_u32 s20, s20, 65536
    buffer_load_dwordx4 v56, s[84:87], s20 offen lds
    s_add_u32 m0, s46, 2048
    s_add_u32 s20, s20, 65536
    buffer_load_dwordx4 v56, s[84:87], s20 offen lds
    s_add_u32 m0, s46, 3072
    s_add_u32 s20, s20, 65536
    buffer_load_dwordx4 v56, s[84:87], s20 offen lds
    ds_read_b64_tr_b16 a[128:129], v58 offset:4096
    ds_read_b64_tr_b16 a[130:131], v58 offset:4352
    ds_read_b64_tr_b16 a[132:133], v58 offset:6144
    ds_read_b64_tr_b16 a[134:135], v58 offset:6400
    ds_read_b64_tr_b16 a[136:137], v58 offset:34816
    ds_read_b64_tr_b16 a[138:139], v58 offset:35072
    ds_read_b64_tr_b16 a[140:141], v58 offset:36864
    ds_read_b64_tr_b16 a[142:143], v58 offset:37120
    s_waitcnt lgkmcnt(0)
    s_waitcnt vmcnt(12)
    s_barrier
    s_xor_b32 s20, s100, 0
    s_lshl_b32 s20, s20, 19
    s_add_u32 s20, s20, s97
    s_add_u32 m0, s46, 4096
    s_nop 0
    buffer_load_dwordx4 v56, s[88:91], s20 offen lds
    s_add_u32 m0, s46, 5120
    s_add_u32 s20, s20, 65536
    buffer_load_dwordx4 v56, s[88:91], s20 offen lds
    s_add_u32 m0, s46, 6144
    s_add_u32 s20, s20, 65536
    buffer_load_dwordx4 v56, s[88:91], s20 offen lds
    s_add_u32 m0, s46, 7168
    s_add_u32 s20, s20, 65536
    buffer_load_dwordx4 v56, s[88:91], s20 offen lds
    ds_read_b64_tr_b16 a[144:145], v58 offset:8192
    ds_read_b64_tr_b16 a[146:147], v58 offset:8448
    ds_read_b64_tr_b16 a[148:149], v58 offset:10240
    ds_read_b64_tr_b16 a[150:151], v58 offset:10496
    ds_read_b64_tr_b16 a[152:153], v58 offset:47104
    ds_read_b64_tr_b16 a[154:155], v58 offset:47360
    ds_read_b64_tr_b16 a[156:157], v58 offset:49152
    ds_read_b64_tr_b16 a[158:159], v58 offset:49408
    s_waitcnt lgkmcnt(0)
    s_waitcnt vmcnt(12)
    s_barrier
    s_xor_b32 s20, s100, 1
    s_lshl_b32 s20, s20, 19
    s_add_u32 s20, s20, s97
    s_add_u32 m0, s46, 8192
    s_nop 0
    buffer_load_dwordx4 v56, s[88:91], s20 offen lds
    s_add_u32 m0, s46, 9216
    s_add_u32 s20, s20, 65536
    buffer_load_dwordx4 v56, s[88:91], s20 offen lds
    s_add_u32 m0, s46, 10240
    s_add_u32 s20, s20, 65536
    buffer_load_dwordx4 v56, s[88:91], s20 offen lds
    s_add_u32 m0, s46, 11264
    s_add_u32 s20, s20, 65536
    buffer_load_dwordx4 v56, s[88:91], s20 offen lds
    ds_read_b64_tr_b16 a[160:161], v58 offset:12288
    ds_read_b64_tr_b16 a[162:163], v58 offset:12544
    ds_read_b64_tr_b16 a[164:165], v58 offset:14336
    ds_read_b64_tr_b16 a[166:167], v58 offset:14592
    ds_read_b64_tr_b16 a[168:169], v58 offset:43008
    ds_read_b64_tr_b16 a[170:171], v58 offset:43264
    ds_read_b64_tr_b16 a[172:173], v58 offset:45056
    ds_read_b64_tr_b16 a[174:175], v58 offset:45312
    s_waitcnt lgkmcnt(0)
    s_waitcnt vmcnt(12)
    s_barrier
    s_xor_b32 s20, s100, 2
    s_lshl_b32 s20, s20, 19
    s_add_u32 s20, s20, s97
    s_add_u32 m0, s46, 12288
    s_nop 0
    buffer_load_dwordx4 v56, s[88:91], s20 offen lds
    s_add_u32 m0, s46, 13312
    s_add_u32 s20, s20, 65536
    buffer_load_dwordx4 v56, s[88:91], s20 offen lds
    s_add_u32 m0, s46, 14336
    s_add_u32 s20, s20, 65536
    buffer_load_dwordx4 v56, s[88:91], s20 offen lds
    s_add_u32 m0, s46, 15360
    s_add_u32 s20, s20, 65536
    buffer_load_dwordx4 v56, s[88:91], s20 offen lds
    ds_read_b64_tr_b16 a[176:177], v58 offset:16384
    ds_read_b64_tr_b16 a[178:179], v58 offset:16640
    ds_read_b64_tr_b16 a[180:181], v58 offset:18432
    ds_read_b64_tr_b16 a[182:183], v58 offset:18688
    ds_read_b64_tr_b16 a[184:185], v58 offset:51200
    ds_read_b64_tr_b16 a[186:187], v58 offset:51456
    ds_read_b64_tr_b16 a[188:189], v58 offset:53248
    ds_read_b64_tr_b16 a[190:191], v58 offset:53504
    s_waitcnt lgkmcnt(0)
    s_waitcnt vmcnt(12)
    s_barrier
    s_xor_b32 s20, s100, 3
    s_lshl_b32 s20, s20, 19
    s_add_u32 s20, s20, s97
    s_add_u32 m0, s46, 16384
    s_nop 0
    buffer_load_dwordx4 v56, s[88:91], s20 offen lds
    s_add_u32 m0, s46, 17408
    s_add_u32 s20, s20, 65536
    buffer_load_dwordx4 v56, s[88:91], s20 offen lds
    s_add_u32 m0, s46, 18432
    s_add_u32 s20, s20, 65536
    buffer_load_dwordx4 v56, s[88:91], s20 offen lds
    s_add_u32 m0, s46, 19456
    s_add_u32 s20, s20, 65536
    buffer_load_dwordx4 v56, s[88:91], s20 offen lds
    ds_read_b64_tr_b16 a[192:193], v58 offset:0
    ds_read_b64_tr_b16 a[194:195], v58 offset:256
    ds_read_b64_tr_b16 a[196:197], v58 offset:2048
    ds_read_b64_tr_b16 a[198:199], v58 offset:2304
    ds_read_b64_tr_b16 a[200:201], v58 offset:38912
    ds_read_b64_tr_b16 a[202:203], v58 offset:39168
    ds_read_b64_tr_b16 a[204:205], v58 offset:40960
    ds_read_b64_tr_b16 a[206:207], v58 offset:41216
    s_waitcnt lgkmcnt(0)
    s_waitcnt vmcnt(12)
    s_barrier
    s_xor_b32 s20, s100, 4
    s_lshl_b32 s20, s20, 19
    s_add_u32 s20, s20, s97
    s_add_u32 m0, s46, 0
    s_nop 0
    buffer_load_dwordx4 v56, s[88:91], s20 offen lds
    s_add_u32 m0, s46, 1024
    s_add_u32 s20, s20, 65536
    buffer_load_dwordx4 v56, s[88:91], s20 offen lds
    s_add_u32 m0, s46, 2048
    s_add_u32 s20, s20, 65536
    buffer_load_dwordx4 v56, s[88:91], s20 offen lds
    s_add_u32 m0, s46, 3072
    s_add_u32 s20, s20, 65536
    buffer_load_dwordx4 v56, s[88:91], s20 offen lds
    ds_read_b64_tr_b16 a[208:209], v58 offset:4096
    ds_read_b64_tr_b16 a[210:211], v58 offset:4352
    ds_read_b64_tr_b16 a[212:213], v58 offset:6144
    ds_read_b64_tr_b16 a[214:215], v58 offset:6400
    ds_read_b64_tr_b16 a[216:217], v58 offset:34816
    ds_read_b64_tr_b16 a[218:219], v58 offset:35072
    ds_read_b64_tr_b16 a[220:221], v58 offset:36864
    ds_read_b64_tr_b16 a[222:223], v58 offset:37120
    s_waitcnt lgkmcnt(0)
    s_waitcnt vmcnt(12)
    s_barrier
    s_xor_b32 s20, s100, 5
    s_lshl_b32 s20, s20, 19
    s_add_u32 s20, s20, s97
    s_add_u32 m0, s46, 4096
    s_nop 0
    buffer_load_dwordx4 v56, s[88:91], s20 offen lds
    s_add_u32 m0, s46, 5120
    s_add_u32 s20, s20, 65536
    buffer_load_dwordx4 v56, s[88:91], s20 offen lds
    s_add_u32 m0, s46, 6144
    s_add_u32 s20, s20, 65536
    buffer_load_dwordx4 v56, s[88:91], s20 offen lds
    s_add_u32 m0, s46, 7168
    s_add_u32 s20, s20, 65536
    buffer_load_dwordx4 v56, s[88:91], s20 offen lds
    ds_read_b64_tr_b16 a[224:225], v58 offset:8192
    ds_read_b64_tr_b16 a[226:227], v58 offset:8448
    ds_read_b64_tr_b16 a[228:229], v58 offset:10240
    ds_read_b64_tr_b16 a[230:231], v58 offset:10496
    ds_read_b64_tr_b16 a[232:233], v58 offset:47104
    ds_read_b64_tr_b16 a[234:235], v58 offset:47360
    ds_read_b64_tr_b16 a[236:237], v58 offset:49152
    ds_read_b64_tr_b16 a[238:239], v58 offset:49408
    s_waitcnt lgkmcnt(0)
    s_waitcnt vmcnt(12)
    s_barrier
    s_xor_b32 s20, s100, 6
    s_lshl_b32 s20, s20, 19
    s_add_u32 s20, s20, s97
    s_add_u32 m0, s46, 8192
    s_nop 0
    buffer_load_dwordx4 v56, s[88:91], s20 offen lds
    s_add_u32 m0, s46, 9216
    s_add_u32 s20, s20, 65536
    buffer_load_dwordx4 v56, s[88:91], s20 offen lds
    s_add_u32 m0, s46, 10240
    s_add_u32 s20, s20, 65536
    buffer_load_dwordx4 v56, s[88:91], s20 offen lds
    s_add_u32 m0, s46, 11264
    s_add_u32 s20, s20, 65536
    buffer_load_dwordx4 v56, s[88:91], s20 offen lds
    ds_read_b64_tr_b16 v[64:65], v58 offset:12288
    ds_read_b64_tr_b16 v[66:67], v58 offset:12544
    ds_read_b64_tr_b16 v[68:69], v58 offset:14336
    ds_read_b64_tr_b16 v[70:71], v58 offset:14592
    ds_read_b64_tr_b16 v[72:73], v58 offset:43008
    ds_read_b64_tr_b16 v[74:75], v58 offset:43264
    ds_read_b64_tr_b16 v[76:77], v58 offset:45056
    ds_read_b64_tr_b16 v[78:79], v58 offset:45312
    s_waitcnt lgkmcnt(0)
    s_waitcnt vmcnt(12)
    s_barrier
    s_xor_b32 s20, s100, 7
    s_lshl_b32 s20, s20, 19
    s_add_u32 s20, s20, s97
    s_add_u32 m0, s46, 12288
    s_nop 0
    buffer_load_dwordx4 v56, s[88:91], s20 offen lds
    s_add_u32 m0, s46, 13312
    s_add_u32 s20, s20, 65536
    buffer_load_dwordx4 v56, s[88:91], s20 offen lds
    s_add_u32 m0, s46, 14336
    s_add_u32 s20, s20, 65536
    buffer_load_dwordx4 v56, s[88:91], s20 offen lds
    s_add_u32 m0, s46, 15360
    s_add_u32 s20, s20, 65536
    buffer_load_dwordx4 v56, s[88:91], s20 offen lds
    ds_read_b64_tr_b16 v[80:81], v58 offset:16384
    ds_read_b64_tr_b16 v[82:83], v58 offset:16640
    ds_read_b64_tr_b16 v[84:85], v58 offset:18432
    ds_read_b64_tr_b16 v[86:87], v58 offset:18688
    ds_read_b64_tr_b16 v[88:89], v58 offset:51200
    ds_read_b64_tr_b16 v[90:91], v58 offset:51456
    ds_read_b64_tr_b16 v[92:93], v58 offset:53248
    ds_read_b64_tr_b16 v[94:95], v58 offset:53504
    s_waitcnt lgkmcnt(0)
    s_waitcnt vmcnt(12)
    s_barrier
    s_add_u32 s20, s97, 4194304
    s_add_u32 m0, s46, 16384
    s_nop 0
    buffer_load_dwordx4 v56, s[88:91], s20 offen lds
    s_add_u32 m0, s46, 17408
    s_add_u32 s20, s20, 65536
    buffer_load_dwordx4 v56, s[88:91], s20 offen lds
    s_add_u32 m0, s46, 18432
    s_add_u32 s20, s20, 65536
    buffer_load_dwordx4 v56, s[88:91], s20 offen lds
    s_add_u32 m0, s46, 19456
    s_add_u32 s20, s20, 65536
    buffer_load_dwordx4 v56, s[88:91], s20 offen lds
    ds_read_b64_tr_b16 v[96:97], v58 offset:0
    ds_read_b64_tr_b16 v[98:99], v58 offset:256
    ds_read_b64_tr_b16 v[100:101], v58 offset:2048
    ds_read_b64_tr_b16 v[102:103], v58 offset:2304
    ds_read_b64_tr_b16 v[104:105], v58 offset:38912
    ds_read_b64_tr_b16 v[106:107], v58 offset:39168
    ds_read_b64_tr_b16 v[108:109], v58 offset:40960
    ds_read_b64_tr_b16 v[110:111], v58 offset:41216
    s_waitcnt lgkmcnt(0)
    s_waitcnt vmcnt(12)
    s_barrier
    s_xor_b32 s20, s100, 0
    s_lshl_b32 s20, s20, 19
    s_add_u32 s20, s20, s97
    s_add_u32 m0, s46, 0
    s_nop 0
    buffer_load_dwordx4 v56, s[80:83], s20 offen lds
    s_add_u32 m0, s46, 1024
    s_add_u32 s20, s20, 65536
    buffer_load_dwordx4 v56, s[80:83], s20 offen lds
    s_add_u32 m0, s46, 2048
    s_add_u32 s20, s20, 65536
    buffer_load_dwordx4 v56, s[80:83], s20 offen lds
    s_add_u32 m0, s46, 3072
    s_add_u32 s20, s20, 65536
    buffer_load_dwordx4 v56, s[80:83], s20 offen lds
    ds_read_b64_tr_b16 v[112:113], v58 offset:4096
    ds_read_b64_tr_b16 v[114:115], v58 offset:4352
    ds_read_b64_tr_b16 v[116:117], v58 offset:6144
    ds_read_b64_tr_b16 v[118:119], v58 offset:6400
    ds_read_b64_tr_b16 v[120:121], v58 offset:34816
    ds_read_b64_tr_b16 v[122:123], v58 offset:35072
    ds_read_b64_tr_b16 v[124:125], v58 offset:36864
    ds_read_b64_tr_b16 v[126:127], v58 offset:37120
    s_waitcnt lgkmcnt(0)
    s_waitcnt vmcnt(12)
    s_barrier
    s_xor_b32 s20, s100, 2
    s_lshl_b32 s20, s20, 19
    s_add_u32 s20, s20, s97
    s_add_u32 m0, s46, 4096
    s_nop 0
    buffer_load_dwordx4 v56, s[80:83], s20 offen lds
    s_add_u32 m0, s46, 5120
    s_add_u32 s20, s20, 65536
    buffer_load_dwordx4 v56, s[80:83], s20 offen lds
    s_add_u32 m0, s46, 6144
    s_add_u32 s20, s20, 65536
    buffer_load_dwordx4 v56, s[80:83], s20 offen lds
    s_add_u32 m0, s46, 7168
    s_add_u32 s20, s20, 65536
    buffer_load_dwordx4 v56, s[80:83], s20 offen lds
    ds_read_b64_tr_b16 v[128:129], v58 offset:8192
    ds_read_b64_tr_b16 v[130:131], v58 offset:8448
    ds_read_b64_tr_b16 v[132:133], v58 offset:10240
    ds_read_b64_tr_b16 v[134:135], v58 offset:10496
    ds_read_b64_tr_b16 v[136:137], v58 offset:47104
    ds_read_b64_tr_b16 v[138:139], v58 offset:47360
    ds_read_b64_tr_b16 v[140:141], v58 offset:49152
    ds_read_b64_tr_b16 v[142:143], v58 offset:49408
    s_waitcnt lgkmcnt(0)
    s_waitcnt vmcnt(12)
    s_barrier
    s_xor_b32 s20, s100, 1
    s_lshl_b32 s20, s20, 19
    s_add_u32 s20, s20, s97
    s_add_u32 m0, s46, 8192
    s_nop 0
    buffer_load_dwordx4 v56, s[80:83], s20 offen lds
    s_add_u32 m0, s46, 9216
    s_add_u32 s20, s20, 65536
    buffer_load_dwordx4 v56, s[80:83], s20 offen lds
    s_add_u32 m0, s46, 10240
    s_add_u32 s20, s20, 65536
    buffer_load_dwordx4 v56, s[80:83], s20 offen lds
    s_add_u32 m0, s46, 11264
    s_add_u32 s20, s20, 65536
    buffer_load_dwordx4 v56, s[80:83], s20 offen lds
    ds_read_b64_tr_b16 v[144:145], v58 offset:12288
    ds_read_b64_tr_b16 v[146:147], v58 offset:12544
    ds_read_b64_tr_b16 v[148:149], v58 offset:14336
    ds_read_b64_tr_b16 v[150:151], v58 offset:14592
    ds_read_b64_tr_b16 v[152:153], v58 offset:43008
    ds_read_b64_tr_b16 v[154:155], v58 offset:43264
    ds_read_b64_tr_b16 v[156:157], v58 offset:45056
    ds_read_b64_tr_b16 v[158:159], v58 offset:45312
    s_waitcnt lgkmcnt(0)
    s_waitcnt vmcnt(12)
    s_barrier
    s_xor_b32 s20, s100, 3
    s_lshl_b32 s20, s20, 19
    s_add_u32 s20, s20, s97
    s_add_u32 m0, s46, 12288
    s_nop 0
    buffer_load_dwordx4 v56, s[80:83], s20 offen lds
    s_add_u32 m0, s46, 13312
    s_add_u32 s20, s20, 65536
    buffer_load_dwordx4 v56, s[80:83], s20 offen lds
    s_add_u32 m0, s46, 14336
    s_add_u32 s20, s20, 65536
    buffer_load_dwordx4 v56, s[80:83], s20 offen lds
    s_add_u32 m0, s46, 15360
    s_add_u32 s20, s20, 65536
    buffer_load_dwordx4 v56, s[80:83], s20 offen lds
    ds_read_b64_tr_b16 a[240:241], v58 offset:16384
    ds_read_b64_tr_b16 a[242:243], v58 offset:16640
    ds_read_b64_tr_b16 a[244:245], v58 offset:18432
    ds_read_b64_tr_b16 a[246:247], v58 offset:18688
    ds_read_b64_tr_b16 a[248:249], v58 offset:51200
    ds_read_b64_tr_b16 a[250:251], v58 offset:51456
    ds_read_b64_tr_b16 a[252:253], v58 offset:53248
    ds_read_b64_tr_b16 a[254:255], v58 offset:53504
    s_waitcnt lgkmcnt(0)
    s_waitcnt vmcnt(12)
    s_barrier
    s_add_u32 s20, s97, 4194304
    s_add_u32 m0, s46, 16384
    s_nop 0
    buffer_load_dwordx4 v56, s[84:87], s20 offen lds
    s_add_u32 m0, s46, 17408
    s_add_u32 s20, s20, 65536
    buffer_load_dwordx4 v56, s[84:87], s20 offen lds
    s_add_u32 m0, s46, 18432
    s_add_u32 s20, s20, 65536
    buffer_load_dwordx4 v56, s[84:87], s20 offen lds
    s_add_u32 m0, s46, 19456
    s_add_u32 s20, s20, 65536
    buffer_load_dwordx4 v56, s[84:87], s20 offen lds
    ds_read_b64_tr_b16 v[28:29], v58 offset:0
    ds_read_b64_tr_b16 v[30:31], v58 offset:256
    ds_read_b64_tr_b16 v[32:33], v58 offset:2048
    ds_read_b64_tr_b16 v[34:35], v58 offset:2304
    ds_read_b64_tr_b16 v[36:37], v58 offset:38912
    ds_read_b64_tr_b16 v[38:39], v58 offset:39168
    ds_read_b64_tr_b16 v[40:41], v58 offset:40960
    ds_read_b64_tr_b16 v[42:43], v58 offset:41216
    s_waitcnt lgkmcnt(0)
    s_waitcnt vmcnt(12)
    s_barrier
    ds_write_b128 v1, v[28:31] offset:0
    ds_write_b128 v1, v[32:35] offset:1024
    ds_write_b128 v1, v[36:39] offset:2048
    ds_write_b128 v1, v[40:43] offset:3072
    ds_read_b64_tr_b16 v[12:13], v58 offset:4096
    ds_read_b64_tr_b16 v[14:15], v58 offset:4352
    ds_read_b64_tr_b16 v[16:17], v58 offset:6144
    ds_read_b64_tr_b16 v[18:19], v58 offset:6400
    ds_read_b64_tr_b16 v[20:21], v58 offset:34816
    ds_read_b64_tr_b16 v[22:23], v58 offset:35072
    ds_read_b64_tr_b16 v[24:25], v58 offset:36864
    ds_read_b64_tr_b16 v[26:27], v58 offset:37120
    s_waitcnt lgkmcnt(0)
    s_waitcnt vmcnt(8)
    s_barrier
    ds_write_b128 v1, v[12:15] offset:4096
    ds_write_b128 v1, v[16:19] offset:5120
    ds_write_b128 v1, v[20:23] offset:6144
    ds_write_b128 v1, v[24:27] offset:7168
    ds_read_b64_tr_b16 v[28:29], v58 offset:8192
    ds_read_b64_tr_b16 v[30:31], v58 offset:8448
    ds_read_b64_tr_b16 v[32:33], v58 offset:10240
    ds_read_b64_tr_b16 v[34:35], v58 offset:10496
    ds_read_b64_tr_b16 v[36:37], v58 offset:47104
    ds_read_b64_tr_b16 v[38:39], v58 offset:47360
    ds_read_b64_tr_b16 v[40:41], v58 offset:49152
    ds_read_b64_tr_b16 v[42:43], v58 offset:49408
    s_waitcnt lgkmcnt(0)
    s_waitcnt vmcnt(4)
    s_barrier
    ds_write_b128 v1, v[28:31] offset:8192
    ds_write_b128 v1, v[32:35] offset:9216
    ds_write_b128 v1, v[36:39] offset:10240
    ds_write_b128 v1, v[40:43] offset:11264
    ds_read_b64_tr_b16 v[12:13], v58 offset:12288
    ds_read_b64_tr_b16 v[14:15], v58 offset:12544
    ds_read_b64_tr_b16 v[16:17], v58 offset:14336
    ds_read_b64_tr_b16 v[18:19], v58 offset:14592
    ds_read_b64_tr_b16 v[20:21], v58 offset:43008
    ds_read_b64_tr_b16 v[22:23], v58 offset:43264
    ds_read_b64_tr_b16 v[24:25], v58 offset:45056
    ds_read_b64_tr_b16 v[26:27], v58 offset:45312
    s_waitcnt lgkmcnt(0)
    s_waitcnt vmcnt(0)
    s_barrier
    ds_write_b128 v1, v[12:15] offset:12288
    ds_write_b128 v1, v[16:19] offset:13312
    ds_write_b128 v1, v[20:23] offset:14336
    ds_write_b128 v1, v[24:27] offset:15360
    ds_read_b64_tr_b16 v[28:29], v58 offset:16384
    ds_read_b64_tr_b16 v[30:31], v58 offset:16640
    ds_read_b64_tr_b16 v[32:33], v58 offset:18432
    ds_read_b64_tr_b16 v[34:35], v58 offset:18688
    ds_read_b64_tr_b16 v[36:37], v58 offset:51200
    ds_read_b64_tr_b16 v[38:39], v58 offset:51456
    ds_read_b64_tr_b16 v[40:41], v58 offset:53248
    ds_read_b64_tr_b16 v[42:43], v58 offset:53504
    s_waitcnt lgkmcnt(0)
    s_barrier
    ds_write_b128 v1, v[28:31] offset:16384
    ds_write_b128 v1, v[32:35] offset:17408
    ds_write_b128 v1, v[36:39] offset:18432
    ds_write_b128 v1, v[40:43] offset:19456
    s_waitcnt lgkmcnt(0)
    s_branch wjoin_m_10
wodd_m_9:
    s_xor_b32 s20, s17, 0
    s_mul_i32 s20, s20, 36864
    s_add_u32 s20, s20, s96
    s_add_u32 s20, s20, 0
    s_add_u32 m0, s46, 16384
    s_nop 0
    buffer_load_dwordx4 v57, s[92:95], s20 offen lds
    s_add_u32 m0, s46, 17408
    s_add_u32 s20, s20, 9216
    buffer_load_dwordx4 v57, s[92:95], s20 offen lds
    s_add_u32 m0, s46, 18432
    s_add_u32 s20, s20, 9216
    buffer_load_dwordx4 v57, s[92:95], s20 offen lds
    s_add_u32 m0, s46, 19456
    s_add_u32 s20, s20, 9216
    buffer_load_dwordx4 v57, s[92:95], s20 offen lds
    s_xor_b32 s20, s17, 0
    s_mul_i32 s20, s20, 36864
    s_add_u32 s20, s20, s96
    s_add_u32 s20, s20, 128
    s_add_u32 m0, s46, 4096
    s_nop 0
    buffer_load_dwordx4 v57, s[92:95], s20 offen lds
    s_add_u32 m0, s46, 5120
    s_add_u32 s20, s20, 9216
    buffer_load_dwordx4 v57, s[92:95], s20 offen lds
    s_add_u32 m0, s46, 6144
    s_add_u32 s20, s20, 9216
    buffer_load_dwordx4 v57, s[92:95], s20 offen lds
    s_add_u32 m0, s46, 7168
    s_add_u32 s20, s20, 9216
    buffer_load_dwordx4 v57, s[92:95], s20 offen lds
    s_xor_b32 s20, s17, 1
    s_mul_i32 s20, s20, 36864
    s_add_u32 s20, s20, s96
    s_add_u32 s20, s20, 0
    s_add_u32 m0, s46, 0
    s_nop 0
    buffer_load_dwordx4 v57, s[92:95], s20 offen lds
    s_add_u32 m0, s46, 1024
    s_add_u32 s20, s20, 9216
    buffer_load_dwordx4 v57, s[92:95], s20 offen lds
    s_add_u32 m0, s46, 2048
    s_add_u32 s20, s20, 9216
    buffer_load_dwordx4 v57, s[92:95], s20 offen lds
    s_add_u32 m0, s46, 3072
    s_add_u32 s20, s20, 9216
    buffer_load_dwordx4 v57, s[92:95], s20 offen lds
    s_xor_b32 s20, s17, 1
    s_mul_i32 s20, s20, 36864
    s_add_u32 s20, s20, s96
    s_add_u32 s20, s20, 128
    s_add_u32 m0, s46, 12288
    s_nop 0
    buffer_load_dwordx4 v57, s[92:95], s20 offen lds
    s_add_u32 m0, s46, 13312
    s_add_u32 s20, s20, 9216
    buffer_load_dwordx4 v57, s[92:95], s20 offen lds
    s_add_u32 m0, s46, 14336
    s_add_u32 s20, s20, 9216
    buffer_load_dwordx4 v57, s[92:95], s20 offen lds
    s_add_u32 m0, s46, 15360
    s_add_u32 s20, s20, 9216
    buffer_load_dwordx4 v57, s[92:95], s20 offen lds
    s_waitcnt vmcnt(12)
    s_barrier
    s_xor_b32 s20, s17, 2
    s_mul_i32 s20, s20, 36864
    s_add_u32 s20, s20, s96
    s_add_u32 s20, s20, 0
    s_add_u32 m0, s46, 8192
    s_nop 0
    buffer_load_dwordx4 v57, s[92:95], s20 offen lds
    s_add_u32 m0, s46, 9216
    s_add_u32 s20, s20, 9216
    buffer_load_dwordx4 v57, s[92:95], s20 offen lds
    s_add_u32 m0, s46, 10240
    s_add_u32 s20, s20, 9216
    buffer_load_dwordx4 v57, s[92:95], s20 offen lds
    s_add_u32 m0, s46, 11264
    s_add_u32 s20, s20, 9216
    buffer_load_dwordx4 v57, s[92:95], s20 offen lds
    s_cmp_lg_u32 s17, 0
    s_cbranch_scc1 noann_m_12
    s_getreg_b32 s20, hwreg(HW_REG_XCC_ID)
    s_and_b32 s20, s20, 15
    s_add_u32 s20, s20, 1
    v_mov_b32 v20, s20
    v_mov_b32 v21, s16
    buffer_store_byte v20, v21, s[12:15], 0 offen sc1
    s_waitcnt vmcnt(0)
noann_m_12:
    ds_read_b64_tr_b16 v[160:161], v59 offset:51200
    ds_read_b64_tr_b16 v[162:163], v59 offset:51456
    ds_read_b64_tr_b16 v[164:165], v59 offset:52224
    ds_read_b64_tr_b16 v[166:167], v59 offset:52480
    ds_read_b64_tr_b16 v[176:177], v59 offset:51264
    ds_read_b64_tr_b16 v[178:179], v59 offset:51520
    ds_read_b64_tr_b16 v[180:181], v59 offset:52288
    ds_read_b64_tr_b16 v[182:183], v59 offset:52544
    s_waitcnt lgkmcnt(0)
    s_waitcnt vmcnt(12)
    s_barrier
    s_xor_b32 s20, s17, 2
    s_mul_i32 s20, s20, 36864
    s_add_u32 s20, s20, s96
    s_add_u32 s20, s20, 128
    s_add_u32 m0, s46, 16384
    s_nop 0
    buffer_load_dwordx4 v57, s[92:95], s20 offen lds
    s_add_u32 m0, s46, 17408
    s_add_u32 s20, s20, 9216
    buffer_load_dwordx4 v57, s[92:95], s20 offen lds
    s_add_u32 m0, s46, 18432
    s_add_u32 s20, s20, 9216
    buffer_load_dwordx4 v57, s[92:95], s20 offen lds
    s_add_u32 m0, s46, 19456
    s_add_u32 s20, s20, 9216
    buffer_load_dwordx4 v57, s[92:95], s20 offen lds
    ds_read_b64_tr_b16 v[28:29], v59 offset:38912
    ds_read_b64_tr_b16 v[30:31], v59 offset:39168
    ds_read_b64_tr_b16 v[32:33], v59 offset:39936
    ds_read_b64_tr_b16 v[34:35], v59 offset:40192
    ds_read_b64_tr_b16 v[224:225], v59 offset:38976
    ds_read_b64_tr_b16 v[226:227], v59 offset:39232
    ds_read_b64_tr_b16 v[228:229], v59 offset:40000
    ds_read_b64_tr_b16 v[230:231], v59 offset:40256
    s_waitcnt lgkmcnt(0)
    s_waitcnt vmcnt(12)
    s_barrier
    s_xor_b32 s20, s17, 3
    s_mul_i32 s20, s20, 36864
    s_add_u32 s20, s20, s96
    s_add_u32 s20, s20, 0
    s_add_u32 m0, s46, 4096
    s_nop 0
    buffer_load_dwordx4 v57, s[92:95], s20 offen lds
    s_add_u32 m0, s46, 5120
    s_add_u32 s20, s20, 9216
    buffer_load_dwordx4 v57, s[92:95], s20 offen lds
    s_add_u32 m0, s46, 6144
    s_add_u32 s20, s20, 9216
    buffer_load_dwordx4 v57, s[92:95], s20 offen lds
    s_add_u32 m0, s46, 7168
    s_add_u32 s20, s20, 9216
    buffer_load_dwordx4 v57, s[92:95], s20 offen lds
    ds_write_b128 v1, v[28:31] offset:24576
    ds_write_b128 v1, v[32:35] offset:25600
    ds_read_b64_tr_b16 v[168:169], v59 offset:34816
    ds_read_b64_tr_b16 v[170:171], v59 offset:35072
    ds_read_b64_tr_b16 v[172:173], v59 offset:35840
    ds_read_b64_tr_b16 v[174:175], v59 offset:36096
    ds_read_b64_tr_b16 v[184:185], v59 offset:34880
    ds_read_b64_tr_b16 v[186:187], v59 offset:35136
    ds_read_b64_tr_b16 v[188:189], v59 offset:35904
    ds_read_b64_tr_b16 v[190:191], v59 offset:36160
    s_waitcnt lgkmcnt(0)
    s_waitcnt vmcnt(12)
    s_barrier
    s_xor_b32 s20, s17, 3
    s_mul_i32 s20, s20, 36864
    s_add_u32 s20, s20, s96
    s_add_u32 s20, s20, 128
    s_add_u32 m0, s46, 0
    s_nop 0
    buffer_load_dwordx4 v57, s[92:95], s20 offen lds
    s_add_u32 m0, s46, 1024
    s_add_u32 s20, s20, 9216
    buffer_load_dwordx4 v57, s[92:95], s20 offen lds
    s_add_u32 m0, s46, 2048
    s_add_u32 s20, s20, 9216
    buffer_load_dwordx4 v57, s[92:95], s20 offen lds
    s_add_u32 m0, s46, 3072
    s_add_u32 s20, s20, 9216
    buffer_load_dwordx4 v57, s[92:95], s20 offen lds
    ds_read_b64_tr_b16 v[28:29], v59 offset:47104
    ds_read_b64_tr_b16 v[30:31], v59 offset:47360
    ds_read_b64_tr_b16 v[32:33], v59 offset:48128
    ds_read_b64_tr_b16 v[34:35], v59 offset:48384
    ds_read_b64_tr_b16 v[232:233], v59 offset:47168
    ds_read_b64_tr_b16 v[234:235], v59 offset:47424
    ds_read_b64_tr_b16 v[236:237], v59 offset:48192
    ds_read_b64_tr_b16 v[238:239], v59 offset:48448
    s_waitcnt lgkmcnt(0)
    s_waitcnt vmcnt(12)
    s_barrier
    s_mul_i32 s20, s17, 36864
    s_mul_i32 s21, s16, 147456
    s_add_u32 s20, s20, s21
    s_add_u32 s20, s20, 1024
    s_add_u32 m0, s46, 12288
    s_nop 0
    buffer_load_dwordx4 v57, s[92:95], s20 offen lds
    s_add_u32 m0, s46, 13312
    s_add_u32 s20, s20, 9216
    buffer_load_dwordx4 v57, s[92:95], s20 offen lds
    s_add_u32 m0, s46, 14336
    s_add_u32 s20, s20, 9216
    buffer_load_dwordx4 v57, s[92:95], s20 offen lds
    s_add_u32 m0, s46, 15360
    s_add_u32 s20, s20, 9216
    buffer_load_dwordx4 v57, s[92:95], s20 offen lds
    ds_write_b128 v1, v[28:31] offset:26624
    ds_write_b128 v1, v[32:35] offset:27648
    ds_read_b64_tr_b16 v[12:13], v59 offset:43008
    ds_read_b64_tr_b16 v[14:15], v59 offset:43264
    ds_read_b64_tr_b16 v[16:17], v59 offset:44032
    ds_read_b64_tr_b16 v[18:19], v59 offset:44288
    ds_read_b64_tr_b16 v[192:193], v59 offset:43072
    ds_read_b64_tr_b16 v[194:195], v59 offset:43328
    ds_read_b64_tr_b16 v[196:197], v59 offset:44096
    ds_read_b64_tr_b16 v[198:199], v59 offset:44352
    s_waitcnt lgkmcnt(0)
    s_waitcnt vmcnt(12)
    s_barrier
    s_xor_b32 s20, s100, 4
    s_lshl_b32 s20, s20, 19
    s_add_u32 s20, s20, s97
    s_add_u32 s20, s20, 262144
    s_add_u32 m0, s46, 8192
    s_nop 0
    buffer_load_dwordx4 v56, s[80:83], s20 offen lds
    s_add_u32 m0, s46, 9216
    s_add_u32 s20, s20, 65536
    buffer_load_dwordx4 v56, s[80:83], s20 offen lds
    s_add_u32 m0, s46, 10240
    s_add_u32 s20, s20, 65536
    buffer_load_dwordx4 v56, s[80:83], s20 offen lds
    s_add_u32 m0, s46, 11264
    s_add_u32 s20, s20, 65536
    buffer_load_dwordx4 v56, s[80:83], s20 offen lds
    ds_write_b128 v1, v[12:15] offset:20480
    ds_write_b128 v1, v[16:19] offset:21504
    ds_read_b64_tr_b16 v[208:209], v59 offset:51200
    ds_read_b64_tr_b16 v[210:211], v59 offset:51456
    ds_read_b64_tr_b16 v[212:213], v59 offset:52224
    ds_read_b64_tr_b16 v[214:215], v59 offset:52480
    ds_read_b64_tr_b16 v[36:37], v59 offset:51264
    ds_read_b64_tr_b16 v[38:39], v59 offset:51520
    ds_read_b64_tr_b16 v[40:41], v59 offset:52288
    ds_read_b64_tr_b16 v[42:43], v59 offset:52544
    s_waitcnt lgkmcnt(0)
    s_waitcnt vmcnt(12)
    s_barrier
    s_xor_b32 s20, s100, 5
    s_lshl_b32 s20, s20, 19
    s_add_u32 s20, s20, s97
    s_add_u32 s20, s20, 262144
    s_add_u32 m0, s46, 16384
    s_nop 0
    buffer_load_dwordx4 v56, s[80:83], s20 offen lds
    s_add_u32 m0, s46, 17408
    s_add_u32 s20, s20, 65536
    buffer_load_dwordx4 v56, s[80:83], s20 offen lds
    s_add_u32 m0, s46, 18432
    s_add_u32 s20, s20, 65536
    buffer_load_dwordx4 v56, s[80:83], s20 offen lds
    s_add_u32 m0, s46, 19456
    s_add_u32 s20, s20, 65536
    buffer_load_dwordx4 v56, s[80:83], s20 offen lds
    ds_write_b128 v1, v[36:39] offset:28672
    ds_write_b128 v1, v[40:43] offset:29696
    ds_read_b64_tr_b16 v[12:13], v59 offset:38912
    ds_read_b64_tr_b16 v[14:15], v59 offset:39168
    ds_read_b64_tr_b16 v[16:17], v59 offset:39936
    ds_read_b64_tr_b16 v[18:19], v59 offset:40192
    ds_read_b64_tr_b16 v[200:201], v59 offset:38976
    ds_read_b64_tr_b16 v[202:203], v59 offset:39232
    ds_read_b64_tr_b16 v[204:205], v59 offset:40000
    ds_read_b64_tr_b16 v[206:207], v59 offset:40256
    s_waitcnt lgkmcnt(0)
    s_waitcnt vmcnt(12)
    s_barrier
    s_xor_b32 s20, s100, 6
    s_lshl_b32 s20, s20, 19
    s_add_u32 s20, s20, s97
    s_add_u32 s20, s20, 262144
    s_add_u32 m0, s46, 4096
    s_nop 0
    buffer_load_dwordx4 v56, s[80:83], s20 offen lds
    s_add_u32 m0, s46, 5120
    s_add_u32 s20, s20, 65536
    buffer_load_dwordx4 v56, s[80:83], s20 offen lds
    s_add_u32 m0, s46, 6144
    s_add_u32 s20, s20, 65536
    buffer_load_dwordx4 v56, s[80:83], s20 offen lds
    s_add_u32 m0, s46, 7168
    s_add_u32 s20, s20, 65536
    buffer_load_dwordx4 v56, s[80:83], s20 offen lds
    ds_write_b128 v1, v[12:15] offset:22528
    ds_write_b128 v1, v[16:19] offset:23552
    ds_read_b64_tr_b16 v[216:217], v59 offset:34816
    ds_read_b64_tr_b16 v[218:219], v59 offset:35072
    ds_read_b64_tr_b16 v[220:221], v59 offset:35840
    ds_read_b64_tr_b16 v[222:223], v59 offset:36096
    ds_read_b64_tr_b16 v[36:37], v59 offset:34880
    ds_read_b64_tr_b16 v[38:39], v59 offset:35136
    ds_read_b64_tr_b16 v[40:41], v59 offset:35904
    ds_read_b64_tr_b16 v[42:43], v59 offset:36160
    s_waitcnt lgkmcnt(0)
    s_waitcnt vmcnt(12)
    s_barrier
    s_xor_b32 s20, s100, 7
    s_lshl_b32 s20, s20, 19
    s_add_u32 s20, s20, s97
    s_add_u32 s20, s20, 262144
    s_add_u32 m0, s46, 0
    s_nop 0
    buffer_load_dwordx4 v56, s[80:83], s20 offen lds
    s_add_u32 m0, s46, 1024
    s_add_u32 s20, s20, 65536
    buffer_load_dwordx4 v56, s[80:83], s20 offen lds
    s_add_u32 m0, s46, 2048
    s_add_u32 s20, s20, 65536
    buffer_load_dwordx4 v56, s[80:83], s20 offen lds
    s_add_u32 m0, s46, 3072
    s_add_u32 s20, s20, 65536
    buffer_load_dwordx4 v56, s[80:83], s20 offen lds
    ds_write_b128 v1, v[36:39] offset:30720
    ds_write_b128 v1, v[40:43] offset:31744
    ds_read_b64_tr_b16 v[240:241], v59 offset:47168
    ds_read_b64_tr_b16 v[242:243], v59 offset:47424
    ds_read_b64_tr_b16 v[244:245], v59 offset:48192
    ds_read_b64_tr_b16 v[246:247], v59 offset:48448
    ds_read_b64_tr_b16 v[248:249], v59 offset:8256
    ds_read_b64_tr_b16 v[250:251], v59 offset:8512
    ds_read_b64_tr_b16 v[252:253], v59 offset:9280
    ds_read_b64_tr_b16 v[254:255], v59 offset:9536
    s_waitcnt lgkmcnt(0)
    s_waitcnt vmcnt(12)
    s_barrier
    s_add_u32 s20, s97, 4456448
    s_add_u32 m0, s46, 12288
    s_nop 0
    buffer_load_dwordx4 v56, s[80:83], s20 offen lds
    s_add_u32 m0, s46, 13312
    s_add_u32 s20, s20, 65536
    buffer_load_dwordx4 v56, s[80:83], s20 offen lds
    s_add_u32 m0, s46, 14336
    s_add_u32 s20, s20, 65536
    buffer_load_dwordx4 v56, s[80:83], s20 offen lds
    s_add_u32 m0, s46, 15360
    s_add_u32 s20, s20, 65536
    buffer_load_dwordx4 v56, s[80:83], s20 offen lds
    ds_read_b64_tr_b16 a[48:49], v58 offset:12352
    ds_read_b64_tr_b16 a[50:51], v58 offset:12608
    ds_read_b64_tr_b16 a[52:53], v58 offset:14400
    ds_read_b64_tr_b16 a[54:55], v58 offset:14656
    ds_read_b64_tr_b16 a[56:57], v58 offset:43072
    ds_read_b64_tr_b16 a[58:59], v58 offset:43328
    ds_read_b64_tr_b16 a[60:61], v58 offset:45120
    ds_read_b64_tr_b16 a[62:63], v58 offset:45376
    s_waitcnt lgkmcnt(0)
    s_waitcnt vmcnt(12)
    s_barrier
    s_xor_b32 s20, s100, 0
    s_lshl_b32 s20, s20, 19
    s_add_u32 s20, s20, s97
    s_add_u32 s20, s20, 262144
    s_add_u32 m0, s46, 8192
    s_nop 0
    buffer_load_dwordx4 v56, s[84:87], s20 offen lds
    s_add_u32 m0, s46, 9216
    s_add_u32 s20, s20, 65536
    buffer_load_dwordx4 v56, s[84:87], s20 offen lds
    s_add_u32 m0, s46, 10240
    s_add_u32 s20, s20, 65536
    buffer_load_dwordx4 v56, s[84:87], s20 offen lds
    s_add_u32 m0, s46, 11264
    s_add_u32 s20, s20, 65536
    buffer_load_dwordx4 v56, s[84:87], s20 offen lds
    ds_read_b64_tr_b16 a[64:65], v58 offset:16448
    ds_read_b64_tr_b16 a[66:67], v58 offset:16704
    ds_read_b64_tr_b16 a[68:69], v58 offset:18496
    ds_read_b64_tr_b16 a[70:71], v58 offset:18752
    ds_read_b64_tr_b16 a[72:73], v58 offset:51264
    ds_read_b64_tr_b16 a[74:75], v58 offset:51520
    ds_read_b64_tr_b16 a[76:77], v58 offset:53312
    ds_read_b64_tr_b16 a[78:79], v58 offset:53568
    s_waitcnt lgkmcnt(0)
    s_waitcnt vmcnt(12)
    s_barrier
    s_xor_b32 s20, s100, 1
    s_lshl_b32 s20, s20, 19
    s_add_u32 s20, s20, s97
    s_add_u32 s20, s20, 262144
    s_add_u32 m0, s46, 16384
    s_nop 0
    buffer_load_dwordx4 v56, s[84:87], s20 offen lds
    s_add_u32 m0, s46, 17408
    s_add_u32 s20, s20, 65536
    buffer_load_dwordx4 v56, s[84:87], s20 offen lds
    s_add_u32 m0, s46, 18432
    s_add_u32 s20, s20, 65536
    buffer_load_dwordx4 v56, s[84:87], s20 offen lds
    s_add_u32 m0, s46, 19456
    s_add_u32 s20, s20, 65536
    buffer_load_dwordx4 v56, s[84:87], s20 offen lds
    ds_read_b64_tr_b16 a[16:17], v58 offset:64
    ds_read_b64_tr_b16 a[18:19], v58 offset:320
    ds_read_b64_tr_b16 a[20:21], v58 offset:2112
    ds_read_b64_tr_b16 a[22:23], v58 offset:2368
    ds_read_b64_tr_b16 a[24:25], v58 offset:38976
    ds_read_b64_tr_b16 a[26:27], v58 offset:39232
    ds_read_b64_tr_b16 a[28:29], v58 offset:41024
    ds_read_b64_tr_b16 a[30:31], v58 offset:41280
    s_waitcnt lgkmcnt(0)
    s_waitcnt vmcnt(12)
    s_barrier
    s_xor_b32 s20, s100, 2
    s_lshl_b32 s20, s20, 19
    s_add_u32 s20, s20, s97
    s_add_u32 s20, s20, 262144
    s_add_u32 m0, s46, 4096
    s_nop 0
    buffer_load_dwordx4 v56, s[84:87], s20 offen lds
    s_add_u32 m0, s46, 5120
    s_add_u32 s20, s20, 65536
    buffer_load_dwordx4 v56, s[84:87], s20 offen lds
    s_add_u32 m0, s46, 6144
    s_add_u32 s20, s20, 65536
    buffer_load_dwordx4 v56, s[84:87], s20 offen lds
    s_add_u32 m0, s46, 7168
    s_add_u32 s20, s20, 65536
    buffer_load_dwordx4 v56, s[84:87], s20 offen lds
    ds_read_b64_tr_b16 a[32:33], v58 offset:4160
    ds_read_b64_tr_b16 a[34:35], v58 offset:4416
    ds_read_b64_tr_b16 a[36:37], v58 offset:6208
    ds_read_b64_tr_b16 a[38:39], v58 offset:6464
    ds_read_b64_tr_b16 a[40:41], v58 offset:34880
    ds_read_b64_tr_b16 a[42:43], v58 offset:35136
    ds_read_b64_tr_b16 a[44:45], v58 offset:36928
    ds_read_b64_tr_b16 a[46:47], v58 offset:37184
    s_waitcnt lgkmcnt(0)
    s_waitcnt vmcnt(12)
    s_barrier
    s_xor_b32 s20, s100, 3
    s_lshl_b32 s20, s20, 19
    s_add_u32 s20, s20, s97
    s_add_u32 s20, s20, 262144
    s_add_u32 m0, s46, 0
    s_nop 0
    buffer_load_dwordx4 v56, s[84:87], s20 offen lds
    s_add_u32 m0, s46, 1024
    s_add_u32 s20, s20, 65536
    buffer_load_dwordx4 v56, s[84:87], s20 offen lds
    s_add_u32 m0, s46, 2048
    s_add_u32 s20, s20, 65536
    buffer_load_dwordx4 v56, s[84:87], s20 offen lds
    s_add_u32 m0, s46, 3072
    s_add_u32 s20, s20, 65536
    buffer_load_dwordx4 v56, s[84:87], s20 offen lds
    ds_read_b64_tr_b16 a[0:1], v58 offset:47168
    ds_read_b64_tr_b16 a[2:3], v58 offset:47424
    ds_read_b64_tr_b16 a[4:5], v58 offset:49216
    ds_read_b64_tr_b16 a[6:7], v58 offset:49472
    ds_read_b64_tr_b16 a[8:9], v58 offset:8256
    ds_read_b64_tr_b16 a[10:11], v58 offset:8512
    ds_read_b64_tr_b16 a[12:13], v58 offset:10304
    ds_read_b64_tr_b16 a[14:15], v58 offset:10560
    s_waitcnt lgkmcnt(0)
    s_waitcnt vmcnt(12)
    s_barrier
    s_xor_b32 s20, s100, 4
    s_lshl_b32 s20, s20, 19
    s_add_u32 s20, s20, s97
    s_add_u32 s20, s20, 262144
    s_add_u32 m0, s46, 12288
    s_nop 0
    buffer_load_dwordx4 v56, s[84:87], s20 offen lds
    s_add_u32 m0, s46, 13312
    s_add_u32 s20, s20, 65536
    buffer_load_dwordx4 v56, s[84:87], s20 offen lds
    s_add_u32 m0, s46, 14336
    s_add_u32 s20, s20, 65536
    buffer_load_dwordx4 v56, s[84:87], s20 offen lds
    s_add_u32 m0, s46, 15360
    s_add_u32 s20, s20, 65536
    buffer_load_dwordx4 v56, s[84:87], s20 offen lds
    ds_read_b64_tr_b16 a[112:113], v58 offset:12352
    ds_read_b64_tr_b16 a[114:115], v58 offset:12608
    ds_read_b64_tr_b16 a[116:117], v58 offset:14400
    ds_read_b64_tr_b16 a[118:119], v58 offset:14656
    ds_read_b64_tr_b16 a[120:121], v58 offset:43072
    ds_read_b64_tr_b16 a[122:123], v58 offset:43328
    ds_read_b64_tr_b16 a[124:125], v58 offset:45120
    ds_read_b64_tr_b16 a[126:127], v58 offset:45376
    s_waitcnt lgkmcnt(0)
    s_waitcnt vmcnt(12)
    s_barrier
    s_xor_b32 s20, s100, 5
    s_lshl_b32 s20, s20, 19
    s_add_u32 s20, s20, s97
    s_add_u32 s20, s20, 262144
    s_add_u32 m0, s46, 8192
    s_nop 0
    buffer_load_dwordx4 v56, s[84:87], s20 offen lds
    s_add_u32 m0, s46, 9216
    s_add_u32 s20, s20, 65536
    buffer_load_dwordx4 v56, s[84:87], s20 offen lds
    s_add_u32 m0, s46, 10240
    s_add_u32 s20, s20, 65536
    buffer_load_dwordx4 v56, s[84:87], s20 offen lds
    s_add_u32 m0, s46, 11264
    s_add_u32 s20, s20, 65536
    buffer_load_dwordx4 v56, s[84:87], s20 offen lds
    ds_read_b64_tr_b16 a[128:129], v58 offset:16448
    ds_read_b64_tr_b16 a[130:131], v58 offset:16704
    ds_read_b64_tr_b16 a[132:133], v58 offset:18496
    ds_read_b64_tr_b16 a[134:135], v58 offset:18752
    ds_read_b64_tr_b16 a[136:137], v58 offset:51264
    ds_read_b64_tr_b16 a[138:139], v58 offset:51520
    ds_read_b64_tr_b16 a[140:141], v58 offset:53312
    ds_read_b64_tr_b16 a[142:143], v58 offset:53568
    s_waitcnt lgkmcnt(0)
    s_waitcnt vmcnt(12)
    s_barrier
    s_xor_b32 s20, s100, 6
    s_lshl_b32 s20, s20, 19
    s_add_u32 s20, s20, s97
    s_add_u32 s20, s20, 262144
    s_add_u32 m0, s46, 16384
    s_nop 0
    buffer_load_dwordx4 v56, s[84:87], s20 offen lds
    s_add_u32 m0, s46, 17408
    s_add_u32 s20, s20, 65536
    buffer_load_dwordx4 v56, s[84:87], s20 offen lds
    s_add_u32 m0, s46, 18432
    s_add_u32 s20, s20, 65536
    buffer_load_dwordx4 v56, s[84:87], s20 offen lds
    s_add_u32 m0, s46, 19456
    s_add_u32 s20, s20, 65536
    buffer_load_dwordx4 v56, s[84:87], s20 offen lds
    ds_read_b64_tr_b16 a[80:81], v58 offset:64
    ds_read_b64_tr_b16 a[82:83], v58 offset:320
    ds_read_b64_tr_b16 a[84:85], v58 offset:2112
    ds_read_b64_tr_b16 a[86:87], v58 offset:2368
    ds_read_b64_tr_b16 a[88:89], v58 offset:38976
    ds_read_b64_tr_b16 a[90:91], v58 offset:39232
    ds_read_b64_tr_b16 a[92:93], v58 offset:41024
    ds_read_b64_tr_b16 a[94:95], v58 offset:41280
    s_waitcnt lgkmcnt(0)
    s_waitcnt vmcnt(12)
    s_barrier
    s_xor_b32 s20, s100, 7
    s_lshl_b32 s20, s20, 19
    s_add_u32 s20, s20, s97
    s_add_u32 s20, s20, 262144
    s_add_u32 m0, s46, 4096
    s_nop 0
    buffer_load_dwordx4 v56, s[84:87], s20 offen lds
    s_add_u32 m0, s46, 5120
    s_add_u32 s20, s20, 65536
    buffer_load_dwordx4 v56, s[84:87], s20 offen lds
    s_add_u32 m0, s46, 6144
    s_add_u32 s20, s20, 65536
    buffer_load_dwordx4 v56, s[84:87], s20 offen lds
    s_add_u32 m0, s46, 7168
    s_add_u32 s20, s20, 65536
    buffer_load_dwordx4 v56, s[84:87], s20 offen lds
    ds_read_b64_tr_b16 a[96:97], v58 offset:4160
    ds_read_b64_tr_b16 a[98:99], v58 offset:4416
    ds_read_b64_tr_b16 a[100:101], v58 offset:6208
    ds_read_b64_tr_b16 a[102:103], v58 offset:6464
    ds_read_b64_tr_b16 a[104:105], v58 offset:34880
    ds_read_b64_tr_b16 a[106:107], v58 offset:35136
    ds_read_b64_tr_b16 a[108:109], v58 offset:36928
    ds_read_b64_tr_b16 a[110:111], v58 offset:37184
    s_waitcnt lgkmcnt(0)
    s_waitcnt vmcnt(12)
    s_barrier
    s_xor_b32 s20, s100, 0
    s_lshl_b32 s20, s20, 19
    s_add_u32 s20, s20, s97
    s_add_u32 s20, s20, 262144
    s_add_u32 m0, s46, 0
    s_nop 0
    buffer_load_dwordx4 v56, s[88:91], s20 offen lds
    s_add_u32 m0, s46, 1024
    s_add_u32 s20, s20, 65536
    buffer_load_dwordx4 v56, s[88:91], s20 offen lds
    s_add_u32 m0, s46, 2048
    s_add_u32 s20, s20, 65536
    buffer_load_dwordx4 v56, s[88:91], s20 offen lds
    s_add_u32 m0, s46, 3072
    s_add_u32 s20, s20, 65536
    buffer_load_dwordx4 v56, s[88:91], s20 offen lds
    ds_read_b64_tr_b16 a[176:177], v58 offset:8256
    ds_read_b64_tr_b16 a[178:179], v58 offset:8512
    ds_read_b64_tr_b16 a[180:181], v58 offset:10304
    ds_read_b64_tr_b16 a[182:183], v58 offset:10560
    ds_read_b64_tr_b16 a[184:185], v58 offset:47168
    ds_read_b64_tr_b16 a[186:187], v58 offset:47424
    ds_read_b64_tr_b16 a[188:189], v58 offset:49216
    ds_read_b64_tr_b16 a[190:191], v58 offset:49472
    s_waitcnt lgkmcnt(0)
    s_waitcnt vmcnt(12)
    s_barrier
    s_xor_b32 s20, s100, 1
    s_lshl_b32 s20, s20, 19
    s_add_u32 s20, s20, s97
    s_add_u32 s20, s20, 262144
    s_add_u32 m0, s46, 12288
    s_nop 0
    buffer_load_dwordx4 v56, s[88:91], s20 offen lds
    s_add_u32 m0, s46, 13312
    s_add_u32 s20, s20, 65536
    buffer_load_dwordx4 v56, s[88:91], s20 offen lds
    s_add_u32 m0, s46, 14336
    s_add_u32 s20, s20, 65536
    buffer_load_dwordx4 v56, s[88:91], s20 offen lds
    s_add_u32 m0, s46, 15360
    s_add_u32 s20, s20, 65536
    buffer_load_dwordx4 v56, s[88:91], s20 offen lds
    ds_read_b64_tr_b16 a[192:193], v58 offset:12352
    ds_read_b64_tr_b16 a[194:195], v58 offset:12608
    ds_read_b64_tr_b16 a[196:197], v58 offset:14400
    ds_read_b64_tr_b16 a[198:199], v58 offset:14656
    ds_read_b64_tr_b16 a[200:201], v58 offset:43072
    ds_read_b64_tr_b16 a[202:203], v58 offset:43328
    ds_read_b64_tr_b16 a[204:205], v58 offset:45120
    ds_read_b64_tr_b16 a[206:207], v58 offset:45376
    s_waitcnt lgkmcnt(0)
    s_waitcnt vmcnt(12)
    s_barrier
    s_xor_b32 s20, s100, 2
    s_lshl_b32 s20, s20, 19
    s_add_u32 s20, s20, s97
    s_add_u32 s20, s20, 262144
    s_add_u32 m0, s46, 8192
    s_nop 0
    buffer_load_dwordx4 v56, s[88:91], s20 offen lds
    s_add_u32 m0, s46, 9216
    s_add_u32 s20, s20, 65536
    buffer_load_dwordx4 v56, s[88:91], s20 offen lds
    s_add_u32 m0, s46, 10240
    s_add_u32 s20, s20, 65536
    buffer_load_dwordx4 v56, s[88:91], s20 offen lds
    s_add_u32 m0, s46, 11264
    s_add_u32 s20, s20, 65536
    buffer_load_dwordx4 v56, s[88:91], s20 offen lds
    ds_read_b64_tr_b16 a[144:145], v58 offset:16448
    ds_read_b64_tr_b16 a[146:147], v58 offset:16704
    ds_read_b64_tr_b16 a[148:149], v58 offset:18496
    ds_read_b64_tr_b16 a[150:151], v58 offset:18752
    ds_read_b64_tr_b16 a[152:153], v58 offset:51264
    ds_read_b64_tr_b16 a[154:155], v58 offset:51520
    ds_read_b64_tr_b16 a[156:157], v58 offset:53312
    ds_read_b64_tr_b16 a[158:159], v58 offset:53568
    s_waitcnt lgkmcnt(0)
    s_waitcnt vmcnt(12)
    s_barrier
    s_xor_b32 s20, s100, 3
    s_lshl_b32 s20, s20, 19
    s_add_u32 s20, s20, s97
    s_add_u32 s20, s20, 262144
    s_add_u32 m0, s46, 16384
    s_nop 0
    buffer_load_dwordx4 v56, s[88:91], s20 offen lds
    s_add_u32 m0, s46, 17408
    s_add_u32 s20, s20, 65536
    buffer_load_dwordx4 v56, s[88:91], s20 offen lds
    s_add_u32 m0, s46, 18432
    s_add_u32 s20, s20, 65536
    buffer_load_dwordx4 v56, s[88:91], s20 offen lds
    s_add_u32 m0, s46, 19456
    s_add_u32 s20, s20, 65536
    buffer_load_dwordx4 v56, s[88:91], s20 offen lds
    ds_read_b64_tr_b16 a[160:161], v58 offset:64
    ds_read_b64_tr_b16 a[162:163], v58 offset:320
    ds_read_b64_tr_b16 a[164:165], v58 offset:2112
    ds_read_b64_tr_b16 a[166:167], v58 offset:2368
    ds_read_b64_tr_b16 a[168:169], v58 offset:38976
    ds_read_b64_tr_b16 a[170:171], v58 offset:39232
    ds_read_b64_tr_b16 a[172:173], v58 offset:41024
    ds_read_b64_tr_b16 a[174:175], v58 offset:41280
    s_waitcnt lgkmcnt(0)
    s_waitcnt vmcnt(12)
    s_barrier
    s_xor_b32 s20, s100, 4
    s_lshl_b32 s20, s20, 19
    s_add_u32 s20, s20, s97
    s_add_u32 s20, s20, 262144
    s_add_u32 m0, s46, 4096
    s_nop 0
    buffer_load_dwordx4 v56, s[88:91], s20 offen lds
    s_add_u32 m0, s46, 5120
    s_add_u32 s20, s20, 65536
    buffer_load_dwordx4 v56, s[88:91], s20 offen lds
    s_add_u32 m0, s46, 6144
    s_add_u32 s20, s20, 65536
    buffer_load_dwordx4 v56, s[88:91], s20 offen lds
    s_add_u32 m0, s46, 7168
    s_add_u32 s20, s20, 65536
    buffer_load_dwordx4 v56, s[88:91], s20 offen lds
    ds_read_b64_tr_b16 v[64:65], v58 offset:4160
    ds_read_b64_tr_b16 v[66:67], v58 offset:4416
    ds_read_b64_tr_b16 v[68:69], v58 offset:6208
    ds_read_b64_tr_b16 v[70:71], v58 offset:6464
    ds_read_b64_tr_b16 v[72:73], v58 offset:34880
    ds_read_b64_tr_b16 v[74:75], v58 offset:35136
    ds_read_b64_tr_b16 v[76:77], v58 offset:36928
    ds_read_b64_tr_b16 v[78:79], v58 offset:37184
    s_waitcnt lgkmcnt(0)
    s_waitcnt vmcnt(12)
    s_barrier
    s_xor_b32 s20, s100, 5
    s_lshl_b32 s20, s20, 19
    s_add_u32 s20, s20, s97
    s_add_u32 s20, s20, 262144
    s_add_u32 m0, s46, 0
    s_nop 0
    buffer_load_dwordx4 v56, s[88:91], s20 offen lds
    s_add_u32 m0, s46, 1024
    s_add_u32 s20, s20, 65536
    buffer_load_dwordx4 v56, s[88:91], s20 offen lds
    s_add_u32 m0, s46, 2048
    s_add_u32 s20, s20, 65536
    buffer_load_dwordx4 v56, s[88:91], s20 offen lds
    s_add_u32 m0, s46, 3072
    s_add_u32 s20, s20, 65536
    buffer_load_dwordx4 v56, s[88:91], s20 offen lds
    ds_read_b64_tr_b16 v[80:81], v58 offset:8256
    ds_read_b64_tr_b16 v[82:83], v58 offset:8512
    ds_read_b64_tr_b16 v[84:85], v58 offset:10304
    ds_read_b64_tr_b16 v[86:87], v58 offset:10560
    ds_read_b64_tr_b16 v[88:89], v58 offset:47168
    ds_read_b64_tr_b16 v[90:91], v58 offset:47424
    ds_read_b64_tr_b16 v[92:93], v58 offset:49216
    ds_read_b64_tr_b16 v[94:95], v58 offset:49472
    s_waitcnt lgkmcnt(0)
    s_waitcnt vmcnt(12)
    s_barrier
    s_xor_b32 s20, s100, 6
    s_lshl_b32 s20, s20, 19
    s_add_u32 s20, s20, s97
    s_add_u32 s20, s20, 262144
    s_add_u32 m0, s46, 12288
    s_nop 0
    buffer_load_dwordx4 v56, s[88:91], s20 offen lds
    s_add_u32 m0, s46, 13312
    s_add_u32 s20, s20, 65536
    buffer_load_dwordx4 v56, s[88:91], s20 offen lds
    s_add_u32 m0, s46, 14336
    s_add_u32 s20, s20, 65536
    buffer_load_dwordx4 v56, s[88:91], s20 offen lds
    s_add_u32 m0, s46, 15360
    s_add_u32 s20, s20, 65536
    buffer_load_dwordx4 v56, s[88:91], s20 offen lds
    ds_read_b64_tr_b16 a[208:209], v58 offset:12352
    ds_read_b64_tr_b16 a[210:211], v58 offset:12608
    ds_read_b64_tr_b16 a[212:213], v58 offset:14400
    ds_read_b64_tr_b16 a[214:215], v58 offset:14656
    ds_read_b64_tr_b16 a[216:217], v58 offset:43072
    ds_read_b64_tr_b16 a[218:219], v58 offset:43328
    ds_read_b64_tr_b16 a[220:221], v58 offset:45120
    ds_read_b64_tr_b16 a[222:223], v58 offset:45376
    s_waitcnt lgkmcnt(0)
    s_waitcnt vmcnt(12)
    s_barrier
    s_xor_b32 s20, s100, 7
    s_lshl_b32 s20, s20, 19
    s_add_u32 s20, s20, s97
    s_add_u32 s20, s20, 262144
    s_add_u32 m0, s46, 8192
    s_nop 0
    buffer_load_dwordx4 v56, s[88:91], s20 offen lds
    s_add_u32 m0, s46, 9216
    s_add_u32 s20, s20, 65536
    buffer_load_dwordx4 v56, s[88:91], s20 offen lds
    s_add_u32 m0, s46, 10240
    s_add_u32 s20, s20, 65536
    buffer_load_dwordx4 v56, s[88:91], s20 offen lds
    s_add_u32 m0, s46, 11264
    s_add_u32 s20, s20, 65536
    buffer_load_dwordx4 v56, s[88:91], s20 offen lds
    ds_read_b64_tr_b16 a[224:225], v58 offset:16448
    ds_read_b64_tr_b16 a[226:227], v58 offset:16704
    ds_read_b64_tr_b16 a[228:229], v58 offset:18496
    ds_read_b64_tr_b16 a[230:231], v58 offset:18752
    ds_read_b64_tr_b16 a[232:233], v58 offset:51264
    ds_read_b64_tr_b16 a[234:235], v58 offset:51520
    ds_read_b64_tr_b16 a[236:237], v58 offset:53312
    ds_read_b64_tr_b16 a[238:239], v58 offset:53568
    s_waitcnt lgkmcnt(0)
    s_waitcnt vmcnt(12)
    s_barrier
    s_add_u32 s20, s97, 4456448
    s_add_u32 m0, s46, 16384
    s_nop 0
    buffer_load_dwordx4 v56, s[88:91], s20 offen lds
    s_add_u32 m0, s46, 17408
    s_add_u32 s20, s20, 65536
    buffer_load_dwordx4 v56, s[88:91], s20 offen lds
    s_add_u32 m0, s46, 18432
    s_add_u32 s20, s20, 65536
    buffer_load_dwordx4 v56, s[88:91], s20 offen lds
    s_add_u32 m0, s46, 19456
    s_add_u32 s20, s20, 65536
    buffer_load_dwordx4 v56, s[88:91], s20 offen lds
    ds_read_b64_tr_b16 v[128:129], v58 offset:64
    ds_read_b64_tr_b16 v[130:131], v58 offset:320
    ds_read_b64_tr_b16 v[132:133], v58 offset:2112
    ds_read_b64_tr_b16 v[134:135], v58 offset:2368
    ds_read_b64_tr_b16 v[136:137], v58 offset:38976
    ds_read_b64_tr_b16 v[138:139], v58 offset:39232
    ds_read_b64_tr_b16 v[140:141], v58 offset:41024
    ds_read_b64_tr_b16 v[142:143], v58 offset:41280
    s_waitcnt lgkmcnt(0)
    s_waitcnt vmcnt(12)
    s_barrier
    s_xor_b32 s20, s100, 0
    s_lshl_b32 s20, s20, 19
    s_add_u32 s20, s20, s97
    s_add_u32 s20, s20, 262144
    s_add_u32 m0, s46, 4096
    s_nop 0
    buffer_load_dwordx4 v56, s[80:83], s20 offen lds
    s_add_u32 m0, s46, 5120
    s_add_u32 s20, s20, 65536
    buffer_load_dwordx4 v56, s[80:83], s20 offen lds
    s_add_u32 m0, s46, 6144
    s_add_u32 s20, s20, 65536
    buffer_load_dwordx4 v56, s[80:83], s20 offen lds
    s_add_u32 m0, s46, 7168
    s_add_u32 s20, s20, 65536
    buffer_load_dwordx4 v56, s[80:83], s20 offen lds
    ds_read_b64_tr_b16 v[144:145], v58 offset:4160
    ds_read_b64_tr_b16 v[146:147], v58 offset:4416
    ds_read_b64_tr_b16 v[148:149], v58 offset:6208
    ds_read_b64_tr_b16 v[150:151], v58 offset:6464
    ds_read_b64_tr_b16 v[152:153], v58 offset:34880
    ds_read_b64_tr_b16 v[154:155], v58 offset:35136
    ds_read_b64_tr_b16 v[156:157], v58 offset:36928
    ds_read_b64_tr_b16 v[158:159], v58 offset:37184
    s_waitcnt lgkmcnt(0)
    s_waitcnt vmcnt(12)
    s_barrier
    s_xor_b32 s20, s100, 2
    s_lshl_b32 s20, s20, 19
    s_add_u32 s20, s20, s97
    s_add_u32 s20, s20, 262144
    s_add_u32 m0, s46, 0
    s_nop 0
    buffer_load_dwordx4 v56, s[80:83], s20 offen lds
    s_add_u32 m0, s46, 1024
    s_add_u32 s20, s20, 65536
    buffer_load_dwordx4 v56, s[80:83], s20 offen lds
    s_add_u32 m0, s46, 2048
    s_add_u32 s20, s20, 65536
    buffer_load_dwordx4 v56, s[80:83], s20 offen lds
    s_add_u32 m0, s46, 3072
    s_add_u32 s20, s20, 65536
    buffer_load_dwordx4 v56, s[80:83], s20 offen lds
    ds_read_b64_tr_b16 v[96:97], v58 offset:8256
    ds_read_b64_tr_b16 v[98:99], v58 offset:8512
    ds_read_b64_tr_b16 v[100:101], v58 offset:10304
    ds_read_b64_tr_b16 v[102:103], v58 offset:10560
    ds_read_b64_tr_b16 v[104:105], v58 offset:47168
    ds_read_b64_tr_b16 v[106:107], v58 offset:47424
    ds_read_b64_tr_b16 v[108:109], v58 offset:49216
    ds_read_b64_tr_b16 v[110:111], v58 offset:49472
    s_waitcnt lgkmcnt(0)
    s_waitcnt vmcnt(12)
    s_barrier
    s_xor_b32 s20, s100, 1
    s_lshl_b32 s20, s20, 19
    s_add_u32 s20, s20, s97
    s_add_u32 s20, s20, 262144
    s_add_u32 m0, s46, 12288
    s_nop 0
    buffer_load_dwordx4 v56, s[80:83], s20 offen lds
    s_add_u32 m0, s46, 13312
    s_add_u32 s20, s20, 65536
    buffer_load_dwordx4 v56, s[80:83], s20 offen lds
    s_add_u32 m0, s46, 14336
    s_add_u32 s20, s20, 65536
    buffer_load_dwordx4 v56, s[80:83], s20 offen lds
    s_add_u32 m0, s46, 15360
    s_add_u32 s20, s20, 65536
    buffer_load_dwordx4 v56, s[80:83], s20 offen lds
    ds_read_b64_tr_b16 v[112:113], v58 offset:12352
    ds_read_b64_tr_b16 v[114:115], v58 offset:12608
    ds_read_b64_tr_b16 v[116:117], v58 offset:14400
    ds_read_b64_tr_b16 v[118:119], v58 offset:14656
    ds_read_b64_tr_b16 v[120:121], v58 offset:43072
    ds_read_b64_tr_b16 v[122:123], v58 offset:43328
    ds_read_b64_tr_b16 v[124:125], v58 offset:45120
    ds_read_b64_tr_b16 v[126:127], v58 offset:45376
    s_waitcnt lgkmcnt(0)
    s_waitcnt vmcnt(12)
    s_barrier
    s_xor_b32 s20, s100, 3
    s_lshl_b32 s20, s20, 19
    s_add_u32 s20, s20, s97
    s_add_u32 s20, s20, 262144
    s_add_u32 m0, s46, 8192
    s_nop 0
    buffer_load_dwordx4 v56, s[80:83], s20 offen lds
    s_add_u32 m0, s46, 9216
    s_add_u32 s20, s20, 65536
    buffer_load_dwordx4 v56, s[80:83], s20 offen lds
    s_add_u32 m0, s46, 10240
    s_add_u32 s20, s20, 65536
    buffer_load_dwordx4 v56, s[80:83], s20 offen lds
    s_add_u32 m0, s46, 11264
    s_add_u32 s20, s20, 65536
    buffer_load_dwordx4 v56, s[80:83], s20 offen lds
    ds_read_b64_tr_b16 a[240:241], v58 offset:51264
    ds_read_b64_tr_b16 a[242:243], v58 offset:51520
    ds_read_b64_tr_b16 a[244:245], v58 offset:53312
    ds_read_b64_tr_b16 a[246:247], v58 offset:53568
    ds_read_b64_tr_b16 a[248:249], v58 offset:16448
    ds_read_b64_tr_b16 a[250:251], v58 offset:16704
    ds_read_b64_tr_b16 a[252:253], v58 offset:18496
    ds_read_b64_tr_b16 a[254:255], v58 offset:18752
    s_waitcnt lgkmcnt(0)
    s_waitcnt vmcnt(12)
    s_barrier
    s_add_u32 s20, s97, 4456448
    s_add_u32 m0, s46, 16384
    s_nop 0
    buffer_load_dwordx4 v56, s[84:87], s20 offen lds
    s_add_u32 m0, s46, 17408
    s_add_u32 s20, s20, 65536
    buffer_load_dwordx4 v56, s[84:87], s20 offen lds
    s_add_u32 m0, s46, 18432
    s_add_u32 s20, s20, 65536
    buffer_load_dwordx4 v56, s[84:87], s20 offen lds
    s_add_u32 m0, s46, 19456
    s_add_u32 s20, s20, 65536
    buffer_load_dwordx4 v56, s[84:87], s20 offen lds
    ds_read_b64_tr_b16 v[28:29], v58 offset:64
    ds_read_b64_tr_b16 v[30:31], v58 offset:320
    ds_read_b64_tr_b16 v[32:33], v58 offset:2112
    ds_read_b64_tr_b16 v[34:35], v58 offset:2368
    ds_read_b64_tr_b16 v[36:37], v58 offset:38976
    ds_read_b64_tr_b16 v[38:39], v58 offset:39232
    ds_read_b64_tr_b16 v[40:41], v58 offset:41024
    ds_read_b64_tr_b16 v[42:43], v58 offset:41280
    s_waitcnt lgkmcnt(0)
    s_waitcnt vmcnt(12)
    s_barrier
    ds_write_b128 v1, v[28:31] offset:4096
    ds_write_b128 v1, v[32:35] offset:5120
    ds_write_b128 v1, v[36:39] offset:6144
    ds_write_b128 v1, v[40:43] offset:7168
    ds_read_b64_tr_b16 v[12:13], v58 offset:4160
    ds_read_b64_tr_b16 v[14:15], v58 offset:4416
    ds_read_b64_tr_b16 v[16:17], v58 offset:6208
    ds_read_b64_tr_b16 v[18:19], v58 offset:6464
    ds_read_b64_tr_b16 v[20:21], v58 offset:34880
    ds_read_b64_tr_b16 v[22:23], v58 offset:35136
    ds_read_b64_tr_b16 v[24:25], v58 offset:36928
    ds_read_b64_tr_b16 v[26:27], v58 offset:37184
    s_waitcnt lgkmcnt(0)
    s_waitcnt vmcnt(8)
    s_barrier
    ds_write_b128 v1, v[12:15] offset:0
    ds_write_b128 v1, v[16:19] offset:1024
    ds_write_b128 v1, v[20:23] offset:2048
    ds_write_b128 v1, v[24:27] offset:3072
    ds_read_b64_tr_b16 v[28:29], v58 offset:8256
    ds_read_b64_tr_b16 v[30:31], v58 offset:8512
    ds_read_b64_tr_b16 v[32:33], v58 offset:10304
    ds_read_b64_tr_b16 v[34:35], v58 offset:10560
    ds_read_b64_tr_b16 v[36:37], v58 offset:47168
    ds_read_b64_tr_b16 v[38:39], v58 offset:47424
    ds_read_b64_tr_b16 v[40:41], v58 offset:49216
    ds_read_b64_tr_b16 v[42:43], v58 offset:49472
    s_waitcnt lgkmcnt(0)
    s_waitcnt vmcnt(4)
    s_barrier
    ds_write_b128 v1, v[28:31] offset:12288
    ds_write_b128 v1, v[32:35] offset:13312
    ds_write_b128 v1, v[36:39] offset:14336
    ds_write_b128 v1, v[40:43] offset:15360
    ds_read_b64_tr_b16 v[12:13], v58 offset:12352
    ds_read_b64_tr_b16 v[14:15], v58 offset:12608
    ds_read_b64_tr_b16 v[16:17], v58 offset:14400
    ds_read_b64_tr_b16 v[18:19], v58 offset:14656
    ds_read_b64_tr_b16 v[20:21], v58 offset:43072
    ds_read_b64_tr_b16 v[22:23], v58 offset:43328
    ds_read_b64_tr_b16 v[24:25], v58 offset:45120
    ds_read_b64_tr_b16 v[26:27], v58 offset:45376
    s_waitcnt lgkmcnt(0)
    s_waitcnt vmcnt(0)
    s_barrier
    ds_write_b128 v1, v[12:15] offset:8192
    ds_write_b128 v1, v[16:19] offset:9216
    ds_write_b128 v1, v[20:23] offset:10240
    ds_write_b128 v1, v[24:27] offset:11264
    ds_read_b64_tr_b16 v[28:29], v58 offset:51264
    ds_read_b64_tr_b16 v[30:31], v58 offset:51520
    ds_read_b64_tr_b16 v[32:33], v58 offset:53312
    ds_read_b64_tr_b16 v[34:35], v58 offset:53568
    ds_read_b64_tr_b16 v[36:37], v58 offset:16448
    ds_read_b64_tr_b16 v[38:39], v58 offset:16704
    ds_read_b64_tr_b16 v[40:41], v58 offset:18496
    ds_read_b64_tr_b16 v[42:43], v58 offset:18752
    s_waitcnt lgkmcnt(0)
    s_barrier
    ds_write_b128 v1, v[28:31] offset:16384
    ds_write_b128 v1, v[32:35] offset:17408
    ds_write_b128 v1, v[36:39] offset:18432
    ds_write_b128 v1, v[40:43] offset:19456
    s_waitcnt lgkmcnt(0)
wjoin_m_10:
    s_mov_b32 s18, 0
    s_mul_i32 s20, s17, 2048
    s_add_u32 s32, s20, 183500800
    s_mov_b32 s77, 183508992
    s_lshl_b32 s78, s17, 11
    s_mov_b32 s79, 183500800
    s_and_b32 s20, s17, 1
    s_mul_i32 s20, s20, 512
    s_add_u32 s33, s20, 183508992
    s_mov_b32 s66, 182452224
    s_mov_b32 s71, s3
    s_add_u32 s35, s66, s50
    s_add_u32 s36, s35, s51
    s_add_u32 s37, s35, s71
    s_add_u32 s38, s36, s71
    s_add_u32 s34, s66, s60
    s_mov_b32 s39, 183510016
    s_bfe_u32 s40, s16, 131074
    s_mul_i32 s69, s16, 1024
    s_cmp_lt_u32 s16, 9
    s_cselect_b32 s69, s69, 1073741824
    s_cmp_eq_u32 s17, 3
    s_cselect_b32 s69, s69, 1073741824
    s_mov_b32 s67, 0
    s_mov_b32 s70, 0
    s_add_u32 s68, s69, 183528448
    s_lshl_b32 s20, s16, 13
    s_lshl_b32 s21, s17, 10
    s_add_u32 s41, s20, 20971520
    s_add_u32 s41, s41, s21
    s_add_u32 s42, s20, 37748736
    s_add_u32 s42, s42, s21
    s_add_u32 s42, s42, s21
    s_lshl_b32 s22, s16, 11
    s_add_u32 s43, s22, 201326592
    s_lshl_b32 s22, s65, 3
    s_add_u32 s64, s20, s22
    s_cmp_lt_u32 s17, 2
    s_cselect_b32 s22, 0, 16777216
    s_add_u32 s64, s64, s22
    s_add_u32 s64, s64, 20971520
    s_lshl_b32 s20, s16, 11
    s_add_u32 s44, s20, 75497472
    s_add_u32 s44, s44, s61
    s_lshl_b32 s52, s17, 10
    s_add_u32 s52, s52, 9216
    s_add_u32 s53, s46, 32768
    v_lshrrev_b32 v20, 4, v0
    v_and_b32 v20, 31, v20
    s_nop 1
L_m_13:
    s_sub_u32 s19, s19, 1
    s_cbranch_scc1 abort_m_4
    buffer_load_ubyte v21, v20, s[12:15], 0 offen sc1
    s_waitcnt vmcnt(0)
    v_cmp_eq_u32 vcc, 0, v21
    s_nop 0
    s_cbranch_vccnz L_m_13
    v_readfirstlane_b32 s20, v21
    s_nop 1
    v_cmp_ne_u32 vcc, s20, v21
    s_nop 0
    s_cmp_eq_u64 vcc, 0
    s_cselect_b32 s54, 1, 0
    s_mov_b32 s80, 0
    v_mov_b32 v10, 23808
    v_mov_b64 v[32:33], 0
    ds_write_b64 v10, v[32:33]
    s_waitcnt lgkmcnt(0)
    s_lshl_b32 s20, s16, 8
    s_add_u32 s81, s20, 184288256
    s_cmp_eq_u32 s17, 0
    s_cselect_b32 s81, s81, 1073741824
    s_lshr_b32 s20, s16, 1
    s_lshl_b32 s20, s20, 2
    s_add_u32 s3, s20, 184287552
L_m_14:
    s_sub_u32 s19, s19, 1
    s_cbranch_scc1 abort_m_4
    buffer_load_dword v10, off, s[12:15], 0 offset:64 sc1
    s_waitcnt vmcnt(0)
    v_cmp_eq_u32 vcc, 0, v10
    s_nop 0
    s_cbranch_vccnz L_m_14
    s_add_u32 s20, s18, 1
    s_min_u32 s20, s20, 64
    s_cmp_ge_u32 s80, s20
    s_cbranch_scc1 kvok_m_15
    v_and_b32 v10, 64, v0
    s_nop 1
L_m_16:
    s_sub_u32 s19, s19, 1
    s_cbranch_scc1 abort_m_4
    buffer_load_dword v11, v10, s[4:7], s3 offen sc1
    s_waitcnt vmcnt(0)
    v_readlane_b32 s21, v11, 0
    v_readlane_b32 s22, v11, 4
    s_nop 0
    s_min_u32 s80, s21, s22
    s_cmp_lt_u32 s80, s20
    s_nop 0
    s_cbranch_scc1 L_m_16
kvok_m_15:
    s_mov_b32 m0, s52
    s_nop 0
    buffer_load_dwordx4 v0, s[4:7], s41 offen sc1 lds
    s_add_u32 m0, s52, 4096
    s_add_u32 s20, s41, 4096
    buffer_load_dwordx4 v0, s[4:7], s20 offen sc1 lds
    s_waitcnt vmcnt(0)
    s_barrier
    s_cmp_eq_u32 s54, 0
    s_cbranch_scc1 slow_m_6
L_m_17:
    s_add_u32 s20, s18, 2
    s_min_u32 s20, s20, 64
    s_cmp_ge_u32 s80, s20
    s_cbranch_scc1 kvok_m_18
    v_and_b32 v10, 64, v0
    s_nop 1
L_m_19:
    s_sub_u32 s19, s19, 1
    s_cbranch_scc1 abort_m_4
    buffer_load_dword v11, v10, s[4:7], s3 offen sc1
    s_waitcnt vmcnt(0)
    v_readlane_b32 s21, v11, 0
    v_readlane_b32 s22, v11, 4
    s_nop 0
    s_min_u32 s80, s21, s22
    s_cmp_lt_u32 s80, s20
    s_nop 0
    s_cbranch_scc1 L_m_19
kvok_m_18:
    s_mov_b32 m0, s78
    s_nop 0
    buffer_load_dwordx4 v0, s[4:7], s32 offen sc1 lds
    buffer_load_dwordx4 v0, s[4:7], s32 offen offset:1024 sc1 lds
    s_add_u32 m0, s65, 8192
    s_mov_b64 exec, 4294967295
    buffer_load_dwordx4 v0, s[4:7], s33 offen sc1 lds
    s_mov_b64 exec, -1
    ds_read_b128 v[48:51], v1 offset:0
    ds_read_b128 v[52:55], v1 offset:1024
    ds_read_b128 v[56:59], v1 offset:2048
    ds_read_b128 v[60:63], v1 offset:3072
    v_mov_b32 v10, 23808
    ds_read_b64 v[32:33], v10
    v_mov_b64 v[44:45], 0
    v_mov_b64 v[46:47], 0
    v_mov_b64 v[36:37], 0
    v_mov_b64 v[38:39], 0
    v_mov_b64 v[40:41], 0
    v_mov_b64 v[42:43], 0
    s_waitcnt lgkmcnt(0)
    v_min_u32 v10, v32, v33
    s_nop 0
    v_readfirstlane_b32 s20, v10
    s_nop 0
    s_max_u32 s80, s80, s20
    v_lshlrev_b32 v11, 2, v0
    s_waitcnt lgkmcnt(0)
    s_waitcnt vmcnt(1)
    ds_read_b128 v[12:15], v6 offset:0
    ds_read_b128 v[16:19], v6 offset:512
    ds_read_b128 v[20:23], v6 offset:1024
    ds_read_b128 v[24:27], v6 offset:1536
    s_waitcnt vmcnt(0)
    ds_read_b128 v[28:31], v7
    s_waitcnt lgkmcnt(4)
    v_max3_u32 v32, v12, v13, v14
    v_mov_b32 v33, v15
    s_waitcnt lgkmcnt(3)
    v_max3_u32 v32, v32, v16, v17
    v_max3_u32 v33, v33, v18, v19
    s_waitcnt lgkmcnt(2)
    v_max3_u32 v32, v32, v20, v21
    v_max3_u32 v33, v33, v22, v23
    s_waitcnt lgkmcnt(1)
    v_max3_u32 v32, v32, v24, v25
    v_max3_u32 v33, v33, v26, v27
    s_waitcnt lgkmcnt(0)
    v_max3_u32 v32, v32, v28, v29
    v_max3_u32 v33, v33, v30, v31
    v_max_u32 v32, v32, v33
    v_cmp_eq_u32 vcc, -1, v32
    s_nop 0
    s_cbranch_vccz gok_m_20
L_m_21:
    s_sub_u32 s19, s19, 1
    s_cbranch_scc1 abort_m_4
    s_mov_b32 m0, s78
    s_nop 0
    buffer_load_dwordx4 v0, s[4:7], s32 offen sc1 lds
    buffer_load_dwordx4 v0, s[4:7], s32 offen offset:1024 sc1 lds
    s_add_u32 m0, s65, 8192
    s_mov_b64 exec, 4294967295
    buffer_load_dwordx4 v0, s[4:7], s33 offen sc1 lds
    s_mov_b64 exec, -1
    s_waitcnt vmcnt(1)
    ds_read_b128 v[12:15], v6 offset:0
    ds_read_b128 v[16:19], v6 offset:512
    ds_read_b128 v[20:23], v6 offset:1024
    ds_read_b128 v[24:27], v6 offset:1536
    s_waitcnt vmcnt(0)
    ds_read_b128 v[28:31], v7
    s_waitcnt lgkmcnt(4)
    v_max3_u32 v32, v12, v13, v14
    v_mov_b32 v33, v15
    s_waitcnt lgkmcnt(3)
    v_max3_u32 v32, v32, v16, v17
    v_max3_u32 v33, v33, v18, v19
    s_waitcnt lgkmcnt(2)
    v_max3_u32 v32, v32, v20, v21
    v_max3_u32 v33, v33, v22, v23
    s_waitcnt lgkmcnt(1)
    v_max3_u32 v32, v32, v24, v25
    v_max3_u32 v33, v33, v26, v27
    s_waitcnt lgkmcnt(0)
    v_max3_u32 v32, v32, v28, v29
    v_max3_u32 v33, v33, v30, v31
    v_max_u32 v32, v32, v33
    v_cmp_eq_u32 vcc, -1, v32
    s_nop 0
    s_cbranch_vccnz L_m_21
gok_m_20:
    s_cmp_eq_u32 s18, 63
    s_cbranch_scc1 last_m_22
    v_smfmac_f32_16x16x64_bf16 v[40:43], v[12:15], v[48:55], v2
    ds_read_b128 v[48:51], v1 offset:8192
    ds_read_b128 v[52:55], v1 offset:9216
    s_barrier
    v_smfmac_f32_16x16x64_bf16 v[44:47], v[12:15], a[80:87], v2
    s_mov_b32 m0, s53
    s_add_u32 s41, s41, 262144
    v_xor_b32 v10, 512, v7
    v_smfmac_f32_16x16x64_bf16 v[36:39], v[12:15], a[208:215], v2
    ds_read_b128 v[32:35], v10
    buffer_load_dwordx4 v0, s[4:7], s42 offen sc1 lds
    v_smfmac_f32_16x16x64_bf16 v[40:43], v[16:19], v[56:63], v2
    ds_read_b128 v[56:59], v1 offset:10240
    ds_read_b128 v[60:63], v1 offset:11264
    v_xor_b32 v10, 2048, v6
    v_smfmac_f32_16x16x64_bf16 v[44:47], v[16:19], a[88:95], v2
    ds_read_b128 v[12:15], v10 offset:0
    buffer_load_dwordx4 v0, s[4:7], s42 offen offset:1024 sc1 lds
    v_smfmac_f32_16x16x64_bf16 v[36:39], v[16:19], a[216:223], v2
    ds_read_b128 v[16:19], v10 offset:512
    s_add_u32 s42, s42, 262144
    s_waitcnt lgkmcnt(5)
    v_smfmac_f32_16x16x64_bf16 v[40:43], v[20:23], v[48:55], v2
    ds_read_b128 v[48:51], v1 offset:16384
    ds_read_b128 v[52:55], v1 offset:17408
    s_add_u32 s64, s64, 262144
    v_smfmac_f32_16x16x64_bf16 v[44:47], v[20:23], a[96:103], v2
    s_mov_b32 m0, 23552
    s_nop 0
    buffer_load_dword v11, s[4:7], s64 offen lds
    v_smfmac_f32_16x16x64_bf16 v[36:39], v[20:23], a[224:231], v2
    ds_read_b128 v[20:23], v10 offset:1024
    s_mov_b32 m0, 23808
    s_waitcnt lgkmcnt(5)
    v_smfmac_f32_16x16x64_bf16 v[40:43], v[24:27], v[56:63], v2
    ds_read_b128 v[56:59], v1 offset:18432
    ds_read_b128 v[60:63], v1 offset:19456
    v_min_u32 v11, 64, v11
    v_smfmac_f32_16x16x64_bf16 v[44:47], v[24:27], a[104:111], v2
    buffer_load_dword v11, s[4:7], s3 offen sc1 lds
    v_smfmac_f32_16x16x64_bf16 v[36:39], v[24:27], a[232:239], v2
    ds_read_b128 v[24:27], v10 offset:1536
    s_mov_b32 m0, s52
    v_xor_b32 v10, 4096, v6
    v_smfmac_f32_16x16x64_bf16 v[40:43], v[28:31], a[0:7], v2
    s_waitcnt lgkmcnt(4)
    v_smfmac_f32_16x16x64_bf16 v[44:47], v[28:31], v[48:55], v2
    ds_read_b128 v[48:51], v1 offset:4096
    ds_read_b128 v[52:55], v1 offset:5120
    v_mov_b32 v11, s18
    v_smfmac_f32_16x16x64_bf16 v[36:39], v[28:31], a[240:247], v2
    ds_read_b128 v[28:31], v10 offset:0
    buffer_store_dword v11, off, s[4:7], s81 sc1
    v_smfmac_f32_16x16x64_bf16 v[40:43], v[32:35], a[8:15], v2
    s_waitcnt lgkmcnt(4)
    v_smfmac_f32_16x16x64_bf16 v[44:47], v[32:35], v[56:63], v2
    ds_read_b128 v[56:59], v1 offset:6144
    ds_read_b128 v[60:63], v1 offset:7168
    v_lshrrev_b32 v11, 1, v0
    v_smfmac_f32_16x16x64_bf16 v[36:39], v[32:35], a[248:255], v2
    ds_read_b128 v[32:35], v10 offset:512
    s_waitcnt lgkmcnt(4)
    v_smfmac_f32_16x16x64_bf16 v[40:43], v[12:15], v[48:55], v2
    ds_read_b128 v[48:51], v1 offset:12288
    ds_read_b128 v[52:55], v1 offset:13312
    v_smfmac_f32_16x16x64_bf16 v[44:47], v[12:15], a[112:119], v2
    v_smfmac_f32_16x16x64_bf16 v[36:39], v[12:15], v[64:71], v2
    ds_read_b128 v[12:15], v10 offset:1024
    s_waitcnt lgkmcnt(4)
    v_smfmac_f32_16x16x64_bf16 v[40:43], v[16:19], v[56:63], v2
    ds_read_b128 v[56:59], v1 offset:14336
    ds_read_b128 v[60:63], v1 offset:15360
    v_smfmac_f32_16x16x64_bf16 v[44:47], v[16:19], a[120:127], v2
    v_smfmac_f32_16x16x64_bf16 v[36:39], v[16:19], v[72:79], v2
    ds_read_b128 v[16:19], v10 offset:1536
    s_waitcnt lgkmcnt(4)
    v_smfmac_f32_16x16x64_bf16 v[40:43], v[20:23], v[48:55], v2
    ds_read_b128 v[48:51], v0 offset:9216
    ds_read_b128 v[52:55], v0 offset:13312
    v_xor_b32 v10, 6144, v6
    v_smfmac_f32_16x16x64_bf16 v[44:47], v[20:23], a[128:135], v2
    ds_read_b128 v[20:23], v10 offset:0
    s_waitcnt lgkmcnt(4)
    v_smfmac_f32_16x16x64_bf16 v[40:43], v[24:27], v[56:63], v2
    ds_read_b128 v[56:59], v0 offset:10240
    ds_read_b128 v[60:63], v0 offset:14336
    v_smfmac_f32_16x16x64_bf16 v[44:47], v[24:27], a[136:143], v2
    ds_read_b128 v[24:27], v10 offset:512
    v_smfmac_f32_16x16x64_bf16 v[40:43], v[28:31], a[16:23], v2
    v_smfmac_f32_16x16x64_bf16 v[44:47], v[28:31], a[144:151], v2
    ds_read_b128 v[28:31], v10 offset:1024
    v_smfmac_f32_16x16x64_bf16 v[40:43], v[32:35], a[24:31], v2
    v_smfmac_f32_16x16x64_bf16 v[44:47], v[32:35], a[152:159], v2
    ds_read_b128 v[32:35], v10 offset:1536
    v_xor_b32 v10, 2048, v6
    v_smfmac_f32_16x16x64_bf16 v[40:43], v[12:15], a[32:39], v2
    v_smfmac_f32_16x16x64_bf16 v[44:47], v[12:15], a[160:167], v2
    s_waitcnt lgkmcnt(8)
    v_smfmac_f32_16x16x64_bf16 v[40:43], v[16:19], a[40:47], v2
    v_smfmac_f32_16x16x64_bf16 v[44:47], v[16:19], a[168:175], v2
    s_waitcnt lgkmcnt(5)
    v_smfmac_f32_16x16x64_bf16 v[40:43], v[20:23], a[48:55], v2
    v_smfmac_f32_16x16x64_bf16 v[44:47], v[20:23], a[176:183], v2
    s_waitcnt lgkmcnt(2)
    v_smfmac_f32_16x16x64_bf16 v[40:43], v[24:27], a[56:63], v2
    v_smfmac_f32_16x16x64_bf16 v[44:47], v[24:27], a[184:191], v2
    s_waitcnt lgkmcnt(1)
    v_smfmac_f32_16x16x64_bf16 v[40:43], v[28:31], a[64:71], v2
    v_smfmac_f32_16x16x64_bf16 v[44:47], v[28:31], a[192:199], v2
    s_waitcnt lgkmcnt(0)
    v_smfmac_f32_16x16x64_bf16 v[40:43], v[32:35], a[72:79], v2
    v_smfmac_f32_16x16x64_bf16 v[44:47], v[32:35], a[200:207], v2
    v_smfmac_f32_16x16x64_bf16 v[36:39], v[12:15], v[112:119], v2
    ds_read_b128 v[12:15], v10 offset:1024
    v_cvt_pk_bf16_f32 v40, v40, v41
    v_cvt_pk_bf16_f32 v41, v42, v43
    s_nop 0
    v_cvt_pk_bf16_f32 v44, v44, v45
    v_cvt_pk_bf16_f32 v45, v46, v47
    v_smfmac_f32_16x16x64_bf16 v[36:39], v[16:19], v[120:127], v2
    ds_write_b64 v3, v[40:41] offset:17408
    ds_write_b64 v3, v[44:45] offset:19456
    ds_read_b128 v[16:19], v10 offset:1536
    v_smfmac_f32_16x16x64_bf16 v[36:39], v[20:23], v[128:135], v2
    buffer_store_dwordx2 v[44:45], v3, s[4:7], s43 offen sc1
    v_smfmac_f32_16x16x64_bf16 v[36:39], v[24:27], v[136:143], v2
    v_xor_b32 v10, 4096, v6
    v_smfmac_f32_16x16x64_bf16 v[36:39], v[28:31], v[144:151], v2
    ds_read_b128 v[20:23], v10 offset:0
    ds_read_b128 v[24:27], v10 offset:512
    v_lshrrev_b32 v10, 1, v0
    v_smfmac_f32_16x16x64_bf16 v[36:39], v[32:35], v[152:159], v2
    s_waitcnt lgkmcnt(3)
    s_barrier
    v_smfmac_f32_16x16x64_bf16 v[36:39], v[12:15], v[80:87], v2
    ds_read_b64_tr_b16 v[28:29], v4 offset:17408
    ds_read_b64_tr_b16 v[30:31], v4 offset:17536
    ds_read_b64_tr_b16 v[32:33], v4 offset:17920
    ds_read_b64_tr_b16 v[34:35], v4 offset:18048
    ds_read_b64_tr_b16 v[12:13], v4 offset:18432
    s_waitcnt lgkmcnt(7)
    v_smfmac_f32_16x16x64_bf16 v[36:39], v[16:19], v[88:95], v2
    ds_read_b64_tr_b16 v[14:15], v4 offset:18560
    ds_read_b64_tr_b16 v[16:17], v4 offset:18944
    s_waitcnt lgkmcnt(8)
    v_smfmac_f32_16x16x64_bf16 v[36:39], v[20:23], v[96:103], v2
    ds_read_b128 v[20:23], v0 offset:11264
    ds_read_b64_tr_b16 v[18:19], v4 offset:19072
    s_waitcnt lgkmcnt(9)
    v_smfmac_f32_16x16x64_bf16 v[36:39], v[24:27], v[104:111], v2
    ds_read_b128 v[24:27], v0 offset:15360
    s_waitcnt lgkmcnt(8)
    v_mfma_f32_16x16x32_bf16 v[40:43], v[48:51], v[28:31], 0
    ds_read_b128 v[48:51], v0 offset:12288
    s_waitcnt lgkmcnt(7)
    v_mfma_f32_16x16x32_bf16 v[40:43], v[56:59], v[32:35], v[40:43]
    ds_read_b64_tr_b16 v[56:57], v4 offset:19456
    ds_read_b64_tr_b16 v[58:59], v4 offset:19584
    v_cvt_pk_bf16_f32 v36, v36, v37
    v_mfma_f32_16x16x32_bf16 v[44:47], v[52:55], v[28:31], 0
    ds_read_b128 v[52:55], v0 offset:16384
    v_cvt_pk_bf16_f32 v37, v38, v39
    buffer_store_dwordx2 v[36:37], v11, s[4:7], s44 offen sc1
    v_mfma_f32_16x16x32_bf16 v[44:47], v[60:63], v[32:35], v[44:47]
    ds_read_b64_tr_b16 v[60:61], v4 offset:19968
    ds_read_b64_tr_b16 v[62:63], v4 offset:20096
    s_waitcnt lgkmcnt(8)
    v_mfma_f32_16x16x32_bf16 v[40:43], v[20:23], v[12:15], v[40:43]
    ds_read_b64_tr_b16 v[20:21], v4 offset:20480
    ds_read_b64_tr_b16 v[22:23], v4 offset:20608
    s_waitcnt lgkmcnt(8)
    v_mfma_f32_16x16x32_bf16 v[44:47], v[24:27], v[12:15], v[44:47]
    ds_read_b64_tr_b16 v[24:25], v4 offset:20992
    ds_read_b64_tr_b16 v[26:27], v4 offset:21120
    s_waitcnt lgkmcnt(9)
    v_mfma_f32_16x16x32_bf16 v[40:43], v[48:51], v[16:19], v[40:43]
    v_cndmask_b32 v38, v36, 0, s[28:29]
    s_waitcnt lgkmcnt(7)
    v_mfma_f32_16x16x32_bf16 v[48:51], v[56:59], v[28:31], 0
    v_cndmask_b32 v39, v37, 0, s[28:29]
    s_waitcnt lgkmcnt(4)
    v_mfma_f32_16x16x32_bf16 v[48:51], v[60:63], v[32:35], v[48:51]
    ds_read_b128 v[60:63], v1 offset:23552
    v_max3_f32 v56, v40, v41, v42
    s_waitcnt lgkmcnt(3)
    v_mfma_f32_16x16x32_bf16 v[48:51], v[20:23], v[12:15], v[48:51]
    s_waitcnt vmcnt(6)
    ds_read_b128 v[20:23], v1 offset:32768
    s_waitcnt lgkmcnt(2)
    v_mfma_f32_16x16x32_bf16 v[48:51], v[24:27], v[16:19], v[48:51]
    s_waitcnt vmcnt(5)
    ds_read_b128 v[24:27], v1 offset:33792
    v_cndmask_b32 v36, 0, v36, s[28:29]
    v_mfma_f32_16x16x32_bf16 v[44:47], v[52:55], v[16:19], v[44:47]
    v_cndmask_b32 v37, 0, v37, s[28:29]
    v_add_u32 v11, s61, v5
    v_mov_b64 v[52:53], s[30:31]
    v_mov_b64 v[54:55], s[30:31]
    s_nop 3
    v_max3_f32 v57, v43, v44, v45
    v_max3_f32 v56, v56, v46, v47
    v_max_f32 v56, v56, v57
    v_mov_b32 v57, v56
    s_nop 1
    v_permlane32_swap_b32 v56, v57
    v_max3_f32 v56, v56, v57, v48
    v_max3_f32 v57, v49, v50, v51
    v_max_f32 v56, v56, v57
    v_mov_b32 v57, v56
    s_nop 1
    v_permlane16_swap_b32 v56, v57
    v_max_f32 v56, v56, v57
    v_mul_f32 v58, s26, v56
    v_pk_fma_f32 v[40:41], v[40:41], s[26:27], v[58:59] op_sel_hi:[1,1,0] neg_lo:[0,0,1] neg_hi:[0,0,1]
    v_pk_fma_f32 v[42:43], v[42:43], s[26:27], v[58:59] op_sel_hi:[1,1,0] neg_lo:[0,0,1] neg_hi:[0,0,1]
    v_exp_f32 v40, v40
    v_exp_f32 v41, v41
    v_pk_fma_f32 v[44:45], v[44:45], s[26:27], v[58:59] op_sel_hi:[1,1,0] neg_lo:[0,0,1] neg_hi:[0,0,1]
    v_pk_fma_f32 v[46:47], v[46:47], s[26:27], v[58:59] op_sel_hi:[1,1,0] neg_lo:[0,0,1] neg_hi:[0,0,1]
    v_exp_f32 v42, v42
    v_exp_f32 v43, v43
    v_exp_f32 v44, v44
    v_exp_f32 v45, v45
    v_exp_f32 v46, v46
    v_exp_f32 v47, v47
    v_cvt_pk_bf16_f32 v40, v40, v41
    v_pk_fma_f32 v[48:49], v[48:49], s[26:27], v[58:59] op_sel_hi:[1,1,0] neg_lo:[0,0,1] neg_hi:[0,0,1]
    v_cvt_pk_bf16_f32 v41, v42, v43
    v_pk_fma_f32 v[50:51], v[50:51], s[26:27], v[58:59] op_sel_hi:[1,1,0] neg_lo:[0,0,1] neg_hi:[0,0,1]
    v_exp_f32 v48, v48
    ds_read_b128 v[56:59], v1 offset:22528
    v_exp_f32 v49, v49
    v_cvt_pk_bf16_f32 v42, v44, v45
    v_cvt_pk_bf16_f32 v43, v46, v47
    v_exp_f32 v50, v50
    s_waitcnt lgkmcnt(2)
    v_mfma_f32_16x16x32_bf16 v[28:31], v[20:23], v[40:43], 0
    v_exp_f32 v51, v51
    s_waitcnt lgkmcnt(1)
    v_mfma_f32_16x16x32_bf16 v[32:35], v[24:27], v[40:43], 0
    v_cvt_pk_bf16_f32 v48, v48, v49
    v_cvt_pk_bf16_f32 v49, v50, v51
    v_mfma_f32_16x16x32_bf16 v[12:15], v[52:55], v[40:43], 0
    ds_read_b128 v[52:55], v1 offset:25600
    v_mov_b64 v[50:51], s[98:99]
    v_mov_b64 v[20:21], 0
    v_mfma_f32_16x16x16_bf16 v[28:31], v[38:39], v[48:49], v[28:31]
    v_mov_b64 v[22:23], 0
    v_mov_b64 v[24:25], 0
    v_mfma_f32_16x16x16_bf16 v[12:15], v[50:51], v[48:49], v[12:15]
    v_mov_b64 v[26:27], 0
    v_mov_b64 v[38:39], 0
    v_mfma_f32_16x16x16_bf16 v[32:35], v[36:37], v[48:49], v[32:35]
    ds_read_b128 v[48:51], v1 offset:24576
    v_mov_b64 v[44:45], 0
    v_mov_b64 v[46:47], 0
    v_mov_b64 v[36:37], 0
    s_nop 0
    v_rcp_f32 v12, v12
    v_mov_b64 v[40:41], 0
    v_pk_mul_f32 v[28:29], v[28:29], v[12:13] op_sel_hi:[1,0]
    v_pk_mul_f32 v[30:31], v[30:31], v[12:13] op_sel_hi:[1,0]
    v_pk_mul_f32 v[32:33], v[32:33], v[12:13] op_sel_hi:[1,0]
    v_pk_mul_f32 v[34:35], v[34:35], v[12:13] op_sel_hi:[1,0]
    v_cvt_pk_bf16_f32 v16, v28, v29
    v_cvt_pk_bf16_f32 v17, v30, v31
    v_cvt_pk_bf16_f32 v18, v32, v33
    v_cvt_pk_bf16_f32 v19, v34, v35
    ds_write_b128 v11, v[16:19] offset:21504
    v_xor_b32 v12, 1536, v11
    v_xor_b32 v28, 512, v11
    v_xor_b32 v32, 1024, v11
    v_mov_b64 v[42:43], 0
    v_smfmac_f32_16x16x64_bf16 v[44:47], v[16:19], v[240:247], v2
    s_waitcnt lgkmcnt(0)
    s_barrier
    ds_read_b128 v[12:15], v12 offset:21504
    v_smfmac_f32_16x16x64_bf16 v[20:23], v[16:19], v[160:167], v2
    ds_read_b128 v[28:31], v28 offset:21504
    ds_read_b128 v[32:35], v32 offset:21504
    buffer_load_dwordx4 v0, s[4:7], s41 offen sc1 lds
    v_smfmac_f32_16x16x64_bf16 v[24:27], v[16:19], v[176:183], v2
    s_add_u32 m0, s52, 4096
    s_add_u32 s20, s41, 4096
    buffer_load_dwordx4 v0, s[4:7], s20 offen sc1 lds
    v_smfmac_f32_16x16x64_bf16 v[36:39], v[16:19], v[48:55], v2
    ds_read_b128 v[48:51], v1 offset:20480
    ds_read_b128 v[52:55], v1 offset:21504
    v_smfmac_f32_16x16x64_bf16 v[40:43], v[16:19], v[224:231], v2
    s_waitcnt lgkmcnt(3)
    v_smfmac_f32_16x16x64_bf16 v[44:47], v[28:31], v[248:255], v2
    v_smfmac_f32_16x16x64_bf16 v[20:23], v[28:31], v[168:175], v2
    s_nop 3
    v_cvt_pk_bf16_f32 v44, v44, v45
    v_cvt_pk_bf16_f32 v45, v46, v47
    v_bfi_b32 v44, 1, s67, v44
    buffer_store_dwordx2 v[44:45], v10, s[4:7], s34 offen offset:2048
    s_waitcnt lgkmcnt(0)
    v_smfmac_f32_16x16x64_bf16 v[20:23], v[32:35], v[48:55], v2
    ds_read_b128 v[48:51], v1 offset:28672
    ds_read_b128 v[52:55], v1 offset:29696
    v_smfmac_f32_16x16x64_bf16 v[20:23], v[12:15], v[56:63], v2
    ds_read_b128 v[56:59], v1 offset:26624
    ds_read_b128 v[60:63], v1 offset:27648
    v_smfmac_f32_16x16x64_bf16 v[24:27], v[28:31], v[184:191], v2
    v_smfmac_f32_16x16x64_bf16 v[24:27], v[32:35], v[192:199], v2
    v_cvt_pk_bf16_f32 v20, v20, v21
    v_smfmac_f32_16x16x64_bf16 v[24:27], v[12:15], v[200:207], v2
    v_cvt_pk_bf16_f32 v21, v22, v23
    v_bfi_b32 v20, 1, s67, v20
    buffer_store_dwordx2 v[20:21], v10, s[4:7], s34 offen offset:0
    s_nop 4
    v_cvt_pk_bf16_f32 v24, v24, v25
    v_cvt_pk_bf16_f32 v25, v26, v27
    v_bfi_b32 v24, 1, s67, v24
    buffer_store_dwordx2 v[24:25], v10, s[4:7], s34 offen offset:512
    s_waitcnt lgkmcnt(0)
    v_smfmac_f32_16x16x64_bf16 v[36:39], v[28:31], v[56:63], v2
    ds_read_b128 v[56:59], v1 offset:30720
    ds_read_b128 v[60:63], v1 offset:31744
    v_smfmac_f32_16x16x64_bf16 v[36:39], v[32:35], v[208:215], v2
    v_smfmac_f32_16x16x64_bf16 v[36:39], v[12:15], v[216:223], v2
    v_smfmac_f32_16x16x64_bf16 v[40:43], v[28:31], v[232:239], v2
    v_smfmac_f32_16x16x64_bf16 v[40:43], v[32:35], v[48:55], v2
    v_cvt_pk_bf16_f32 v36, v36, v37
    v_cvt_pk_bf16_f32 v37, v38, v39
    v_bfi_b32 v36, 1, s67, v36
    buffer_store_dwordx2 v[36:37], v10, s[4:7], s34 offen offset:1024
    s_waitcnt lgkmcnt(0)
    v_smfmac_f32_16x16x64_bf16 v[40:43], v[12:15], v[56:63], v2
    s_nop 7
    v_cvt_pk_bf16_f32 v40, v40, v41
    v_cvt_pk_bf16_f32 v41, v42, v43
    v_bfi_b32 v40, 1, s67, v40
    buffer_store_dwordx2 v[40:41], v10, s[4:7], s34 offen offset:1536
    s_cmp_eq_u32 s45, 1
    s_cbranch_scc0 spec_m_24
    v_bfe_u32 v24, v0, 4, 4
    v_and_b32 v25, 3, v24
    v_lshlrev_b32 v25, 2, v25
    v_lshrrev_b32 v24, 2, v24
    v_add_u32 v25, v25, v24
    v_and_b32 v24, 1, v25
    v_lshlrev_b32 v24, 4, v24
    v_mov_b32 v26, 16256
    v_lshlrev_b32 v26, v24, v26
    v_lshrrev_b32 v25, 1, v25
    v_cmp_eq_u32 vcc, 0, v25
    s_nop 1
    v_cndmask_b32 v12, 0, v26, vcc
    v_cmp_eq_u32 vcc, 1, v25
    s_nop 1
    v_cndmask_b32 v13, 0, v26, vcc
    v_cmp_eq_u32 vcc, 2, v25
    s_nop 1
    v_cndmask_b32 v14, 0, v26, vcc
    v_cmp_eq_u32 vcc, 3, v25
    s_nop 1
    v_cndmask_b32 v15, 0, v26, vcc
    s_sleep 1
    buffer_load_dwordx4 v[48:51], v8, s[4:7], s35 offen sc1
    buffer_load_dwordx4 v[52:55], v8, s[4:7], s36 offen sc1
    buffer_load_dwordx4 v[56:59], v8, s[4:7], s37 offen sc1
    buffer_load_dwordx4 v[60:63], v8, s[4:7], s38 offen sc1
    s_waitcnt vmcnt(3)
    v_mfma_f32_16x16x32_bf16 v[16:19], v[12:15], v[48:51], 0
    v_bitop3_b32 v24, v48, v50, s67 bitop3:0x7e
    s_waitcnt vmcnt(2)
    v_mfma_f32_16x16x32_bf16 v[16:19], v[12:15], v[52:55], v[16:19]
    v_bitop3_b32 v25, v52, v54, s67 bitop3:0x7e
    s_waitcnt vmcnt(1)
    v_mfma_f32_16x16x32_bf16 v[16:19], v[12:15], v[56:59], v[16:19]
    v_bitop3_b32 v26, v56, v58, s67 bitop3:0x7e
    s_waitcnt vmcnt(0)
    v_mfma_f32_16x16x32_bf16 v[16:19], v[12:15], v[60:63], v[16:19]
    v_bitop3_b32 v27, v60, v62, s67 bitop3:0x7e
    v_or3_b32 v24, v24, v25, v26
    v_or_b32 v24, v24, v27
    v_and_b32 v24, 1, v24
    v_cmp_ne_u32 vcc, 0, v24
    s_nop 1
    s_cbranch_vccz rok_m_25
L_m_26:
    s_sub_u32 s19, s19, 1
    s_cbranch_scc1 abort_m_4
    buffer_load_dwordx4 v[48:51], v8, s[4:7], s35 offen sc1
    buffer_load_dwordx4 v[52:55], v8, s[4:7], s36 offen sc1
    buffer_load_dwordx4 v[56:59], v8, s[4:7], s37 offen sc1
    buffer_load_dwordx4 v[60:63], v8, s[4:7], s38 offen sc1
    s_waitcnt vmcnt(3)
    v_mfma_f32_16x16x32_bf16 v[16:19], v[12:15], v[48:51], 0
    v_bitop3_b32 v24, v48, v50, s67 bitop3:0x7e
    s_waitcnt vmcnt(2)
    v_mfma_f32_16x16x32_bf16 v[16:19], v[12:15], v[52:55], v[16:19]
    v_bitop3_b32 v25, v52, v54, s67 bitop3:0x7e
    s_waitcnt vmcnt(1)
    v_mfma_f32_16x16x32_bf16 v[16:19], v[12:15], v[56:59], v[16:19]
    v_bitop3_b32 v26, v56, v58, s67 bitop3:0x7e
    s_waitcnt vmcnt(0)
    v_mfma_f32_16x16x32_bf16 v[16:19], v[12:15], v[60:63], v[16:19]
    v_bitop3_b32 v27, v60, v62, s67 bitop3:0x7e
    v_or3_b32 v24, v24, v25, v26
    v_or_b32 v24, v24, v27
    v_and_b32 v24, 1, v24
    v_cmp_ne_u32 vcc, 0, v24
    s_nop 1
    s_cbranch_vccnz L_m_26
rok_m_25:
    v_add_f32_dpp v16, v16, v16 row_ror:8 row_mask:0xf bank_mask:0xf
    v_add_f32_dpp v17, v17, v17 row_ror:8 row_mask:0xf bank_mask:0xf
    v_cvt_pk_bf16_f32 v16, v16, v17
    v_min_u32 v16, s49, v16
    buffer_store_dword v16, v9, s[4:7], s39 offen
    s_branch nored_m_23
spec_m_24:
    s_cmp_eq_u32 s45, 0
    s_cbranch_scc1 w3_m_27
    v_bfe_u32 v24, v0, 4, 4
    v_and_b32 v25, 3, v24
    v_lshlrev_b32 v25, 2, v25
    v_lshrrev_b32 v24, 2, v24
    v_add_u32 v25, v25, v24
    v_and_b32 v24, 1, v25
    v_lshlrev_b32 v24, 4, v24
    v_mov_b32 v26, 16256
    v_lshlrev_b32 v26, v24, v26
    v_lshrrev_b32 v25, 1, v25
    v_cmp_eq_u32 vcc, 0, v25
    s_nop 1
    v_cndmask_b32 v12, 0, v26, vcc
    v_cmp_eq_u32 vcc, 1, v25
    s_nop 1
    v_cndmask_b32 v13, 0, v26, vcc
    v_cmp_eq_u32 vcc, 2, v25
    s_nop 1
    v_cndmask_b32 v14, 0, v26, vcc
    v_cmp_eq_u32 vcc, 3, v25
    s_nop 1
    v_cndmask_b32 v15, 0, v26, vcc
    s_sleep 1
    buffer_load_dwordx4 v[48:51], v8, s[4:7], s35 offen sc1
    buffer_load_dwordx4 v[52:55], v8, s[4:7], s36 offen sc1
    buffer_load_dwordx4 v[56:59], v8, s[4:7], s37 offen sc1
    buffer_load_dwordx4 v[60:63], v8, s[4:7], s38 offen sc1
    s_waitcnt vmcnt(3)
    v_mfma_f32_16x16x32_bf16 v[16:19], v[12:15], v[48:51], 0
    v_bitop3_b32 v24, v48, v50, s67 bitop3:0x7e
    s_waitcnt vmcnt(2)
    v_mfma_f32_16x16x32_bf16 v[16:19], v[12:15], v[52:55], v[16:19]
    v_bitop3_b32 v25, v52, v54, s67 bitop3:0x7e
    s_waitcnt vmcnt(1)
    v_mfma_f32_16x16x32_bf16 v[16:19], v[12:15], v[56:59], v[16:19]
    v_bitop3_b32 v26, v56, v58, s67 bitop3:0x7e
    s_waitcnt vmcnt(0)
    v_mfma_f32_16x16x32_bf16 v[16:19], v[12:15], v[60:63], v[16:19]
    v_bitop3_b32 v27, v60, v62, s67 bitop3:0x7e
    v_or3_b32 v24, v24, v25, v26
    v_or_b32 v24, v24, v27
    v_and_b32 v24, 1, v24
    v_cmp_ne_u32 vcc, 0, v24
    s_nop 1
    s_cbranch_vccz rok_m_28
L_m_29:
    s_sub_u32 s19, s19, 1
    s_cbranch_scc1 abort_m_4
    buffer_load_dwordx4 v[48:51], v8, s[4:7], s35 offen sc1
    buffer_load_dwordx4 v[52:55], v8, s[4:7], s36 offen sc1
    buffer_load_dwordx4 v[56:59], v8, s[4:7], s37 offen sc1
    buffer_load_dwordx4 v[60:63], v8, s[4:7], s38 offen sc1
    s_waitcnt vmcnt(3)
    v_mfma_f32_16x16x32_bf16 v[16:19], v[12:15], v[48:51], 0
    v_bitop3_b32 v24, v48, v50, s67 bitop3:0x7e
    s_waitcnt vmcnt(2)
    v_mfma_f32_16x16x32_bf16 v[16:19], v[12:15], v[52:55], v[16:19]
    v_bitop3_b32 v25, v52, v54, s67 bitop3:0x7e
    s_waitcnt vmcnt(1)
    v_mfma_f32_16x16x32_bf16 v[16:19], v[12:15], v[56:59], v[16:19]
    v_bitop3_b32 v26, v56, v58, s67 bitop3:0x7e
    s_waitcnt vmcnt(0)
    v_mfma_f32_16x16x32_bf16 v[16:19], v[12:15], v[60:63], v[16:19]
    v_bitop3_b32 v27, v60, v62, s67 bitop3:0x7e
    v_or3_b32 v24, v24, v25, v26
    v_or_b32 v24, v24, v27
    v_and_b32 v24, 1, v24
    v_cmp_ne_u32 vcc, 0, v24
    s_nop 1
    s_cbranch_vccnz L_m_29
rok_m_28:
    v_add_f32_dpp v16, v16, v16 row_ror:4 row_mask:0xf bank_mask:0xf
    v_add_f32_dpp v17, v17, v17 row_ror:4 row_mask:0xf bank_mask:0xf
    s_nop 0
    v_add_f32_dpp v16, v16, v16 row_ror:8 row_mask:0xf bank_mask:0xf
    v_add_f32_dpp v17, v17, v17 row_ror:8 row_mask:0xf bank_mask:0xf
    v_cvt_pk_bf16_f32 v16, v16, v17
    v_min_u32 v16, s49, v16
    buffer_store_dword v16, v9, s[4:7], s39 offen
    s_branch nored_m_23
w3_m_27:
    s_cmp_eq_u32 s69, 1073741824
    s_cbranch_scc1 idle_m_30
    v_mov_b64 v[12:13], -1
    v_mov_b64 v[14:15], -1
    buffer_store_dwordx4 v[12:15], v0, s[4:7], s68 offen
    s_nop 1
idle_m_30:
    s_sleep 13
nored_m_23:
    s_add_u32 s18, s18, 1
    s_xor_b32 s66, s66, 327680
    s_add_u32 s35, s66, s50
    s_add_u32 s36, s35, s51
    s_add_u32 s37, s35, s71
    s_add_u32 s38, s36, s71
    s_add_u32 s34, s66, s60
    s_add_u32 s68, s79, s69
    s_mov_b32 s79, s39
    s_add_u32 s39, s39, 9216
    s_cmp_eq_u32 s39, 183537664
    s_cselect_b32 s39, 183500800, s39
    s_add_u32 s32, s79, s78
    s_add_u32 s33, s79, s65
    s_add_u32 s33, s33, 8192
    s_bfe_u32 s67, s18, 65537
    s_add_u32 s43, s43, 65536
    s_add_u32 s44, s44, 65536
    s_branch L_m_17
last_m_22:
    v_smfmac_f32_16x16x64_bf16 v[44:47], v[12:15], a[80:87], v2
    ds_read_b128 v[48:51], v1 offset:16384
    ds_read_b128 v[52:55], v1 offset:17408
    s_barrier
    v_smfmac_f32_16x16x64_bf16 v[36:39], v[12:15], a[208:215], v2
    ds_read_b128 v[56:59], v1 offset:18432
    ds_read_b128 v[60:63], v1 offset:19456
    v_xor_b32 v10, 512, v7
    v_smfmac_f32_16x16x64_bf16 v[44:47], v[16:19], a[88:95], v2
    ds_read_b128 v[32:35], v10
    v_xor_b32 v10, 2048, v6
    v_smfmac_f32_16x16x64_bf16 v[36:39], v[16:19], a[216:223], v2
    ds_read_b128 v[12:15], v10 offset:0
    ds_read_b128 v[16:19], v10 offset:512
    v_mov_b32 v11, s18
    v_smfmac_f32_16x16x64_bf16 v[44:47], v[20:23], a[96:103], v2
    buffer_store_dword v11, off, s[4:7], s81 sc1
    v_smfmac_f32_16x16x64_bf16 v[36:39], v[20:23], a[224:231], v2
    ds_read_b128 v[20:23], v10 offset:1024
    v_lshrrev_b32 v11, 1, v0
    v_smfmac_f32_16x16x64_bf16 v[44:47], v[24:27], a[104:111], v2
    v_smfmac_f32_16x16x64_bf16 v[36:39], v[24:27], a[232:239], v2
    ds_read_b128 v[24:27], v10 offset:1536
    s_waitcnt lgkmcnt(7)
    v_smfmac_f32_16x16x64_bf16 v[44:47], v[28:31], v[48:55], v2
    v_xor_b32 v10, 4096, v6
    v_smfmac_f32_16x16x64_bf16 v[36:39], v[28:31], a[240:247], v2
    ds_read_b128 v[28:31], v10 offset:0
    s_waitcnt lgkmcnt(5)
    v_smfmac_f32_16x16x64_bf16 v[44:47], v[32:35], v[56:63], v2
    v_smfmac_f32_16x16x64_bf16 v[36:39], v[32:35], a[248:255], v2
    ds_read_b128 v[32:35], v10 offset:512
    s_waitcnt lgkmcnt(5)
    v_smfmac_f32_16x16x64_bf16 v[44:47], v[12:15], a[112:119], v2
    v_smfmac_f32_16x16x64_bf16 v[36:39], v[12:15], v[64:71], v2
    ds_read_b128 v[12:15], v10 offset:1024
    s_waitcnt lgkmcnt(5)
    v_smfmac_f32_16x16x64_bf16 v[44:47], v[16:19], a[120:127], v2
    v_smfmac_f32_16x16x64_bf16 v[36:39], v[16:19], v[72:79], v2
    ds_read_b128 v[16:19], v10 offset:1536
    s_waitcnt lgkmcnt(5)
    v_smfmac_f32_16x16x64_bf16 v[44:47], v[20:23], a[128:135], v2
    s_waitcnt lgkmcnt(4)
    v_smfmac_f32_16x16x64_bf16 v[44:47], v[24:27], a[136:143], v2
    s_waitcnt lgkmcnt(3)
    v_smfmac_f32_16x16x64_bf16 v[44:47], v[28:31], a[144:151], v2
    v_xor_b32 v10, 6144, v6
    ds_read_b128 v[20:23], v10 offset:0
    s_waitcnt lgkmcnt(3)
    v_smfmac_f32_16x16x64_bf16 v[44:47], v[32:35], a[152:159], v2
    ds_read_b128 v[24:27], v10 offset:512
    ds_read_b128 v[28:31], v10 offset:1024
    s_waitcnt lgkmcnt(4)
    v_smfmac_f32_16x16x64_bf16 v[44:47], v[12:15], a[160:167], v2
    ds_read_b128 v[32:35], v10 offset:1536
    s_waitcnt lgkmcnt(4)
    v_smfmac_f32_16x16x64_bf16 v[44:47], v[16:19], a[168:175], v2
    v_xor_b32 v10, 2048, v6
    s_waitcnt lgkmcnt(3)
    v_smfmac_f32_16x16x64_bf16 v[44:47], v[20:23], a[176:183], v2
    s_waitcnt lgkmcnt(2)
    v_smfmac_f32_16x16x64_bf16 v[44:47], v[24:27], a[184:191], v2
    s_waitcnt lgkmcnt(1)
    v_smfmac_f32_16x16x64_bf16 v[44:47], v[28:31], a[192:199], v2
    s_waitcnt lgkmcnt(0)
    v_smfmac_f32_16x16x64_bf16 v[44:47], v[32:35], a[200:207], v2
    v_smfmac_f32_16x16x64_bf16 v[36:39], v[12:15], v[112:119], v2
    ds_read_b128 v[12:15], v10 offset:1024
    v_smfmac_f32_16x16x64_bf16 v[36:39], v[16:19], v[120:127], v2
    ds_read_b128 v[16:19], v10 offset:1536
    v_xor_b32 v10, 4096, v6
    v_smfmac_f32_16x16x64_bf16 v[36:39], v[20:23], v[128:135], v2
    ds_read_b128 v[20:23], v10 offset:0
    v_cvt_pk_bf16_f32 v44, v44, v45
    v_smfmac_f32_16x16x64_bf16 v[36:39], v[24:27], v[136:143], v2
    ds_read_b128 v[24:27], v10 offset:512
    v_cvt_pk_bf16_f32 v45, v46, v47
    v_smfmac_f32_16x16x64_bf16 v[36:39], v[28:31], v[144:151], v2
    buffer_store_dwordx2 v[44:45], v3, s[4:7], s43 offen sc1
    v_smfmac_f32_16x16x64_bf16 v[36:39], v[32:35], v[152:159], v2
    s_waitcnt lgkmcnt(3)
    v_smfmac_f32_16x16x64_bf16 v[36:39], v[12:15], v[80:87], v2
    s_waitcnt lgkmcnt(2)
    v_smfmac_f32_16x16x64_bf16 v[36:39], v[16:19], v[88:95], v2
    s_waitcnt lgkmcnt(1)
    v_smfmac_f32_16x16x64_bf16 v[36:39], v[20:23], v[96:103], v2
    s_waitcnt lgkmcnt(0)
    v_smfmac_f32_16x16x64_bf16 v[36:39], v[24:27], v[104:111], v2
    s_nop 7
    v_cvt_pk_bf16_f32 v36, v36, v37
    v_cvt_pk_bf16_f32 v37, v38, v39
    buffer_store_dwordx2 v[36:37], v11, s[4:7], s44 offen sc1
    s_branch done_m_5
slow_m_6:
L_m_31:
    s_add_u32 s20, s18, 2
    s_min_u32 s20, s20, 64
    s_cmp_ge_u32 s80, s20
    s_cbranch_scc1 kvok_m_32
    v_and_b32 v10, 64, v0
    s_nop 1
L_m_33:
    s_sub_u32 s19, s19, 1
    s_cbranch_scc1 abort_m_4
    buffer_load_dword v11, v10, s[4:7], s3 offen sc1
    s_waitcnt vmcnt(0)
    v_readlane_b32 s21, v11, 0
    v_readlane_b32 s22, v11, 4
    s_nop 0
    s_min_u32 s80, s21, s22
    s_cmp_lt_u32 s80, s20
    s_nop 0
    s_cbranch_scc1 L_m_33
kvok_m_32:
    s_mov_b32 m0, s78
    s_nop 0
    buffer_load_dwordx4 v0, s[4:7], s32 offen sc1 lds
    buffer_load_dwordx4 v0, s[4:7], s32 offen offset:1024 sc1 lds
    s_add_u32 m0, s65, 8192
    s_mov_b64 exec, 4294967295
    buffer_load_dwordx4 v0, s[4:7], s33 offen sc1 lds
    s_mov_b64 exec, -1
    ds_read_b128 v[48:51], v1 offset:0
    ds_read_b128 v[52:55], v1 offset:1024
    ds_read_b128 v[56:59], v1 offset:2048
    ds_read_b128 v[60:63], v1 offset:3072
    v_mov_b32 v10, 23808
    ds_read_b64 v[32:33], v10
    v_mov_b64 v[44:45], 0
    v_mov_b64 v[46:47], 0
    v_mov_b64 v[36:37], 0
    v_mov_b64 v[38:39], 0
    v_mov_b64 v[40:41], 0
    v_mov_b64 v[42:43], 0
    s_waitcnt lgkmcnt(0)
    v_min_u32 v10, v32, v33
    s_nop 0
    v_readfirstlane_b32 s20, v10
    s_nop 0
    s_max_u32 s80, s80, s20
    v_lshlrev_b32 v11, 2, v0
    s_waitcnt lgkmcnt(0)
    s_waitcnt vmcnt(1)
    ds_read_b128 v[12:15], v6 offset:0
    ds_read_b128 v[16:19], v6 offset:512
    ds_read_b128 v[20:23], v6 offset:1024
    ds_read_b128 v[24:27], v6 offset:1536
    s_waitcnt vmcnt(0)
    ds_read_b128 v[28:31], v7
    s_waitcnt lgkmcnt(4)
    v_max3_u32 v32, v12, v13, v14
    v_mov_b32 v33, v15
    s_waitcnt lgkmcnt(3)
    v_max3_u32 v32, v32, v16, v17
    v_max3_u32 v33, v33, v18, v19
    s_waitcnt lgkmcnt(2)
    v_max3_u32 v32, v32, v20, v21
    v_max3_u32 v33, v33, v22, v23
    s_waitcnt lgkmcnt(1)
    v_max3_u32 v32, v32, v24, v25
    v_max3_u32 v33, v33, v26, v27
    s_waitcnt lgkmcnt(0)
    v_max3_u32 v32, v32, v28, v29
    v_max3_u32 v33, v33, v30, v31
    v_max_u32 v32, v32, v33
    v_cmp_eq_u32 vcc, -1, v32
    s_nop 0
    s_cbranch_vccz gok_m_34
L_m_35:
    s_sub_u32 s19, s19, 1
    s_cbranch_scc1 abort_m_4
    s_mov_b32 m0, s78
    s_nop 0
    buffer_load_dwordx4 v0, s[4:7], s32 offen sc1 lds
    buffer_load_dwordx4 v0, s[4:7], s32 offen offset:1024 sc1 lds
    s_add_u32 m0, s65, 8192
    s_mov_b64 exec, 4294967295
    buffer_load_dwordx4 v0, s[4:7], s33 offen sc1 lds
    s_mov_b64 exec, -1
    s_waitcnt vmcnt(1)
    ds_read_b128 v[12:15], v6 offset:0
    ds_read_b128 v[16:19], v6 offset:512
    ds_read_b128 v[20:23], v6 offset:1024
    ds_read_b128 v[24:27], v6 offset:1536
    s_waitcnt vmcnt(0)
    ds_read_b128 v[28:31], v7
    s_waitcnt lgkmcnt(4)
    v_max3_u32 v32, v12, v13, v14
    v_mov_b32 v33, v15
    s_waitcnt lgkmcnt(3)
    v_max3_u32 v32, v32, v16, v17
    v_max3_u32 v33, v33, v18, v19
    s_waitcnt lgkmcnt(2)
    v_max3_u32 v32, v32, v20, v21
    v_max3_u32 v33, v33, v22, v23
    s_waitcnt lgkmcnt(1)
    v_max3_u32 v32, v32, v24, v25
    v_max3_u32 v33, v33, v26, v27
    s_waitcnt lgkmcnt(0)
    v_max3_u32 v32, v32, v28, v29
    v_max3_u32 v33, v33, v30, v31
    v_max_u32 v32, v32, v33
    v_cmp_eq_u32 vcc, -1, v32
    s_nop 0
    s_cbranch_vccnz L_m_35
gok_m_34:
    s_cmp_eq_u32 s18, 63
    s_cbranch_scc1 last_m_36
    v_smfmac_f32_16x16x64_bf16 v[40:43], v[12:15], v[48:55], v2
    ds_read_b128 v[48:51], v1 offset:8192
    ds_read_b128 v[52:55], v1 offset:9216
    s_barrier
    v_smfmac_f32_16x16x64_bf16 v[44:47], v[12:15], a[80:87], v2
    s_mov_b32 m0, s53
    s_add_u32 s41, s41, 262144
    v_xor_b32 v10, 512, v7
    v_smfmac_f32_16x16x64_bf16 v[36:39], v[12:15], a[208:215], v2
    ds_read_b128 v[32:35], v10
    buffer_load_dwordx4 v0, s[4:7], s42 offen sc1 lds
    v_smfmac_f32_16x16x64_bf16 v[40:43], v[16:19], v[56:63], v2
    ds_read_b128 v[56:59], v1 offset:10240
    ds_read_b128 v[60:63], v1 offset:11264
    v_xor_b32 v10, 2048, v6
    v_smfmac_f32_16x16x64_bf16 v[44:47], v[16:19], a[88:95], v2
    ds_read_b128 v[12:15], v10 offset:0
    buffer_load_dwordx4 v0, s[4:7], s42 offen offset:1024 sc1 lds
    v_smfmac_f32_16x16x64_bf16 v[36:39], v[16:19], a[216:223], v2
    ds_read_b128 v[16:19], v10 offset:512
    s_add_u32 s42, s42, 262144
    s_waitcnt lgkmcnt(5)
    v_smfmac_f32_16x16x64_bf16 v[40:43], v[20:23], v[48:55], v2
    ds_read_b128 v[48:51], v1 offset:16384
    ds_read_b128 v[52:55], v1 offset:17408
    s_add_u32 s64, s64, 262144
    v_smfmac_f32_16x16x64_bf16 v[44:47], v[20:23], a[96:103], v2
    s_mov_b32 m0, 23552
    s_nop 0
    buffer_load_dword v11, s[4:7], s64 offen lds
    v_smfmac_f32_16x16x64_bf16 v[36:39], v[20:23], a[224:231], v2
    ds_read_b128 v[20:23], v10 offset:1024
    s_mov_b32 m0, 23808
    s_waitcnt lgkmcnt(5)
    v_smfmac_f32_16x16x64_bf16 v[40:43], v[24:27], v[56:63], v2
    ds_read_b128 v[56:59], v1 offset:18432
    ds_read_b128 v[60:63], v1 offset:19456
    v_min_u32 v11, 64, v11
    v_smfmac_f32_16x16x64_bf16 v[44:47], v[24:27], a[104:111], v2
    buffer_load_dword v11, s[4:7], s3 offen sc1 lds
    v_smfmac_f32_16x16x64_bf16 v[36:39], v[24:27], a[232:239], v2
    ds_read_b128 v[24:27], v10 offset:1536
    s_mov_b32 m0, s52
    v_xor_b32 v10, 4096, v6
    v_smfmac_f32_16x16x64_bf16 v[40:43], v[28:31], a[0:7], v2
    s_waitcnt lgkmcnt(4)
    v_smfmac_f32_16x16x64_bf16 v[44:47], v[28:31], v[48:55], v2
    ds_read_b128 v[48:51], v1 offset:4096
    ds_read_b128 v[52:55], v1 offset:5120
    v_mov_b32 v11, s18
    v_smfmac_f32_16x16x64_bf16 v[36:39], v[28:31], a[240:247], v2
    ds_read_b128 v[28:31], v10 offset:0
    buffer_store_dword v11, off, s[4:7], s81 sc1
    v_smfmac_f32_16x16x64_bf16 v[40:43], v[32:35], a[8:15], v2
    s_waitcnt lgkmcnt(4)
    v_smfmac_f32_16x16x64_bf16 v[44:47], v[32:35], v[56:63], v2
    ds_read_b128 v[56:59], v1 offset:6144
    ds_read_b128 v[60:63], v1 offset:7168
    v_lshrrev_b32 v11, 1, v0
    v_smfmac_f32_16x16x64_bf16 v[36:39], v[32:35], a[248:255], v2
    ds_read_b128 v[32:35], v10 offset:512
    s_waitcnt lgkmcnt(4)
    v_smfmac_f32_16x16x64_bf16 v[40:43], v[12:15], v[48:55], v2
    ds_read_b128 v[48:51], v1 offset:12288
    ds_read_b128 v[52:55], v1 offset:13312
    v_smfmac_f32_16x16x64_bf16 v[44:47], v[12:15], a[112:119], v2
    v_smfmac_f32_16x16x64_bf16 v[36:39], v[12:15], v[64:71], v2
    ds_read_b128 v[12:15], v10 offset:1024
    s_waitcnt lgkmcnt(4)
    v_smfmac_f32_16x16x64_bf16 v[40:43], v[16:19], v[56:63], v2
    ds_read_b128 v[56:59], v1 offset:14336
    ds_read_b128 v[60:63], v1 offset:15360
    v_smfmac_f32_16x16x64_bf16 v[44:47], v[16:19], a[120:127], v2
    v_smfmac_f32_16x16x64_bf16 v[36:39], v[16:19], v[72:79], v2
    ds_read_b128 v[16:19], v10 offset:1536
    s_waitcnt lgkmcnt(4)
    v_smfmac_f32_16x16x64_bf16 v[40:43], v[20:23], v[48:55], v2
    ds_read_b128 v[48:51], v0 offset:9216
    ds_read_b128 v[52:55], v0 offset:13312
    v_xor_b32 v10, 6144, v6
    v_smfmac_f32_16x16x64_bf16 v[44:47], v[20:23], a[128:135], v2
    ds_read_b128 v[20:23], v10 offset:0
    s_waitcnt lgkmcnt(4)
    v_smfmac_f32_16x16x64_bf16 v[40:43], v[24:27], v[56:63], v2
    ds_read_b128 v[56:59], v0 offset:10240
    ds_read_b128 v[60:63], v0 offset:14336
    v_smfmac_f32_16x16x64_bf16 v[44:47], v[24:27], a[136:143], v2
    ds_read_b128 v[24:27], v10 offset:512
    v_smfmac_f32_16x16x64_bf16 v[40:43], v[28:31], a[16:23], v2
    v_smfmac_f32_16x16x64_bf16 v[44:47], v[28:31], a[144:151], v2
    ds_read_b128 v[28:31], v10 offset:1024
    v_smfmac_f32_16x16x64_bf16 v[40:43], v[32:35], a[24:31], v2
    v_smfmac_f32_16x16x64_bf16 v[44:47], v[32:35], a[152:159], v2
    ds_read_b128 v[32:35], v10 offset:1536
    v_xor_b32 v10, 2048, v6
    v_smfmac_f32_16x16x64_bf16 v[40:43], v[12:15], a[32:39], v2
    v_smfmac_f32_16x16x64_bf16 v[44:47], v[12:15], a[160:167], v2
    s_waitcnt lgkmcnt(8)
    v_smfmac_f32_16x16x64_bf16 v[40:43], v[16:19], a[40:47], v2
    v_smfmac_f32_16x16x64_bf16 v[44:47], v[16:19], a[168:175], v2
    s_waitcnt lgkmcnt(5)
    v_smfmac_f32_16x16x64_bf16 v[40:43], v[20:23], a[48:55], v2
    v_smfmac_f32_16x16x64_bf16 v[44:47], v[20:23], a[176:183], v2
    s_waitcnt lgkmcnt(2)
    v_smfmac_f32_16x16x64_bf16 v[40:43], v[24:27], a[56:63], v2
    v_smfmac_f32_16x16x64_bf16 v[44:47], v[24:27], a[184:191], v2
    s_waitcnt lgkmcnt(1)
    v_smfmac_f32_16x16x64_bf16 v[40:43], v[28:31], a[64:71], v2
    v_smfmac_f32_16x16x64_bf16 v[44:47], v[28:31], a[192:199], v2
    s_waitcnt lgkmcnt(0)
    v_smfmac_f32_16x16x64_bf16 v[40:43], v[32:35], a[72:79], v2
    v_smfmac_f32_16x16x64_bf16 v[44:47], v[32:35], a[200:207], v2
    v_smfmac_f32_16x16x64_bf16 v[36:39], v[12:15], v[112:119], v2
    ds_read_b128 v[12:15], v10 offset:1024
    v_cvt_pk_bf16_f32 v40, v40, v41
    v_cvt_pk_bf16_f32 v41, v42, v43
    s_nop 0
    v_cvt_pk_bf16_f32 v44, v44, v45
    v_cvt_pk_bf16_f32 v45, v46, v47
    v_smfmac_f32_16x16x64_bf16 v[36:39], v[16:19], v[120:127], v2
    ds_write_b64 v3, v[40:41] offset:17408
    ds_write_b64 v3, v[44:45] offset:19456
    ds_read_b128 v[16:19], v10 offset:1536
    v_smfmac_f32_16x16x64_bf16 v[36:39], v[20:23], v[128:135], v2
    buffer_store_dwordx2 v[44:45], v3, s[4:7], s43 offen sc1
    v_smfmac_f32_16x16x64_bf16 v[36:39], v[24:27], v[136:143], v2
    v_xor_b32 v10, 4096, v6
    v_smfmac_f32_16x16x64_bf16 v[36:39], v[28:31], v[144:151], v2
    ds_read_b128 v[20:23], v10 offset:0
    ds_read_b128 v[24:27], v10 offset:512
    v_lshrrev_b32 v10, 1, v0
    v_smfmac_f32_16x16x64_bf16 v[36:39], v[32:35], v[152:159], v2
    s_waitcnt lgkmcnt(3)
    s_barrier
    v_smfmac_f32_16x16x64_bf16 v[36:39], v[12:15], v[80:87], v2
    ds_read_b64_tr_b16 v[28:29], v4 offset:17408
    ds_read_b64_tr_b16 v[30:31], v4 offset:17536
    ds_read_b64_tr_b16 v[32:33], v4 offset:17920
    ds_read_b64_tr_b16 v[34:35], v4 offset:18048
    ds_read_b64_tr_b16 v[12:13], v4 offset:18432
    s_waitcnt lgkmcnt(7)
    v_smfmac_f32_16x16x64_bf16 v[36:39], v[16:19], v[88:95], v2
    ds_read_b64_tr_b16 v[14:15], v4 offset:18560
    ds_read_b64_tr_b16 v[16:17], v4 offset:18944
    s_waitcnt lgkmcnt(8)
    v_smfmac_f32_16x16x64_bf16 v[36:39], v[20:23], v[96:103], v2
    ds_read_b128 v[20:23], v0 offset:11264
    ds_read_b64_tr_b16 v[18:19], v4 offset:19072
    s_waitcnt lgkmcnt(9)
    v_smfmac_f32_16x16x64_bf16 v[36:39], v[24:27], v[104:111], v2
    ds_read_b128 v[24:27], v0 offset:15360
    s_waitcnt lgkmcnt(8)
    v_mfma_f32_16x16x32_bf16 v[40:43], v[48:51], v[28:31], 0
    ds_read_b128 v[48:51], v0 offset:12288
    s_waitcnt lgkmcnt(7)
    v_mfma_f32_16x16x32_bf16 v[40:43], v[56:59], v[32:35], v[40:43]
    ds_read_b64_tr_b16 v[56:57], v4 offset:19456
    ds_read_b64_tr_b16 v[58:59], v4 offset:19584
    v_cvt_pk_bf16_f32 v36, v36, v37
    v_mfma_f32_16x16x32_bf16 v[44:47], v[52:55], v[28:31], 0
    ds_read_b128 v[52:55], v0 offset:16384
    v_cvt_pk_bf16_f32 v37, v38, v39
    buffer_store_dwordx2 v[36:37], v11, s[4:7], s44 offen sc1
    v_mfma_f32_16x16x32_bf16 v[44:47], v[60:63], v[32:35], v[44:47]
    ds_read_b64_tr_b16 v[60:61], v4 offset:19968
    ds_read_b64_tr_b16 v[62:63], v4 offset:20096
    s_waitcnt lgkmcnt(8)
    v_mfma_f32_16x16x32_bf16 v[40:43], v[20:23], v[12:15], v[40:43]
    ds_read_b64_tr_b16 v[20:21], v4 offset:20480
    ds_read_b64_tr_b16 v[22:23], v4 offset:20608
    s_waitcnt lgkmcnt(8)
    v_mfma_f32_16x16x32_bf16 v[44:47], v[24:27], v[12:15], v[44:47]
    ds_read_b64_tr_b16 v[24:25], v4 offset:20992
    ds_read_b64_tr_b16 v[26:27], v4 offset:21120
    s_waitcnt lgkmcnt(9)
    v_mfma_f32_16x16x32_bf16 v[40:43], v[48:51], v[16:19], v[40:43]
    v_cndmask_b32 v38, v36, 0, s[28:29]
    s_waitcnt lgkmcnt(7)
    v_mfma_f32_16x16x32_bf16 v[48:51], v[56:59], v[28:31], 0
    v_cndmask_b32 v39, v37, 0, s[28:29]
    s_waitcnt lgkmcnt(4)
    v_mfma_f32_16x16x32_bf16 v[48:51], v[60:63], v[32:35], v[48:51]
    ds_read_b128 v[60:63], v1 offset:23552
    v_max3_f32 v56, v40, v41, v42
    s_waitcnt lgkmcnt(3)
    v_mfma_f32_16x16x32_bf16 v[48:51], v[20:23], v[12:15], v[48:51]
    s_waitcnt vmcnt(6)
    ds_read_b128 v[20:23], v1 offset:32768
    s_waitcnt lgkmcnt(2)
    v_mfma_f32_16x16x32_bf16 v[48:51], v[24:27], v[16:19], v[48:51]
    s_waitcnt vmcnt(5)
    ds_read_b128 v[24:27], v1 offset:33792
    v_cndmask_b32 v36, 0, v36, s[28:29]
    v_mfma_f32_16x16x32_bf16 v[44:47], v[52:55], v[16:19], v[44:47]
    v_cndmask_b32 v37, 0, v37, s[28:29]
    v_add_u32 v11, s61, v5
    v_mov_b64 v[52:53], s[30:31]
    v_mov_b64 v[54:55], s[30:31]
    s_nop 3
    v_max3_f32 v57, v43, v44, v45
    v_max3_f32 v56, v56, v46, v47
    v_max_f32 v56, v56, v57
    v_mov_b32 v57, v56
    s_nop 1
    v_permlane32_swap_b32 v56, v57
    v_max3_f32 v56, v56, v57, v48
    v_max3_f32 v57, v49, v50, v51
    v_max_f32 v56, v56, v57
    v_mov_b32 v57, v56
    s_nop 1
    v_permlane16_swap_b32 v56, v57
    v_max_f32 v56, v56, v57
    v_mul_f32 v58, s26, v56
    v_pk_fma_f32 v[40:41], v[40:41], s[26:27], v[58:59] op_sel_hi:[1,1,0] neg_lo:[0,0,1] neg_hi:[0,0,1]
    v_pk_fma_f32 v[42:43], v[42:43], s[26:27], v[58:59] op_sel_hi:[1,1,0] neg_lo:[0,0,1] neg_hi:[0,0,1]
    v_exp_f32 v40, v40
    v_exp_f32 v41, v41
    v_pk_fma_f32 v[44:45], v[44:45], s[26:27], v[58:59] op_sel_hi:[1,1,0] neg_lo:[0,0,1] neg_hi:[0,0,1]
    v_pk_fma_f32 v[46:47], v[46:47], s[26:27], v[58:59] op_sel_hi:[1,1,0] neg_lo:[0,0,1] neg_hi:[0,0,1]
    v_exp_f32 v42, v42
    v_exp_f32 v43, v43
    v_exp_f32 v44, v44
    v_exp_f32 v45, v45
    v_exp_f32 v46, v46
    v_exp_f32 v47, v47
    v_cvt_pk_bf16_f32 v40, v40, v41
    v_pk_fma_f32 v[48:49], v[48:49], s[26:27], v[58:59] op_sel_hi:[1,1,0] neg_lo:[0,0,1] neg_hi:[0,0,1]
    v_cvt_pk_bf16_f32 v41, v42, v43
    v_pk_fma_f32 v[50:51], v[50:51], s[26:27], v[58:59] op_sel_hi:[1,1,0] neg_lo:[0,0,1] neg_hi:[0,0,1]
    v_exp_f32 v48, v48
    ds_read_b128 v[56:59], v1 offset:22528
    v_exp_f32 v49, v49
    v_cvt_pk_bf16_f32 v42, v44, v45
    v_cvt_pk_bf16_f32 v43, v46, v47
    v_exp_f32 v50, v50
    s_waitcnt lgkmcnt(2)
    v_mfma_f32_16x16x32_bf16 v[28:31], v[20:23], v[40:43], 0
    v_exp_f32 v51, v51
    s_waitcnt lgkmcnt(1)
    v_mfma_f32_16x16x32_bf16 v[32:35], v[24:27], v[40:43], 0
    v_cvt_pk_bf16_f32 v48, v48, v49
    v_cvt_pk_bf16_f32 v49, v50, v51
    v_mfma_f32_16x16x32_bf16 v[12:15], v[52:55], v[40:43], 0
    ds_read_b128 v[52:55], v1 offset:25600
    v_mov_b64 v[50:51], s[98:99]
    v_mov_b64 v[20:21], 0
    v_mfma_f32_16x16x16_bf16 v[28:31], v[38:39], v[48:49], v[28:31]
    v_mov_b64 v[22:23], 0
    v_mov_b64 v[24:25], 0
    v_mfma_f32_16x16x16_bf16 v[12:15], v[50:51], v[48:49], v[12:15]
    v_mov_b64 v[26:27], 0
    v_mov_b64 v[38:39], 0
    v_mfma_f32_16x16x16_bf16 v[32:35], v[36:37], v[48:49], v[32:35]
    ds_read_b128 v[48:51], v1 offset:24576
    v_mov_b64 v[44:45], 0
    v_mov_b64 v[46:47], 0
    v_mov_b64 v[36:37], 0
    s_nop 0
    v_rcp_f32 v12, v12
    v_mov_b64 v[40:41], 0
    v_pk_mul_f32 v[28:29], v[28:29], v[12:13] op_sel_hi:[1,0]
    v_pk_mul_f32 v[30:31], v[30:31], v[12:13] op_sel_hi:[1,0]
    v_pk_mul_f32 v[32:33], v[32:33], v[12:13] op_sel_hi:[1,0]
    v_pk_mul_f32 v[34:35], v[34:35], v[12:13] op_sel_hi:[1,0]
    v_cvt_pk_bf16_f32 v16, v28, v29
    v_cvt_pk_bf16_f32 v17, v30, v31
    v_cvt_pk_bf16_f32 v18, v32, v33
    v_cvt_pk_bf16_f32 v19, v34, v35
    ds_write_b128 v11, v[16:19] offset:21504
    v_xor_b32 v12, 1536, v11
    v_xor_b32 v28, 512, v11
    v_xor_b32 v32, 1024, v11
    v_mov_b64 v[42:43], 0
    v_smfmac_f32_16x16x64_bf16 v[44:47], v[16:19], v[240:247], v2
    s_waitcnt lgkmcnt(0)
    s_barrier
    ds_read_b128 v[12:15], v12 offset:21504
    v_smfmac_f32_16x16x64_bf16 v[20:23], v[16:19], v[160:167], v2
    ds_read_b128 v[28:31], v28 offset:21504
    ds_read_b128 v[32:35], v32 offset:21504
    buffer_load_dwordx4 v0, s[4:7], s41 offen sc1 lds
    v_smfmac_f32_16x16x64_bf16 v[24:27], v[16:19], v[176:183], v2
    s_add_u32 m0, s52, 4096
    s_add_u32 s20, s41, 4096
    buffer_load_dwordx4 v0, s[4:7], s20 offen sc1 lds
    v_smfmac_f32_16x16x64_bf16 v[36:39], v[16:19], v[48:55], v2
    ds_read_b128 v[48:51], v1 offset:20480
    ds_read_b128 v[52:55], v1 offset:21504
    v_smfmac_f32_16x16x64_bf16 v[40:43], v[16:19], v[224:231], v2
    s_waitcnt lgkmcnt(3)
    v_smfmac_f32_16x16x64_bf16 v[44:47], v[28:31], v[248:255], v2
    v_smfmac_f32_16x16x64_bf16 v[20:23], v[28:31], v[168:175], v2
    s_nop 3
    v_cvt_pk_bf16_f32 v44, v44, v45
    v_cvt_pk_bf16_f32 v45, v46, v47
    v_bfi_b32 v44, 1, s67, v44
    buffer_store_dwordx2 v[44:45], v10, s[4:7], s34 offen offset:2048 sc1
    s_waitcnt lgkmcnt(0)
    v_smfmac_f32_16x16x64_bf16 v[20:23], v[32:35], v[48:55], v2
    ds_read_b128 v[48:51], v1 offset:28672
    ds_read_b128 v[52:55], v1 offset:29696
    v_smfmac_f32_16x16x64_bf16 v[20:23], v[12:15], v[56:63], v2
    ds_read_b128 v[56:59], v1 offset:26624
    ds_read_b128 v[60:63], v1 offset:27648
    v_smfmac_f32_16x16x64_bf16 v[24:27], v[28:31], v[184:191], v2
    v_smfmac_f32_16x16x64_bf16 v[24:27], v[32:35], v[192:199], v2
    v_cvt_pk_bf16_f32 v20, v20, v21
    v_smfmac_f32_16x16x64_bf16 v[24:27], v[12:15], v[200:207], v2
    v_cvt_pk_bf16_f32 v21, v22, v23
    v_bfi_b32 v20, 1, s67, v20
    buffer_store_dwordx2 v[20:21], v10, s[4:7], s34 offen offset:0 sc1
    s_nop 4
    v_cvt_pk_bf16_f32 v24, v24, v25
    v_cvt_pk_bf16_f32 v25, v26, v27
    v_bfi_b32 v24, 1, s67, v24
    buffer_store_dwordx2 v[24:25], v10, s[4:7], s34 offen offset:512 sc1
    s_waitcnt lgkmcnt(0)
    v_smfmac_f32_16x16x64_bf16 v[36:39], v[28:31], v[56:63], v2
    ds_read_b128 v[56:59], v1 offset:30720
    ds_read_b128 v[60:63], v1 offset:31744
    v_smfmac_f32_16x16x64_bf16 v[36:39], v[32:35], v[208:215], v2
    v_smfmac_f32_16x16x64_bf16 v[36:39], v[12:15], v[216:223], v2
    v_smfmac_f32_16x16x64_bf16 v[40:43], v[28:31], v[232:239], v2
    v_smfmac_f32_16x16x64_bf16 v[40:43], v[32:35], v[48:55], v2
    v_cvt_pk_bf16_f32 v36, v36, v37
    v_cvt_pk_bf16_f32 v37, v38, v39
    v_bfi_b32 v36, 1, s67, v36
    buffer_store_dwordx2 v[36:37], v10, s[4:7], s34 offen offset:1024 sc1
    s_waitcnt lgkmcnt(0)
    v_smfmac_f32_16x16x64_bf16 v[40:43], v[12:15], v[56:63], v2
    s_nop 7
    v_cvt_pk_bf16_f32 v40, v40, v41
    v_cvt_pk_bf16_f32 v41, v42, v43
    v_bfi_b32 v40, 1, s67, v40
    buffer_store_dwordx2 v[40:41], v10, s[4:7], s34 offen offset:1536 sc1
    s_cmp_eq_u32 s45, 1
    s_cbranch_scc0 spec_m_38
    v_bfe_u32 v24, v0, 4, 4
    v_and_b32 v25, 3, v24
    v_lshlrev_b32 v25, 2, v25
    v_lshrrev_b32 v24, 2, v24
    v_add_u32 v25, v25, v24
    v_and_b32 v24, 1, v25
    v_lshlrev_b32 v24, 4, v24
    v_mov_b32 v26, 16256
    v_lshlrev_b32 v26, v24, v26
    v_lshrrev_b32 v25, 1, v25
    v_cmp_eq_u32 vcc, 0, v25
    s_nop 1
    v_cndmask_b32 v12, 0, v26, vcc
    v_cmp_eq_u32 vcc, 1, v25
    s_nop 1
    v_cndmask_b32 v13, 0, v26, vcc
    v_cmp_eq_u32 vcc, 2, v25
    s_nop 1
    v_cndmask_b32 v14, 0, v26, vcc
    v_cmp_eq_u32 vcc, 3, v25
    s_nop 1
    v_cndmask_b32 v15, 0, v26, vcc
    s_sleep 1
    buffer_load_dwordx4 v[48:51], v8, s[4:7], s35 offen sc1
    buffer_load_dwordx4 v[52:55], v8, s[4:7], s36 offen sc1
    buffer_load_dwordx4 v[56:59], v8, s[4:7], s37 offen sc1
    buffer_load_dwordx4 v[60:63], v8, s[4:7], s38 offen sc1
    s_waitcnt vmcnt(3)
    v_mfma_f32_16x16x32_bf16 v[16:19], v[12:15], v[48:51], 0
    v_bitop3_b32 v24, v48, v50, s67 bitop3:0x7e
    s_waitcnt vmcnt(2)
    v_mfma_f32_16x16x32_bf16 v[16:19], v[12:15], v[52:55], v[16:19]
    v_bitop3_b32 v25, v52, v54, s67 bitop3:0x7e
    s_waitcnt vmcnt(1)
    v_mfma_f32_16x16x32_bf16 v[16:19], v[12:15], v[56:59], v[16:19]
    v_bitop3_b32 v26, v56, v58, s67 bitop3:0x7e
    s_waitcnt vmcnt(0)
    v_mfma_f32_16x16x32_bf16 v[16:19], v[12:15], v[60:63], v[16:19]
    v_bitop3_b32 v27, v60, v62, s67 bitop3:0x7e
    v_or3_b32 v24, v24, v25, v26
    v_or_b32 v24, v24, v27
    v_and_b32 v24, 1, v24
    v_cmp_ne_u32 vcc, 0, v24
    s_nop 1
    s_cbranch_vccz rok_m_39
L_m_40:
    s_sub_u32 s19, s19, 1
    s_cbranch_scc1 abort_m_4
    buffer_load_dwordx4 v[48:51], v8, s[4:7], s35 offen sc1
    buffer_load_dwordx4 v[52:55], v8, s[4:7], s36 offen sc1
    buffer_load_dwordx4 v[56:59], v8, s[4:7], s37 offen sc1
    buffer_load_dwordx4 v[60:63], v8, s[4:7], s38 offen sc1
    s_waitcnt vmcnt(3)
    v_mfma_f32_16x16x32_bf16 v[16:19], v[12:15], v[48:51], 0
    v_bitop3_b32 v24, v48, v50, s67 bitop3:0x7e
    s_waitcnt vmcnt(2)
    v_mfma_f32_16x16x32_bf16 v[16:19], v[12:15], v[52:55], v[16:19]
    v_bitop3_b32 v25, v52, v54, s67 bitop3:0x7e
    s_waitcnt vmcnt(1)
    v_mfma_f32_16x16x32_bf16 v[16:19], v[12:15], v[56:59], v[16:19]
    v_bitop3_b32 v26, v56, v58, s67 bitop3:0x7e
    s_waitcnt vmcnt(0)
    v_mfma_f32_16x16x32_bf16 v[16:19], v[12:15], v[60:63], v[16:19]
    v_bitop3_b32 v27, v60, v62, s67 bitop3:0x7e
    v_or3_b32 v24, v24, v25, v26
    v_or_b32 v24, v24, v27
    v_and_b32 v24, 1, v24
    v_cmp_ne_u32 vcc, 0, v24
    s_nop 1
    s_cbranch_vccnz L_m_40
rok_m_39:
    v_add_f32_dpp v16, v16, v16 row_ror:8 row_mask:0xf bank_mask:0xf
    v_add_f32_dpp v17, v17, v17 row_ror:8 row_mask:0xf bank_mask:0xf
    v_cvt_pk_bf16_f32 v16, v16, v17
    v_min_u32 v16, s49, v16
    buffer_store_dword v16, v9, s[4:7], s39 offen sc1
    s_branch nored_m_37
spec_m_38:
    s_cmp_eq_u32 s45, 0
    s_cbranch_scc1 w3_m_41
    v_bfe_u32 v24, v0, 4, 4
    v_and_b32 v25, 3, v24
    v_lshlrev_b32 v25, 2, v25
    v_lshrrev_b32 v24, 2, v24
    v_add_u32 v25, v25, v24
    v_and_b32 v24, 1, v25
    v_lshlrev_b32 v24, 4, v24
    v_mov_b32 v26, 16256
    v_lshlrev_b32 v26, v24, v26
    v_lshrrev_b32 v25, 1, v25
    v_cmp_eq_u32 vcc, 0, v25
    s_nop 1
    v_cndmask_b32 v12, 0, v26, vcc
    v_cmp_eq_u32 vcc, 1, v25
    s_nop 1
    v_cndmask_b32 v13, 0, v26, vcc
    v_cmp_eq_u32 vcc, 2, v25
    s_nop 1
    v_cndmask_b32 v14, 0, v26, vcc
    v_cmp_eq_u32 vcc, 3, v25
    s_nop 1
    v_cndmask_b32 v15, 0, v26, vcc
    s_sleep 1
    buffer_load_dwordx4 v[48:51], v8, s[4:7], s35 offen sc1
    buffer_load_dwordx4 v[52:55], v8, s[4:7], s36 offen sc1
    buffer_load_dwordx4 v[56:59], v8, s[4:7], s37 offen sc1
    buffer_load_dwordx4 v[60:63], v8, s[4:7], s38 offen sc1
    s_waitcnt vmcnt(3)
    v_mfma_f32_16x16x32_bf16 v[16:19], v[12:15], v[48:51], 0
    v_bitop3_b32 v24, v48, v50, s67 bitop3:0x7e
    s_waitcnt vmcnt(2)
    v_mfma_f32_16x16x32_bf16 v[16:19], v[12:15], v[52:55], v[16:19]
    v_bitop3_b32 v25, v52, v54, s67 bitop3:0x7e
    s_waitcnt vmcnt(1)
    v_mfma_f32_16x16x32_bf16 v[16:19], v[12:15], v[56:59], v[16:19]
    v_bitop3_b32 v26, v56, v58, s67 bitop3:0x7e
    s_waitcnt vmcnt(0)
    v_mfma_f32_16x16x32_bf16 v[16:19], v[12:15], v[60:63], v[16:19]
    v_bitop3_b32 v27, v60, v62, s67 bitop3:0x7e
    v_or3_b32 v24, v24, v25, v26
    v_or_b32 v24, v24, v27
    v_and_b32 v24, 1, v24
    v_cmp_ne_u32 vcc, 0, v24
    s_nop 1
    s_cbranch_vccz rok_m_42
L_m_43:
    s_sub_u32 s19, s19, 1
    s_cbranch_scc1 abort_m_4
    buffer_load_dwordx4 v[48:51], v8, s[4:7], s35 offen sc1
    buffer_load_dwordx4 v[52:55], v8, s[4:7], s36 offen sc1
    buffer_load_dwordx4 v[56:59], v8, s[4:7], s37 offen sc1
    buffer_load_dwordx4 v[60:63], v8, s[4:7], s38 offen sc1
    s_waitcnt vmcnt(3)
    v_mfma_f32_16x16x32_bf16 v[16:19], v[12:15], v[48:51], 0
    v_bitop3_b32 v24, v48, v50, s67 bitop3:0x7e
    s_waitcnt vmcnt(2)
    v_mfma_f32_16x16x32_bf16 v[16:19], v[12:15], v[52:55], v[16:19]
    v_bitop3_b32 v25, v52, v54, s67 bitop3:0x7e
    s_waitcnt vmcnt(1)
    v_mfma_f32_16x16x32_bf16 v[16:19], v[12:15], v[56:59], v[16:19]
    v_bitop3_b32 v26, v56, v58, s67 bitop3:0x7e
    s_waitcnt vmcnt(0)
    v_mfma_f32_16x16x32_bf16 v[16:19], v[12:15], v[60:63], v[16:19]
    v_bitop3_b32 v27, v60, v62, s67 bitop3:0x7e
    v_or3_b32 v24, v24, v25, v26
    v_or_b32 v24, v24, v27
    v_and_b32 v24, 1, v24
    v_cmp_ne_u32 vcc, 0, v24
    s_nop 1
    s_cbranch_vccnz L_m_43
rok_m_42:
    v_add_f32_dpp v16, v16, v16 row_ror:4 row_mask:0xf bank_mask:0xf
    v_add_f32_dpp v17, v17, v17 row_ror:4 row_mask:0xf bank_mask:0xf
    s_nop 0
    v_add_f32_dpp v16, v16, v16 row_ror:8 row_mask:0xf bank_mask:0xf
    v_add_f32_dpp v17, v17, v17 row_ror:8 row_mask:0xf bank_mask:0xf
    v_cvt_pk_bf16_f32 v16, v16, v17
    v_min_u32 v16, s49, v16
    buffer_store_dword v16, v9, s[4:7], s39 offen sc1
    s_branch nored_m_37
w3_m_41:
    s_cmp_eq_u32 s69, 1073741824
    s_cbranch_scc1 idle_m_44
    v_mov_b64 v[12:13], -1
    v_mov_b64 v[14:15], -1
    buffer_store_dwordx4 v[12:15], v0, s[4:7], s68 offen sc1
    s_nop 1
idle_m_44:
    s_sleep 13
nored_m_37:
    s_add_u32 s18, s18, 1
    s_xor_b32 s66, s66, 327680
    s_add_u32 s35, s66, s50
    s_add_u32 s36, s35, s51
    s_add_u32 s37, s35, s71
    s_add_u32 s38, s36, s71
    s_add_u32 s34, s66, s60
    s_add_u32 s68, s79, s69
    s_mov_b32 s79, s39
    s_add_u32 s39, s39, 9216
    s_cmp_eq_u32 s39, 183537664
    s_cselect_b32 s39, 183500800, s39
    s_add_u32 s32, s79, s78
    s_add_u32 s33, s79, s65
    s_add_u32 s33, s33, 8192
    s_bfe_u32 s67, s18, 65537
    s_add_u32 s43, s43, 65536
    s_add_u32 s44, s44, 65536
    s_branch L_m_31
last_m_36:
    v_smfmac_f32_16x16x64_bf16 v[44:47], v[12:15], a[80:87], v2
    ds_read_b128 v[48:51], v1 offset:16384
    ds_read_b128 v[52:55], v1 offset:17408
    s_barrier
    v_smfmac_f32_16x16x64_bf16 v[36:39], v[12:15], a[208:215], v2
    ds_read_b128 v[56:59], v1 offset:18432
    ds_read_b128 v[60:63], v1 offset:19456
    v_xor_b32 v10, 512, v7
    v_smfmac_f32_16x16x64_bf16 v[44:47], v[16:19], a[88:95], v2
    ds_read_b128 v[32:35], v10
    v_xor_b32 v10, 2048, v6
    v_smfmac_f32_16x16x64_bf16 v[36:39], v[16:19], a[216:223], v2
    ds_read_b128 v[12:15], v10 offset:0
    ds_read_b128 v[16:19], v10 offset:512
    v_mov_b32 v11, s18
    v_smfmac_f32_16x16x64_bf16 v[44:47], v[20:23], a[96:103], v2
    buffer_store_dword v11, off, s[4:7], s81 sc1
    v_smfmac_f32_16x16x64_bf16 v[36:39], v[20:23], a[224:231], v2
    ds_read_b128 v[20:23], v10 offset:1024
    v_lshrrev_b32 v11, 1, v0
    v_smfmac_f32_16x16x64_bf16 v[44:47], v[24:27], a[104:111], v2
    v_smfmac_f32_16x16x64_bf16 v[36:39], v[24:27], a[232:239], v2
    ds_read_b128 v[24:27], v10 offset:1536
    s_waitcnt lgkmcnt(7)
    v_smfmac_f32_16x16x64_bf16 v[44:47], v[28:31], v[48:55], v2
    v_xor_b32 v10, 4096, v6
    v_smfmac_f32_16x16x64_bf16 v[36:39], v[28:31], a[240:247], v2
    ds_read_b128 v[28:31], v10 offset:0
    s_waitcnt lgkmcnt(5)
    v_smfmac_f32_16x16x64_bf16 v[44:47], v[32:35], v[56:63], v2
    v_smfmac_f32_16x16x64_bf16 v[36:39], v[32:35], a[248:255], v2
    ds_read_b128 v[32:35], v10 offset:512
    s_waitcnt lgkmcnt(5)
    v_smfmac_f32_16x16x64_bf16 v[44:47], v[12:15], a[112:119], v2
    v_smfmac_f32_16x16x64_bf16 v[36:39], v[12:15], v[64:71], v2
    ds_read_b128 v[12:15], v10 offset:1024
    s_waitcnt lgkmcnt(5)
    v_smfmac_f32_16x16x64_bf16 v[44:47], v[16:19], a[120:127], v2
    v_smfmac_f32_16x16x64_bf16 v[36:39], v[16:19], v[72:79], v2
    ds_read_b128 v[16:19], v10 offset:1536
    s_waitcnt lgkmcnt(5)
    v_smfmac_f32_16x16x64_bf16 v[44:47], v[20:23], a[128:135], v2
    s_waitcnt lgkmcnt(4)
    v_smfmac_f32_16x16x64_bf16 v[44:47], v[24:27], a[136:143], v2
    s_waitcnt lgkmcnt(3)
    v_smfmac_f32_16x16x64_bf16 v[44:47], v[28:31], a[144:151], v2
    v_xor_b32 v10, 6144, v6
    ds_read_b128 v[20:23], v10 offset:0
    s_waitcnt lgkmcnt(3)
    v_smfmac_f32_16x16x64_bf16 v[44:47], v[32:35], a[152:159], v2
    ds_read_b128 v[24:27], v10 offset:512
    ds_read_b128 v[28:31], v10 offset:1024
    s_waitcnt lgkmcnt(4)
    v_smfmac_f32_16x16x64_bf16 v[44:47], v[12:15], a[160:167], v2
    ds_read_b128 v[32:35], v10 offset:1536
    s_waitcnt lgkmcnt(4)
    v_smfmac_f32_16x16x64_bf16 v[44:47], v[16:19], a[168:175], v2
    v_xor_b32 v10, 2048, v6
    s_waitcnt lgkmcnt(3)
    v_smfmac_f32_16x16x64_bf16 v[44:47], v[20:23], a[176:183], v2
    s_waitcnt lgkmcnt(2)
    v_smfmac_f32_16x16x64_bf16 v[44:47], v[24:27], a[184:191], v2
    s_waitcnt lgkmcnt(1)
    v_smfmac_f32_16x16x64_bf16 v[44:47], v[28:31], a[192:199], v2
    s_waitcnt lgkmcnt(0)
    v_smfmac_f32_16x16x64_bf16 v[44:47], v[32:35], a[200:207], v2
    v_smfmac_f32_16x16x64_bf16 v[36:39], v[12:15], v[112:119], v2
    ds_read_b128 v[12:15], v10 offset:1024
    v_smfmac_f32_16x16x64_bf16 v[36:39], v[16:19], v[120:127], v2
    ds_read_b128 v[16:19], v10 offset:1536
    v_xor_b32 v10, 4096, v6
    v_smfmac_f32_16x16x64_bf16 v[36:39], v[20:23], v[128:135], v2
    ds_read_b128 v[20:23], v10 offset:0
    v_cvt_pk_bf16_f32 v44, v44, v45
    v_smfmac_f32_16x16x64_bf16 v[36:39], v[24:27], v[136:143], v2
    ds_read_b128 v[24:27], v10 offset:512
    v_cvt_pk_bf16_f32 v45, v46, v47
    v_smfmac_f32_16x16x64_bf16 v[36:39], v[28:31], v[144:151], v2
    buffer_store_dwordx2 v[44:45], v3, s[4:7], s43 offen sc1
    v_smfmac_f32_16x16x64_bf16 v[36:39], v[32:35], v[152:159], v2
    s_waitcnt lgkmcnt(3)
    v_smfmac_f32_16x16x64_bf16 v[36:39], v[12:15], v[80:87], v2
    s_waitcnt lgkmcnt(2)
    v_smfmac_f32_16x16x64_bf16 v[36:39], v[16:19], v[88:95], v2
    s_waitcnt lgkmcnt(1)
    v_smfmac_f32_16x16x64_bf16 v[36:39], v[20:23], v[96:103], v2
    s_waitcnt lgkmcnt(0)
    v_smfmac_f32_16x16x64_bf16 v[36:39], v[24:27], v[104:111], v2
    s_nop 7
    v_cvt_pk_bf16_f32 v36, v36, v37
    v_cvt_pk_bf16_f32 v37, v38, v39
    buffer_store_dwordx2 v[36:37], v11, s[4:7], s44 offen sc1
    s_branch done_m_5
done_m_5:
    s_waitcnt vmcnt(0) lgkmcnt(0)
    s_barrier
    v_mov_b32 v10, 64
    buffer_store_dword v10, off, s[4:7], s81 sc1
    s_nop 0
abort_m_4:
    s_endpgm
exit_m_1:
    s_endpgm
workers_m_3:
    s_lshr_b32 s20, s2, 5
    s_mul_i32 s20, s20, 7
    s_add_u32 s20, s20, s3
    s_sub_u32 s20, s20, 1
    s_mov_b32 s70, 846615568
    s_mov_b32 s71, 14395788
    s_lshl_b32 s24, s20, 2
    s_lshr_b64 s[70:71], s[70:71], s24
    s_and_b32 s24, s70, 15
    s_cmp_lt_u32 s20, 14
    s_cselect_b32 s20, s24, s20
    s_lshl_b32 s20, s20, 2
    s_bfe_u32 s3, s2, 131075
    s_add_u32 s20, s20, s3
    s_cmp_ge_u32 s20, 48
    s_cbranch_scc1 nqkv_m_45
    s_load_dwordx2 s[32:33], s[0:1], 112
    s_load_dwordx2 s[34:35], s[0:1], 16
    s_load_dwordx2 s[36:37], s[0:1], 24
    s_load_dwordx2 s[38:39], s[0:1], 32
    v_lshrrev_b32 v3, 6, v0
    s_nop 0
    v_readfirstlane_b32 s21, v3
    v_and_b32 v1, 63, v0
    v_lshlrev_b32 v2, 4, v1
    s_mov_b32 s23, 4194304
    s_waitcnt lgkmcnt(0)
    s_mov_b32 s4, s32
    s_and_b32 s5, s33, 65535
    s_mov_b32 s6, 268435456
    s_mov_b32 s7, 131072
    s_lshr_b32 s26, s20, 4
    s_cmp_eq_u32 s26, 1
    s_cselect_b64 s[46:47], s[36:37], s[34:35]
    s_cmp_eq_u32 s26, 2
    s_cselect_b64 s[46:47], s[38:39], s[46:47]
    s_mov_b32 s8, s46
    s_and_b32 s9, s47, 65535
    s_mov_b32 s10, 4718592
    s_mov_b32 s11, 131072
    s_and_b32 s24, s20, 15
    s_lshl_b32 s48, s24, 9
    s_lshl_b32 s25, s21, 7
    s_add_u32 s48, s48, s25
    s_lshl_b32 s49, s21, 15
    v_lshrrev_b32 v6, 3, v1
    s_mov_b32 s24, 8192
    v_mul_lo_u32 v4, v6, s24
    v_and_b32 v6, 7, v1
    v_lshl_add_u32 v4, v6, 4, v4
    v_lshrrev_b32 v6, 5, v1
    v_lshlrev_b32 v6, 3, v6
    v_bfe_u32 v7, v1, 2, 2
    v_add_u32 v6, v6, v7
    v_mul_u32_u24 v5, 128, v6
    v_bfe_u32 v6, v1, 4, 1
    v_lshl_add_u32 v5, v6, 5, v5
    v_and_b32 v6, 3, v1
    v_lshl_add_u32 v5, v6, 3, v5
    v_add_u32 v5, s49, v5
    s_add_u32 s25, s48, 0
    s_add_u32 m0, s49, 0
    s_nop 0
    buffer_load_dwordx4 v4, s[8:11], s25 offen lds
    s_add_u32 m0, s49, 1024
    s_add_u32 s25, s25, 65536
    buffer_load_dwordx4 v4, s[8:11], s25 offen lds
    s_add_u32 m0, s49, 2048
    s_add_u32 s25, s25, 65536
    buffer_load_dwordx4 v4, s[8:11], s25 offen lds
    s_add_u32 m0, s49, 3072
    s_add_u32 s25, s25, 65536
    buffer_load_dwordx4 v4, s[8:11], s25 offen lds
    s_add_u32 m0, s49, 4096
    s_add_u32 s25, s25, 65536
    buffer_load_dwordx4 v4, s[8:11], s25 offen lds
    s_add_u32 m0, s49, 5120
    s_add_u32 s25, s25, 65536
    buffer_load_dwordx4 v4, s[8:11], s25 offen lds
    s_add_u32 m0, s49, 6144
    s_add_u32 s25, s25, 65536
    buffer_load_dwordx4 v4, s[8:11], s25 offen lds
    s_add_u32 m0, s49, 7168
    s_add_u32 s25, s25, 65536
    buffer_load_dwordx4 v4, s[8:11], s25 offen lds
    s_add_u32 s25, s48, 524288
    s_add_u32 m0, s49, 8192
    s_nop 0
    buffer_load_dwordx4 v4, s[8:11], s25 offen lds
    s_add_u32 m0, s49, 9216
    s_add_u32 s25, s25, 65536
    buffer_load_dwordx4 v4, s[8:11], s25 offen lds
    s_add_u32 m0, s49, 10240
    s_add_u32 s25, s25, 65536
    buffer_load_dwordx4 v4, s[8:11], s25 offen lds
    s_add_u32 m0, s49, 11264
    s_add_u32 s25, s25, 65536
    buffer_load_dwordx4 v4, s[8:11], s25 offen lds
    s_add_u32 m0, s49, 12288
    s_add_u32 s25, s25, 65536
    buffer_load_dwordx4 v4, s[8:11], s25 offen lds
    s_add_u32 m0, s49, 13312
    s_add_u32 s25, s25, 65536
    buffer_load_dwordx4 v4, s[8:11], s25 offen lds
    s_add_u32 m0, s49, 14336
    s_add_u32 s25, s25, 65536
    buffer_load_dwordx4 v4, s[8:11], s25 offen lds
    s_add_u32 m0, s49, 15360
    s_add_u32 s25, s25, 65536
    buffer_load_dwordx4 v4, s[8:11], s25 offen lds
    s_add_u32 s25, s48, 1048576
    s_add_u32 m0, s49, 16384
    s_nop 0
    buffer_load_dwordx4 v4, s[8:11], s25 offen lds
    s_add_u32 m0, s49, 17408
    s_add_u32 s25, s25, 65536
    buffer_load_dwordx4 v4, s[8:11], s25 offen lds
    s_add_u32 m0, s49, 18432
    s_add_u32 s25, s25, 65536
    buffer_load_dwordx4 v4, s[8:11], s25 offen lds
    s_add_u32 m0, s49, 19456
    s_add_u32 s25, s25, 65536
    buffer_load_dwordx4 v4, s[8:11], s25 offen lds
    s_add_u32 m0, s49, 20480
    s_add_u32 s25, s25, 65536
    buffer_load_dwordx4 v4, s[8:11], s25 offen lds
    s_add_u32 m0, s49, 21504
    s_add_u32 s25, s25, 65536
    buffer_load_dwordx4 v4, s[8:11], s25 offen lds
    s_add_u32 m0, s49, 22528
    s_add_u32 s25, s25, 65536
    buffer_load_dwordx4 v4, s[8:11], s25 offen lds
    s_add_u32 m0, s49, 23552
    s_add_u32 s25, s25, 65536
    buffer_load_dwordx4 v4, s[8:11], s25 offen lds
    s_add_u32 s25, s48, 1572864
    s_add_u32 m0, s49, 24576
    s_nop 0
    buffer_load_dwordx4 v4, s[8:11], s25 offen lds
    s_add_u32 m0, s49, 25600
    s_add_u32 s25, s25, 65536
    buffer_load_dwordx4 v4, s[8:11], s25 offen lds
    s_add_u32 m0, s49, 26624
    s_add_u32 s25, s25, 65536
    buffer_load_dwordx4 v4, s[8:11], s25 offen lds
    s_add_u32 m0, s49, 27648
    s_add_u32 s25, s25, 65536
    buffer_load_dwordx4 v4, s[8:11], s25 offen lds
    s_add_u32 m0, s49, 28672
    s_add_u32 s25, s25, 65536
    buffer_load_dwordx4 v4, s[8:11], s25 offen lds
    s_add_u32 m0, s49, 29696
    s_add_u32 s25, s25, 65536
    buffer_load_dwordx4 v4, s[8:11], s25 offen lds
    s_add_u32 m0, s49, 30720
    s_add_u32 s25, s25, 65536
    buffer_load_dwordx4 v4, s[8:11], s25 offen lds
    s_add_u32 m0, s49, 31744
    s_add_u32 s25, s25, 65536
    buffer_load_dwordx4 v4, s[8:11], s25 offen lds
    s_waitcnt vmcnt(24)
    ds_read_b64_tr_b16 a[0:1], v5 offset:0
    ds_read_b64_tr_b16 a[2:3], v5 offset:512
    ds_read_b64_tr_b16 a[4:5], v5 offset:64
    ds_read_b64_tr_b16 a[6:7], v5 offset:576
    ds_read_b64_tr_b16 a[8:9], v5 offset:2048
    ds_read_b64_tr_b16 a[10:11], v5 offset:2560
    ds_read_b64_tr_b16 a[12:13], v5 offset:2112
    ds_read_b64_tr_b16 a[14:15], v5 offset:2624
    ds_read_b64_tr_b16 a[16:17], v5 offset:4096
    ds_read_b64_tr_b16 a[18:19], v5 offset:4608
    ds_read_b64_tr_b16 a[20:21], v5 offset:4160
    ds_read_b64_tr_b16 a[22:23], v5 offset:4672
    ds_read_b64_tr_b16 a[24:25], v5 offset:6144
    ds_read_b64_tr_b16 a[26:27], v5 offset:6656
    ds_read_b64_tr_b16 a[28:29], v5 offset:6208
    ds_read_b64_tr_b16 a[30:31], v5 offset:6720
    s_waitcnt lgkmcnt(0)
    s_add_u32 s25, s48, 2097152
    s_add_u32 m0, s49, 0
    s_nop 0
    buffer_load_dwordx4 v4, s[8:11], s25 offen lds
    s_add_u32 m0, s49, 1024
    s_add_u32 s25, s25, 65536
    buffer_load_dwordx4 v4, s[8:11], s25 offen lds
    s_add_u32 m0, s49, 2048
    s_add_u32 s25, s25, 65536
    buffer_load_dwordx4 v4, s[8:11], s25 offen lds
    s_add_u32 m0, s49, 3072
    s_add_u32 s25, s25, 65536
    buffer_load_dwordx4 v4, s[8:11], s25 offen lds
    s_add_u32 m0, s49, 4096
    s_add_u32 s25, s25, 65536
    buffer_load_dwordx4 v4, s[8:11], s25 offen lds
    s_add_u32 m0, s49, 5120
    s_add_u32 s25, s25, 65536
    buffer_load_dwordx4 v4, s[8:11], s25 offen lds
    s_add_u32 m0, s49, 6144
    s_add_u32 s25, s25, 65536
    buffer_load_dwordx4 v4, s[8:11], s25 offen lds
    s_add_u32 m0, s49, 7168
    s_add_u32 s25, s25, 65536
    buffer_load_dwordx4 v4, s[8:11], s25 offen lds
    s_waitcnt vmcnt(24)
    ds_read_b64_tr_b16 a[32:33], v5 offset:8192
    ds_read_b64_tr_b16 a[34:35], v5 offset:8704
    ds_read_b64_tr_b16 a[36:37], v5 offset:8256
    ds_read_b64_tr_b16 a[38:39], v5 offset:8768
    ds_read_b64_tr_b16 a[40:41], v5 offset:10240
    ds_read_b64_tr_b16 a[42:43], v5 offset:10752
    ds_read_b64_tr_b16 a[44:45], v5 offset:10304
    ds_read_b64_tr_b16 a[46:47], v5 offset:10816
    ds_read_b64_tr_b16 a[48:49], v5 offset:12288
    ds_read_b64_tr_b16 a[50:51], v5 offset:12800
    ds_read_b64_tr_b16 a[52:53], v5 offset:12352
    ds_read_b64_tr_b16 a[54:55], v5 offset:12864
    ds_read_b64_tr_b16 a[56:57], v5 offset:14336
    ds_read_b64_tr_b16 a[58:59], v5 offset:14848
    ds_read_b64_tr_b16 a[60:61], v5 offset:14400
    ds_read_b64_tr_b16 a[62:63], v5 offset:14912
    s_waitcnt lgkmcnt(0)
    s_add_u32 s25, s48, 2621440
    s_add_u32 m0, s49, 8192
    s_nop 0
    buffer_load_dwordx4 v4, s[8:11], s25 offen lds
    s_add_u32 m0, s49, 9216
    s_add_u32 s25, s25, 65536
    buffer_load_dwordx4 v4, s[8:11], s25 offen lds
    s_add_u32 m0, s49, 10240
    s_add_u32 s25, s25, 65536
    buffer_load_dwordx4 v4, s[8:11], s25 offen lds
    s_add_u32 m0, s49, 11264
    s_add_u32 s25, s25, 65536
    buffer_load_dwordx4 v4, s[8:11], s25 offen lds
    s_add_u32 m0, s49, 12288
    s_add_u32 s25, s25, 65536
    buffer_load_dwordx4 v4, s[8:11], s25 offen lds
    s_add_u32 m0, s49, 13312
    s_add_u32 s25, s25, 65536
    buffer_load_dwordx4 v4, s[8:11], s25 offen lds
    s_add_u32 m0, s49, 14336
    s_add_u32 s25, s25, 65536
    buffer_load_dwordx4 v4, s[8:11], s25 offen lds
    s_add_u32 m0, s49, 15360
    s_add_u32 s25, s25, 65536
    buffer_load_dwordx4 v4, s[8:11], s25 offen lds
    s_waitcnt vmcnt(24)
    ds_read_b64_tr_b16 a[64:65], v5 offset:16384
    ds_read_b64_tr_b16 a[66:67], v5 offset:16896
    ds_read_b64_tr_b16 a[68:69], v5 offset:16448
    ds_read_b64_tr_b16 a[70:71], v5 offset:16960
    ds_read_b64_tr_b16 a[72:73], v5 offset:18432
    ds_read_b64_tr_b16 a[74:75], v5 offset:18944
    ds_read_b64_tr_b16 a[76:77], v5 offset:18496
    ds_read_b64_tr_b16 a[78:79], v5 offset:19008
    ds_read_b64_tr_b16 a[80:81], v5 offset:20480
    ds_read_b64_tr_b16 a[82:83], v5 offset:20992
    ds_read_b64_tr_b16 a[84:85], v5 offset:20544
    ds_read_b64_tr_b16 a[86:87], v5 offset:21056
    ds_read_b64_tr_b16 a[88:89], v5 offset:22528
    ds_read_b64_tr_b16 a[90:91], v5 offset:23040
    ds_read_b64_tr_b16 a[92:93], v5 offset:22592
    ds_read_b64_tr_b16 a[94:95], v5 offset:23104
    s_waitcnt lgkmcnt(0)
    s_add_u32 s25, s48, 3145728
    s_add_u32 m0, s49, 16384
    s_nop 0
    buffer_load_dwordx4 v4, s[8:11], s25 offen lds
    s_add_u32 m0, s49, 17408
    s_add_u32 s25, s25, 65536
    buffer_load_dwordx4 v4, s[8:11], s25 offen lds
    s_add_u32 m0, s49, 18432
    s_add_u32 s25, s25, 65536
    buffer_load_dwordx4 v4, s[8:11], s25 offen lds
    s_add_u32 m0, s49, 19456
    s_add_u32 s25, s25, 65536
    buffer_load_dwordx4 v4, s[8:11], s25 offen lds
    s_add_u32 m0, s49, 20480
    s_add_u32 s25, s25, 65536
    buffer_load_dwordx4 v4, s[8:11], s25 offen lds
    s_add_u32 m0, s49, 21504
    s_add_u32 s25, s25, 65536
    buffer_load_dwordx4 v4, s[8:11], s25 offen lds
    s_add_u32 m0, s49, 22528
    s_add_u32 s25, s25, 65536
    buffer_load_dwordx4 v4, s[8:11], s25 offen lds
    s_add_u32 m0, s49, 23552
    s_add_u32 s25, s25, 65536
    buffer_load_dwordx4 v4, s[8:11], s25 offen lds
    s_waitcnt vmcnt(24)
    ds_read_b64_tr_b16 a[96:97], v5 offset:24576
    ds_read_b64_tr_b16 a[98:99], v5 offset:25088
    ds_read_b64_tr_b16 a[100:101], v5 offset:24640
    ds_read_b64_tr_b16 a[102:103], v5 offset:25152
    ds_read_b64_tr_b16 a[104:105], v5 offset:26624
    ds_read_b64_tr_b16 a[106:107], v5 offset:27136
    ds_read_b64_tr_b16 a[108:109], v5 offset:26688
    ds_read_b64_tr_b16 a[110:111], v5 offset:27200
    ds_read_b64_tr_b16 a[112:113], v5 offset:28672
    ds_read_b64_tr_b16 a[114:115], v5 offset:29184
    ds_read_b64_tr_b16 a[116:117], v5 offset:28736
    ds_read_b64_tr_b16 a[118:119], v5 offset:29248
    ds_read_b64_tr_b16 a[120:121], v5 offset:30720
    ds_read_b64_tr_b16 a[122:123], v5 offset:31232
    ds_read_b64_tr_b16 a[124:125], v5 offset:30784
    ds_read_b64_tr_b16 a[126:127], v5 offset:31296
    s_waitcnt lgkmcnt(0)
    s_add_u32 s25, s48, 3670016
    s_add_u32 m0, s49, 24576
    s_nop 0
    buffer_load_dwordx4 v4, s[8:11], s25 offen lds
    s_add_u32 m0, s49, 25600
    s_add_u32 s25, s25, 65536
    buffer_load_dwordx4 v4, s[8:11], s25 offen lds
    s_add_u32 m0, s49, 26624
    s_add_u32 s25, s25, 65536
    buffer_load_dwordx4 v4, s[8:11], s25 offen lds
    s_add_u32 m0, s49, 27648
    s_add_u32 s25, s25, 65536
    buffer_load_dwordx4 v4, s[8:11], s25 offen lds
    s_add_u32 m0, s49, 28672
    s_add_u32 s25, s25, 65536
    buffer_load_dwordx4 v4, s[8:11], s25 offen lds
    s_add_u32 m0, s49, 29696
    s_add_u32 s25, s25, 65536
    buffer_load_dwordx4 v4, s[8:11], s25 offen lds
    s_add_u32 m0, s49, 30720
    s_add_u32 s25, s25, 65536
    buffer_load_dwordx4 v4, s[8:11], s25 offen lds
    s_add_u32 m0, s49, 31744
    s_add_u32 s25, s25, 65536
    buffer_load_dwordx4 v4, s[8:11], s25 offen lds
    s_waitcnt vmcnt(24)
    ds_read_b64_tr_b16 a[128:129], v5 offset:0
    ds_read_b64_tr_b16 a[130:131], v5 offset:512
    ds_read_b64_tr_b16 a[132:133], v5 offset:64
    ds_read_b64_tr_b16 a[134:135], v5 offset:576
    ds_read_b64_tr_b16 a[136:137], v5 offset:2048
    ds_read_b64_tr_b16 a[138:139], v5 offset:2560
    ds_read_b64_tr_b16 a[140:141], v5 offset:2112
    ds_read_b64_tr_b16 a[142:143], v5 offset:2624
    ds_read_b64_tr_b16 a[144:145], v5 offset:4096
    ds_read_b64_tr_b16 a[146:147], v5 offset:4608
    ds_read_b64_tr_b16 a[148:149], v5 offset:4160
    ds_read_b64_tr_b16 a[150:151], v5 offset:4672
    ds_read_b64_tr_b16 a[152:153], v5 offset:6144
    ds_read_b64_tr_b16 a[154:155], v5 offset:6656
    ds_read_b64_tr_b16 a[156:157], v5 offset:6208
    ds_read_b64_tr_b16 a[158:159], v5 offset:6720
    s_waitcnt lgkmcnt(0)
    s_add_u32 s25, s48, 4194304
    s_add_u32 m0, s49, 0
    s_nop 0
    buffer_load_dwordx4 v4, s[8:11], s25 offen lds
    s_add_u32 m0, s49, 1024
    s_add_u32 s25, s25, 65536
    buffer_load_dwordx4 v4, s[8:11], s25 offen lds
    s_add_u32 m0, s49, 2048
    s_add_u32 s25, s25, 65536
    buffer_load_dwordx4 v4, s[8:11], s25 offen lds
    s_add_u32 m0, s49, 3072
    s_add_u32 s25, s25, 65536
    buffer_load_dwordx4 v4, s[8:11], s25 offen lds
    s_add_u32 m0, s49, 4096
    s_add_u32 s25, s25, 65536
    buffer_load_dwordx4 v4, s[8:11], s25 offen lds
    s_add_u32 m0, s49, 5120
    s_add_u32 s25, s25, 65536
    buffer_load_dwordx4 v4, s[8:11], s25 offen lds
    s_add_u32 m0, s49, 6144
    s_add_u32 s25, s25, 65536
    buffer_load_dwordx4 v4, s[8:11], s25 offen lds
    s_add_u32 m0, s49, 7168
    s_add_u32 s25, s25, 65536
    buffer_load_dwordx4 v4, s[8:11], s25 offen lds
    s_waitcnt vmcnt(24)
    ds_read_b64_tr_b16 a[160:161], v5 offset:8192
    ds_read_b64_tr_b16 a[162:163], v5 offset:8704
    ds_read_b64_tr_b16 a[164:165], v5 offset:8256
    ds_read_b64_tr_b16 a[166:167], v5 offset:8768
    ds_read_b64_tr_b16 a[168:169], v5 offset:10240
    ds_read_b64_tr_b16 a[170:171], v5 offset:10752
    ds_read_b64_tr_b16 a[172:173], v5 offset:10304
    ds_read_b64_tr_b16 a[174:175], v5 offset:10816
    ds_read_b64_tr_b16 a[176:177], v5 offset:12288
    ds_read_b64_tr_b16 a[178:179], v5 offset:12800
    ds_read_b64_tr_b16 a[180:181], v5 offset:12352
    ds_read_b64_tr_b16 a[182:183], v5 offset:12864
    ds_read_b64_tr_b16 a[184:185], v5 offset:14336
    ds_read_b64_tr_b16 a[186:187], v5 offset:14848
    ds_read_b64_tr_b16 a[188:189], v5 offset:14400
    ds_read_b64_tr_b16 a[190:191], v5 offset:14912
    s_waitcnt lgkmcnt(0)
    s_waitcnt vmcnt(16)
    ds_read_b64_tr_b16 a[192:193], v5 offset:16384
    ds_read_b64_tr_b16 a[194:195], v5 offset:16896
    ds_read_b64_tr_b16 a[196:197], v5 offset:16448
    ds_read_b64_tr_b16 a[198:199], v5 offset:16960
    ds_read_b64_tr_b16 a[200:201], v5 offset:18432
    ds_read_b64_tr_b16 a[202:203], v5 offset:18944
    ds_read_b64_tr_b16 a[204:205], v5 offset:18496
    ds_read_b64_tr_b16 a[206:207], v5 offset:19008
    ds_read_b64_tr_b16 a[208:209], v5 offset:20480
    ds_read_b64_tr_b16 a[210:211], v5 offset:20992
    ds_read_b64_tr_b16 a[212:213], v5 offset:20544
    ds_read_b64_tr_b16 a[214:215], v5 offset:21056
    ds_read_b64_tr_b16 a[216:217], v5 offset:22528
    ds_read_b64_tr_b16 a[218:219], v5 offset:23040
    ds_read_b64_tr_b16 a[220:221], v5 offset:22592
    ds_read_b64_tr_b16 a[222:223], v5 offset:23104
    s_waitcnt lgkmcnt(0)
    s_waitcnt vmcnt(8)
    ds_read_b64_tr_b16 a[224:225], v5 offset:24576
    ds_read_b64_tr_b16 a[226:227], v5 offset:25088
    ds_read_b64_tr_b16 a[228:229], v5 offset:24640
    ds_read_b64_tr_b16 a[230:231], v5 offset:25152
    ds_read_b64_tr_b16 a[232:233], v5 offset:26624
    ds_read_b64_tr_b16 a[234:235], v5 offset:27136
    ds_read_b64_tr_b16 a[236:237], v5 offset:26688
    ds_read_b64_tr_b16 a[238:239], v5 offset:27200
    ds_read_b64_tr_b16 a[240:241], v5 offset:28672
    ds_read_b64_tr_b16 a[242:243], v5 offset:29184
    ds_read_b64_tr_b16 a[244:245], v5 offset:28736
    ds_read_b64_tr_b16 a[246:247], v5 offset:29248
    ds_read_b64_tr_b16 a[248:249], v5 offset:30720
    ds_read_b64_tr_b16 a[250:251], v5 offset:31232
    ds_read_b64_tr_b16 a[252:253], v5 offset:30784
    ds_read_b64_tr_b16 a[254:255], v5 offset:31296
    s_waitcnt lgkmcnt(0)
    s_waitcnt vmcnt(0)
    ds_read_b64_tr_b16 v[224:225], v5 offset:0
    ds_read_b64_tr_b16 v[226:227], v5 offset:512
    ds_read_b64_tr_b16 v[228:229], v5 offset:64
    ds_read_b64_tr_b16 v[230:231], v5 offset:576
    ds_read_b64_tr_b16 v[232:233], v5 offset:2048
    ds_read_b64_tr_b16 v[234:235], v5 offset:2560
    ds_read_b64_tr_b16 v[236:237], v5 offset:2112
    ds_read_b64_tr_b16 v[238:239], v5 offset:2624
    ds_read_b64_tr_b16 v[240:241], v5 offset:4096
    ds_read_b64_tr_b16 v[242:243], v5 offset:4608
    ds_read_b64_tr_b16 v[244:245], v5 offset:4160
    ds_read_b64_tr_b16 v[246:247], v5 offset:4672
    ds_read_b64_tr_b16 v[248:249], v5 offset:6144
    ds_read_b64_tr_b16 v[250:251], v5 offset:6656
    ds_read_b64_tr_b16 v[252:253], v5 offset:6208
    ds_read_b64_tr_b16 v[254:255], v5 offset:6720
    s_waitcnt lgkmcnt(0)
    s_and_b32 s24, s20, 15
    s_lshl_b32 s24, s24, 1
    s_lshr_b32 s25, s21, 1
    s_add_u32 s24, s24, s25
    s_lshl_b32 s50, s24, 13
    s_mul_i32 s25, s26, 16777216
    s_add_u32 s50, s50, s25
    s_add_u32 s50, s50, 4194304
    v_and_b32 v6, 31, v1
    v_lshrrev_b32 v7, 5, v1
    s_and_b32 s27, s21, 1
    s_cmp_eq_u32 s26, 2
    s_cbranch_scc1 isv_m_48
    v_lshrrev_b32 v4, 4, v6
    v_lshlrev_b32 v4, 12, v4
    v_and_b32 v5, 15, v6
    v_lshl_add_u32 v9, v5, 4, v4
    s_cmp_eq_u32 s26, 0
    s_cbranch_scc1 go_m_49
    v_bfe_u32 v4, v6, 3, 1
    v_lshlrev_b32 v4, 12, v4
    v_and_b32 v5, 7, v6
    v_lshl_add_u32 v9, v5, 4, v4
    v_lshrrev_b32 v5, 4, v6
    v_lshl_add_u32 v9, v5, 7, v9
    s_nop 1
go_m_49:
    v_lshl_add_u32 v9, v7, 8, v9
    s_lshl_b32 s27, s27, 11
    v_add_u32 v9, s27, v9
    s_mul_i32 s45, s21, 9216
    s_add_u32 s44, s45, 0
    s_mov_b32 s22, 0
    v_add_u32 v8, 36864, v2
    s_barrier
    s_load_dwordx2 s[30:31], s[0:1], 104
    s_waitcnt lgkmcnt(0)
    s_mov_b32 s16, s30
    s_and_b32 s17, s31, 65535
    s_mov_b32 s18, 256
    s_mov_b32 s19, 131072
L_m_50:
    s_sub_u32 s23, s23, 1
    s_cbranch_scc1 abqkv_m_46
    buffer_load_dword v3, off, s[16:19], 0 offset:64 sc1
    s_waitcnt vmcnt(0)
    v_cmp_eq_u32 vcc, 0, v3
    s_nop 0
    s_cbranch_vccnz L_m_50
    s_cmp_lg_u32 s21, 0
    s_cbranch_scc1 nopoll_m_51
    v_min_u32 v10, 63, v1
    v_mul_u32_u24 v10, 4, v10
    s_mov_b32 s29, 184287232
    buffer_load_dword v11, v10, s[4:7], s29 offen sc1
    s_waitcnt vmcnt(0)
    v_cmp_gt_u32 vcc, 1, v11
    s_nop 0
    s_cbranch_vccz fok_m_52
L_m_53:
    s_sleep 8
    s_sub_u32 s23, s23, 1
    s_cbranch_scc1 abqkv_m_46
    buffer_load_dword v11, v10, s[4:7], s29 offen sc1
    s_waitcnt vmcnt(0)
    v_cmp_gt_u32 vcc, 1, v11
    s_nop 0
    s_cbranch_vccnz L_m_53
fok_m_52:
nopoll_m_51:
    s_barrier
    s_add_u32 m0, s45, 0
    s_add_u32 s25, s44, 0
    buffer_load_dwordx4 v2, s[4:7], s25 offen lds
    s_add_u32 m0, s45, 1024
    s_add_u32 s25, s44, 1024
    buffer_load_dwordx4 v2, s[4:7], s25 offen lds
    s_add_u32 m0, s45, 2048
    s_add_u32 s25, s44, 2048
    buffer_load_dwordx4 v2, s[4:7], s25 offen lds
    s_add_u32 m0, s45, 3072
    s_add_u32 s25, s44, 3072
    buffer_load_dwordx4 v2, s[4:7], s25 offen lds
    s_add_u32 m0, s45, 4096
    s_add_u32 s25, s44, 4096
    buffer_load_dwordx4 v2, s[4:7], s25 offen lds
    s_add_u32 m0, s45, 5120
    s_add_u32 s25, s44, 5120
    buffer_load_dwordx4 v2, s[4:7], s25 offen lds
    s_add_u32 m0, s45, 6144
    s_add_u32 s25, s44, 6144
    buffer_load_dwordx4 v2, s[4:7], s25 offen lds
    s_add_u32 m0, s45, 7168
    s_add_u32 s25, s44, 7168
    buffer_load_dwordx4 v2, s[4:7], s25 offen lds
    s_add_u32 m0, s45, 8192
    s_add_u32 s25, s44, 8192
    buffer_load_dwordx4 v2, s[4:7], s25 offen lds
    s_waitcnt vmcnt(0)
L_m_54:
    s_add_u32 s44, s44, 36864
    s_waitcnt vmcnt(4)
    s_cmp_lg_u32 s21, 0
    s_cbranch_scc1 nopace_m_55
    s_cmp_le_u32 s22, 12
    s_cbranch_scc1 nopace_m_55
    s_sub_u32 s28, s22, 12
    s_and_b32 s27, s20, 15
    s_lshl_b32 s27, s27, 1
    v_min_u32 v10, 0, v1
    v_mul_u32_u24 v10, 4, v10
    s_lshr_b32 s29, s27, 0
    s_lshl_b32 s29, s29, 8
    s_add_u32 s29, s29, 184288256
    buffer_load_dword v11, v10, s[4:7], s29 offen sc1
    s_waitcnt vmcnt(0)
    v_cmp_gt_u32 vcc, s28, v11
    s_nop 0
    s_cbranch_vccz fok_m_56
L_m_57:
    s_sleep 8
    s_sub_u32 s23, s23, 1
    s_cbranch_scc1 abqkv_m_46
    buffer_load_dword v11, v10, s[4:7], s29 offen sc1
    s_waitcnt vmcnt(0)
    v_cmp_gt_u32 vcc, s28, v11
    s_nop 0
    s_cbranch_vccnz L_m_57
fok_m_56:
nopace_m_55:
    s_barrier
    s_max_u32 s28, s22, 1
    s_add_u32 s28, s28, -1
    s_cmp_lg_u32 s21, 0
    s_cbranch_scc1 noset_m_58
    s_lshr_b32 s29, s20, 6
    s_lshl_b32 s29, s29, 8
    s_and_b32 s92, s20, 63
    s_lshl_b32 s92, s92, 2
    s_add_u32 s29, s29, s92
    s_add_u32 s29, s29, 184287488
    v_mov_b32 v11, s28
    buffer_store_dword v11, off, s[4:7], s29 sc1
    s_nop 0
noset_m_58:
    s_cmp_ge_u32 s22, 63
    s_cbranch_scc1 nodma_m_59
    s_add_u32 m0, s45, 36864
    s_add_u32 s25, s44, 0
    buffer_load_dwordx4 v2, s[4:7], s25 offen lds
    s_add_u32 m0, s45, 37888
    s_add_u32 s25, s44, 1024
    buffer_load_dwordx4 v2, s[4:7], s25 offen lds
    s_add_u32 m0, s45, 38912
    s_add_u32 s25, s44, 2048
    buffer_load_dwordx4 v2, s[4:7], s25 offen lds
    s_add_u32 m0, s45, 39936
    s_add_u32 s25, s44, 3072
    buffer_load_dwordx4 v2, s[4:7], s25 offen lds
    s_add_u32 m0, s45, 40960
    s_add_u32 s25, s44, 4096
    buffer_load_dwordx4 v2, s[4:7], s25 offen lds
    s_add_u32 m0, s45, 41984
    s_add_u32 s25, s44, 5120
    buffer_load_dwordx4 v2, s[4:7], s25 offen lds
    s_add_u32 m0, s45, 43008
    s_add_u32 s25, s44, 6144
    buffer_load_dwordx4 v2, s[4:7], s25 offen lds
    s_add_u32 m0, s45, 44032
    s_add_u32 s25, s44, 7168
    buffer_load_dwordx4 v2, s[4:7], s25 offen lds
    s_add_u32 m0, s45, 45056
    s_add_u32 s25, s44, 8192
    buffer_load_dwordx4 v2, s[4:7], s25 offen lds
nodma_m_59:
    ds_read_b128 v[64:67], v2 offset:0
    ds_read_b128 v[68:71], v2 offset:1024
    ds_read_b128 v[72:75], v2 offset:2048
    ds_read_b128 v[76:79], v2 offset:3072
    ds_read_b128 v[80:83], v2 offset:4096
    ds_read_b128 v[84:87], v2 offset:5120
    s_waitcnt lgkmcnt(5)
    v_mfma_f32_32x32x16_bf16 v[16:31], a[0:3], v[64:67], 0
    v_mfma_f32_32x32x16_bf16 v[32:47], a[4:7], v[64:67], 0
    ds_read_b128 v[64:67], v2 offset:6144
    s_waitcnt lgkmcnt(5)
    v_mfma_f32_32x32x16_bf16 v[16:31], a[8:11], v[68:71], v[16:31]
    v_mfma_f32_32x32x16_bf16 v[32:47], a[12:15], v[68:71], v[32:47]
    ds_read_b128 v[68:71], v2 offset:7168
    s_waitcnt lgkmcnt(5)
    v_mfma_f32_32x32x16_bf16 v[16:31], a[16:19], v[72:75], v[16:31]
    v_mfma_f32_32x32x16_bf16 v[32:47], a[20:23], v[72:75], v[32:47]
    ds_read_b128 v[72:75], v2 offset:8192
    s_waitcnt lgkmcnt(5)
    v_mfma_f32_32x32x16_bf16 v[16:31], a[24:27], v[76:79], v[16:31]
    v_mfma_f32_32x32x16_bf16 v[32:47], a[28:31], v[76:79], v[32:47]
    ds_read_b128 v[76:79], v2 offset:9216
    s_waitcnt lgkmcnt(5)
    v_mfma_f32_32x32x16_bf16 v[16:31], a[32:35], v[80:83], v[16:31]
    v_mfma_f32_32x32x16_bf16 v[32:47], a[36:39], v[80:83], v[32:47]
    ds_read_b128 v[80:83], v2 offset:10240
    s_waitcnt lgkmcnt(5)
    v_mfma_f32_32x32x16_bf16 v[16:31], a[40:43], v[84:87], v[16:31]
    v_mfma_f32_32x32x16_bf16 v[32:47], a[44:47], v[84:87], v[32:47]
    ds_read_b128 v[84:87], v2 offset:11264
    s_waitcnt lgkmcnt(5)
    v_mfma_f32_32x32x16_bf16 v[16:31], a[48:51], v[64:67], v[16:31]
    v_mfma_f32_32x32x16_bf16 v[32:47], a[52:55], v[64:67], v[32:47]
    ds_read_b128 v[64:67], v2 offset:12288
    s_waitcnt lgkmcnt(5)
    v_mfma_f32_32x32x16_bf16 v[16:31], a[56:59], v[68:71], v[16:31]
    v_mfma_f32_32x32x16_bf16 v[32:47], a[60:63], v[68:71], v[32:47]
    ds_read_b128 v[68:71], v2 offset:13312
    s_waitcnt lgkmcnt(5)
    v_mfma_f32_32x32x16_bf16 v[16:31], a[64:67], v[72:75], v[16:31]
    v_mfma_f32_32x32x16_bf16 v[32:47], a[68:71], v[72:75], v[32:47]
    ds_read_b128 v[72:75], v2 offset:14336
    s_waitcnt lgkmcnt(5)
    v_mfma_f32_32x32x16_bf16 v[16:31], a[72:75], v[76:79], v[16:31]
    v_mfma_f32_32x32x16_bf16 v[32:47], a[76:79], v[76:79], v[32:47]
    ds_read_b128 v[76:79], v2 offset:15360
    s_waitcnt lgkmcnt(5)
    v_mfma_f32_32x32x16_bf16 v[16:31], a[80:83], v[80:83], v[16:31]
    v_mfma_f32_32x32x16_bf16 v[32:47], a[84:87], v[80:83], v[32:47]
    ds_read_b128 v[80:83], v2 offset:16384
    s_waitcnt lgkmcnt(5)
    v_mfma_f32_32x32x16_bf16 v[16:31], a[88:91], v[84:87], v[16:31]
    v_mfma_f32_32x32x16_bf16 v[32:47], a[92:95], v[84:87], v[32:47]
    ds_read_b128 v[84:87], v2 offset:17408
    s_waitcnt lgkmcnt(5)
    v_mfma_f32_32x32x16_bf16 v[16:31], a[96:99], v[64:67], v[16:31]
    v_mfma_f32_32x32x16_bf16 v[32:47], a[100:103], v[64:67], v[32:47]
    ds_read_b128 v[64:67], v2 offset:18432
    s_waitcnt lgkmcnt(5)
    v_mfma_f32_32x32x16_bf16 v[16:31], a[104:107], v[68:71], v[16:31]
    v_mfma_f32_32x32x16_bf16 v[32:47], a[108:111], v[68:71], v[32:47]
    ds_read_b128 v[68:71], v2 offset:19456
    s_waitcnt lgkmcnt(5)
    v_mfma_f32_32x32x16_bf16 v[16:31], a[112:115], v[72:75], v[16:31]
    v_mfma_f32_32x32x16_bf16 v[32:47], a[116:119], v[72:75], v[32:47]
    ds_read_b128 v[72:75], v2 offset:20480
    s_waitcnt lgkmcnt(5)
    v_mfma_f32_32x32x16_bf16 v[16:31], a[120:123], v[76:79], v[16:31]
    v_mfma_f32_32x32x16_bf16 v[32:47], a[124:127], v[76:79], v[32:47]
    ds_read_b128 v[76:79], v2 offset:21504
    s_waitcnt lgkmcnt(5)
    v_mfma_f32_32x32x16_bf16 v[16:31], a[128:131], v[80:83], v[16:31]
    v_mfma_f32_32x32x16_bf16 v[32:47], a[132:135], v[80:83], v[32:47]
    ds_read_b128 v[80:83], v2 offset:22528
    s_waitcnt lgkmcnt(5)
    v_mfma_f32_32x32x16_bf16 v[16:31], a[136:139], v[84:87], v[16:31]
    v_mfma_f32_32x32x16_bf16 v[32:47], a[140:143], v[84:87], v[32:47]
    ds_read_b128 v[84:87], v2 offset:23552
    s_waitcnt lgkmcnt(5)
    v_mfma_f32_32x32x16_bf16 v[16:31], a[144:147], v[64:67], v[16:31]
    v_mfma_f32_32x32x16_bf16 v[32:47], a[148:151], v[64:67], v[32:47]
    ds_read_b128 v[64:67], v2 offset:24576
    s_waitcnt lgkmcnt(5)
    v_mfma_f32_32x32x16_bf16 v[16:31], a[152:155], v[68:71], v[16:31]
    v_mfma_f32_32x32x16_bf16 v[32:47], a[156:159], v[68:71], v[32:47]
    ds_read_b128 v[68:71], v2 offset:25600
    s_waitcnt lgkmcnt(5)
    v_mfma_f32_32x32x16_bf16 v[16:31], a[160:163], v[72:75], v[16:31]
    v_mfma_f32_32x32x16_bf16 v[32:47], a[164:167], v[72:75], v[32:47]
    ds_read_b128 v[72:75], v2 offset:26624
    s_waitcnt lgkmcnt(5)
    v_mfma_f32_32x32x16_bf16 v[16:31], a[168:171], v[76:79], v[16:31]
    v_mfma_f32_32x32x16_bf16 v[32:47], a[172:175], v[76:79], v[32:47]
    ds_read_b128 v[76:79], v2 offset:27648
    s_waitcnt lgkmcnt(5)
    v_mfma_f32_32x32x16_bf16 v[16:31], a[176:179], v[80:83], v[16:31]
    v_mfma_f32_32x32x16_bf16 v[32:47], a[180:183], v[80:83], v[32:47]
    ds_read_b128 v[80:83], v2 offset:28672
    s_waitcnt lgkmcnt(5)
    v_mfma_f32_32x32x16_bf16 v[16:31], a[184:187], v[84:87], v[16:31]
    v_mfma_f32_32x32x16_bf16 v[32:47], a[188:191], v[84:87], v[32:47]
    ds_read_b128 v[84:87], v2 offset:29696
    s_waitcnt lgkmcnt(5)
    v_mfma_f32_32x32x16_bf16 v[16:31], a[192:195], v[64:67], v[16:31]
    v_mfma_f32_32x32x16_bf16 v[32:47], a[196:199], v[64:67], v[32:47]
    ds_read_b128 v[64:67], v2 offset:30720
    s_waitcnt lgkmcnt(5)
    v_mfma_f32_32x32x16_bf16 v[16:31], a[200:203], v[68:71], v[16:31]
    v_mfma_f32_32x32x16_bf16 v[32:47], a[204:207], v[68:71], v[32:47]
    ds_read_b128 v[68:71], v2 offset:31744
    s_waitcnt lgkmcnt(5)
    v_mfma_f32_32x32x16_bf16 v[16:31], a[208:211], v[72:75], v[16:31]
    v_mfma_f32_32x32x16_bf16 v[32:47], a[212:215], v[72:75], v[32:47]
    ds_read_b128 v[72:75], v2 offset:32768
    s_waitcnt lgkmcnt(5)
    v_mfma_f32_32x32x16_bf16 v[16:31], a[216:219], v[76:79], v[16:31]
    v_mfma_f32_32x32x16_bf16 v[32:47], a[220:223], v[76:79], v[32:47]
    ds_read_b128 v[76:79], v2 offset:33792
    s_waitcnt lgkmcnt(5)
    v_mfma_f32_32x32x16_bf16 v[16:31], a[224:227], v[80:83], v[16:31]
    v_mfma_f32_32x32x16_bf16 v[32:47], a[228:231], v[80:83], v[32:47]
    ds_read_b128 v[80:83], v2 offset:34816
    s_waitcnt lgkmcnt(5)
    v_mfma_f32_32x32x16_bf16 v[16:31], a[232:235], v[84:87], v[16:31]
    v_mfma_f32_32x32x16_bf16 v[32:47], a[236:239], v[84:87], v[32:47]
    ds_read_b128 v[84:87], v2 offset:35840
    s_waitcnt lgkmcnt(5)
    v_mfma_f32_32x32x16_bf16 v[16:31], a[240:243], v[64:67], v[16:31]
    v_mfma_f32_32x32x16_bf16 v[32:47], a[244:247], v[64:67], v[32:47]
    s_waitcnt lgkmcnt(4)
    v_mfma_f32_32x32x16_bf16 v[16:31], a[248:251], v[68:71], v[16:31]
    v_mfma_f32_32x32x16_bf16 v[32:47], a[252:255], v[68:71], v[32:47]
    s_waitcnt lgkmcnt(3)
    v_mfma_f32_32x32x16_bf16 v[16:31], v[224:227], v[72:75], v[16:31]
    v_mfma_f32_32x32x16_bf16 v[32:47], v[228:231], v[72:75], v[32:47]
    s_waitcnt lgkmcnt(2)
    v_mfma_f32_32x32x16_bf16 v[16:31], v[232:235], v[76:79], v[16:31]
    v_mfma_f32_32x32x16_bf16 v[32:47], v[236:239], v[76:79], v[32:47]
    s_waitcnt lgkmcnt(1)
    v_mfma_f32_32x32x16_bf16 v[16:31], v[240:243], v[80:83], v[16:31]
    v_mfma_f32_32x32x16_bf16 v[32:47], v[244:247], v[80:83], v[32:47]
    s_waitcnt lgkmcnt(0)
    v_mfma_f32_32x32x16_bf16 v[16:31], v[248:251], v[84:87], v[16:31]
    v_mfma_f32_32x32x16_bf16 v[32:47], v[252:255], v[84:87], v[32:47]
    s_lshl_b32 s24, s22, 18
    s_add_u32 s24, s24, s50
    s_nop 1
    v_cvt_pk_bf16_f32 v16, v16, v17
    v_cvt_pk_bf16_f32 v17, v18, v19
    v_cvt_pk_bf16_f32 v18, v20, v21
    v_cvt_pk_bf16_f32 v19, v22, v23
    v_cvt_pk_bf16_f32 v20, v24, v25
    v_cvt_pk_bf16_f32 v21, v26, v27
    v_cvt_pk_bf16_f32 v22, v28, v29
    v_cvt_pk_bf16_f32 v23, v30, v31
    buffer_store_dwordx4 v[16:19], v9, s[4:7], s24 offen offset:0 sc1
    buffer_store_dwordx4 v[20:23], v9, s[4:7], s24 offen offset:512 sc1
    v_cvt_pk_bf16_f32 v32, v32, v33
    v_cvt_pk_bf16_f32 v33, v34, v35
    v_cvt_pk_bf16_f32 v34, v36, v37
    v_cvt_pk_bf16_f32 v35, v38, v39
    v_cvt_pk_bf16_f32 v36, v40, v41
    v_cvt_pk_bf16_f32 v37, v42, v43
    v_cvt_pk_bf16_f32 v38, v44, v45
    v_cvt_pk_bf16_f32 v39, v46, v47
    buffer_store_dwordx4 v[32:35], v9, s[4:7], s24 offen offset:1024 sc1
    buffer_store_dwordx4 v[36:39], v9, s[4:7], s24 offen offset:1536 sc1
    s_add_u32 s22, s22, 1
    s_cmp_gt_u32 s22, 3
    s_cbranch_scc1 late_m_60
    s_waitcnt vmcnt(0)
    s_barrier
    s_max_u32 s28, s22, 0
    s_add_u32 s28, s28, 0
    s_cmp_lg_u32 s21, 0
    s_cbranch_scc1 noset_m_61
    s_lshr_b32 s29, s20, 6
    s_lshl_b32 s29, s29, 8
    s_and_b32 s92, s20, 63
    s_lshl_b32 s92, s92, 2
    s_add_u32 s29, s29, s92
    s_add_u32 s29, s29, 184287488
    v_mov_b32 v11, s28
    buffer_store_dword v11, off, s[4:7], s29 sc1
    s_nop 0
noset_m_61:
late_m_60:
    s_add_u32 s44, s44, 36864
    s_waitcnt vmcnt(4)
    s_cmp_lg_u32 s21, 0
    s_cbranch_scc1 nopace_m_62
    s_cmp_le_u32 s22, 12
    s_cbranch_scc1 nopace_m_62
    s_sub_u32 s28, s22, 12
    s_and_b32 s27, s20, 15
    s_lshl_b32 s27, s27, 1
    v_min_u32 v10, 0, v1
    v_mul_u32_u24 v10, 4, v10
    s_lshr_b32 s29, s27, 0
    s_lshl_b32 s29, s29, 8
    s_add_u32 s29, s29, 184288256
    buffer_load_dword v11, v10, s[4:7], s29 offen sc1
    s_waitcnt vmcnt(0)
    v_cmp_gt_u32 vcc, s28, v11
    s_nop 0
    s_cbranch_vccz fok_m_63
L_m_64:
    s_sleep 8
    s_sub_u32 s23, s23, 1
    s_cbranch_scc1 abqkv_m_46
    buffer_load_dword v11, v10, s[4:7], s29 offen sc1
    s_waitcnt vmcnt(0)
    v_cmp_gt_u32 vcc, s28, v11
    s_nop 0
    s_cbranch_vccnz L_m_64
fok_m_63:
nopace_m_62:
    s_barrier
    s_max_u32 s28, s22, 1
    s_add_u32 s28, s28, -1
    s_cmp_lg_u32 s21, 0
    s_cbranch_scc1 noset_m_65
    s_lshr_b32 s29, s20, 6
    s_lshl_b32 s29, s29, 8
    s_and_b32 s92, s20, 63
    s_lshl_b32 s92, s92, 2
    s_add_u32 s29, s29, s92
    s_add_u32 s29, s29, 184287488
    v_mov_b32 v11, s28
    buffer_store_dword v11, off, s[4:7], s29 sc1
    s_nop 0
noset_m_65:
    s_cmp_ge_u32 s22, 63
    s_cbranch_scc1 nodma_m_66
    s_add_u32 m0, s45, 0
    s_add_u32 s25, s44, 0
    buffer_load_dwordx4 v2, s[4:7], s25 offen lds
    s_add_u32 m0, s45, 1024
    s_add_u32 s25, s44, 1024
    buffer_load_dwordx4 v2, s[4:7], s25 offen lds
    s_add_u32 m0, s45, 2048
    s_add_u32 s25, s44, 2048
    buffer_load_dwordx4 v2, s[4:7], s25 offen lds
    s_add_u32 m0, s45, 3072
    s_add_u32 s25, s44, 3072
    buffer_load_dwordx4 v2, s[4:7], s25 offen lds
    s_add_u32 m0, s45, 4096
    s_add_u32 s25, s44, 4096
    buffer_load_dwordx4 v2, s[4:7], s25 offen lds
    s_add_u32 m0, s45, 5120
    s_add_u32 s25, s44, 5120
    buffer_load_dwordx4 v2, s[4:7], s25 offen lds
    s_add_u32 m0, s45, 6144
    s_add_u32 s25, s44, 6144
    buffer_load_dwordx4 v2, s[4:7], s25 offen lds
    s_add_u32 m0, s45, 7168
    s_add_u32 s25, s44, 7168
    buffer_load_dwordx4 v2, s[4:7], s25 offen lds
    s_add_u32 m0, s45, 8192
    s_add_u32 s25, s44, 8192
    buffer_load_dwordx4 v2, s[4:7], s25 offen lds
nodma_m_66:
    ds_read_b128 v[64:67], v8 offset:0
    ds_read_b128 v[68:71], v8 offset:1024
    ds_read_b128 v[72:75], v8 offset:2048
    ds_read_b128 v[76:79], v8 offset:3072
    ds_read_b128 v[80:83], v8 offset:4096
    ds_read_b128 v[84:87], v8 offset:5120
    s_waitcnt lgkmcnt(5)
    v_mfma_f32_32x32x16_bf16 v[16:31], a[0:3], v[64:67], 0
    v_mfma_f32_32x32x16_bf16 v[32:47], a[4:7], v[64:67], 0
    ds_read_b128 v[64:67], v8 offset:6144
    s_waitcnt lgkmcnt(5)
    v_mfma_f32_32x32x16_bf16 v[16:31], a[8:11], v[68:71], v[16:31]
    v_mfma_f32_32x32x16_bf16 v[32:47], a[12:15], v[68:71], v[32:47]
    ds_read_b128 v[68:71], v8 offset:7168
    s_waitcnt lgkmcnt(5)
    v_mfma_f32_32x32x16_bf16 v[16:31], a[16:19], v[72:75], v[16:31]
    v_mfma_f32_32x32x16_bf16 v[32:47], a[20:23], v[72:75], v[32:47]
    ds_read_b128 v[72:75], v8 offset:8192
    s_waitcnt lgkmcnt(5)
    v_mfma_f32_32x32x16_bf16 v[16:31], a[24:27], v[76:79], v[16:31]
    v_mfma_f32_32x32x16_bf16 v[32:47], a[28:31], v[76:79], v[32:47]
    ds_read_b128 v[76:79], v8 offset:9216
    s_waitcnt lgkmcnt(5)
    v_mfma_f32_32x32x16_bf16 v[16:31], a[32:35], v[80:83], v[16:31]
    v_mfma_f32_32x32x16_bf16 v[32:47], a[36:39], v[80:83], v[32:47]
    ds_read_b128 v[80:83], v8 offset:10240
    s_waitcnt lgkmcnt(5)
    v_mfma_f32_32x32x16_bf16 v[16:31], a[40:43], v[84:87], v[16:31]
    v_mfma_f32_32x32x16_bf16 v[32:47], a[44:47], v[84:87], v[32:47]
    ds_read_b128 v[84:87], v8 offset:11264
    s_waitcnt lgkmcnt(5)
    v_mfma_f32_32x32x16_bf16 v[16:31], a[48:51], v[64:67], v[16:31]
    v_mfma_f32_32x32x16_bf16 v[32:47], a[52:55], v[64:67], v[32:47]
    ds_read_b128 v[64:67], v8 offset:12288
    s_waitcnt lgkmcnt(5)
    v_mfma_f32_32x32x16_bf16 v[16:31], a[56:59], v[68:71], v[16:31]
    v_mfma_f32_32x32x16_bf16 v[32:47], a[60:63], v[68:71], v[32:47]
    ds_read_b128 v[68:71], v8 offset:13312
    s_waitcnt lgkmcnt(5)
    v_mfma_f32_32x32x16_bf16 v[16:31], a[64:67], v[72:75], v[16:31]
    v_mfma_f32_32x32x16_bf16 v[32:47], a[68:71], v[72:75], v[32:47]
    ds_read_b128 v[72:75], v8 offset:14336
    s_waitcnt lgkmcnt(5)
    v_mfma_f32_32x32x16_bf16 v[16:31], a[72:75], v[76:79], v[16:31]
    v_mfma_f32_32x32x16_bf16 v[32:47], a[76:79], v[76:79], v[32:47]
    ds_read_b128 v[76:79], v8 offset:15360
    s_waitcnt lgkmcnt(5)
    v_mfma_f32_32x32x16_bf16 v[16:31], a[80:83], v[80:83], v[16:31]
    v_mfma_f32_32x32x16_bf16 v[32:47], a[84:87], v[80:83], v[32:47]
    ds_read_b128 v[80:83], v8 offset:16384
    s_waitcnt lgkmcnt(5)
    v_mfma_f32_32x32x16_bf16 v[16:31], a[88:91], v[84:87], v[16:31]
    v_mfma_f32_32x32x16_bf16 v[32:47], a[92:95], v[84:87], v[32:47]
    ds_read_b128 v[84:87], v8 offset:17408
    s_waitcnt lgkmcnt(5)
    v_mfma_f32_32x32x16_bf16 v[16:31], a[96:99], v[64:67], v[16:31]
    v_mfma_f32_32x32x16_bf16 v[32:47], a[100:103], v[64:67], v[32:47]
    ds_read_b128 v[64:67], v8 offset:18432
    s_waitcnt lgkmcnt(5)
    v_mfma_f32_32x32x16_bf16 v[16:31], a[104:107], v[68:71], v[16:31]
    v_mfma_f32_32x32x16_bf16 v[32:47], a[108:111], v[68:71], v[32:47]
    ds_read_b128 v[68:71], v8 offset:19456
    s_waitcnt lgkmcnt(5)
    v_mfma_f32_32x32x16_bf16 v[16:31], a[112:115], v[72:75], v[16:31]
    v_mfma_f32_32x32x16_bf16 v[32:47], a[116:119], v[72:75], v[32:47]
    ds_read_b128 v[72:75], v8 offset:20480
    s_waitcnt lgkmcnt(5)
    v_mfma_f32_32x32x16_bf16 v[16:31], a[120:123], v[76:79], v[16:31]
    v_mfma_f32_32x32x16_bf16 v[32:47], a[124:127], v[76:79], v[32:47]
    ds_read_b128 v[76:79], v8 offset:21504
    s_waitcnt lgkmcnt(5)
    v_mfma_f32_32x32x16_bf16 v[16:31], a[128:131], v[80:83], v[16:31]
    v_mfma_f32_32x32x16_bf16 v[32:47], a[132:135], v[80:83], v[32:47]
    ds_read_b128 v[80:83], v8 offset:22528
    s_waitcnt lgkmcnt(5)
    v_mfma_f32_32x32x16_bf16 v[16:31], a[136:139], v[84:87], v[16:31]
    v_mfma_f32_32x32x16_bf16 v[32:47], a[140:143], v[84:87], v[32:47]
    ds_read_b128 v[84:87], v8 offset:23552
    s_waitcnt lgkmcnt(5)
    v_mfma_f32_32x32x16_bf16 v[16:31], a[144:147], v[64:67], v[16:31]
    v_mfma_f32_32x32x16_bf16 v[32:47], a[148:151], v[64:67], v[32:47]
    ds_read_b128 v[64:67], v8 offset:24576
    s_waitcnt lgkmcnt(5)
    v_mfma_f32_32x32x16_bf16 v[16:31], a[152:155], v[68:71], v[16:31]
    v_mfma_f32_32x32x16_bf16 v[32:47], a[156:159], v[68:71], v[32:47]
    ds_read_b128 v[68:71], v8 offset:25600
    s_waitcnt lgkmcnt(5)
    v_mfma_f32_32x32x16_bf16 v[16:31], a[160:163], v[72:75], v[16:31]
    v_mfma_f32_32x32x16_bf16 v[32:47], a[164:167], v[72:75], v[32:47]
    ds_read_b128 v[72:75], v8 offset:26624
    s_waitcnt lgkmcnt(5)
    v_mfma_f32_32x32x16_bf16 v[16:31], a[168:171], v[76:79], v[16:31]
    v_mfma_f32_32x32x16_bf16 v[32:47], a[172:175], v[76:79], v[32:47]
    ds_read_b128 v[76:79], v8 offset:27648
    s_waitcnt lgkmcnt(5)
    v_mfma_f32_32x32x16_bf16 v[16:31], a[176:179], v[80:83], v[16:31]
    v_mfma_f32_32x32x16_bf16 v[32:47], a[180:183], v[80:83], v[32:47]
    ds_read_b128 v[80:83], v8 offset:28672
    s_waitcnt lgkmcnt(5)
    v_mfma_f32_32x32x16_bf16 v[16:31], a[184:187], v[84:87], v[16:31]
    v_mfma_f32_32x32x16_bf16 v[32:47], a[188:191], v[84:87], v[32:47]
    ds_read_b128 v[84:87], v8 offset:29696
    s_waitcnt lgkmcnt(5)
    v_mfma_f32_32x32x16_bf16 v[16:31], a[192:195], v[64:67], v[16:31]
    v_mfma_f32_32x32x16_bf16 v[32:47], a[196:199], v[64:67], v[32:47]
    ds_read_b128 v[64:67], v8 offset:30720
    s_waitcnt lgkmcnt(5)
    v_mfma_f32_32x32x16_bf16 v[16:31], a[200:203], v[68:71], v[16:31]
    v_mfma_f32_32x32x16_bf16 v[32:47], a[204:207], v[68:71], v[32:47]
    ds_read_b128 v[68:71], v8 offset:31744
    s_waitcnt lgkmcnt(5)
    v_mfma_f32_32x32x16_bf16 v[16:31], a[208:211], v[72:75], v[16:31]
    v_mfma_f32_32x32x16_bf16 v[32:47], a[212:215], v[72:75], v[32:47]
    ds_read_b128 v[72:75], v8 offset:32768
    s_waitcnt lgkmcnt(5)
    v_mfma_f32_32x32x16_bf16 v[16:31], a[216:219], v[76:79], v[16:31]
    v_mfma_f32_32x32x16_bf16 v[32:47], a[220:223], v[76:79], v[32:47]
    ds_read_b128 v[76:79], v8 offset:33792
    s_waitcnt lgkmcnt(5)
    v_mfma_f32_32x32x16_bf16 v[16:31], a[224:227], v[80:83], v[16:31]
    v_mfma_f32_32x32x16_bf16 v[32:47], a[228:231], v[80:83], v[32:47]
    ds_read_b128 v[80:83], v8 offset:34816
    s_waitcnt lgkmcnt(5)
    v_mfma_f32_32x32x16_bf16 v[16:31], a[232:235], v[84:87], v[16:31]
    v_mfma_f32_32x32x16_bf16 v[32:47], a[236:239], v[84:87], v[32:47]
    ds_read_b128 v[84:87], v8 offset:35840
    s_waitcnt lgkmcnt(5)
    v_mfma_f32_32x32x16_bf16 v[16:31], a[240:243], v[64:67], v[16:31]
    v_mfma_f32_32x32x16_bf16 v[32:47], a[244:247], v[64:67], v[32:47]
    s_waitcnt lgkmcnt(4)
    v_mfma_f32_32x32x16_bf16 v[16:31], a[248:251], v[68:71], v[16:31]
    v_mfma_f32_32x32x16_bf16 v[32:47], a[252:255], v[68:71], v[32:47]
    s_waitcnt lgkmcnt(3)
    v_mfma_f32_32x32x16_bf16 v[16:31], v[224:227], v[72:75], v[16:31]
    v_mfma_f32_32x32x16_bf16 v[32:47], v[228:231], v[72:75], v[32:47]
    s_waitcnt lgkmcnt(2)
    v_mfma_f32_32x32x16_bf16 v[16:31], v[232:235], v[76:79], v[16:31]
    v_mfma_f32_32x32x16_bf16 v[32:47], v[236:239], v[76:79], v[32:47]
    s_waitcnt lgkmcnt(1)
    v_mfma_f32_32x32x16_bf16 v[16:31], v[240:243], v[80:83], v[16:31]
    v_mfma_f32_32x32x16_bf16 v[32:47], v[244:247], v[80:83], v[32:47]
    s_waitcnt lgkmcnt(0)
    v_mfma_f32_32x32x16_bf16 v[16:31], v[248:251], v[84:87], v[16:31]
    v_mfma_f32_32x32x16_bf16 v[32:47], v[252:255], v[84:87], v[32:47]
    s_lshl_b32 s24, s22, 18
    s_add_u32 s24, s24, s50
    s_nop 1
    v_cvt_pk_bf16_f32 v16, v16, v17
    v_cvt_pk_bf16_f32 v17, v18, v19
    v_cvt_pk_bf16_f32 v18, v20, v21
    v_cvt_pk_bf16_f32 v19, v22, v23
    v_cvt_pk_bf16_f32 v20, v24, v25
    v_cvt_pk_bf16_f32 v21, v26, v27
    v_cvt_pk_bf16_f32 v22, v28, v29
    v_cvt_pk_bf16_f32 v23, v30, v31
    buffer_store_dwordx4 v[16:19], v9, s[4:7], s24 offen offset:0 sc1
    buffer_store_dwordx4 v[20:23], v9, s[4:7], s24 offen offset:512 sc1
    v_cvt_pk_bf16_f32 v32, v32, v33
    v_cvt_pk_bf16_f32 v33, v34, v35
    v_cvt_pk_bf16_f32 v34, v36, v37
    v_cvt_pk_bf16_f32 v35, v38, v39
    v_cvt_pk_bf16_f32 v36, v40, v41
    v_cvt_pk_bf16_f32 v37, v42, v43
    v_cvt_pk_bf16_f32 v38, v44, v45
    v_cvt_pk_bf16_f32 v39, v46, v47
    buffer_store_dwordx4 v[32:35], v9, s[4:7], s24 offen offset:1024 sc1
    buffer_store_dwordx4 v[36:39], v9, s[4:7], s24 offen offset:1536 sc1
    s_add_u32 s22, s22, 1
    s_cmp_gt_u32 s22, 3
    s_cbranch_scc1 late_m_67
    s_waitcnt vmcnt(0)
    s_barrier
    s_max_u32 s28, s22, 0
    s_add_u32 s28, s28, 0
    s_cmp_lg_u32 s21, 0
    s_cbranch_scc1 noset_m_68
    s_lshr_b32 s29, s20, 6
    s_lshl_b32 s29, s29, 8
    s_and_b32 s92, s20, 63
    s_lshl_b32 s92, s92, 2
    s_add_u32 s29, s29, s92
    s_add_u32 s29, s29, 184287488
    v_mov_b32 v11, s28
    buffer_store_dword v11, off, s[4:7], s29 sc1
    s_nop 0
noset_m_68:
late_m_67:
    s_cmp_lt_u32 s22, 64
    s_cbranch_scc1 L_m_54
    s_waitcnt vmcnt(0)
    s_barrier
    s_max_u32 s28, s22, 0
    s_add_u32 s28, s28, 0
    s_cmp_lg_u32 s21, 0
    s_cbranch_scc1 noset_m_69
    s_lshr_b32 s29, s20, 6
    s_lshl_b32 s29, s29, 8
    s_and_b32 s92, s20, 63
    s_lshl_b32 s92, s92, 2
    s_add_u32 s29, s29, s92
    s_add_u32 s29, s29, 184287488
    v_mov_b32 v11, s28
    buffer_store_dword v11, off, s[4:7], s29 sc1
    s_nop 0
noset_m_69:
    s_branch qdone_m_70
isv_m_48:
    v_lshrrev_b32 v4, 4, v6
    v_lshlrev_b32 v4, 10, v4
    v_and_b32 v5, 15, v6
    v_lshl_add_u32 v9, v5, 4, v4
    v_lshl_add_u32 v9, v7, 8, v9
    s_lshl_b32 s27, s27, 12
    v_add_u32 v9, s27, v9
    s_mul_i32 s45, s21, 9216
    s_add_u32 s44, s45, 0
    s_mov_b32 s22, 0
    v_add_u32 v8, 36864, v2
    s_barrier
    s_load_dwordx2 s[30:31], s[0:1], 104
    s_waitcnt lgkmcnt(0)
    s_mov_b32 s16, s30
    s_and_b32 s17, s31, 65535
    s_mov_b32 s18, 256
    s_mov_b32 s19, 131072
L_m_71:
    s_sub_u32 s23, s23, 1
    s_cbranch_scc1 abqkv_m_46
    buffer_load_dword v3, off, s[16:19], 0 offset:64 sc1
    s_waitcnt vmcnt(0)
    v_cmp_eq_u32 vcc, 0, v3
    s_nop 0
    s_cbranch_vccnz L_m_71
    s_cmp_lg_u32 s21, 0
    s_cbranch_scc1 nopoll_m_72
    v_min_u32 v10, 63, v1
    v_mul_u32_u24 v10, 4, v10
    s_mov_b32 s29, 184287232
    buffer_load_dword v11, v10, s[4:7], s29 offen sc1
    s_waitcnt vmcnt(0)
    v_cmp_gt_u32 vcc, 1, v11
    s_nop 0
    s_cbranch_vccz fok_m_73
L_m_74:
    s_sleep 8
    s_sub_u32 s23, s23, 1
    s_cbranch_scc1 abqkv_m_46
    buffer_load_dword v11, v10, s[4:7], s29 offen sc1
    s_waitcnt vmcnt(0)
    v_cmp_gt_u32 vcc, 1, v11
    s_nop 0
    s_cbranch_vccnz L_m_74
fok_m_73:
nopoll_m_72:
    s_barrier
    s_add_u32 m0, s45, 0
    s_add_u32 s25, s44, 0
    buffer_load_dwordx4 v2, s[4:7], s25 offen lds
    s_add_u32 m0, s45, 1024
    s_add_u32 s25, s44, 1024
    buffer_load_dwordx4 v2, s[4:7], s25 offen lds
    s_add_u32 m0, s45, 2048
    s_add_u32 s25, s44, 2048
    buffer_load_dwordx4 v2, s[4:7], s25 offen lds
    s_add_u32 m0, s45, 3072
    s_add_u32 s25, s44, 3072
    buffer_load_dwordx4 v2, s[4:7], s25 offen lds
    s_add_u32 m0, s45, 4096
    s_add_u32 s25, s44, 4096
    buffer_load_dwordx4 v2, s[4:7], s25 offen lds
    s_add_u32 m0, s45, 5120
    s_add_u32 s25, s44, 5120
    buffer_load_dwordx4 v2, s[4:7], s25 offen lds
    s_add_u32 m0, s45, 6144
    s_add_u32 s25, s44, 6144
    buffer_load_dwordx4 v2, s[4:7], s25 offen lds
    s_add_u32 m0, s45, 7168
    s_add_u32 s25, s44, 7168
    buffer_load_dwordx4 v2, s[4:7], s25 offen lds
    s_add_u32 m0, s45, 8192
    s_add_u32 s25, s44, 8192
    buffer_load_dwordx4 v2, s[4:7], s25 offen lds
    s_waitcnt vmcnt(0)
L_m_75:
    s_add_u32 s44, s44, 36864
    s_waitcnt vmcnt(4)
    s_cmp_lg_u32 s21, 0
    s_cbranch_scc1 nopace_m_76
    s_cmp_le_u32 s22, 12
    s_cbranch_scc1 nopace_m_76
    s_sub_u32 s28, s22, 12
    s_and_b32 s27, s20, 15
    s_lshl_b32 s27, s27, 1
    v_min_u32 v10, 0, v1
    v_mul_u32_u24 v10, 4, v10
    s_lshr_b32 s29, s27, 0
    s_lshl_b32 s29, s29, 8
    s_add_u32 s29, s29, 184288256
    buffer_load_dword v11, v10, s[4:7], s29 offen sc1
    s_waitcnt vmcnt(0)
    v_cmp_gt_u32 vcc, s28, v11
    s_nop 0
    s_cbranch_vccz fok_m_77
L_m_78:
    s_sleep 8
    s_sub_u32 s23, s23, 1
    s_cbranch_scc1 abqkv_m_46
    buffer_load_dword v11, v10, s[4:7], s29 offen sc1
    s_waitcnt vmcnt(0)
    v_cmp_gt_u32 vcc, s28, v11
    s_nop 0
    s_cbranch_vccnz L_m_78
fok_m_77:
nopace_m_76:
    s_barrier
    s_max_u32 s28, s22, 1
    s_add_u32 s28, s28, -1
    s_cmp_lg_u32 s21, 0
    s_cbranch_scc1 noset_m_79
    s_lshr_b32 s29, s20, 6
    s_lshl_b32 s29, s29, 8
    s_and_b32 s92, s20, 63
    s_lshl_b32 s92, s92, 2
    s_add_u32 s29, s29, s92
    s_add_u32 s29, s29, 184287488
    v_mov_b32 v11, s28
    buffer_store_dword v11, off, s[4:7], s29 sc1
    s_nop 0
noset_m_79:
    s_cmp_ge_u32 s22, 63
    s_cbranch_scc1 nodma_m_80
    s_add_u32 m0, s45, 36864
    s_add_u32 s25, s44, 0
    buffer_load_dwordx4 v2, s[4:7], s25 offen lds
    s_add_u32 m0, s45, 37888
    s_add_u32 s25, s44, 1024
    buffer_load_dwordx4 v2, s[4:7], s25 offen lds
    s_add_u32 m0, s45, 38912
    s_add_u32 s25, s44, 2048
    buffer_load_dwordx4 v2, s[4:7], s25 offen lds
    s_add_u32 m0, s45, 39936
    s_add_u32 s25, s44, 3072
    buffer_load_dwordx4 v2, s[4:7], s25 offen lds
    s_add_u32 m0, s45, 40960
    s_add_u32 s25, s44, 4096
    buffer_load_dwordx4 v2, s[4:7], s25 offen lds
    s_add_u32 m0, s45, 41984
    s_add_u32 s25, s44, 5120
    buffer_load_dwordx4 v2, s[4:7], s25 offen lds
    s_add_u32 m0, s45, 43008
    s_add_u32 s25, s44, 6144
    buffer_load_dwordx4 v2, s[4:7], s25 offen lds
    s_add_u32 m0, s45, 44032
    s_add_u32 s25, s44, 7168
    buffer_load_dwordx4 v2, s[4:7], s25 offen lds
    s_add_u32 m0, s45, 45056
    s_add_u32 s25, s44, 8192
    buffer_load_dwordx4 v2, s[4:7], s25 offen lds
nodma_m_80:
    ds_read_b128 v[64:67], v2 offset:0
    ds_read_b128 v[68:71], v2 offset:1024
    ds_read_b128 v[72:75], v2 offset:2048
    ds_read_b128 v[76:79], v2 offset:3072
    ds_read_b128 v[80:83], v2 offset:4096
    ds_read_b128 v[84:87], v2 offset:5120
    s_waitcnt lgkmcnt(5)
    v_mfma_f32_32x32x16_bf16 v[16:31], v[64:67], a[0:3], 0
    v_mfma_f32_32x32x16_bf16 v[32:47], v[64:67], a[4:7], 0
    ds_read_b128 v[64:67], v2 offset:6144
    s_waitcnt lgkmcnt(5)
    v_mfma_f32_32x32x16_bf16 v[16:31], v[68:71], a[8:11], v[16:31]
    v_mfma_f32_32x32x16_bf16 v[32:47], v[68:71], a[12:15], v[32:47]
    ds_read_b128 v[68:71], v2 offset:7168
    s_waitcnt lgkmcnt(5)
    v_mfma_f32_32x32x16_bf16 v[16:31], v[72:75], a[16:19], v[16:31]
    v_mfma_f32_32x32x16_bf16 v[32:47], v[72:75], a[20:23], v[32:47]
    ds_read_b128 v[72:75], v2 offset:8192
    s_waitcnt lgkmcnt(5)
    v_mfma_f32_32x32x16_bf16 v[16:31], v[76:79], a[24:27], v[16:31]
    v_mfma_f32_32x32x16_bf16 v[32:47], v[76:79], a[28:31], v[32:47]
    ds_read_b128 v[76:79], v2 offset:9216
    s_waitcnt lgkmcnt(5)
    v_mfma_f32_32x32x16_bf16 v[16:31], v[80:83], a[32:35], v[16:31]
    v_mfma_f32_32x32x16_bf16 v[32:47], v[80:83], a[36:39], v[32:47]
    ds_read_b128 v[80:83], v2 offset:10240
    s_waitcnt lgkmcnt(5)
    v_mfma_f32_32x32x16_bf16 v[16:31], v[84:87], a[40:43], v[16:31]
    v_mfma_f32_32x32x16_bf16 v[32:47], v[84:87], a[44:47], v[32:47]
    ds_read_b128 v[84:87], v2 offset:11264
    s_waitcnt lgkmcnt(5)
    v_mfma_f32_32x32x16_bf16 v[16:31], v[64:67], a[48:51], v[16:31]
    v_mfma_f32_32x32x16_bf16 v[32:47], v[64:67], a[52:55], v[32:47]
    ds_read_b128 v[64:67], v2 offset:12288
    s_waitcnt lgkmcnt(5)
    v_mfma_f32_32x32x16_bf16 v[16:31], v[68:71], a[56:59], v[16:31]
    v_mfma_f32_32x32x16_bf16 v[32:47], v[68:71], a[60:63], v[32:47]
    ds_read_b128 v[68:71], v2 offset:13312
    s_waitcnt lgkmcnt(5)
    v_mfma_f32_32x32x16_bf16 v[16:31], v[72:75], a[64:67], v[16:31]
    v_mfma_f32_32x32x16_bf16 v[32:47], v[72:75], a[68:71], v[32:47]
    ds_read_b128 v[72:75], v2 offset:14336
    s_waitcnt lgkmcnt(5)
    v_mfma_f32_32x32x16_bf16 v[16:31], v[76:79], a[72:75], v[16:31]
    v_mfma_f32_32x32x16_bf16 v[32:47], v[76:79], a[76:79], v[32:47]
    ds_read_b128 v[76:79], v2 offset:15360
    s_waitcnt lgkmcnt(5)
    v_mfma_f32_32x32x16_bf16 v[16:31], v[80:83], a[80:83], v[16:31]
    v_mfma_f32_32x32x16_bf16 v[32:47], v[80:83], a[84:87], v[32:47]
    ds_read_b128 v[80:83], v2 offset:16384
    s_waitcnt lgkmcnt(5)
    v_mfma_f32_32x32x16_bf16 v[16:31], v[84:87], a[88:91], v[16:31]
    v_mfma_f32_32x32x16_bf16 v[32:47], v[84:87], a[92:95], v[32:47]
    ds_read_b128 v[84:87], v2 offset:17408
    s_waitcnt lgkmcnt(5)
    v_mfma_f32_32x32x16_bf16 v[16:31], v[64:67], a[96:99], v[16:31]
    v_mfma_f32_32x32x16_bf16 v[32:47], v[64:67], a[100:103], v[32:47]
    ds_read_b128 v[64:67], v2 offset:18432
    s_waitcnt lgkmcnt(5)
    v_mfma_f32_32x32x16_bf16 v[16:31], v[68:71], a[104:107], v[16:31]
    v_mfma_f32_32x32x16_bf16 v[32:47], v[68:71], a[108:111], v[32:47]
    ds_read_b128 v[68:71], v2 offset:19456
    s_waitcnt lgkmcnt(5)
    v_mfma_f32_32x32x16_bf16 v[16:31], v[72:75], a[112:115], v[16:31]
    v_mfma_f32_32x32x16_bf16 v[32:47], v[72:75], a[116:119], v[32:47]
    ds_read_b128 v[72:75], v2 offset:20480
    s_waitcnt lgkmcnt(5)
    v_mfma_f32_32x32x16_bf16 v[16:31], v[76:79], a[120:123], v[16:31]
    v_mfma_f32_32x32x16_bf16 v[32:47], v[76:79], a[124:127], v[32:47]
    ds_read_b128 v[76:79], v2 offset:21504
    s_waitcnt lgkmcnt(5)
    v_mfma_f32_32x32x16_bf16 v[16:31], v[80:83], a[128:131], v[16:31]
    v_mfma_f32_32x32x16_bf16 v[32:47], v[80:83], a[132:135], v[32:47]
    ds_read_b128 v[80:83], v2 offset:22528
    s_waitcnt lgkmcnt(5)
    v_mfma_f32_32x32x16_bf16 v[16:31], v[84:87], a[136:139], v[16:31]
    v_mfma_f32_32x32x16_bf16 v[32:47], v[84:87], a[140:143], v[32:47]
    ds_read_b128 v[84:87], v2 offset:23552
    s_waitcnt lgkmcnt(5)
    v_mfma_f32_32x32x16_bf16 v[16:31], v[64:67], a[144:147], v[16:31]
    v_mfma_f32_32x32x16_bf16 v[32:47], v[64:67], a[148:151], v[32:47]
    ds_read_b128 v[64:67], v2 offset:24576
    s_waitcnt lgkmcnt(5)
    v_mfma_f32_32x32x16_bf16 v[16:31], v[68:71], a[152:155], v[16:31]
    v_mfma_f32_32x32x16_bf16 v[32:47], v[68:71], a[156:159], v[32:47]
    ds_read_b128 v[68:71], v2 offset:25600
    s_waitcnt lgkmcnt(5)
    v_mfma_f32_32x32x16_bf16 v[16:31], v[72:75], a[160:163], v[16:31]
    v_mfma_f32_32x32x16_bf16 v[32:47], v[72:75], a[164:167], v[32:47]
    ds_read_b128 v[72:75], v2 offset:26624
    s_waitcnt lgkmcnt(5)
    v_mfma_f32_32x32x16_bf16 v[16:31], v[76:79], a[168:171], v[16:31]
    v_mfma_f32_32x32x16_bf16 v[32:47], v[76:79], a[172:175], v[32:47]
    ds_read_b128 v[76:79], v2 offset:27648
    s_waitcnt lgkmcnt(5)
    v_mfma_f32_32x32x16_bf16 v[16:31], v[80:83], a[176:179], v[16:31]
    v_mfma_f32_32x32x16_bf16 v[32:47], v[80:83], a[180:183], v[32:47]
    ds_read_b128 v[80:83], v2 offset:28672
    s_waitcnt lgkmcnt(5)
    v_mfma_f32_32x32x16_bf16 v[16:31], v[84:87], a[184:187], v[16:31]
    v_mfma_f32_32x32x16_bf16 v[32:47], v[84:87], a[188:191], v[32:47]
    ds_read_b128 v[84:87], v2 offset:29696
    s_waitcnt lgkmcnt(5)
    v_mfma_f32_32x32x16_bf16 v[16:31], v[64:67], a[192:195], v[16:31]
    v_mfma_f32_32x32x16_bf16 v[32:47], v[64:67], a[196:199], v[32:47]
    ds_read_b128 v[64:67], v2 offset:30720
    s_waitcnt lgkmcnt(5)
    v_mfma_f32_32x32x16_bf16 v[16:31], v[68:71], a[200:203], v[16:31]
    v_mfma_f32_32x32x16_bf16 v[32:47], v[68:71], a[204:207], v[32:47]
    ds_read_b128 v[68:71], v2 offset:31744
    s_waitcnt lgkmcnt(5)
    v_mfma_f32_32x32x16_bf16 v[16:31], v[72:75], a[208:211], v[16:31]
    v_mfma_f32_32x32x16_bf16 v[32:47], v[72:75], a[212:215], v[32:47]
    ds_read_b128 v[72:75], v2 offset:32768
    s_waitcnt lgkmcnt(5)
    v_mfma_f32_32x32x16_bf16 v[16:31], v[76:79], a[216:219], v[16:31]
    v_mfma_f32_32x32x16_bf16 v[32:47], v[76:79], a[220:223], v[32:47]
    ds_read_b128 v[76:79], v2 offset:33792
    s_waitcnt lgkmcnt(5)
    v_mfma_f32_32x32x16_bf16 v[16:31], v[80:83], a[224:227], v[16:31]
    v_mfma_f32_32x32x16_bf16 v[32:47], v[80:83], a[228:231], v[32:47]
    ds_read_b128 v[80:83], v2 offset:34816
    s_waitcnt lgkmcnt(5)
    v_mfma_f32_32x32x16_bf16 v[16:31], v[84:87], a[232:235], v[16:31]
    v_mfma_f32_32x32x16_bf16 v[32:47], v[84:87], a[236:239], v[32:47]
    ds_read_b128 v[84:87], v2 offset:35840
    s_waitcnt lgkmcnt(5)
    v_mfma_f32_32x32x16_bf16 v[16:31], v[64:67], a[240:243], v[16:31]
    v_mfma_f32_32x32x16_bf16 v[32:47], v[64:67], a[244:247], v[32:47]
    s_waitcnt lgkmcnt(4)
    v_mfma_f32_32x32x16_bf16 v[16:31], v[68:71], a[248:251], v[16:31]
    v_mfma_f32_32x32x16_bf16 v[32:47], v[68:71], a[252:255], v[32:47]
    s_waitcnt lgkmcnt(3)
    v_mfma_f32_32x32x16_bf16 v[16:31], v[72:75], v[224:227], v[16:31]
    v_mfma_f32_32x32x16_bf16 v[32:47], v[72:75], v[228:231], v[32:47]
    s_waitcnt lgkmcnt(2)
    v_mfma_f32_32x32x16_bf16 v[16:31], v[76:79], v[232:235], v[16:31]
    v_mfma_f32_32x32x16_bf16 v[32:47], v[76:79], v[236:239], v[32:47]
    s_waitcnt lgkmcnt(1)
    v_mfma_f32_32x32x16_bf16 v[16:31], v[80:83], v[240:243], v[16:31]
    v_mfma_f32_32x32x16_bf16 v[32:47], v[80:83], v[244:247], v[32:47]
    s_waitcnt lgkmcnt(0)
    v_mfma_f32_32x32x16_bf16 v[16:31], v[84:87], v[248:251], v[16:31]
    v_mfma_f32_32x32x16_bf16 v[32:47], v[84:87], v[252:255], v[32:47]
    s_lshl_b32 s24, s22, 18
    s_add_u32 s24, s24, s50
    s_nop 1
    v_cvt_pk_bf16_f32 v16, v16, v17
    v_cvt_pk_bf16_f32 v17, v18, v19
    v_cvt_pk_bf16_f32 v18, v20, v21
    v_cvt_pk_bf16_f32 v19, v22, v23
    v_cvt_pk_bf16_f32 v20, v24, v25
    v_cvt_pk_bf16_f32 v21, v26, v27
    v_cvt_pk_bf16_f32 v22, v28, v29
    v_cvt_pk_bf16_f32 v23, v30, v31
    buffer_store_dwordx4 v[16:19], v9, s[4:7], s24 offen offset:0 sc1
    buffer_store_dwordx4 v[20:23], v9, s[4:7], s24 offen offset:512 sc1
    v_cvt_pk_bf16_f32 v32, v32, v33
    v_cvt_pk_bf16_f32 v33, v34, v35
    v_cvt_pk_bf16_f32 v34, v36, v37
    v_cvt_pk_bf16_f32 v35, v38, v39
    v_cvt_pk_bf16_f32 v36, v40, v41
    v_cvt_pk_bf16_f32 v37, v42, v43
    v_cvt_pk_bf16_f32 v38, v44, v45
    v_cvt_pk_bf16_f32 v39, v46, v47
    buffer_store_dwordx4 v[32:35], v9, s[4:7], s24 offen offset:2048 sc1
    buffer_store_dwordx4 v[36:39], v9, s[4:7], s24 offen offset:2560 sc1
    s_add_u32 s22, s22, 1
    s_cmp_gt_u32 s22, 3
    s_cbranch_scc1 late_m_81
    s_waitcnt vmcnt(0)
    s_barrier
    s_max_u32 s28, s22, 0
    s_add_u32 s28, s28, 0
    s_cmp_lg_u32 s21, 0
    s_cbranch_scc1 noset_m_82
    s_lshr_b32 s29, s20, 6
    s_lshl_b32 s29, s29, 8
    s_and_b32 s92, s20, 63
    s_lshl_b32 s92, s92, 2
    s_add_u32 s29, s29, s92
    s_add_u32 s29, s29, 184287488
    v_mov_b32 v11, s28
    buffer_store_dword v11, off, s[4:7], s29 sc1
    s_nop 0
noset_m_82:
late_m_81:
    s_add_u32 s44, s44, 36864
    s_waitcnt vmcnt(4)
    s_cmp_lg_u32 s21, 0
    s_cbranch_scc1 nopace_m_83
    s_cmp_le_u32 s22, 12
    s_cbranch_scc1 nopace_m_83
    s_sub_u32 s28, s22, 12
    s_and_b32 s27, s20, 15
    s_lshl_b32 s27, s27, 1
    v_min_u32 v10, 0, v1
    v_mul_u32_u24 v10, 4, v10
    s_lshr_b32 s29, s27, 0
    s_lshl_b32 s29, s29, 8
    s_add_u32 s29, s29, 184288256
    buffer_load_dword v11, v10, s[4:7], s29 offen sc1
    s_waitcnt vmcnt(0)
    v_cmp_gt_u32 vcc, s28, v11
    s_nop 0
    s_cbranch_vccz fok_m_84
L_m_85:
    s_sleep 8
    s_sub_u32 s23, s23, 1
    s_cbranch_scc1 abqkv_m_46
    buffer_load_dword v11, v10, s[4:7], s29 offen sc1
    s_waitcnt vmcnt(0)
    v_cmp_gt_u32 vcc, s28, v11
    s_nop 0
    s_cbranch_vccnz L_m_85
fok_m_84:
nopace_m_83:
    s_barrier
    s_max_u32 s28, s22, 1
    s_add_u32 s28, s28, -1
    s_cmp_lg_u32 s21, 0
    s_cbranch_scc1 noset_m_86
    s_lshr_b32 s29, s20, 6
    s_lshl_b32 s29, s29, 8
    s_and_b32 s92, s20, 63
    s_lshl_b32 s92, s92, 2
    s_add_u32 s29, s29, s92
    s_add_u32 s29, s29, 184287488
    v_mov_b32 v11, s28
    buffer_store_dword v11, off, s[4:7], s29 sc1
    s_nop 0
noset_m_86:
    s_cmp_ge_u32 s22, 63
    s_cbranch_scc1 nodma_m_87
    s_add_u32 m0, s45, 0
    s_add_u32 s25, s44, 0
    buffer_load_dwordx4 v2, s[4:7], s25 offen lds
    s_add_u32 m0, s45, 1024
    s_add_u32 s25, s44, 1024
    buffer_load_dwordx4 v2, s[4:7], s25 offen lds
    s_add_u32 m0, s45, 2048
    s_add_u32 s25, s44, 2048
    buffer_load_dwordx4 v2, s[4:7], s25 offen lds
    s_add_u32 m0, s45, 3072
    s_add_u32 s25, s44, 3072
    buffer_load_dwordx4 v2, s[4:7], s25 offen lds
    s_add_u32 m0, s45, 4096
    s_add_u32 s25, s44, 4096
    buffer_load_dwordx4 v2, s[4:7], s25 offen lds
    s_add_u32 m0, s45, 5120
    s_add_u32 s25, s44, 5120
    buffer_load_dwordx4 v2, s[4:7], s25 offen lds
    s_add_u32 m0, s45, 6144
    s_add_u32 s25, s44, 6144
    buffer_load_dwordx4 v2, s[4:7], s25 offen lds
    s_add_u32 m0, s45, 7168
    s_add_u32 s25, s44, 7168
    buffer_load_dwordx4 v2, s[4:7], s25 offen lds
    s_add_u32 m0, s45, 8192
    s_add_u32 s25, s44, 8192
    buffer_load_dwordx4 v2, s[4:7], s25 offen lds
nodma_m_87:
    ds_read_b128 v[64:67], v8 offset:0
    ds_read_b128 v[68:71], v8 offset:1024
    ds_read_b128 v[72:75], v8 offset:2048
    ds_read_b128 v[76:79], v8 offset:3072
    ds_read_b128 v[80:83], v8 offset:4096
    ds_read_b128 v[84:87], v8 offset:5120
    s_waitcnt lgkmcnt(5)
    v_mfma_f32_32x32x16_bf16 v[16:31], v[64:67], a[0:3], 0
    v_mfma_f32_32x32x16_bf16 v[32:47], v[64:67], a[4:7], 0
    ds_read_b128 v[64:67], v8 offset:6144
    s_waitcnt lgkmcnt(5)
    v_mfma_f32_32x32x16_bf16 v[16:31], v[68:71], a[8:11], v[16:31]
    v_mfma_f32_32x32x16_bf16 v[32:47], v[68:71], a[12:15], v[32:47]
    ds_read_b128 v[68:71], v8 offset:7168
    s_waitcnt lgkmcnt(5)
    v_mfma_f32_32x32x16_bf16 v[16:31], v[72:75], a[16:19], v[16:31]
    v_mfma_f32_32x32x16_bf16 v[32:47], v[72:75], a[20:23], v[32:47]
    ds_read_b128 v[72:75], v8 offset:8192
    s_waitcnt lgkmcnt(5)
    v_mfma_f32_32x32x16_bf16 v[16:31], v[76:79], a[24:27], v[16:31]
    v_mfma_f32_32x32x16_bf16 v[32:47], v[76:79], a[28:31], v[32:47]
    ds_read_b128 v[76:79], v8 offset:9216
    s_waitcnt lgkmcnt(5)
    v_mfma_f32_32x32x16_bf16 v[16:31], v[80:83], a[32:35], v[16:31]
    v_mfma_f32_32x32x16_bf16 v[32:47], v[80:83], a[36:39], v[32:47]
    ds_read_b128 v[80:83], v8 offset:10240
    s_waitcnt lgkmcnt(5)
    v_mfma_f32_32x32x16_bf16 v[16:31], v[84:87], a[40:43], v[16:31]
    v_mfma_f32_32x32x16_bf16 v[32:47], v[84:87], a[44:47], v[32:47]
    ds_read_b128 v[84:87], v8 offset:11264
    s_waitcnt lgkmcnt(5)
    v_mfma_f32_32x32x16_bf16 v[16:31], v[64:67], a[48:51], v[16:31]
    v_mfma_f32_32x32x16_bf16 v[32:47], v[64:67], a[52:55], v[32:47]
    ds_read_b128 v[64:67], v8 offset:12288
    s_waitcnt lgkmcnt(5)
    v_mfma_f32_32x32x16_bf16 v[16:31], v[68:71], a[56:59], v[16:31]
    v_mfma_f32_32x32x16_bf16 v[32:47], v[68:71], a[60:63], v[32:47]
    ds_read_b128 v[68:71], v8 offset:13312
    s_waitcnt lgkmcnt(5)
    v_mfma_f32_32x32x16_bf16 v[16:31], v[72:75], a[64:67], v[16:31]
    v_mfma_f32_32x32x16_bf16 v[32:47], v[72:75], a[68:71], v[32:47]
    ds_read_b128 v[72:75], v8 offset:14336
    s_waitcnt lgkmcnt(5)
    v_mfma_f32_32x32x16_bf16 v[16:31], v[76:79], a[72:75], v[16:31]
    v_mfma_f32_32x32x16_bf16 v[32:47], v[76:79], a[76:79], v[32:47]
    ds_read_b128 v[76:79], v8 offset:15360
    s_waitcnt lgkmcnt(5)
    v_mfma_f32_32x32x16_bf16 v[16:31], v[80:83], a[80:83], v[16:31]
    v_mfma_f32_32x32x16_bf16 v[32:47], v[80:83], a[84:87], v[32:47]
    ds_read_b128 v[80:83], v8 offset:16384
    s_waitcnt lgkmcnt(5)
    v_mfma_f32_32x32x16_bf16 v[16:31], v[84:87], a[88:91], v[16:31]
    v_mfma_f32_32x32x16_bf16 v[32:47], v[84:87], a[92:95], v[32:47]
    ds_read_b128 v[84:87], v8 offset:17408
    s_waitcnt lgkmcnt(5)
    v_mfma_f32_32x32x16_bf16 v[16:31], v[64:67], a[96:99], v[16:31]
    v_mfma_f32_32x32x16_bf16 v[32:47], v[64:67], a[100:103], v[32:47]
    ds_read_b128 v[64:67], v8 offset:18432
    s_waitcnt lgkmcnt(5)
    v_mfma_f32_32x32x16_bf16 v[16:31], v[68:71], a[104:107], v[16:31]
    v_mfma_f32_32x32x16_bf16 v[32:47], v[68:71], a[108:111], v[32:47]
    ds_read_b128 v[68:71], v8 offset:19456
    s_waitcnt lgkmcnt(5)
    v_mfma_f32_32x32x16_bf16 v[16:31], v[72:75], a[112:115], v[16:31]
    v_mfma_f32_32x32x16_bf16 v[32:47], v[72:75], a[116:119], v[32:47]
    ds_read_b128 v[72:75], v8 offset:20480
    s_waitcnt lgkmcnt(5)
    v_mfma_f32_32x32x16_bf16 v[16:31], v[76:79], a[120:123], v[16:31]
    v_mfma_f32_32x32x16_bf16 v[32:47], v[76:79], a[124:127], v[32:47]
    ds_read_b128 v[76:79], v8 offset:21504
    s_waitcnt lgkmcnt(5)
    v_mfma_f32_32x32x16_bf16 v[16:31], v[80:83], a[128:131], v[16:31]
    v_mfma_f32_32x32x16_bf16 v[32:47], v[80:83], a[132:135], v[32:47]
    ds_read_b128 v[80:83], v8 offset:22528
    s_waitcnt lgkmcnt(5)
    v_mfma_f32_32x32x16_bf16 v[16:31], v[84:87], a[136:139], v[16:31]
    v_mfma_f32_32x32x16_bf16 v[32:47], v[84:87], a[140:143], v[32:47]
    ds_read_b128 v[84:87], v8 offset:23552
    s_waitcnt lgkmcnt(5)
    v_mfma_f32_32x32x16_bf16 v[16:31], v[64:67], a[144:147], v[16:31]
    v_mfma_f32_32x32x16_bf16 v[32:47], v[64:67], a[148:151], v[32:47]
    ds_read_b128 v[64:67], v8 offset:24576
    s_waitcnt lgkmcnt(5)
    v_mfma_f32_32x32x16_bf16 v[16:31], v[68:71], a[152:155], v[16:31]
    v_mfma_f32_32x32x16_bf16 v[32:47], v[68:71], a[156:159], v[32:47]
    ds_read_b128 v[68:71], v8 offset:25600
    s_waitcnt lgkmcnt(5)
    v_mfma_f32_32x32x16_bf16 v[16:31], v[72:75], a[160:163], v[16:31]
    v_mfma_f32_32x32x16_bf16 v[32:47], v[72:75], a[164:167], v[32:47]
    ds_read_b128 v[72:75], v8 offset:26624
    s_waitcnt lgkmcnt(5)
    v_mfma_f32_32x32x16_bf16 v[16:31], v[76:79], a[168:171], v[16:31]
    v_mfma_f32_32x32x16_bf16 v[32:47], v[76:79], a[172:175], v[32:47]
    ds_read_b128 v[76:79], v8 offset:27648
    s_waitcnt lgkmcnt(5)
    v_mfma_f32_32x32x16_bf16 v[16:31], v[80:83], a[176:179], v[16:31]
    v_mfma_f32_32x32x16_bf16 v[32:47], v[80:83], a[180:183], v[32:47]
    ds_read_b128 v[80:83], v8 offset:28672
    s_waitcnt lgkmcnt(5)
    v_mfma_f32_32x32x16_bf16 v[16:31], v[84:87], a[184:187], v[16:31]
    v_mfma_f32_32x32x16_bf16 v[32:47], v[84:87], a[188:191], v[32:47]
    ds_read_b128 v[84:87], v8 offset:29696
    s_waitcnt lgkmcnt(5)
    v_mfma_f32_32x32x16_bf16 v[16:31], v[64:67], a[192:195], v[16:31]
    v_mfma_f32_32x32x16_bf16 v[32:47], v[64:67], a[196:199], v[32:47]
    ds_read_b128 v[64:67], v8 offset:30720
    s_waitcnt lgkmcnt(5)
    v_mfma_f32_32x32x16_bf16 v[16:31], v[68:71], a[200:203], v[16:31]
    v_mfma_f32_32x32x16_bf16 v[32:47], v[68:71], a[204:207], v[32:47]
    ds_read_b128 v[68:71], v8 offset:31744
    s_waitcnt lgkmcnt(5)
    v_mfma_f32_32x32x16_bf16 v[16:31], v[72:75], a[208:211], v[16:31]
    v_mfma_f32_32x32x16_bf16 v[32:47], v[72:75], a[212:215], v[32:47]
    ds_read_b128 v[72:75], v8 offset:32768
    s_waitcnt lgkmcnt(5)
    v_mfma_f32_32x32x16_bf16 v[16:31], v[76:79], a[216:219], v[16:31]
    v_mfma_f32_32x32x16_bf16 v[32:47], v[76:79], a[220:223], v[32:47]
    ds_read_b128 v[76:79], v8 offset:33792
    s_waitcnt lgkmcnt(5)
    v_mfma_f32_32x32x16_bf16 v[16:31], v[80:83], a[224:227], v[16:31]
    v_mfma_f32_32x32x16_bf16 v[32:47], v[80:83], a[228:231], v[32:47]
    ds_read_b128 v[80:83], v8 offset:34816
    s_waitcnt lgkmcnt(5)
    v_mfma_f32_32x32x16_bf16 v[16:31], v[84:87], a[232:235], v[16:31]
    v_mfma_f32_32x32x16_bf16 v[32:47], v[84:87], a[236:239], v[32:47]
    ds_read_b128 v[84:87], v8 offset:35840
    s_waitcnt lgkmcnt(5)
    v_mfma_f32_32x32x16_bf16 v[16:31], v[64:67], a[240:243], v[16:31]
    v_mfma_f32_32x32x16_bf16 v[32:47], v[64:67], a[244:247], v[32:47]
    s_waitcnt lgkmcnt(4)
    v_mfma_f32_32x32x16_bf16 v[16:31], v[68:71], a[248:251], v[16:31]
    v_mfma_f32_32x32x16_bf16 v[32:47], v[68:71], a[252:255], v[32:47]
    s_waitcnt lgkmcnt(3)
    v_mfma_f32_32x32x16_bf16 v[16:31], v[72:75], v[224:227], v[16:31]
    v_mfma_f32_32x32x16_bf16 v[32:47], v[72:75], v[228:231], v[32:47]
    s_waitcnt lgkmcnt(2)
    v_mfma_f32_32x32x16_bf16 v[16:31], v[76:79], v[232:235], v[16:31]
    v_mfma_f32_32x32x16_bf16 v[32:47], v[76:79], v[236:239], v[32:47]
    s_waitcnt lgkmcnt(1)
    v_mfma_f32_32x32x16_bf16 v[16:31], v[80:83], v[240:243], v[16:31]
    v_mfma_f32_32x32x16_bf16 v[32:47], v[80:83], v[244:247], v[32:47]
    s_waitcnt lgkmcnt(0)
    v_mfma_f32_32x32x16_bf16 v[16:31], v[84:87], v[248:251], v[16:31]
    v_mfma_f32_32x32x16_bf16 v[32:47], v[84:87], v[252:255], v[32:47]
    s_lshl_b32 s24, s22, 18
    s_add_u32 s24, s24, s50
    s_nop 1
    v_cvt_pk_bf16_f32 v16, v16, v17
    v_cvt_pk_bf16_f32 v17, v18, v19
    v_cvt_pk_bf16_f32 v18, v20, v21
    v_cvt_pk_bf16_f32 v19, v22, v23
    v_cvt_pk_bf16_f32 v20, v24, v25
    v_cvt_pk_bf16_f32 v21, v26, v27
    v_cvt_pk_bf16_f32 v22, v28, v29
    v_cvt_pk_bf16_f32 v23, v30, v31
    buffer_store_dwordx4 v[16:19], v9, s[4:7], s24 offen offset:0 sc1
    buffer_store_dwordx4 v[20:23], v9, s[4:7], s24 offen offset:512 sc1
    v_cvt_pk_bf16_f32 v32, v32, v33
    v_cvt_pk_bf16_f32 v33, v34, v35
    v_cvt_pk_bf16_f32 v34, v36, v37
    v_cvt_pk_bf16_f32 v35, v38, v39
    v_cvt_pk_bf16_f32 v36, v40, v41
    v_cvt_pk_bf16_f32 v37, v42, v43
    v_cvt_pk_bf16_f32 v38, v44, v45
    v_cvt_pk_bf16_f32 v39, v46, v47
    buffer_store_dwordx4 v[32:35], v9, s[4:7], s24 offen offset:2048 sc1
    buffer_store_dwordx4 v[36:39], v9, s[4:7], s24 offen offset:2560 sc1
    s_add_u32 s22, s22, 1
    s_cmp_gt_u32 s22, 3
    s_cbranch_scc1 late_m_88
    s_waitcnt vmcnt(0)
    s_barrier
    s_max_u32 s28, s22, 0
    s_add_u32 s28, s28, 0
    s_cmp_lg_u32 s21, 0
    s_cbranch_scc1 noset_m_89
    s_lshr_b32 s29, s20, 6
    s_lshl_b32 s29, s29, 8
    s_and_b32 s92, s20, 63
    s_lshl_b32 s92, s92, 2
    s_add_u32 s29, s29, s92
    s_add_u32 s29, s29, 184287488
    v_mov_b32 v11, s28
    buffer_store_dword v11, off, s[4:7], s29 sc1
    s_nop 0
noset_m_89:
late_m_88:
    s_cmp_lt_u32 s22, 64
    s_cbranch_scc1 L_m_75
    s_waitcnt vmcnt(0)
    s_barrier
    s_max_u32 s28, s22, 0
    s_add_u32 s28, s28, 0
    s_cmp_lg_u32 s21, 0
    s_cbranch_scc1 noset_m_90
    s_lshr_b32 s29, s20, 6
    s_lshl_b32 s29, s29, 8
    s_and_b32 s92, s20, 63
    s_lshl_b32 s92, s92, 2
    s_add_u32 s29, s29, s92
    s_add_u32 s29, s29, 184287488
    v_mov_b32 v11, s28
    buffer_store_dword v11, off, s[4:7], s29 sc1
    s_nop 0
noset_m_90:
qdone_m_70:
    s_load_dwordx2 s[34:35], s[0:1], 0
    s_load_dwordx2 s[36:37], s[0:1], 88
    s_load_dwordx2 s[38:39], s[0:1], 96
    s_waitcnt lgkmcnt(0)
    s_cmp_ge_u32 s20, 32
    s_cbranch_scc1 r2f_m_91
    s_and_b32 s45, s20, 7
    s_lshr_b32 s22, s20, 3
    s_add_u32 s22, s22, 52
    s_mov_b32 s50, 16256
    s_mov_b32 s51, 1065353216
    v_cmp_gt_u32 s[52:53], 16, v1
    v_mov_b32 v17, 2147483648
    v_lshrrev_b32 v14, 4, v1
    v_bfe_u32 v15, v1, 2, 2
    v_and_b32 v3, 3, v1
    v_lshlrev_b32 v12, 11, v14
    v_lshl_add_u32 v12, v15, 8, v12
    v_lshl_add_u32 v4, v3, 4, v12
    v_lshlrev_b32 v12, 7, v15
    v_lshl_add_u32 v12, v3, 3, v12
    v_cndmask_b32 v5, v17, v12, s[52:53]
    v_mul_u32_u24 v13, 1152, v3
    s_mul_i32 s24, s21, 288
    v_add_u32 v13, s24, v13
    v_lshl_add_u32 v12, v14, 3, v15
    v_lshl_add_u32 v6, v12, 3, v13
    v_lshl_add_u32 v12, v15, 3, v13
    v_add_u32 v12, 256, v12
    v_cndmask_b32 v7, v17, v12, s[52:53]
    s_lshl_b32 s24, s21, 8
    v_add_u32 v12, s24, v2
    v_cndmask_b32 v16, v17, v12, s[52:53]
    v_lshlrev_b32 v18, 2, v3
    s_lshr_b32 s24, s45, 2
    s_and_b32 s25, s45, 3
    s_mul_i32 s27, s21, 9216
    s_lshl_b32 s46, s24, 10
    s_lshl_b32 s26, s25, 6
    s_add_u32 s46, s46, s26
    s_add_u32 s46, s46, s27
    s_lshl_b32 s49, s24, 9
    s_lshl_b32 s26, s25, 5
    s_add_u32 s49, s49, s26
    s_add_u32 s49, s49, 8192
    s_add_u32 s49, s49, s27
    s_mov_b32 s8, s34
    s_and_b32 s9, s35, 65535
    s_mov_b32 s10, 2359296
    s_mov_b32 s11, 131072
    v_lshrrev_b32 v12, 1, v15
    v_lshlrev_b32 v12, 9, v12
    v_and_b32 v13, 1, v15
    v_lshl_add_u32 v12, v13, 3, v12
    v_lshl_add_u32 v12, v3, 4, v12
    s_lshl_b32 s24, s45, 6
    s_add_u32 s24, s24, s27
    v_add_u32 v12, s24, v12
    v_lshl_add_u32 v8, v14, 11, v12
    v_add_u32 v12, 8192, v12
    v_cndmask_b32 v9, v17, v12, s[52:53]
    s_nop 1
L_m_92:
    s_lshl_b32 s47, s22, 3
    s_add_u32 s47, s47, s45
    s_mul_i32 s48, s47, 9216
    s_add_u32 s48, s48, 117440512
    s_mul_i32 s47, s47, 4608
    s_lshl_b32 s24, s21, 11
    s_add_u32 s54, s48, s24
    s_add_u32 s55, s48, 8192
    buffer_load_dwordx2 v[32:33], v6, s[8:11], s47 offen offset:0
    buffer_load_dwordx2 v[34:35], v6, s[8:11], s47 offen offset:32
    buffer_load_dwordx2 v[36:37], v7, s[8:11], s47 offen offset:0
    s_add_u32 s28, s22, 1
    s_and_b32 s27, s22, 1
    s_lshl_b32 s27, s27, 1
    s_lshr_b32 s26, s45, 2
    s_add_u32 s27, s27, s26
    s_lshl_b32 s27, s27, 6
    s_cmp_lg_u32 s21, 0
    s_cbranch_scc1 nopoll_m_93
    v_min_u32 v10, 31, v1
    v_mul_u32_u24 v10, 4, v10
    s_lshr_b32 s29, s27, 6
    s_lshl_b32 s29, s29, 8
    s_and_b32 s92, s27, 63
    s_lshl_b32 s92, s92, 2
    s_add_u32 s29, s29, s92
    s_add_u32 s29, s29, 184300544
    buffer_load_dword v11, v10, s[4:7], s29 offen sc1
    s_waitcnt vmcnt(0)
    v_cmp_gt_u32 vcc, s28, v11
    s_nop 0
    s_cbranch_vccz fok_m_94
L_m_95:
    s_sleep 8
    s_sub_u32 s23, s23, 1
    s_cbranch_scc1 abqkv_m_46
    buffer_load_dword v11, v10, s[4:7], s29 offen sc1
    s_waitcnt vmcnt(0)
    v_cmp_gt_u32 vcc, s28, v11
    s_nop 0
    s_cbranch_vccnz L_m_95
fok_m_94:
nopoll_m_93:
    s_barrier
    s_waitcnt vmcnt(0)
    s_mul_i32 s24, s22, 294912
    s_add_u32 s24, s24, 79691776
    s_add_u32 s27, s24, s49
    s_add_u32 s24, s24, s46
    buffer_load_dwordx4 v[64:67], v4, s[4:7], s24 offen
    buffer_load_dwordx2 v[104:105], v5, s[4:7], s27 offen
    s_add_u32 s24, s24, 36864
    s_add_u32 s27, s27, 36864
    buffer_load_dwordx4 v[68:71], v4, s[4:7], s24 offen
    buffer_load_dwordx2 v[106:107], v5, s[4:7], s27 offen
    s_add_u32 s24, s24, 36864
    s_add_u32 s27, s27, 36864
    buffer_load_dwordx4 v[72:75], v4, s[4:7], s24 offen
    buffer_load_dwordx2 v[108:109], v5, s[4:7], s27 offen
    s_add_u32 s24, s24, 36864
    s_add_u32 s27, s27, 36864
    buffer_load_dwordx4 v[76:79], v4, s[4:7], s24 offen
    buffer_load_dwordx2 v[110:111], v5, s[4:7], s27 offen
    s_add_u32 s24, s24, 36864
    s_add_u32 s27, s27, 36864
    buffer_load_dwordx4 v[80:83], v4, s[4:7], s24 offen
    buffer_load_dwordx2 v[112:113], v5, s[4:7], s27 offen
    s_add_u32 s24, s24, 36864
    s_add_u32 s27, s27, 36864
    buffer_load_dwordx4 v[84:87], v4, s[4:7], s24 offen
    buffer_load_dwordx2 v[114:115], v5, s[4:7], s27 offen
    s_add_u32 s24, s24, 36864
    s_add_u32 s27, s27, 36864
    buffer_load_dwordx4 v[88:91], v4, s[4:7], s24 offen
    buffer_load_dwordx2 v[116:117], v5, s[4:7], s27 offen
    s_add_u32 s24, s24, 36864
    s_add_u32 s27, s27, 36864
    buffer_load_dwordx4 v[92:95], v4, s[4:7], s24 offen
    buffer_load_dwordx2 v[118:119], v5, s[4:7], s27 offen
    v_lshlrev_b32 v20, 16, v32
    v_and_b32 v21, 4294901760, v32
    v_lshlrev_b32 v22, 16, v33
    v_and_b32 v23, 4294901760, v33
    v_lshlrev_b32 v24, 16, v34
    v_and_b32 v25, 4294901760, v34
    v_lshlrev_b32 v26, 16, v35
    v_and_b32 v27, 4294901760, v35
    v_lshlrev_b32 v28, 16, v36
    v_and_b32 v29, 4294901760, v36
    v_lshlrev_b32 v30, 16, v37
    v_and_b32 v31, 4294901760, v37
    s_waitcnt vmcnt(15)
    v_dot2c_f32_bf16 v20, s50, v64
    v_dot2c_f32_bf16 v21, s51, v64
    v_dot2c_f32_bf16 v22, s50, v65
    v_dot2c_f32_bf16 v23, s51, v65
    v_dot2c_f32_bf16 v24, s50, v66
    v_dot2c_f32_bf16 v25, s51, v66
    v_dot2c_f32_bf16 v26, s50, v67
    v_dot2c_f32_bf16 v27, s51, v67
    s_waitcnt vmcnt(14)
    v_dot2c_f32_bf16 v28, s50, v104
    v_dot2c_f32_bf16 v29, s51, v104
    v_dot2c_f32_bf16 v30, s50, v105
    v_dot2c_f32_bf16 v31, s51, v105
    s_waitcnt vmcnt(13)
    v_dot2c_f32_bf16 v20, s50, v68
    v_dot2c_f32_bf16 v21, s51, v68
    v_dot2c_f32_bf16 v22, s50, v69
    v_dot2c_f32_bf16 v23, s51, v69
    v_dot2c_f32_bf16 v24, s50, v70
    v_dot2c_f32_bf16 v25, s51, v70
    v_dot2c_f32_bf16 v26, s50, v71
    v_dot2c_f32_bf16 v27, s51, v71
    s_waitcnt vmcnt(12)
    v_dot2c_f32_bf16 v28, s50, v106
    v_dot2c_f32_bf16 v29, s51, v106
    v_dot2c_f32_bf16 v30, s50, v107
    v_dot2c_f32_bf16 v31, s51, v107
    s_waitcnt vmcnt(11)
    v_dot2c_f32_bf16 v20, s50, v72
    v_dot2c_f32_bf16 v21, s51, v72
    v_dot2c_f32_bf16 v22, s50, v73
    v_dot2c_f32_bf16 v23, s51, v73
    v_dot2c_f32_bf16 v24, s50, v74
    v_dot2c_f32_bf16 v25, s51, v74
    v_dot2c_f32_bf16 v26, s50, v75
    v_dot2c_f32_bf16 v27, s51, v75
    s_waitcnt vmcnt(10)
    v_dot2c_f32_bf16 v28, s50, v108
    v_dot2c_f32_bf16 v29, s51, v108
    v_dot2c_f32_bf16 v30, s50, v109
    v_dot2c_f32_bf16 v31, s51, v109
    s_waitcnt vmcnt(9)
    v_dot2c_f32_bf16 v20, s50, v76
    v_dot2c_f32_bf16 v21, s51, v76
    v_dot2c_f32_bf16 v22, s50, v77
    v_dot2c_f32_bf16 v23, s51, v77
    v_dot2c_f32_bf16 v24, s50, v78
    v_dot2c_f32_bf16 v25, s51, v78
    v_dot2c_f32_bf16 v26, s50, v79
    v_dot2c_f32_bf16 v27, s51, v79
    s_waitcnt vmcnt(8)
    v_dot2c_f32_bf16 v28, s50, v110
    v_dot2c_f32_bf16 v29, s51, v110
    v_dot2c_f32_bf16 v30, s50, v111
    v_dot2c_f32_bf16 v31, s51, v111
    s_waitcnt vmcnt(7)
    v_dot2c_f32_bf16 v20, s50, v80
    v_dot2c_f32_bf16 v21, s51, v80
    v_dot2c_f32_bf16 v22, s50, v81
    v_dot2c_f32_bf16 v23, s51, v81
    v_dot2c_f32_bf16 v24, s50, v82
    v_dot2c_f32_bf16 v25, s51, v82
    v_dot2c_f32_bf16 v26, s50, v83
    v_dot2c_f32_bf16 v27, s51, v83
    s_waitcnt vmcnt(6)
    v_dot2c_f32_bf16 v28, s50, v112
    v_dot2c_f32_bf16 v29, s51, v112
    v_dot2c_f32_bf16 v30, s50, v113
    v_dot2c_f32_bf16 v31, s51, v113
    s_waitcnt vmcnt(5)
    v_dot2c_f32_bf16 v20, s50, v84
    v_dot2c_f32_bf16 v21, s51, v84
    v_dot2c_f32_bf16 v22, s50, v85
    v_dot2c_f32_bf16 v23, s51, v85
    v_dot2c_f32_bf16 v24, s50, v86
    v_dot2c_f32_bf16 v25, s51, v86
    v_dot2c_f32_bf16 v26, s50, v87
    v_dot2c_f32_bf16 v27, s51, v87
    s_waitcnt vmcnt(4)
    v_dot2c_f32_bf16 v28, s50, v114
    v_dot2c_f32_bf16 v29, s51, v114
    v_dot2c_f32_bf16 v30, s50, v115
    v_dot2c_f32_bf16 v31, s51, v115
    s_waitcnt vmcnt(3)
    v_dot2c_f32_bf16 v20, s50, v88
    v_dot2c_f32_bf16 v21, s51, v88
    v_dot2c_f32_bf16 v22, s50, v89
    v_dot2c_f32_bf16 v23, s51, v89
    v_dot2c_f32_bf16 v24, s50, v90
    v_dot2c_f32_bf16 v25, s51, v90
    v_dot2c_f32_bf16 v26, s50, v91
    v_dot2c_f32_bf16 v27, s51, v91
    s_waitcnt vmcnt(2)
    v_dot2c_f32_bf16 v28, s50, v116
    v_dot2c_f32_bf16 v29, s51, v116
    v_dot2c_f32_bf16 v30, s50, v117
    v_dot2c_f32_bf16 v31, s51, v117
    s_waitcnt vmcnt(1)
    v_dot2c_f32_bf16 v20, s50, v92
    v_dot2c_f32_bf16 v21, s51, v92
    v_dot2c_f32_bf16 v22, s50, v93
    v_dot2c_f32_bf16 v23, s51, v93
    v_dot2c_f32_bf16 v24, s50, v94
    v_dot2c_f32_bf16 v25, s51, v94
    v_dot2c_f32_bf16 v26, s50, v95
    v_dot2c_f32_bf16 v27, s51, v95
    s_waitcnt vmcnt(0)
    v_dot2c_f32_bf16 v28, s50, v118
    v_dot2c_f32_bf16 v29, s51, v118
    v_dot2c_f32_bf16 v30, s50, v119
    v_dot2c_f32_bf16 v31, s51, v119
    v_pk_add_f32 v[56:57], v[20:21], v[22:23]
    v_pk_add_f32 v[56:57], v[56:57], v[24:25]
    v_pk_add_f32 v[56:57], v[56:57], v[26:27]
    v_pk_add_f32 v[56:57], v[56:57], v[28:29]
    v_pk_add_f32 v[56:57], v[56:57], v[30:31]
    v_add_f32 v56, v56, v57
    s_nop 1
    v_add_f32_dpp v56, v56, v56 row_ror:4 row_mask:0xf bank_mask:0xf
    s_nop 1
    v_add_f32_dpp v56, v56, v56 row_ror:8 row_mask:0xf bank_mask:0xf
    v_mov_b32 v62, v56
    s_nop 1
    v_permlane16_swap_b32 v56, v62
    v_add_f32 v56, v56, v62
    v_mov_b32 v62, v56
    s_nop 1
    v_permlane32_swap_b32 v56, v62
    v_add_f32 v56, v56, v62
    s_lshl_b32 s24, s21, 4
    v_add_u32 v62, s24, v18
    ds_write_b32 v62, v56 offset:0
    s_waitcnt lgkmcnt(0)
    s_barrier
    ds_read_b32 v124, v18 offset:0
    ds_read_b32 v125, v18 offset:16
    ds_read_b32 v126, v18 offset:32
    ds_read_b32 v127, v18 offset:48
    s_waitcnt lgkmcnt(2)
    v_add_f32 v56, v124, v125
    s_waitcnt lgkmcnt(0)
    v_add_f32 v62, v126, v127
    v_add_f32 v56, v56, v62
    v_mul_f32 v60, 987991609, v56
    v_cndmask_b32 v61, 0, v60, s[52:53]
    v_mov_b64 v[58:59], 0
    v_pk_add_f32 v[64:65], v[20:21], v[60:61] op_sel_hi:[1,0] neg_lo:[0,1] neg_hi:[0,1]
    v_pk_fma_f32 v[58:59], v[64:65], v[64:65], v[58:59]
    v_pk_add_f32 v[66:67], v[22:23], v[60:61] op_sel_hi:[1,0] neg_lo:[0,1] neg_hi:[0,1]
    v_pk_fma_f32 v[58:59], v[66:67], v[66:67], v[58:59]
    v_pk_add_f32 v[68:69], v[24:25], v[60:61] op_sel_hi:[1,0] neg_lo:[0,1] neg_hi:[0,1]
    v_pk_fma_f32 v[58:59], v[68:69], v[68:69], v[58:59]
    v_pk_add_f32 v[70:71], v[26:27], v[60:61] op_sel_hi:[1,0] neg_lo:[0,1] neg_hi:[0,1]
    v_pk_fma_f32 v[58:59], v[70:71], v[70:71], v[58:59]
    v_pk_add_f32 v[72:73], v[28:29], v[60:61] op_sel:[0,1] op_sel_hi:[1,1] neg_lo:[0,1] neg_hi:[0,1]
    v_pk_fma_f32 v[58:59], v[72:73], v[72:73], v[58:59]
    v_pk_add_f32 v[74:75], v[30:31], v[60:61] op_sel:[0,1] op_sel_hi:[1,1] neg_lo:[0,1] neg_hi:[0,1]
    v_pk_fma_f32 v[58:59], v[74:75], v[74:75], v[58:59]
    v_add_f32 v58, v58, v59
    s_nop 1
    v_add_f32_dpp v58, v58, v58 row_ror:4 row_mask:0xf bank_mask:0xf
    s_nop 1
    v_add_f32_dpp v58, v58, v58 row_ror:8 row_mask:0xf bank_mask:0xf
    v_mov_b32 v62, v58
    s_nop 1
    v_permlane16_swap_b32 v58, v62
    v_add_f32 v58, v58, v62
    v_mov_b32 v62, v58
    s_nop 1
    v_permlane32_swap_b32 v58, v62
    v_add_f32 v58, v58, v62
    s_lshl_b32 s24, s21, 4
    v_add_u32 v62, s24, v18
    ds_write_b32 v62, v58 offset:64
    s_waitcnt lgkmcnt(0)
    s_barrier
    ds_read_b32 v124, v18 offset:64
    ds_read_b32 v125, v18 offset:80
    ds_read_b32 v126, v18 offset:96
    ds_read_b32 v127, v18 offset:112
    s_waitcnt lgkmcnt(2)
    v_add_f32 v58, v124, v125
    s_waitcnt lgkmcnt(0)
    v_add_f32 v62, v126, v127
    v_add_f32 v58, v58, v62
    v_mov_b32 v60, 925353388
    v_fmac_f32 v60, 987991609, v58
    v_rsq_f32 v60, v60
    s_mul_i32 s27, s22, 36864
    s_add_u32 s27, s27, 122683392
    v_pk_mul_f32 v[64:65], v[64:65], v[60:61] op_sel_hi:[1,0]
    v_cvt_pk_bf16_f32 v32, v64, v65
    v_pk_mul_f32 v[66:67], v[66:67], v[60:61] op_sel_hi:[1,0]
    v_cvt_pk_bf16_f32 v33, v66, v67
    buffer_store_dwordx2 v[32:33], v8, s[4:7], s27 offen offset:0 sc1
    v_pk_mul_f32 v[68:69], v[68:69], v[60:61] op_sel_hi:[1,0]
    v_cvt_pk_bf16_f32 v34, v68, v69
    v_pk_mul_f32 v[70:71], v[70:71], v[60:61] op_sel_hi:[1,0]
    v_cvt_pk_bf16_f32 v35, v70, v71
    buffer_store_dwordx2 v[34:35], v8, s[4:7], s27 offen offset:1024 sc1
    v_pk_mul_f32 v[72:73], v[72:73], v[60:61] op_sel_hi:[1,0]
    v_cvt_pk_bf16_f32 v36, v72, v73
    v_pk_mul_f32 v[74:75], v[74:75], v[60:61] op_sel_hi:[1,0]
    v_cvt_pk_bf16_f32 v37, v74, v75
    buffer_store_dwordx2 v[36:37], v9, s[4:7], s27 offen offset:0 sc1
    buffer_store_dwordx4 v[20:23], v2, s[4:7], s54 offen offset:0 sc1
    buffer_store_dwordx4 v[24:27], v2, s[4:7], s54 offen offset:1024 sc1
    buffer_store_dwordx4 v[28:31], v16, s[4:7], s55 offen sc1
    s_waitcnt vmcnt(0)
    s_barrier
    s_add_u32 s28, s22, 1
    s_cmp_lg_u32 s21, 0
    s_cbranch_scc1 noset_m_96
    s_lshr_b32 s29, s20, 3
    s_lshl_b32 s29, s29, 8
    s_and_b32 s92, s20, 7
    s_lshl_b32 s92, s92, 2
    s_add_u32 s29, s29, s92
    s_add_u32 s29, s29, 184311808
    v_mov_b32 v11, s28
    v_and_b32 v10, 3, v1
    v_lshlrev_b32 v10, 10, v10
    buffer_store_dword v11, v10, s[4:7], s29 offen sc1
    s_nop 0
noset_m_96:
    s_add_u32 s22, s22, 4
    s_cmp_lt_u32 s22, 64
    s_cbranch_scc1 L_m_92
    s_endpgm
r2f_m_91:
    s_sub_u32 s20, s20, 32
    s_and_b32 s45, s20, 7
    s_lshr_b32 s22, s20, 3
    s_add_u32 s22, s22, 52
    s_mov_b32 s50, 16256
    s_mov_b32 s51, 1065353216
    v_cmp_gt_u32 s[52:53], 16, v1
    v_mov_b32 v17, 2147483648
    v_lshrrev_b32 v14, 4, v1
    v_bfe_u32 v15, v1, 2, 2
    v_and_b32 v3, 3, v1
    v_lshlrev_b32 v12, 11, v14
    v_lshl_add_u32 v12, v15, 8, v12
    v_lshl_add_u32 v4, v3, 4, v12
    v_lshlrev_b32 v12, 7, v15
    v_lshl_add_u32 v12, v3, 3, v12
    v_cndmask_b32 v5, v17, v12, s[52:53]
    v_mul_u32_u24 v13, 1152, v3
    s_mul_i32 s24, s21, 288
    v_add_u32 v13, s24, v13
    v_lshl_add_u32 v12, v14, 3, v15
    v_lshl_add_u32 v6, v12, 3, v13
    v_lshl_add_u32 v12, v15, 3, v13
    v_add_u32 v12, 256, v12
    v_cndmask_b32 v7, v17, v12, s[52:53]
    s_lshl_b32 s24, s21, 8
    v_add_u32 v12, s24, v2
    v_cndmask_b32 v16, v17, v12, s[52:53]
    v_lshlrev_b32 v18, 2, v3
    s_lshr_b32 s24, s45, 2
    s_and_b32 s25, s45, 3
    s_mul_i32 s27, s21, 9216
    s_lshl_b32 s46, s24, 10
    s_lshl_b32 s26, s25, 6
    s_add_u32 s46, s46, s26
    s_add_u32 s46, s46, s27
    s_lshl_b32 s49, s24, 9
    s_lshl_b32 s26, s25, 5
    s_add_u32 s49, s49, s26
    s_add_u32 s49, s49, 8192
    s_add_u32 s49, s49, s27
    s_mov_b32 s8, s36
    s_and_b32 s9, s37, 65535
    s_mov_b32 s10, 1152
    s_mov_b32 s11, 131072
    s_mov_b32 s12, s38
    s_and_b32 s13, s39, 65535
    s_mov_b32 s14, 2359296
    s_mov_b32 s15, 131072
    v_mul_u32_u24 v13, 1152, v3
    v_sub_u32 v12, v6, v13
    v_sub_u32 v13, v7, v13
    buffer_load_dwordx2 v[32:33], v12, s[8:11], 0 offen offset:0
    buffer_load_dwordx2 v[34:35], v12, s[8:11], 0 offen offset:32
    buffer_load_dwordx2 v[36:37], v13, s[8:11], 0 offen offset:0
    s_waitcnt vmcnt(2)
    v_lshlrev_b32 v40, 16, v32
    v_and_b32 v41, 4294901760, v32
    v_lshlrev_b32 v42, 16, v33
    v_and_b32 v43, 4294901760, v33
    s_waitcnt vmcnt(1)
    v_lshlrev_b32 v44, 16, v34
    v_and_b32 v45, 4294901760, v34
    v_lshlrev_b32 v46, 16, v35
    v_and_b32 v47, 4294901760, v35
    s_waitcnt vmcnt(0)
    v_lshlrev_b32 v48, 16, v36
    v_and_b32 v49, 4294901760, v36
    v_lshlrev_b32 v50, 16, v37
    v_and_b32 v51, 4294901760, v37
    s_nop 1
L_m_97:
    s_lshl_b32 s47, s22, 3
    s_add_u32 s47, s47, s45
    s_mul_i32 s48, s47, 9216
    s_add_u32 s48, s48, 117440512
    s_mul_i32 s47, s47, 4608
    s_lshl_b32 s24, s21, 11
    s_add_u32 s54, s48, s24
    s_add_u32 s55, s48, 8192
    s_add_u32 s28, s22, 1
    s_and_b32 s27, s22, 1
    s_lshl_b32 s27, s27, 1
    s_lshr_b32 s26, s45, 2
    s_add_u32 s27, s27, s26
    s_lshl_b32 s27, s27, 6
    s_cmp_lg_u32 s21, 0
    s_cbranch_scc1 nopoll_m_98
    v_min_u32 v10, 35, v1
    v_mul_u32_u24 v10, 4, v10
    s_lshr_b32 s29, s27, 6
    s_lshl_b32 s29, s29, 8
    s_and_b32 s92, s27, 63
    s_lshl_b32 s92, s92, 2
    s_add_u32 s29, s29, s92
    s_add_u32 s29, s29, 184310784
    buffer_load_dword v11, v10, s[4:7], s29 offen sc1
    s_waitcnt vmcnt(0)
    v_cmp_gt_u32 vcc, s28, v11
    s_nop 0
    s_cbranch_vccz fok_m_99
L_m_100:
    s_sleep 8
    s_sub_u32 s23, s23, 1
    s_cbranch_scc1 abqkv_m_46
    buffer_load_dword v11, v10, s[4:7], s29 offen sc1
    s_waitcnt vmcnt(0)
    v_cmp_gt_u32 vcc, s28, v11
    s_nop 0
    s_cbranch_vccnz L_m_100
fok_m_99:
nopoll_m_98:
    s_barrier
    s_waitcnt vmcnt(0)
    s_mul_i32 s24, s22, 331776
    s_add_u32 s24, s24, 218103808
    s_add_u32 s27, s24, s49
    s_add_u32 s24, s24, s46
    buffer_load_dwordx4 v[20:23], v2, s[4:7], s54 offen offset:0
    buffer_load_dwordx4 v[24:27], v2, s[4:7], s54 offen offset:1024
    buffer_load_dwordx4 v[28:31], v16, s[4:7], s55 offen
    buffer_load_dwordx4 v[64:67], v4, s[4:7], s24 offen
    buffer_load_dwordx2 v[104:105], v5, s[4:7], s27 offen
    s_add_u32 s24, s24, 36864
    s_add_u32 s27, s27, 36864
    buffer_load_dwordx4 v[68:71], v4, s[4:7], s24 offen
    buffer_load_dwordx2 v[106:107], v5, s[4:7], s27 offen
    s_add_u32 s24, s24, 36864
    s_add_u32 s27, s27, 36864
    buffer_load_dwordx4 v[72:75], v4, s[4:7], s24 offen
    buffer_load_dwordx2 v[108:109], v5, s[4:7], s27 offen
    s_add_u32 s24, s24, 36864
    s_add_u32 s27, s27, 36864
    buffer_load_dwordx4 v[76:79], v4, s[4:7], s24 offen
    buffer_load_dwordx2 v[110:111], v5, s[4:7], s27 offen
    s_add_u32 s24, s24, 36864
    s_add_u32 s27, s27, 36864
    buffer_load_dwordx4 v[80:83], v4, s[4:7], s24 offen
    buffer_load_dwordx2 v[112:113], v5, s[4:7], s27 offen
    s_add_u32 s24, s24, 36864
    s_add_u32 s27, s27, 36864
    buffer_load_dwordx4 v[84:87], v4, s[4:7], s24 offen
    buffer_load_dwordx2 v[114:115], v5, s[4:7], s27 offen
    s_add_u32 s24, s24, 36864
    s_add_u32 s27, s27, 36864
    buffer_load_dwordx4 v[88:91], v4, s[4:7], s24 offen
    buffer_load_dwordx2 v[116:117], v5, s[4:7], s27 offen
    s_add_u32 s24, s24, 36864
    s_add_u32 s27, s27, 36864
    buffer_load_dwordx4 v[92:95], v4, s[4:7], s24 offen
    buffer_load_dwordx2 v[118:119], v5, s[4:7], s27 offen
    s_add_u32 s24, s24, 36864
    s_add_u32 s27, s27, 36864
    buffer_load_dwordx4 v[96:99], v4, s[4:7], s24 offen
    buffer_load_dwordx2 v[120:121], v5, s[4:7], s27 offen
    s_waitcnt vmcnt(20)
    v_pk_add_f32 v[20:21], v[20:21], v[40:41]
    v_pk_add_f32 v[22:23], v[22:23], v[42:43]
    s_waitcnt vmcnt(19)
    v_pk_add_f32 v[24:25], v[24:25], v[44:45]
    v_pk_add_f32 v[26:27], v[26:27], v[46:47]
    s_waitcnt vmcnt(18)
    v_pk_add_f32 v[28:29], v[28:29], v[48:49]
    v_pk_add_f32 v[30:31], v[30:31], v[50:51]
    s_waitcnt vmcnt(17)
    v_dot2c_f32_bf16 v20, s50, v64
    v_dot2c_f32_bf16 v21, s51, v64
    v_dot2c_f32_bf16 v22, s50, v65
    v_dot2c_f32_bf16 v23, s51, v65
    v_dot2c_f32_bf16 v24, s50, v66
    v_dot2c_f32_bf16 v25, s51, v66
    v_dot2c_f32_bf16 v26, s50, v67
    v_dot2c_f32_bf16 v27, s51, v67
    s_waitcnt vmcnt(16)
    v_dot2c_f32_bf16 v28, s50, v104
    v_dot2c_f32_bf16 v29, s51, v104
    v_dot2c_f32_bf16 v30, s50, v105
    v_dot2c_f32_bf16 v31, s51, v105
    s_waitcnt vmcnt(15)
    v_dot2c_f32_bf16 v20, s50, v68
    v_dot2c_f32_bf16 v21, s51, v68
    v_dot2c_f32_bf16 v22, s50, v69
    v_dot2c_f32_bf16 v23, s51, v69
    v_dot2c_f32_bf16 v24, s50, v70
    v_dot2c_f32_bf16 v25, s51, v70
    v_dot2c_f32_bf16 v26, s50, v71
    v_dot2c_f32_bf16 v27, s51, v71
    s_waitcnt vmcnt(14)
    v_dot2c_f32_bf16 v28, s50, v106
    v_dot2c_f32_bf16 v29, s51, v106
    v_dot2c_f32_bf16 v30, s50, v107
    v_dot2c_f32_bf16 v31, s51, v107
    s_waitcnt vmcnt(13)
    v_dot2c_f32_bf16 v20, s50, v72
    v_dot2c_f32_bf16 v21, s51, v72
    v_dot2c_f32_bf16 v22, s50, v73
    v_dot2c_f32_bf16 v23, s51, v73
    v_dot2c_f32_bf16 v24, s50, v74
    v_dot2c_f32_bf16 v25, s51, v74
    v_dot2c_f32_bf16 v26, s50, v75
    v_dot2c_f32_bf16 v27, s51, v75
    s_waitcnt vmcnt(12)
    v_dot2c_f32_bf16 v28, s50, v108
    v_dot2c_f32_bf16 v29, s51, v108
    v_dot2c_f32_bf16 v30, s50, v109
    v_dot2c_f32_bf16 v31, s51, v109
    s_waitcnt vmcnt(11)
    v_dot2c_f32_bf16 v20, s50, v76
    v_dot2c_f32_bf16 v21, s51, v76
    v_dot2c_f32_bf16 v22, s50, v77
    v_dot2c_f32_bf16 v23, s51, v77
    v_dot2c_f32_bf16 v24, s50, v78
    v_dot2c_f32_bf16 v25, s51, v78
    v_dot2c_f32_bf16 v26, s50, v79
    v_dot2c_f32_bf16 v27, s51, v79
    s_waitcnt vmcnt(10)
    v_dot2c_f32_bf16 v28, s50, v110
    v_dot2c_f32_bf16 v29, s51, v110
    v_dot2c_f32_bf16 v30, s50, v111
    v_dot2c_f32_bf16 v31, s51, v111
    s_waitcnt vmcnt(9)
    v_dot2c_f32_bf16 v20, s50, v80
    v_dot2c_f32_bf16 v21, s51, v80
    v_dot2c_f32_bf16 v22, s50, v81
    v_dot2c_f32_bf16 v23, s51, v81
    v_dot2c_f32_bf16 v24, s50, v82
    v_dot2c_f32_bf16 v25, s51, v82
    v_dot2c_f32_bf16 v26, s50, v83
    v_dot2c_f32_bf16 v27, s51, v83
    s_waitcnt vmcnt(8)
    v_dot2c_f32_bf16 v28, s50, v112
    v_dot2c_f32_bf16 v29, s51, v112
    v_dot2c_f32_bf16 v30, s50, v113
    v_dot2c_f32_bf16 v31, s51, v113
    s_waitcnt vmcnt(7)
    v_dot2c_f32_bf16 v20, s50, v84
    v_dot2c_f32_bf16 v21, s51, v84
    v_dot2c_f32_bf16 v22, s50, v85
    v_dot2c_f32_bf16 v23, s51, v85
    v_dot2c_f32_bf16 v24, s50, v86
    v_dot2c_f32_bf16 v25, s51, v86
    v_dot2c_f32_bf16 v26, s50, v87
    v_dot2c_f32_bf16 v27, s51, v87
    s_waitcnt vmcnt(6)
    v_dot2c_f32_bf16 v28, s50, v114
    v_dot2c_f32_bf16 v29, s51, v114
    v_dot2c_f32_bf16 v30, s50, v115
    v_dot2c_f32_bf16 v31, s51, v115
    s_waitcnt vmcnt(5)
    v_dot2c_f32_bf16 v20, s50, v88
    v_dot2c_f32_bf16 v21, s51, v88
    v_dot2c_f32_bf16 v22, s50, v89
    v_dot2c_f32_bf16 v23, s51, v89
    v_dot2c_f32_bf16 v24, s50, v90
    v_dot2c_f32_bf16 v25, s51, v90
    v_dot2c_f32_bf16 v26, s50, v91
    v_dot2c_f32_bf16 v27, s51, v91
    s_waitcnt vmcnt(4)
    v_dot2c_f32_bf16 v28, s50, v116
    v_dot2c_f32_bf16 v29, s51, v116
    v_dot2c_f32_bf16 v30, s50, v117
    v_dot2c_f32_bf16 v31, s51, v117
    s_waitcnt vmcnt(3)
    v_dot2c_f32_bf16 v20, s50, v92
    v_dot2c_f32_bf16 v21, s51, v92
    v_dot2c_f32_bf16 v22, s50, v93
    v_dot2c_f32_bf16 v23, s51, v93
    v_dot2c_f32_bf16 v24, s50, v94
    v_dot2c_f32_bf16 v25, s51, v94
    v_dot2c_f32_bf16 v26, s50, v95
    v_dot2c_f32_bf16 v27, s51, v95
    s_waitcnt vmcnt(2)
    v_dot2c_f32_bf16 v28, s50, v118
    v_dot2c_f32_bf16 v29, s51, v118
    v_dot2c_f32_bf16 v30, s50, v119
    v_dot2c_f32_bf16 v31, s51, v119
    s_waitcnt vmcnt(1)
    v_dot2c_f32_bf16 v20, s50, v96
    v_dot2c_f32_bf16 v21, s51, v96
    v_dot2c_f32_bf16 v22, s50, v97
    v_dot2c_f32_bf16 v23, s51, v97
    v_dot2c_f32_bf16 v24, s50, v98
    v_dot2c_f32_bf16 v25, s51, v98
    v_dot2c_f32_bf16 v26, s50, v99
    v_dot2c_f32_bf16 v27, s51, v99
    s_waitcnt vmcnt(0)
    v_dot2c_f32_bf16 v28, s50, v120
    v_dot2c_f32_bf16 v29, s51, v120
    v_dot2c_f32_bf16 v30, s50, v121
    v_dot2c_f32_bf16 v31, s51, v121
    v_cvt_pk_bf16_f32 v32, v20, v21
    v_cvt_pk_bf16_f32 v33, v22, v23
    buffer_store_dwordx2 v[32:33], v6, s[12:15], s47 offen offset:0
    v_cvt_pk_bf16_f32 v34, v24, v25
    v_cvt_pk_bf16_f32 v35, v26, v27
    buffer_store_dwordx2 v[34:35], v6, s[12:15], s47 offen offset:32
    v_cvt_pk_bf16_f32 v36, v28, v29
    v_cvt_pk_bf16_f32 v37, v30, v31
    buffer_store_dwordx2 v[36:37], v7, s[12:15], s47 offen offset:0
    s_add_u32 s22, s22, 2
    s_cmp_lt_u32 s22, 64
    s_cbranch_scc1 L_m_97
    s_endpgm
    s_endpgm
abqkv_m_46:
    s_endpgm
nqkv_m_45:
    s_sub_u32 s20, s20, 48
    s_cmp_ge_u32 s20, 16
    s_cbranch_scc1 natt_m_101
    s_load_dwordx2 s[32:33], s[0:1], 112
    v_lshrrev_b32 v3, 6, v0
    s_nop 0
    v_readfirstlane_b32 s21, v3
    v_and_b32 v1, 63, v0
    v_lshlrev_b32 v2, 4, v1
    s_mov_b32 s23, 4194304
    s_waitcnt lgkmcnt(0)
    s_mov_b32 s4, s32
    s_and_b32 s5, s33, 65535
    s_mov_b32 s6, 268435456
    s_mov_b32 s7, 131072
    s_lshr_b32 s24, s2, 5
    s_cmp_lt_u32 s24, 2
    s_cbranch_scc1 nowarm_m_103
    s_load_dwordx4 s[60:63], s[0:1], 16
    s_load_dwordx2 s[64:65], s[0:1], 32
    s_sub_u32 s24, s24, 2
    s_lshl_b32 s24, s24, 2
    s_bfe_u32 s25, s2, 131075
    s_add_u32 s24, s24, s25
    s_lshl_b32 s24, s24, 2
    s_add_u32 s24, s24, s21
    s_mul_i32 s24, s24, 49152
    s_and_b32 s25, s2, 7
    s_sub_u32 s25, s25, 1
    s_waitcnt lgkmcnt(0)
    s_mov_b32 s70, 846615568
    s_mov_b32 s71, 14395788
    s_lshl_b32 s27, s25, 2
    s_lshr_b64 s[70:71], s[70:71], s27
    s_and_b32 s27, s70, 15
    s_lshr_b32 s26, s27, 2
    s_cmp_eq_u32 s26, 1
    s_cselect_b64 s[66:67], s[62:63], s[60:61]
    s_cmp_eq_u32 s26, 2
    s_cselect_b64 s[66:67], s[64:65], s[66:67]
    s_mov_b32 s68, s66
    s_and_b32 s69, s67, 65535
    s_mov_b32 s70, 4718592
    s_mov_b32 s71, 131072
    s_and_b32 s26, s27, 3
    s_lshl_b32 s26, s26, 11
    s_add_u32 s26, s26, s24
    buffer_load_dwordx4 v[128:131], v2, s[68:71], s26 offen offset:0
    buffer_load_dwordx4 v[132:135], v2, s[68:71], s26 offen offset:1024
    s_add_u32 s26, s26, 8192
    buffer_load_dwordx4 v[136:139], v2, s[68:71], s26 offen offset:0
    buffer_load_dwordx4 v[140:143], v2, s[68:71], s26 offen offset:1024
    s_add_u32 s26, s26, 8192
    buffer_load_dwordx4 v[144:147], v2, s[68:71], s26 offen offset:0
    buffer_load_dwordx4 v[148:151], v2, s[68:71], s26 offen offset:1024
    s_add_u32 s26, s26, 8192
    buffer_load_dwordx4 v[152:155], v2, s[68:71], s26 offen offset:0
    buffer_load_dwordx4 v[156:159], v2, s[68:71], s26 offen offset:1024
    s_add_u32 s26, s26, 8192
    buffer_load_dwordx4 v[160:163], v2, s[68:71], s26 offen offset:0
    buffer_load_dwordx4 v[164:167], v2, s[68:71], s26 offen offset:1024
    s_add_u32 s26, s26, 8192
    buffer_load_dwordx4 v[168:171], v2, s[68:71], s26 offen offset:0
    buffer_load_dwordx4 v[172:175], v2, s[68:71], s26 offen offset:1024
    s_add_u32 s26, s26, 8192
    s_add_u32 s25, s25, 7
    s_mov_b32 s70, 846615568
    s_mov_b32 s71, 14395788
    s_lshl_b32 s27, s25, 2
    s_lshr_b64 s[70:71], s[70:71], s27
    s_and_b32 s27, s70, 15
    s_cmp_ge_u32 s27, 12
    s_cbranch_scc1 nowarm_m_103
    s_lshr_b32 s26, s27, 2
    s_cmp_eq_u32 s26, 1
    s_cselect_b64 s[66:67], s[62:63], s[60:61]
    s_cmp_eq_u32 s26, 2
    s_cselect_b64 s[66:67], s[64:65], s[66:67]
    s_mov_b32 s68, s66
    s_and_b32 s69, s67, 65535
    s_mov_b32 s70, 4718592
    s_mov_b32 s71, 131072
    s_and_b32 s26, s27, 3
    s_lshl_b32 s26, s26, 11
    s_add_u32 s26, s26, s24
    buffer_load_dwordx4 v[176:179], v2, s[68:71], s26 offen offset:0
    buffer_load_dwordx4 v[180:183], v2, s[68:71], s26 offen offset:1024
    s_add_u32 s26, s26, 8192
    buffer_load_dwordx4 v[184:187], v2, s[68:71], s26 offen offset:0
    buffer_load_dwordx4 v[188:191], v2, s[68:71], s26 offen offset:1024
    s_add_u32 s26, s26, 8192
    buffer_load_dwordx4 v[192:195], v2, s[68:71], s26 offen offset:0
    buffer_load_dwordx4 v[196:199], v2, s[68:71], s26 offen offset:1024
    s_add_u32 s26, s26, 8192
    buffer_load_dwordx4 v[200:203], v2, s[68:71], s26 offen offset:0
    buffer_load_dwordx4 v[204:207], v2, s[68:71], s26 offen offset:1024
    s_add_u32 s26, s26, 8192
    buffer_load_dwordx4 v[208:211], v2, s[68:71], s26 offen offset:0
    buffer_load_dwordx4 v[212:215], v2, s[68:71], s26 offen offset:1024
    s_add_u32 s26, s26, 8192
    buffer_load_dwordx4 v[216:219], v2, s[68:71], s26 offen offset:0
    buffer_load_dwordx4 v[220:223], v2, s[68:71], s26 offen offset:1024
    s_add_u32 s26, s26, 8192
nowarm_m_103:
    s_waitcnt vmcnt(0)
    s_lshl_b32 s44, s20, 2
    s_add_u32 s44, s44, s21
    s_and_b32 s45, s44, 31
    s_lshr_b32 s22, s44, 5
    s_mov_b32 s48, 1040356334
    s_mov_b32 s49, 1040356334
    s_mov_b32 s54, 1065369472
    s_mov_b32 s55, 1065369472
    s_mov_b32 s56, 1056980736
    s_mov_b32 s57, 1056980736
    v_cmp_lt_u32 s[50:51], 31, v1
    v_lshrrev_b32 v4, 4, v1
    v_and_b32 v5, 15, v1
    v_lshrrev_b32 v6, 1, v4
    v_lshlrev_b32 v6, 4, v6
    v_and_b32 v4, 1, v4
    v_lshl_add_u32 v6, v4, 2, v6
    v_sub_u32 v6, v6, v5
    v_cmp_lt_i32 s[60:61], 0, v6
    v_cmp_lt_i32 s[62:63], -1, v6
    v_cmp_lt_i32 s[64:65], -2, v6
    v_cmp_lt_i32 s[66:67], -3, v6
    v_cmp_lt_i32 s[68:69], -8, v6
    v_cmp_lt_i32 s[70:71], -9, v6
    v_cmp_lt_i32 s[72:73], -10, v6
    v_cmp_lt_i32 s[74:75], -11, v6
    v_cmp_lt_i32 s[76:77], 16, v6
    v_cmp_lt_i32 s[78:79], 15, v6
    v_cmp_lt_i32 s[80:81], 14, v6
    v_cmp_lt_i32 s[82:83], 13, v6
    v_cmp_lt_i32 s[84:85], 8, v6
    v_cmp_lt_i32 s[86:87], 7, v6
    v_cmp_lt_i32 s[88:89], 6, v6
    v_cmp_lt_i32 s[90:91], 5, v6
    v_lshlrev_b32 v7, 3, v1
    v_mov_b32 v8, 4286578688
    s_lshl_b32 s24, s21, 11
    v_add_u32 v12, s24, v2
    v_add_u32 v9, v6, v5
    v_bfe_u32 v4, v1, 2, 2
    v_add_u32 v9, v9, v4
    v_lshlrev_b32 v9, 4, v9
    v_and_b32 v4, 1, v1
    v_lshl_add_u32 v9, v4, 3, v9
    s_lshl_b32 s24, s21, 11
    v_add_u32 v9, s24, v9
    v_mov_b64 v[232:233], s[54:55]
    v_mov_b64 v[234:235], s[54:55]
    v_mov_b64 v[236:237], s[56:57]
    s_load_dwordx2 s[30:31], s[0:1], 104
    s_waitcnt lgkmcnt(0)
    s_mov_b32 s16, s30
    s_and_b32 s17, s31, 65535
    s_mov_b32 s18, 256
    s_mov_b32 s19, 131072
L_m_104:
    s_sub_u32 s23, s23, 1
    s_cbranch_scc1 abatt_m_102
    buffer_load_dword v3, off, s[16:19], 0 offset:64 sc1
    s_waitcnt vmcnt(0)
    v_cmp_eq_u32 vcc, 0, v3
    s_nop 0
    s_cbranch_vccnz L_m_104
    s_mov_b32 s58, 0
    s_add_u32 s28, s22, 1
    s_cmp_ge_u32 s58, s28
    s_cbranch_scc1 qok_m_105
    s_lshr_b32 s27, s45, 1
    v_min_u32 v10, 2, v1
    v_mul_u32_u24 v10, 64, v10
    s_lshr_b32 s29, s27, 6
    s_lshl_b32 s29, s29, 8
    s_and_b32 s92, s27, 63
    s_lshl_b32 s92, s92, 2
    s_add_u32 s29, s29, s92
    s_add_u32 s29, s29, 184287488
    buffer_load_dword v11, v10, s[4:7], s29 offen sc1
    s_waitcnt vmcnt(0)
    v_cmp_gt_u32 vcc, s28, v11
    s_nop 0
    s_cbranch_vccz fok_m_106
L_m_107:
    s_sleep 8
    s_sub_u32 s23, s23, 1
    s_cbranch_scc1 abatt_m_102
    buffer_load_dword v11, v10, s[4:7], s29 offen sc1
    s_waitcnt vmcnt(0)
    v_cmp_gt_u32 vcc, s28, v11
    s_nop 0
    s_cbranch_vccnz L_m_107
fok_m_106:
    v_readlane_b32 s58, v11, 0
    v_readlane_b32 s27, v11, 1
    v_readlane_b32 s28, v11, 2
    s_min_u32 s58, s58, s27
    s_min_u32 s58, s58, s28
    s_nop 2
qok_m_105:
    s_lshl_b32 s24, s22, 5
    s_add_u32 s24, s24, s45
    s_lshl_b32 s24, s24, 13
    s_add_u32 s25, s24, 20971520
    s_add_u32 s26, s24, 20975616
    buffer_load_dwordx4 a[32:35], v2, s[4:7], s25 offen offset:0
    buffer_load_dwordx4 a[36:39], v2, s[4:7], s25 offen offset:1024
    buffer_load_dwordx4 a[40:43], v2, s[4:7], s25 offen offset:2048
    buffer_load_dwordx4 a[44:47], v2, s[4:7], s25 offen offset:3072
    buffer_load_dwordx4 a[48:51], v2, s[4:7], s26 offen offset:0
    buffer_load_dwordx4 a[52:55], v2, s[4:7], s26 offen offset:1024
    buffer_load_dwordx4 a[56:59], v2, s[4:7], s26 offen offset:2048
    buffer_load_dwordx4 a[60:63], v2, s[4:7], s26 offen offset:3072
    s_add_u32 s25, s24, 4194304
    s_add_u32 s26, s24, 4198400
    buffer_load_dwordx4 a[0:3], v2, s[4:7], s25 offen offset:0
    buffer_load_dwordx4 a[4:7], v2, s[4:7], s25 offen offset:1024
    buffer_load_dwordx4 a[8:11], v2, s[4:7], s25 offen offset:2048
    buffer_load_dwordx4 a[12:15], v2, s[4:7], s25 offen offset:3072
    buffer_load_dwordx4 a[16:19], v2, s[4:7], s26 offen offset:0
    buffer_load_dwordx4 a[20:23], v2, s[4:7], s26 offen offset:1024
    buffer_load_dwordx4 a[24:27], v2, s[4:7], s26 offen offset:2048
    buffer_load_dwordx4 a[28:31], v2, s[4:7], s26 offen offset:3072
    s_add_u32 s25, s24, 37748736
    s_add_u32 s26, s24, 37752832
    buffer_load_dwordx4 a[64:67], v2, s[4:7], s25 offen offset:0
    buffer_load_dwordx4 a[68:71], v2, s[4:7], s25 offen offset:1024
    buffer_load_dwordx4 a[72:75], v2, s[4:7], s25 offen offset:2048
    buffer_load_dwordx4 a[76:79], v2, s[4:7], s25 offen offset:3072
    buffer_load_dwordx4 a[80:83], v2, s[4:7], s26 offen offset:0
    buffer_load_dwordx4 a[84:87], v2, s[4:7], s26 offen offset:1024
    buffer_load_dwordx4 a[88:91], v2, s[4:7], s26 offen offset:2048
    buffer_load_dwordx4 a[92:95], v2, s[4:7], s26 offen offset:3072
    s_waitcnt vmcnt(0)
L_m_108:
    s_lshl_b32 s46, s22, 5
    s_add_u32 s46, s46, s45
    s_waitcnt vmcnt(0)
    v_mfma_f32_16x16x32_bf16 v[136:139], a[32:35], a[0:3], 0
    v_mfma_f32_16x16x32_bf16 v[140:143], a[48:51], a[0:3], 0
    v_mfma_f32_16x16x32_bf16 v[148:151], a[32:35], a[16:19], 0
    v_mfma_f32_16x16x32_bf16 v[152:155], a[48:51], a[16:19], 0
    v_mfma_f32_16x16x32_bf16 v[136:139], a[36:39], a[4:7], v[136:139]
    v_mfma_f32_16x16x32_bf16 v[140:143], a[52:55], a[4:7], v[140:143]
    v_mfma_f32_16x16x32_bf16 v[148:151], a[36:39], a[20:23], v[148:151]
    v_mfma_f32_16x16x32_bf16 v[152:155], a[52:55], a[20:23], v[152:155]
    v_mfma_f32_16x16x32_bf16 v[136:139], a[40:43], a[8:11], v[136:139]
    v_mfma_f32_16x16x32_bf16 v[140:143], a[56:59], a[8:11], v[140:143]
    v_mfma_f32_16x16x32_bf16 v[148:151], a[40:43], a[24:27], v[148:151]
    v_mfma_f32_16x16x32_bf16 v[152:155], a[56:59], a[24:27], v[152:155]
    v_mfma_f32_16x16x32_bf16 v[136:139], a[44:47], a[12:15], v[136:139]
    v_mfma_f32_16x16x32_bf16 v[140:143], a[60:63], a[12:15], v[140:143]
    v_mfma_f32_16x16x32_bf16 v[148:151], a[44:47], a[28:31], v[148:151]
    v_cndmask_b32 v136, v136, v8, s[60:61]
    v_cndmask_b32 v137, v137, v8, s[62:63]
    v_mfma_f32_16x16x32_bf16 v[152:155], a[60:63], a[28:31], v[152:155]
    v_cndmask_b32 v138, v138, v8, s[64:65]
    v_cndmask_b32 v139, v139, v8, s[66:67]
    v_cndmask_b32 v140, v140, v8, s[68:69]
    v_cndmask_b32 v141, v141, v8, s[70:71]
    v_cndmask_b32 v142, v142, v8, s[72:73]
    v_cndmask_b32 v143, v143, v8, s[74:75]
    v_cndmask_b32 v148, v148, v8, s[76:77]
    v_cndmask_b32 v149, v149, v8, s[78:79]
    v_cndmask_b32 v150, v150, v8, s[80:81]
    v_cndmask_b32 v151, v151, v8, s[82:83]
    v_cndmask_b32 v152, v152, v8, s[84:85]
    v_cndmask_b32 v153, v153, v8, s[86:87]
    v_cndmask_b32 v154, v154, v8, s[88:89]
    v_cndmask_b32 v155, v155, v8, s[90:91]
    s_lshl_b32 s47, s46, 13
    s_add_u32 s47, s47, 54525952
    s_add_u32 s59, s22, 2
    s_min_u32 s59, s59, 63
    s_lshl_b32 s24, s46, 11
    s_add_u32 s25, s24, 75497472
    s_add_u32 s24, s24, 201326592
    s_lshl_b32 m0, s21, 11
    s_add_u32 s28, s22, 1
    s_cmp_lt_u32 s22, 60
    s_cbranch_scc1 mreg_m_111
    s_lshr_b32 s29, s45, 0
    s_lshl_b32 s29, s29, 8
    s_add_u32 s29, s29, 184288256
    s_branch mfirst_m_113
L_m_114:
    s_sleep 16
    s_sub_u32 s23, s23, 1
    s_cbranch_scc1 abatt_m_102
mfirst_m_113:
    buffer_load_dword v13, off, s[4:7], s29 sc1
    buffer_load_dwordx4 v2, s[4:7], s24 offen offset:0 sc1 lds
    buffer_load_dwordx4 v2, s[4:7], s24 offen offset:1024 sc1 lds
    buffer_load_dwordx2 v[128:129], v7, s[4:7], s25 offen offset:0 sc1
    buffer_load_dwordx2 v[130:131], v7, s[4:7], s25 offen offset:512 sc1
    buffer_load_dwordx2 v[132:133], v7, s[4:7], s25 offen offset:1024 sc1
    buffer_load_dwordx2 v[134:135], v7, s[4:7], s25 offen offset:1536 sc1
    s_waitcnt vmcnt(4)
    ds_read_b128 v[80:83], v12 offset:0
    ds_read_b128 v[84:87], v12 offset:1024
    s_waitcnt vmcnt(2)
    v_max3_u32 v10, v128, v129, v130
    s_waitcnt vmcnt(1)
    v_max3_u32 v10, v10, v131, v132
    s_waitcnt vmcnt(0)
    v_max3_u32 v11, v133, v134, v135
    s_waitcnt lgkmcnt(1)
    v_max3_u32 v10, v10, v80, v81
    v_max3_u32 v11, v11, v82, v83
    s_waitcnt lgkmcnt(0)
    v_max3_u32 v10, v10, v84, v85
    v_max3_u32 v11, v11, v86, v87
    v_max_u32 v10, v10, v11
    v_cmp_eq_u32 vcc, -1, v10
    s_nop 0
    s_cbranch_vccz mgot_m_110
    v_cmp_gt_u32 vcc, s28, v13
    s_nop 0
    s_cbranch_vccnz L_m_114
    s_branch mflag_m_112
mreg_m_111:
    v_min_u32 v10, 0, v1
    v_mul_u32_u24 v10, 4, v10
    s_lshr_b32 s29, s45, 0
    s_lshl_b32 s29, s29, 8
    s_add_u32 s29, s29, 184288256
    buffer_load_dword v11, v10, s[4:7], s29 offen sc1
    s_waitcnt vmcnt(0)
    v_cmp_gt_u32 vcc, s28, v11
    s_nop 0
    s_cbranch_vccz fok_m_115
L_m_116:
    s_sleep 8
    s_sub_u32 s23, s23, 1
    s_cbranch_scc1 abatt_m_102
    buffer_load_dword v11, v10, s[4:7], s29 offen sc1
    s_waitcnt vmcnt(0)
    v_cmp_gt_u32 vcc, s28, v11
    s_nop 0
    s_cbranch_vccnz L_m_116
fok_m_115:
mflag_m_112:
    buffer_load_dwordx4 v2, s[4:7], s24 offen offset:0 sc1 lds
    buffer_load_dwordx4 v2, s[4:7], s24 offen offset:1024 sc1 lds
    buffer_load_dwordx2 v[128:129], v7, s[4:7], s25 offen offset:0 sc1
    buffer_load_dwordx2 v[130:131], v7, s[4:7], s25 offen offset:512 sc1
    buffer_load_dwordx2 v[132:133], v7, s[4:7], s25 offen offset:1024 sc1
    buffer_load_dwordx2 v[134:135], v7, s[4:7], s25 offen offset:1536 sc1
    s_waitcnt vmcnt(0)
mgot_m_110:
    ds_read_b64_tr_b16 v[80:81], v9 offset:0
    ds_read_b64_tr_b16 v[82:83], v9 offset:128
    ds_read_b64_tr_b16 v[84:85], v9 offset:512
    ds_read_b64_tr_b16 v[86:87], v9 offset:640
    ds_read_b64_tr_b16 v[88:89], v9 offset:1024
    ds_read_b64_tr_b16 v[90:91], v9 offset:1152
    ds_read_b64_tr_b16 v[92:93], v9 offset:1536
    ds_read_b64_tr_b16 v[94:95], v9 offset:1664
    s_waitcnt lgkmcnt(6)
    v_mfma_f32_16x16x32_bf16 v[144:147], v[80:83], a[0:3], 0
    v_max3_f32 v248, v136, v137, v138
    v_max3_f32 v249, v139, v140, v141
    s_waitcnt lgkmcnt(4)
    v_mfma_f32_16x16x32_bf16 v[144:147], v[84:87], a[4:7], v[144:147]
    v_max3_f32 v248, v248, v142, v143
    v_max_f32 v248, v248, v249
    v_mfma_f32_16x16x32_bf16 v[156:159], v[80:83], a[16:19], 0
    v_mov_b32 v249, v248
    v_max3_f32 v252, v148, v149, v150
    s_waitcnt lgkmcnt(2)
    v_mfma_f32_16x16x32_bf16 v[144:147], v[88:91], a[8:11], v[144:147]
    v_permlane32_swap_b32 v248, v249
    v_mfma_f32_16x16x32_bf16 v[156:159], v[84:87], a[20:23], v[156:159]
    v_max3_f32 v253, v151, v152, v153
    v_max3_f32 v252, v252, v154, v155
    s_waitcnt lgkmcnt(0)
    v_mfma_f32_16x16x32_bf16 v[144:147], v[92:95], a[12:15], v[144:147]
    v_max_f32 v252, v252, v253
    v_mov_b32 v253, v252
    v_mfma_f32_16x16x32_bf16 v[156:159], v[88:91], a[24:27], v[156:159]
    s_nop 0
    v_permlane32_swap_b32 v252, v253
    v_mfma_f32_16x16x32_bf16 v[156:159], v[92:95], a[28:31], v[156:159]
    v_max3_f32 v248, v248, v249, v144
    v_max3_f32 v249, v145, v146, v147
    v_max_f32 v248, v248, v249
    v_mov_b32 v249, v248
    s_nop 1
    v_permlane16_swap_b32 v248, v249
    s_nop 0
    v_max3_f32 v252, v252, v253, v156
    v_max3_f32 v253, v157, v158, v159
    v_max_f32 v248, v248, v249
    v_max_f32 v252, v252, v253
    v_mul_f32 v250, s48, v248
    v_mov_b32 v253, v252
    v_pk_fma_f32 v[136:137], v[136:137], s[48:49], v[250:251] op_sel_hi:[1,1,0] neg_lo:[0,0,1] neg_hi:[0,0,1]
    v_pk_fma_f32 v[138:139], v[138:139], s[48:49], v[250:251] op_sel_hi:[1,1,0] neg_lo:[0,0,1] neg_hi:[0,0,1]
    v_exp_f32 v136, v136
    v_exp_f32 v137, v137
    v_permlane16_swap_b32 v252, v253
    v_exp_f32 v138, v138
    v_exp_f32 v139, v139
    v_pk_fma_f32 v[140:141], v[140:141], s[48:49], v[250:251] op_sel_hi:[1,1,0] neg_lo:[0,0,1] neg_hi:[0,0,1]
    v_pk_fma_f32 v[142:143], v[142:143], s[48:49], v[250:251] op_sel_hi:[1,1,0] neg_lo:[0,0,1] neg_hi:[0,0,1]
    v_exp_f32 v140, v140
    v_exp_f32 v141, v141
    v_exp_f32 v142, v142
    v_exp_f32 v143, v143
    v_cvt_pk_bf16_f32 v136, v136, v137
    v_max_f32 v252, v252, v253
    v_cvt_pk_bf16_f32 v137, v138, v139
    v_mul_f32 v254, s48, v252
    v_pk_fma_f32 v[144:145], v[144:145], s[48:49], v[250:251] op_sel_hi:[1,1,0] neg_lo:[0,0,1] neg_hi:[0,0,1]
    v_cvt_pk_bf16_f32 v138, v140, v141
    v_cvt_pk_bf16_f32 v139, v142, v143
    v_pk_fma_f32 v[148:149], v[148:149], s[48:49], v[254:255] op_sel_hi:[1,1,0] neg_lo:[0,0,1] neg_hi:[0,0,1]
    v_pk_fma_f32 v[146:147], v[146:147], s[48:49], v[250:251] op_sel_hi:[1,1,0] neg_lo:[0,0,1] neg_hi:[0,0,1]
    v_exp_f32 v144, v144
    v_exp_f32 v145, v145
    v_pk_fma_f32 v[150:151], v[150:151], s[48:49], v[254:255] op_sel_hi:[1,1,0] neg_lo:[0,0,1] neg_hi:[0,0,1]
    v_exp_f32 v148, v148
    v_exp_f32 v149, v149
    v_exp_f32 v146, v146
    v_exp_f32 v147, v147
    v_mfma_f32_16x16x32_bf16 v[224:227], v[232:235], v[136:139], 0
    v_exp_f32 v150, v150
    v_exp_f32 v151, v151
    v_pk_fma_f32 v[152:153], v[152:153], s[48:49], v[254:255] op_sel_hi:[1,1,0] neg_lo:[0,0,1] neg_hi:[0,0,1]
    v_pk_fma_f32 v[154:155], v[154:155], s[48:49], v[254:255] op_sel_hi:[1,1,0] neg_lo:[0,0,1] neg_hi:[0,0,1]
    v_cvt_pk_bf16_f32 v144, v144, v145
    v_exp_f32 v152, v152
    v_exp_f32 v153, v153
    v_exp_f32 v154, v154
    v_exp_f32 v155, v155
    v_cvt_pk_bf16_f32 v148, v148, v149
    v_cvt_pk_bf16_f32 v145, v146, v147
    v_cvt_pk_bf16_f32 v149, v150, v151
    v_mfma_f32_16x16x32_bf16 v[160:163], a[64:67], v[136:139], 0
    v_pk_fma_f32 v[156:157], v[156:157], s[48:49], v[254:255] op_sel_hi:[1,1,0] neg_lo:[0,0,1] neg_hi:[0,0,1]
    v_cvt_pk_bf16_f32 v150, v152, v153
    v_cvt_pk_bf16_f32 v151, v154, v155
    v_mfma_f32_16x16x32_bf16 v[168:171], a[72:75], v[136:139], 0
    v_cndmask_b32 v240, v144, 0, s[50:51]
    v_cndmask_b32 v241, v145, 0, s[50:51]
    v_mfma_f32_16x16x16_bf16 v[224:227], v[236:237], v[144:145], v[224:227]
    v_pk_fma_f32 v[158:159], v[158:159], s[48:49], v[254:255] op_sel_hi:[1,1,0] neg_lo:[0,0,1] neg_hi:[0,0,1]
    v_exp_f32 v156, v156
    v_exp_f32 v157, v157
    v_mfma_f32_16x16x32_bf16 v[164:167], a[68:71], v[136:139], 0
    v_exp_f32 v158, v158
    v_mfma_f32_16x16x32_bf16 v[176:179], a[80:83], v[136:139], 0
    v_exp_f32 v159, v159
    v_mfma_f32_16x16x32_bf16 v[228:231], v[232:235], v[148:151], 0
    v_cndmask_b32 v242, 0, v144, s[50:51]
    v_cndmask_b32 v243, 0, v145, s[50:51]
    v_mfma_f32_16x16x32_bf16 v[172:175], a[76:79], v[136:139], 0
    v_cvt_pk_bf16_f32 v156, v156, v157
    v_cvt_pk_bf16_f32 v157, v158, v159
    v_mfma_f32_16x16x32_bf16 v[184:187], a[88:91], v[136:139], 0
    v_cndmask_b32 v244, v156, 0, s[50:51]
    v_cndmask_b32 v245, v157, 0, s[50:51]
    v_mfma_f32_16x16x16_bf16 v[160:163], v[128:129], v[240:241], v[160:163]
    v_rcp_f32 v224, v224
    v_mfma_f32_16x16x32_bf16 v[180:183], a[84:87], v[136:139], 0
    v_cndmask_b32 v246, 0, v156, s[50:51]
    v_cndmask_b32 v247, 0, v157, s[50:51]
    v_mfma_f32_16x16x16_bf16 v[168:171], v[130:131], v[240:241], v[168:171]
    s_nop 1
    v_pk_mul_f32 v[160:161], v[160:161], v[224:225] op_sel_hi:[1,0]
    v_pk_mul_f32 v[162:163], v[162:163], v[224:225] op_sel_hi:[1,0]
    v_mfma_f32_16x16x32_bf16 v[188:191], a[92:95], v[136:139], 0
    v_cvt_pk_bf16_f32 v160, v160, v161
    v_cvt_pk_bf16_f32 v161, v162, v163
    v_mfma_f32_16x16x32_bf16 v[192:195], a[64:67], v[148:151], 0
    v_pk_mul_f32 v[168:169], v[168:169], v[224:225] op_sel_hi:[1,0]
    v_pk_mul_f32 v[170:171], v[170:171], v[224:225] op_sel_hi:[1,0]
    v_mfma_f32_16x16x16_bf16 v[164:167], v[128:129], v[242:243], v[164:167]
    v_cvt_pk_bf16_f32 v168, v168, v169
    v_cvt_pk_bf16_f32 v169, v170, v171
    v_mfma_f32_16x16x16_bf16 v[176:179], v[132:133], v[240:241], v[176:179]
    v_mfma_f32_16x16x32_bf16 v[200:203], a[72:75], v[148:151], 0
    s_nop 2
    v_pk_mul_f32 v[164:165], v[164:165], v[224:225] op_sel_hi:[1,0]
    v_pk_mul_f32 v[166:167], v[166:167], v[224:225] op_sel_hi:[1,0]
    v_mfma_f32_16x16x16_bf16 v[228:231], v[236:237], v[156:157], v[228:231]
    v_pk_mul_f32 v[176:177], v[176:177], v[224:225] op_sel_hi:[1,0]
    v_cvt_pk_bf16_f32 v162, v164, v165
    v_mfma_f32_16x16x16_bf16 v[172:175], v[130:131], v[242:243], v[172:175]
    v_cvt_pk_bf16_f32 v163, v166, v167
    v_pk_mul_f32 v[178:179], v[178:179], v[224:225] op_sel_hi:[1,0]
    v_mfma_f32_16x16x16_bf16 v[184:187], v[134:135], v[240:241], v[184:187]
    buffer_store_dwordx4 v[160:163], v2, s[4:7], s47 offen offset:0 sc1
    v_mfma_f32_16x16x32_bf16 v[196:199], a[68:71], v[148:151], 0
    v_rcp_f32 v228, v228
    v_mfma_f32_16x16x32_bf16 v[208:211], a[80:83], v[148:151], 0
    v_pk_mul_f32 v[172:173], v[172:173], v[224:225] op_sel_hi:[1,0]
    v_pk_mul_f32 v[174:175], v[174:175], v[224:225] op_sel_hi:[1,0]
    v_mfma_f32_16x16x16_bf16 v[180:183], v[132:133], v[242:243], v[180:183]
    v_cvt_pk_bf16_f32 v176, v176, v177
    v_pk_mul_f32 v[184:185], v[184:185], v[224:225] op_sel_hi:[1,0]
    v_mfma_f32_16x16x32_bf16 v[204:207], a[76:79], v[148:151], 0
    v_cvt_pk_bf16_f32 v170, v172, v173
    v_cvt_pk_bf16_f32 v171, v174, v175
    v_mfma_f32_16x16x32_bf16 v[216:219], a[88:91], v[148:151], 0
    buffer_store_dwordx4 v[168:171], v2, s[4:7], s47 offen offset:1024 sc1
    v_mfma_f32_16x16x16_bf16 v[188:191], v[134:135], v[242:243], v[188:191]
    v_cvt_pk_bf16_f32 v177, v178, v179
    v_pk_mul_f32 v[180:181], v[180:181], v[224:225] op_sel_hi:[1,0]
    v_mfma_f32_16x16x16_bf16 v[192:195], v[128:129], v[244:245], v[192:195]
    v_pk_mul_f32 v[182:183], v[182:183], v[224:225] op_sel_hi:[1,0]
    v_pk_mul_f32 v[186:187], v[186:187], v[224:225] op_sel_hi:[1,0]
    v_mfma_f32_16x16x32_bf16 v[212:215], a[84:87], v[148:151], 0
    v_cvt_pk_bf16_f32 v184, v184, v185
    v_cvt_pk_bf16_f32 v178, v180, v181
    v_mfma_f32_16x16x16_bf16 v[200:203], v[130:131], v[244:245], v[200:203]
    v_cvt_pk_bf16_f32 v179, v182, v183
    v_cvt_pk_bf16_f32 v185, v186, v187
    v_mfma_f32_16x16x32_bf16 v[220:223], a[92:95], v[148:151], 0
    buffer_store_dwordx4 v[176:179], v2, s[4:7], s47 offen offset:2048 sc1
    v_mfma_f32_16x16x16_bf16 v[196:199], v[128:129], v[246:247], v[196:199]
    v_pk_mul_f32 v[188:189], v[188:189], v[224:225] op_sel_hi:[1,0]
    v_pk_mul_f32 v[190:191], v[190:191], v[224:225] op_sel_hi:[1,0]
    v_mfma_f32_16x16x16_bf16 v[208:211], v[132:133], v[244:245], v[208:211]
    v_pk_mul_f32 v[192:193], v[192:193], v[228:229] op_sel_hi:[1,0]
    v_cvt_pk_bf16_f32 v186, v188, v189
    v_mfma_f32_16x16x16_bf16 v[204:207], v[130:131], v[246:247], v[204:207]
    v_cvt_pk_bf16_f32 v187, v190, v191
    v_pk_mul_f32 v[194:195], v[194:195], v[228:229] op_sel_hi:[1,0]
    v_mfma_f32_16x16x16_bf16 v[216:219], v[134:135], v[244:245], v[216:219]
    buffer_store_dwordx4 v[184:187], v2, s[4:7], s47 offen offset:3072 sc1
    v_mfma_f32_16x16x16_bf16 v[212:215], v[132:133], v[246:247], v[212:215]
    s_add_u32 s47, s47, 4096
    v_cvt_pk_bf16_f32 v192, v192, v193
    v_pk_mul_f32 v[200:201], v[200:201], v[228:229] op_sel_hi:[1,0]
    v_mfma_f32_16x16x16_bf16 v[220:223], v[134:135], v[246:247], v[220:223]
    v_cvt_pk_bf16_f32 v193, v194, v195
    v_pk_mul_f32 v[196:197], v[196:197], v[228:229] op_sel_hi:[1,0]
    v_pk_mul_f32 v[198:199], v[198:199], v[228:229] op_sel_hi:[1,0]
    v_pk_mul_f32 v[202:203], v[202:203], v[228:229] op_sel_hi:[1,0]
    v_cvt_pk_bf16_f32 v200, v200, v201
    v_pk_mul_f32 v[208:209], v[208:209], v[228:229] op_sel_hi:[1,0]
    v_cvt_pk_bf16_f32 v194, v196, v197
    v_cvt_pk_bf16_f32 v195, v198, v199
    v_cvt_pk_bf16_f32 v201, v202, v203
    v_pk_mul_f32 v[204:205], v[204:205], v[228:229] op_sel_hi:[1,0]
    v_pk_mul_f32 v[206:207], v[206:207], v[228:229] op_sel_hi:[1,0]
    v_pk_mul_f32 v[210:211], v[210:211], v[228:229] op_sel_hi:[1,0]
    v_cvt_pk_bf16_f32 v208, v208, v209
    v_pk_mul_f32 v[216:217], v[216:217], v[228:229] op_sel_hi:[1,0]
    buffer_store_dwordx4 v[192:195], v2, s[4:7], s47 offen offset:0 sc1
    v_cvt_pk_bf16_f32 v202, v204, v205
    v_cvt_pk_bf16_f32 v203, v206, v207
    v_cvt_pk_bf16_f32 v209, v210, v211
    v_pk_mul_f32 v[212:213], v[212:213], v[228:229] op_sel_hi:[1,0]
    v_pk_mul_f32 v[214:215], v[214:215], v[228:229] op_sel_hi:[1,0]
    v_pk_mul_f32 v[218:219], v[218:219], v[228:229] op_sel_hi:[1,0]
    v_cvt_pk_bf16_f32 v216, v216, v217
    buffer_store_dwordx4 v[200:203], v2, s[4:7], s47 offen offset:1024 sc1
    v_cvt_pk_bf16_f32 v210, v212, v213
    v_cvt_pk_bf16_f32 v211, v214, v215
    v_cvt_pk_bf16_f32 v217, v218, v219
    v_pk_mul_f32 v[220:221], v[220:221], v[228:229] op_sel_hi:[1,0]
    v_pk_mul_f32 v[222:223], v[222:223], v[228:229] op_sel_hi:[1,0]
    buffer_store_dwordx4 v[208:211], v2, s[4:7], s47 offen offset:2048 sc1
    v_cvt_pk_bf16_f32 v218, v220, v221
    v_cvt_pk_bf16_f32 v219, v222, v223
    buffer_store_dwordx4 v[216:219], v2, s[4:7], s47 offen offset:3072 sc1
    s_cmp_ge_u32 s22, 62
    s_cbranch_scc1 lastit_m_117
    s_add_u32 s28, s59, 1
    s_cmp_ge_u32 s58, s28
    s_cbranch_scc1 qok_m_119
    s_lshr_b32 s27, s45, 1
    v_min_u32 v10, 2, v1
    v_mul_u32_u24 v10, 64, v10
    s_lshr_b32 s29, s27, 6
    s_lshl_b32 s29, s29, 8
    s_and_b32 s92, s27, 63
    s_lshl_b32 s92, s92, 2
    s_add_u32 s29, s29, s92
    s_add_u32 s29, s29, 184287488
    buffer_load_dword v11, v10, s[4:7], s29 offen sc1
    s_waitcnt vmcnt(0)
    v_cmp_gt_u32 vcc, s28, v11
    s_nop 0
    s_cbranch_vccz fok_m_120
L_m_121:
    s_sleep 8
    s_sub_u32 s23, s23, 1
    s_cbranch_scc1 abatt_m_102
    buffer_load_dword v11, v10, s[4:7], s29 offen sc1
    s_waitcnt vmcnt(0)
    v_cmp_gt_u32 vcc, s28, v11
    s_nop 0
    s_cbranch_vccnz L_m_121
fok_m_120:
    v_readlane_b32 s58, v11, 0
    v_readlane_b32 s27, v11, 1
    v_readlane_b32 s28, v11, 2
    s_min_u32 s58, s58, s27
    s_min_u32 s58, s58, s28
    s_nop 2
qok_m_119:
    s_lshl_b32 s24, s59, 5
    s_add_u32 s24, s24, s45
    s_lshl_b32 s24, s24, 13
    s_add_u32 s25, s24, 20971520
    s_add_u32 s26, s24, 20975616
    buffer_load_dwordx4 a[128:131], v2, s[4:7], s25 offen offset:0
    buffer_load_dwordx4 a[132:135], v2, s[4:7], s25 offen offset:1024
    buffer_load_dwordx4 a[136:139], v2, s[4:7], s25 offen offset:2048
    buffer_load_dwordx4 a[140:143], v2, s[4:7], s25 offen offset:3072
    buffer_load_dwordx4 a[144:147], v2, s[4:7], s26 offen offset:0
    buffer_load_dwordx4 a[148:151], v2, s[4:7], s26 offen offset:1024
    buffer_load_dwordx4 a[152:155], v2, s[4:7], s26 offen offset:2048
    buffer_load_dwordx4 a[156:159], v2, s[4:7], s26 offen offset:3072
    s_add_u32 s25, s24, 4194304
    s_add_u32 s26, s24, 4198400
    buffer_load_dwordx4 a[96:99], v2, s[4:7], s25 offen offset:0
    buffer_load_dwordx4 a[100:103], v2, s[4:7], s25 offen offset:1024
    buffer_load_dwordx4 a[104:107], v2, s[4:7], s25 offen offset:2048
    buffer_load_dwordx4 a[108:111], v2, s[4:7], s25 offen offset:3072
    buffer_load_dwordx4 a[112:115], v2, s[4:7], s26 offen offset:0
    buffer_load_dwordx4 a[116:119], v2, s[4:7], s26 offen offset:1024
    buffer_load_dwordx4 a[120:123], v2, s[4:7], s26 offen offset:2048
    buffer_load_dwordx4 a[124:127], v2, s[4:7], s26 offen offset:3072
    s_add_u32 s25, s24, 37748736
    s_add_u32 s26, s24, 37752832
    buffer_load_dwordx4 a[160:163], v2, s[4:7], s25 offen offset:0
    buffer_load_dwordx4 a[164:167], v2, s[4:7], s25 offen offset:1024
    buffer_load_dwordx4 a[168:171], v2, s[4:7], s25 offen offset:2048
    buffer_load_dwordx4 a[172:175], v2, s[4:7], s25 offen offset:3072
    buffer_load_dwordx4 a[176:179], v2, s[4:7], s26 offen offset:0
    buffer_load_dwordx4 a[180:183], v2, s[4:7], s26 offen offset:1024
    buffer_load_dwordx4 a[184:187], v2, s[4:7], s26 offen offset:2048
    buffer_load_dwordx4 a[188:191], v2, s[4:7], s26 offen offset:3072
    s_waitcnt vmcnt(24)
    s_branch joined_m_118
lastit_m_117:
    s_waitcnt vmcnt(0)
joined_m_118:
    s_add_u32 s28, s22, 1
    s_lshr_b32 s29, s44, 2
    s_lshl_b32 s29, s29, 8
    s_and_b32 s92, s44, 3
    s_lshl_b32 s92, s92, 2
    s_add_u32 s29, s29, s92
    s_add_u32 s29, s29, 184296448
    v_mov_b32 v11, s28
    buffer_store_dword v11, off, s[4:7], s29 sc1
    s_add_u32 s22, s22, 2
    s_cmp_lt_u32 s22, 64
    s_cbranch_scc0 attdone_m_109
    s_lshl_b32 s46, s22, 5
    s_add_u32 s46, s46, s45
    s_waitcnt vmcnt(0)
    v_mfma_f32_16x16x32_bf16 v[136:139], a[128:131], a[96:99], 0
    v_mfma_f32_16x16x32_bf16 v[140:143], a[144:147], a[96:99], 0
    v_mfma_f32_16x16x32_bf16 v[148:151], a[128:131], a[112:115], 0
    v_mfma_f32_16x16x32_bf16 v[152:155], a[144:147], a[112:115], 0
    v_mfma_f32_16x16x32_bf16 v[136:139], a[132:135], a[100:103], v[136:139]
    v_mfma_f32_16x16x32_bf16 v[140:143], a[148:151], a[100:103], v[140:143]
    v_mfma_f32_16x16x32_bf16 v[148:151], a[132:135], a[116:119], v[148:151]
    v_mfma_f32_16x16x32_bf16 v[152:155], a[148:151], a[116:119], v[152:155]
    v_mfma_f32_16x16x32_bf16 v[136:139], a[136:139], a[104:107], v[136:139]
    v_mfma_f32_16x16x32_bf16 v[140:143], a[152:155], a[104:107], v[140:143]
    v_mfma_f32_16x16x32_bf16 v[148:151], a[136:139], a[120:123], v[148:151]
    v_mfma_f32_16x16x32_bf16 v[152:155], a[152:155], a[120:123], v[152:155]
    v_mfma_f32_16x16x32_bf16 v[136:139], a[140:143], a[108:111], v[136:139]
    v_mfma_f32_16x16x32_bf16 v[140:143], a[156:159], a[108:111], v[140:143]
    v_mfma_f32_16x16x32_bf16 v[148:151], a[140:143], a[124:127], v[148:151]
    v_cndmask_b32 v136, v136, v8, s[60:61]
    v_cndmask_b32 v137, v137, v8, s[62:63]
    v_mfma_f32_16x16x32_bf16 v[152:155], a[156:159], a[124:127], v[152:155]
    v_cndmask_b32 v138, v138, v8, s[64:65]
    v_cndmask_b32 v139, v139, v8, s[66:67]
    v_cndmask_b32 v140, v140, v8, s[68:69]
    v_cndmask_b32 v141, v141, v8, s[70:71]
    v_cndmask_b32 v142, v142, v8, s[72:73]
    v_cndmask_b32 v143, v143, v8, s[74:75]
    v_cndmask_b32 v148, v148, v8, s[76:77]
    v_cndmask_b32 v149, v149, v8, s[78:79]
    v_cndmask_b32 v150, v150, v8, s[80:81]
    v_cndmask_b32 v151, v151, v8, s[82:83]
    v_cndmask_b32 v152, v152, v8, s[84:85]
    v_cndmask_b32 v153, v153, v8, s[86:87]
    v_cndmask_b32 v154, v154, v8, s[88:89]
    v_cndmask_b32 v155, v155, v8, s[90:91]
    s_lshl_b32 s47, s46, 13
    s_add_u32 s47, s47, 54525952
    s_add_u32 s59, s22, 2
    s_min_u32 s59, s59, 63
    s_lshl_b32 s24, s46, 11
    s_add_u32 s25, s24, 75497472
    s_add_u32 s24, s24, 201326592
    s_lshl_b32 m0, s21, 11
    s_add_u32 s28, s22, 1
    s_cmp_lt_u32 s22, 60
    s_cbranch_scc1 mreg_m_123
    s_lshr_b32 s29, s45, 0
    s_lshl_b32 s29, s29, 8
    s_add_u32 s29, s29, 184288256
    s_branch mfirst_m_125
L_m_126:
    s_sleep 16
    s_sub_u32 s23, s23, 1
    s_cbranch_scc1 abatt_m_102
mfirst_m_125:
    buffer_load_dword v13, off, s[4:7], s29 sc1
    buffer_load_dwordx4 v2, s[4:7], s24 offen offset:0 sc1 lds
    buffer_load_dwordx4 v2, s[4:7], s24 offen offset:1024 sc1 lds
    buffer_load_dwordx2 v[128:129], v7, s[4:7], s25 offen offset:0 sc1
    buffer_load_dwordx2 v[130:131], v7, s[4:7], s25 offen offset:512 sc1
    buffer_load_dwordx2 v[132:133], v7, s[4:7], s25 offen offset:1024 sc1
    buffer_load_dwordx2 v[134:135], v7, s[4:7], s25 offen offset:1536 sc1
    s_waitcnt vmcnt(4)
    ds_read_b128 v[80:83], v12 offset:0
    ds_read_b128 v[84:87], v12 offset:1024
    s_waitcnt vmcnt(2)
    v_max3_u32 v10, v128, v129, v130
    s_waitcnt vmcnt(1)
    v_max3_u32 v10, v10, v131, v132
    s_waitcnt vmcnt(0)
    v_max3_u32 v11, v133, v134, v135
    s_waitcnt lgkmcnt(1)
    v_max3_u32 v10, v10, v80, v81
    v_max3_u32 v11, v11, v82, v83
    s_waitcnt lgkmcnt(0)
    v_max3_u32 v10, v10, v84, v85
    v_max3_u32 v11, v11, v86, v87
    v_max_u32 v10, v10, v11
    v_cmp_eq_u32 vcc, -1, v10
    s_nop 0
    s_cbranch_vccz mgot_m_122
    v_cmp_gt_u32 vcc, s28, v13
    s_nop 0
    s_cbranch_vccnz L_m_126
    s_branch mflag_m_124
mreg_m_123:
    v_min_u32 v10, 0, v1
    v_mul_u32_u24 v10, 4, v10
    s_lshr_b32 s29, s45, 0
    s_lshl_b32 s29, s29, 8
    s_add_u32 s29, s29, 184288256
    buffer_load_dword v11, v10, s[4:7], s29 offen sc1
    s_waitcnt vmcnt(0)
    v_cmp_gt_u32 vcc, s28, v11
    s_nop 0
    s_cbranch_vccz fok_m_127
L_m_128:
    s_sleep 8
    s_sub_u32 s23, s23, 1
    s_cbranch_scc1 abatt_m_102
    buffer_load_dword v11, v10, s[4:7], s29 offen sc1
    s_waitcnt vmcnt(0)
    v_cmp_gt_u32 vcc, s28, v11
    s_nop 0
    s_cbranch_vccnz L_m_128
fok_m_127:
mflag_m_124:
    buffer_load_dwordx4 v2, s[4:7], s24 offen offset:0 sc1 lds
    buffer_load_dwordx4 v2, s[4:7], s24 offen offset:1024 sc1 lds
    buffer_load_dwordx2 v[128:129], v7, s[4:7], s25 offen offset:0 sc1
    buffer_load_dwordx2 v[130:131], v7, s[4:7], s25 offen offset:512 sc1
    buffer_load_dwordx2 v[132:133], v7, s[4:7], s25 offen offset:1024 sc1
    buffer_load_dwordx2 v[134:135], v7, s[4:7], s25 offen offset:1536 sc1
    s_waitcnt vmcnt(0)
mgot_m_122:
    ds_read_b64_tr_b16 v[80:81], v9 offset:0
    ds_read_b64_tr_b16 v[82:83], v9 offset:128
    ds_read_b64_tr_b16 v[84:85], v9 offset:512
    ds_read_b64_tr_b16 v[86:87], v9 offset:640
    ds_read_b64_tr_b16 v[88:89], v9 offset:1024
    ds_read_b64_tr_b16 v[90:91], v9 offset:1152
    ds_read_b64_tr_b16 v[92:93], v9 offset:1536
    ds_read_b64_tr_b16 v[94:95], v9 offset:1664
    s_waitcnt lgkmcnt(6)
    v_mfma_f32_16x16x32_bf16 v[144:147], v[80:83], a[96:99], 0
    v_max3_f32 v248, v136, v137, v138
    v_max3_f32 v249, v139, v140, v141
    s_waitcnt lgkmcnt(4)
    v_mfma_f32_16x16x32_bf16 v[144:147], v[84:87], a[100:103], v[144:147]
    v_max3_f32 v248, v248, v142, v143
    v_max_f32 v248, v248, v249
    v_mfma_f32_16x16x32_bf16 v[156:159], v[80:83], a[112:115], 0
    v_mov_b32 v249, v248
    v_max3_f32 v252, v148, v149, v150
    s_waitcnt lgkmcnt(2)
    v_mfma_f32_16x16x32_bf16 v[144:147], v[88:91], a[104:107], v[144:147]
    v_permlane32_swap_b32 v248, v249
    v_mfma_f32_16x16x32_bf16 v[156:159], v[84:87], a[116:119], v[156:159]
    v_max3_f32 v253, v151, v152, v153
    v_max3_f32 v252, v252, v154, v155
    s_waitcnt lgkmcnt(0)
    v_mfma_f32_16x16x32_bf16 v[144:147], v[92:95], a[108:111], v[144:147]
    v_max_f32 v252, v252, v253
    v_mov_b32 v253, v252
    v_mfma_f32_16x16x32_bf16 v[156:159], v[88:91], a[120:123], v[156:159]
    s_nop 0
    v_permlane32_swap_b32 v252, v253
    v_mfma_f32_16x16x32_bf16 v[156:159], v[92:95], a[124:127], v[156:159]
    v_max3_f32 v248, v248, v249, v144
    v_max3_f32 v249, v145, v146, v147
    v_max_f32 v248, v248, v249
    v_mov_b32 v249, v248
    s_nop 1
    v_permlane16_swap_b32 v248, v249
    s_nop 0
    v_max3_f32 v252, v252, v253, v156
    v_max3_f32 v253, v157, v158, v159
    v_max_f32 v248, v248, v249
    v_max_f32 v252, v252, v253
    v_mul_f32 v250, s48, v248
    v_mov_b32 v253, v252
    v_pk_fma_f32 v[136:137], v[136:137], s[48:49], v[250:251] op_sel_hi:[1,1,0] neg_lo:[0,0,1] neg_hi:[0,0,1]
    v_pk_fma_f32 v[138:139], v[138:139], s[48:49], v[250:251] op_sel_hi:[1,1,0] neg_lo:[0,0,1] neg_hi:[0,0,1]
    v_exp_f32 v136, v136
    v_exp_f32 v137, v137
    v_permlane16_swap_b32 v252, v253
    v_exp_f32 v138, v138
    v_exp_f32 v139, v139
    v_pk_fma_f32 v[140:141], v[140:141], s[48:49], v[250:251] op_sel_hi:[1,1,0] neg_lo:[0,0,1] neg_hi:[0,0,1]
    v_pk_fma_f32 v[142:143], v[142:143], s[48:49], v[250:251] op_sel_hi:[1,1,0] neg_lo:[0,0,1] neg_hi:[0,0,1]
    v_exp_f32 v140, v140
    v_exp_f32 v141, v141
    v_exp_f32 v142, v142
    v_exp_f32 v143, v143
    v_cvt_pk_bf16_f32 v136, v136, v137
    v_max_f32 v252, v252, v253
    v_cvt_pk_bf16_f32 v137, v138, v139
    v_mul_f32 v254, s48, v252
    v_pk_fma_f32 v[144:145], v[144:145], s[48:49], v[250:251] op_sel_hi:[1,1,0] neg_lo:[0,0,1] neg_hi:[0,0,1]
    v_cvt_pk_bf16_f32 v138, v140, v141
    v_cvt_pk_bf16_f32 v139, v142, v143
    v_pk_fma_f32 v[148:149], v[148:149], s[48:49], v[254:255] op_sel_hi:[1,1,0] neg_lo:[0,0,1] neg_hi:[0,0,1]
    v_pk_fma_f32 v[146:147], v[146:147], s[48:49], v[250:251] op_sel_hi:[1,1,0] neg_lo:[0,0,1] neg_hi:[0,0,1]
    v_exp_f32 v144, v144
    v_exp_f32 v145, v145
    v_pk_fma_f32 v[150:151], v[150:151], s[48:49], v[254:255] op_sel_hi:[1,1,0] neg_lo:[0,0,1] neg_hi:[0,0,1]
    v_exp_f32 v148, v148
    v_exp_f32 v149, v149
    v_exp_f32 v146, v146
    v_exp_f32 v147, v147
    v_mfma_f32_16x16x32_bf16 v[224:227], v[232:235], v[136:139], 0
    v_exp_f32 v150, v150
    v_exp_f32 v151, v151
    v_pk_fma_f32 v[152:153], v[152:153], s[48:49], v[254:255] op_sel_hi:[1,1,0] neg_lo:[0,0,1] neg_hi:[0,0,1]
    v_pk_fma_f32 v[154:155], v[154:155], s[48:49], v[254:255] op_sel_hi:[1,1,0] neg_lo:[0,0,1] neg_hi:[0,0,1]
    v_cvt_pk_bf16_f32 v144, v144, v145
    v_exp_f32 v152, v152
    v_exp_f32 v153, v153
    v_exp_f32 v154, v154
    v_exp_f32 v155, v155
    v_cvt_pk_bf16_f32 v148, v148, v149
    v_cvt_pk_bf16_f32 v145, v146, v147
    v_cvt_pk_bf16_f32 v149, v150, v151
    v_mfma_f32_16x16x32_bf16 v[160:163], a[160:163], v[136:139], 0
    v_pk_fma_f32 v[156:157], v[156:157], s[48:49], v[254:255] op_sel_hi:[1,1,0] neg_lo:[0,0,1] neg_hi:[0,0,1]
    v_cvt_pk_bf16_f32 v150, v152, v153
    v_cvt_pk_bf16_f32 v151, v154, v155
    v_mfma_f32_16x16x32_bf16 v[168:171], a[168:171], v[136:139], 0
    v_cndmask_b32 v240, v144, 0, s[50:51]
    v_cndmask_b32 v241, v145, 0, s[50:51]
    v_mfma_f32_16x16x16_bf16 v[224:227], v[236:237], v[144:145], v[224:227]
    v_pk_fma_f32 v[158:159], v[158:159], s[48:49], v[254:255] op_sel_hi:[1,1,0] neg_lo:[0,0,1] neg_hi:[0,0,1]
    v_exp_f32 v156, v156
    v_exp_f32 v157, v157
    v_mfma_f32_16x16x32_bf16 v[164:167], a[164:167], v[136:139], 0
    v_exp_f32 v158, v158
    v_mfma_f32_16x16x32_bf16 v[176:179], a[176:179], v[136:139], 0
    v_exp_f32 v159, v159
    v_mfma_f32_16x16x32_bf16 v[228:231], v[232:235], v[148:151], 0
    v_cndmask_b32 v242, 0, v144, s[50:51]
    v_cndmask_b32 v243, 0, v145, s[50:51]
    v_mfma_f32_16x16x32_bf16 v[172:175], a[172:175], v[136:139], 0
    v_cvt_pk_bf16_f32 v156, v156, v157
    v_cvt_pk_bf16_f32 v157, v158, v159
    v_mfma_f32_16x16x32_bf16 v[184:187], a[184:187], v[136:139], 0
    v_cndmask_b32 v244, v156, 0, s[50:51]
    v_cndmask_b32 v245, v157, 0, s[50:51]
    v_mfma_f32_16x16x16_bf16 v[160:163], v[128:129], v[240:241], v[160:163]
    v_rcp_f32 v224, v224
    v_mfma_f32_16x16x32_bf16 v[180:183], a[180:183], v[136:139], 0
    v_cndmask_b32 v246, 0, v156, s[50:51]
    v_cndmask_b32 v247, 0, v157, s[50:51]
    v_mfma_f32_16x16x16_bf16 v[168:171], v[130:131], v[240:241], v[168:171]
    s_nop 1
    v_pk_mul_f32 v[160:161], v[160:161], v[224:225] op_sel_hi:[1,0]
    v_pk_mul_f32 v[162:163], v[162:163], v[224:225] op_sel_hi:[1,0]
    v_mfma_f32_16x16x32_bf16 v[188:191], a[188:191], v[136:139], 0
    v_cvt_pk_bf16_f32 v160, v160, v161
    v_cvt_pk_bf16_f32 v161, v162, v163
    v_mfma_f32_16x16x32_bf16 v[192:195], a[160:163], v[148:151], 0
    v_pk_mul_f32 v[168:169], v[168:169], v[224:225] op_sel_hi:[1,0]
    v_pk_mul_f32 v[170:171], v[170:171], v[224:225] op_sel_hi:[1,0]
    v_mfma_f32_16x16x16_bf16 v[164:167], v[128:129], v[242:243], v[164:167]
    v_cvt_pk_bf16_f32 v168, v168, v169
    v_cvt_pk_bf16_f32 v169, v170, v171
    v_mfma_f32_16x16x16_bf16 v[176:179], v[132:133], v[240:241], v[176:179]
    v_mfma_f32_16x16x32_bf16 v[200:203], a[168:171], v[148:151], 0
    s_nop 2
    v_pk_mul_f32 v[164:165], v[164:165], v[224:225] op_sel_hi:[1,0]
    v_pk_mul_f32 v[166:167], v[166:167], v[224:225] op_sel_hi:[1,0]
    v_mfma_f32_16x16x16_bf16 v[228:231], v[236:237], v[156:157], v[228:231]
    v_pk_mul_f32 v[176:177], v[176:177], v[224:225] op_sel_hi:[1,0]
    v_cvt_pk_bf16_f32 v162, v164, v165
    v_mfma_f32_16x16x16_bf16 v[172:175], v[130:131], v[242:243], v[172:175]
    v_cvt_pk_bf16_f32 v163, v166, v167
    v_pk_mul_f32 v[178:179], v[178:179], v[224:225] op_sel_hi:[1,0]
    v_mfma_f32_16x16x16_bf16 v[184:187], v[134:135], v[240:241], v[184:187]
    buffer_store_dwordx4 v[160:163], v2, s[4:7], s47 offen offset:0 sc1
    v_mfma_f32_16x16x32_bf16 v[196:199], a[164:167], v[148:151], 0
    v_rcp_f32 v228, v228
    v_mfma_f32_16x16x32_bf16 v[208:211], a[176:179], v[148:151], 0
    v_pk_mul_f32 v[172:173], v[172:173], v[224:225] op_sel_hi:[1,0]
    v_pk_mul_f32 v[174:175], v[174:175], v[224:225] op_sel_hi:[1,0]
    v_mfma_f32_16x16x16_bf16 v[180:183], v[132:133], v[242:243], v[180:183]
    v_cvt_pk_bf16_f32 v176, v176, v177
    v_pk_mul_f32 v[184:185], v[184:185], v[224:225] op_sel_hi:[1,0]
    v_mfma_f32_16x16x32_bf16 v[204:207], a[172:175], v[148:151], 0
    v_cvt_pk_bf16_f32 v170, v172, v173
    v_cvt_pk_bf16_f32 v171, v174, v175
    v_mfma_f32_16x16x32_bf16 v[216:219], a[184:187], v[148:151], 0
    buffer_store_dwordx4 v[168:171], v2, s[4:7], s47 offen offset:1024 sc1
    v_mfma_f32_16x16x16_bf16 v[188:191], v[134:135], v[242:243], v[188:191]
    v_cvt_pk_bf16_f32 v177, v178, v179
    v_pk_mul_f32 v[180:181], v[180:181], v[224:225] op_sel_hi:[1,0]
    v_mfma_f32_16x16x16_bf16 v[192:195], v[128:129], v[244:245], v[192:195]
    v_pk_mul_f32 v[182:183], v[182:183], v[224:225] op_sel_hi:[1,0]
    v_pk_mul_f32 v[186:187], v[186:187], v[224:225] op_sel_hi:[1,0]
    v_mfma_f32_16x16x32_bf16 v[212:215], a[180:183], v[148:151], 0
    v_cvt_pk_bf16_f32 v184, v184, v185
    v_cvt_pk_bf16_f32 v178, v180, v181
    v_mfma_f32_16x16x16_bf16 v[200:203], v[130:131], v[244:245], v[200:203]
    v_cvt_pk_bf16_f32 v179, v182, v183
    v_cvt_pk_bf16_f32 v185, v186, v187
    v_mfma_f32_16x16x32_bf16 v[220:223], a[188:191], v[148:151], 0
    buffer_store_dwordx4 v[176:179], v2, s[4:7], s47 offen offset:2048 sc1
    v_mfma_f32_16x16x16_bf16 v[196:199], v[128:129], v[246:247], v[196:199]
    v_pk_mul_f32 v[188:189], v[188:189], v[224:225] op_sel_hi:[1,0]
    v_pk_mul_f32 v[190:191], v[190:191], v[224:225] op_sel_hi:[1,0]
    v_mfma_f32_16x16x16_bf16 v[208:211], v[132:133], v[244:245], v[208:211]
    v_pk_mul_f32 v[192:193], v[192:193], v[228:229] op_sel_hi:[1,0]
    v_cvt_pk_bf16_f32 v186, v188, v189
    v_mfma_f32_16x16x16_bf16 v[204:207], v[130:131], v[246:247], v[204:207]
    v_cvt_pk_bf16_f32 v187, v190, v191
    v_pk_mul_f32 v[194:195], v[194:195], v[228:229] op_sel_hi:[1,0]
    v_mfma_f32_16x16x16_bf16 v[216:219], v[134:135], v[244:245], v[216:219]
    buffer_store_dwordx4 v[184:187], v2, s[4:7], s47 offen offset:3072 sc1
    v_mfma_f32_16x16x16_bf16 v[212:215], v[132:133], v[246:247], v[212:215]
    s_add_u32 s47, s47, 4096
    v_cvt_pk_bf16_f32 v192, v192, v193
    v_pk_mul_f32 v[200:201], v[200:201], v[228:229] op_sel_hi:[1,0]
    v_mfma_f32_16x16x16_bf16 v[220:223], v[134:135], v[246:247], v[220:223]
    v_cvt_pk_bf16_f32 v193, v194, v195
    v_pk_mul_f32 v[196:197], v[196:197], v[228:229] op_sel_hi:[1,0]
    v_pk_mul_f32 v[198:199], v[198:199], v[228:229] op_sel_hi:[1,0]
    v_pk_mul_f32 v[202:203], v[202:203], v[228:229] op_sel_hi:[1,0]
    v_cvt_pk_bf16_f32 v200, v200, v201
    v_pk_mul_f32 v[208:209], v[208:209], v[228:229] op_sel_hi:[1,0]
    v_cvt_pk_bf16_f32 v194, v196, v197
    v_cvt_pk_bf16_f32 v195, v198, v199
    v_cvt_pk_bf16_f32 v201, v202, v203
    v_pk_mul_f32 v[204:205], v[204:205], v[228:229] op_sel_hi:[1,0]
    v_pk_mul_f32 v[206:207], v[206:207], v[228:229] op_sel_hi:[1,0]
    v_pk_mul_f32 v[210:211], v[210:211], v[228:229] op_sel_hi:[1,0]
    v_cvt_pk_bf16_f32 v208, v208, v209
    v_pk_mul_f32 v[216:217], v[216:217], v[228:229] op_sel_hi:[1,0]
    buffer_store_dwordx4 v[192:195], v2, s[4:7], s47 offen offset:0 sc1
    v_cvt_pk_bf16_f32 v202, v204, v205
    v_cvt_pk_bf16_f32 v203, v206, v207
    v_cvt_pk_bf16_f32 v209, v210, v211
    v_pk_mul_f32 v[212:213], v[212:213], v[228:229] op_sel_hi:[1,0]
    v_pk_mul_f32 v[214:215], v[214:215], v[228:229] op_sel_hi:[1,0]
    v_pk_mul_f32 v[218:219], v[218:219], v[228:229] op_sel_hi:[1,0]
    v_cvt_pk_bf16_f32 v216, v216, v217
    buffer_store_dwordx4 v[200:203], v2, s[4:7], s47 offen offset:1024 sc1
    v_cvt_pk_bf16_f32 v210, v212, v213
    v_cvt_pk_bf16_f32 v211, v214, v215
    v_cvt_pk_bf16_f32 v217, v218, v219
    v_pk_mul_f32 v[220:221], v[220:221], v[228:229] op_sel_hi:[1,0]
    v_pk_mul_f32 v[222:223], v[222:223], v[228:229] op_sel_hi:[1,0]
    buffer_store_dwordx4 v[208:211], v2, s[4:7], s47 offen offset:2048 sc1
    v_cvt_pk_bf16_f32 v218, v220, v221
    v_cvt_pk_bf16_f32 v219, v222, v223
    buffer_store_dwordx4 v[216:219], v2, s[4:7], s47 offen offset:3072 sc1
    s_cmp_ge_u32 s22, 62
    s_cbranch_scc1 lastit_m_129
    s_add_u32 s28, s59, 1
    s_cmp_ge_u32 s58, s28
    s_cbranch_scc1 qok_m_131
    s_lshr_b32 s27, s45, 1
    v_min_u32 v10, 2, v1
    v_mul_u32_u24 v10, 64, v10
    s_lshr_b32 s29, s27, 6
    s_lshl_b32 s29, s29, 8
    s_and_b32 s92, s27, 63
    s_lshl_b32 s92, s92, 2
    s_add_u32 s29, s29, s92
    s_add_u32 s29, s29, 184287488
    buffer_load_dword v11, v10, s[4:7], s29 offen sc1
    s_waitcnt vmcnt(0)
    v_cmp_gt_u32 vcc, s28, v11
    s_nop 0
    s_cbranch_vccz fok_m_132
L_m_133:
    s_sleep 8
    s_sub_u32 s23, s23, 1
    s_cbranch_scc1 abatt_m_102
    buffer_load_dword v11, v10, s[4:7], s29 offen sc1
    s_waitcnt vmcnt(0)
    v_cmp_gt_u32 vcc, s28, v11
    s_nop 0
    s_cbranch_vccnz L_m_133
fok_m_132:
    v_readlane_b32 s58, v11, 0
    v_readlane_b32 s27, v11, 1
    v_readlane_b32 s28, v11, 2
    s_min_u32 s58, s58, s27
    s_min_u32 s58, s58, s28
    s_nop 2
qok_m_131:
    s_lshl_b32 s24, s59, 5
    s_add_u32 s24, s24, s45
    s_lshl_b32 s24, s24, 13
    s_add_u32 s25, s24, 20971520
    s_add_u32 s26, s24, 20975616
    buffer_load_dwordx4 a[32:35], v2, s[4:7], s25 offen offset:0
    buffer_load_dwordx4 a[36:39], v2, s[4:7], s25 offen offset:1024
    buffer_load_dwordx4 a[40:43], v2, s[4:7], s25 offen offset:2048
    buffer_load_dwordx4 a[44:47], v2, s[4:7], s25 offen offset:3072
    buffer_load_dwordx4 a[48:51], v2, s[4:7], s26 offen offset:0
    buffer_load_dwordx4 a[52:55], v2, s[4:7], s26 offen offset:1024
    buffer_load_dwordx4 a[56:59], v2, s[4:7], s26 offen offset:2048
    buffer_load_dwordx4 a[60:63], v2, s[4:7], s26 offen offset:3072
    s_add_u32 s25, s24, 4194304
    s_add_u32 s26, s24, 4198400
    buffer_load_dwordx4 a[0:3], v2, s[4:7], s25 offen offset:0
    buffer_load_dwordx4 a[4:7], v2, s[4:7], s25 offen offset:1024
    buffer_load_dwordx4 a[8:11], v2, s[4:7], s25 offen offset:2048
    buffer_load_dwordx4 a[12:15], v2, s[4:7], s25 offen offset:3072
    buffer_load_dwordx4 a[16:19], v2, s[4:7], s26 offen offset:0
    buffer_load_dwordx4 a[20:23], v2, s[4:7], s26 offen offset:1024
    buffer_load_dwordx4 a[24:27], v2, s[4:7], s26 offen offset:2048
    buffer_load_dwordx4 a[28:31], v2, s[4:7], s26 offen offset:3072
    s_add_u32 s25, s24, 37748736
    s_add_u32 s26, s24, 37752832
    buffer_load_dwordx4 a[64:67], v2, s[4:7], s25 offen offset:0
    buffer_load_dwordx4 a[68:71], v2, s[4:7], s25 offen offset:1024
    buffer_load_dwordx4 a[72:75], v2, s[4:7], s25 offen offset:2048
    buffer_load_dwordx4 a[76:79], v2, s[4:7], s25 offen offset:3072
    buffer_load_dwordx4 a[80:83], v2, s[4:7], s26 offen offset:0
    buffer_load_dwordx4 a[84:87], v2, s[4:7], s26 offen offset:1024
    buffer_load_dwordx4 a[88:91], v2, s[4:7], s26 offen offset:2048
    buffer_load_dwordx4 a[92:95], v2, s[4:7], s26 offen offset:3072
    s_waitcnt vmcnt(24)
    s_branch joined_m_130
lastit_m_129:
    s_waitcnt vmcnt(0)
joined_m_130:
    s_add_u32 s28, s22, 1
    s_lshr_b32 s29, s44, 2
    s_lshl_b32 s29, s29, 8
    s_and_b32 s92, s44, 3
    s_lshl_b32 s92, s92, 2
    s_add_u32 s29, s29, s92
    s_add_u32 s29, s29, 184296448
    v_mov_b32 v11, s28
    buffer_store_dword v11, off, s[4:7], s29 sc1
    s_add_u32 s22, s22, 2
    s_cmp_lt_u32 s22, 64
    s_cbranch_scc1 L_m_108
attdone_m_109:
    s_endpgm
abatt_m_102:
    s_endpgm
natt_m_101:
    s_sub_u32 s20, s20, 16
    s_cmp_ge_u32 s20, 32
    s_cbranch_scc1 nop_m_134
    s_load_dwordx2 s[32:33], s[0:1], 112
    s_load_dwordx2 s[34:35], s[0:1], 40
    v_lshrrev_b32 v3, 6, v0
    s_nop 0
    v_readfirstlane_b32 s21, v3
    v_and_b32 v1, 63, v0
    v_lshlrev_b32 v2, 4, v1
    s_mov_b32 s23, 4194304
    s_waitcnt lgkmcnt(0)
    s_mov_b32 s4, s32
    s_and_b32 s5, s33, 65535
    s_mov_b32 s6, 268435456
    s_mov_b32 s7, 131072
    s_lshr_b32 s24, s2, 5
    s_cmp_lt_u32 s24, 2
    s_cbranch_scc1 nowarm_m_136
    s_load_dwordx4 s[60:63], s[0:1], 16
    s_load_dwordx2 s[64:65], s[0:1], 32
    s_sub_u32 s24, s24, 2
    s_lshl_b32 s24, s24, 2
    s_bfe_u32 s25, s2, 131075
    s_add_u32 s24, s24, s25
    s_lshl_b32 s24, s24, 2
    s_add_u32 s24, s24, s21
    s_mul_i32 s24, s24, 49152
    s_and_b32 s25, s2, 7
    s_sub_u32 s25, s25, 1
    s_waitcnt lgkmcnt(0)
    s_mov_b32 s70, 846615568
    s_mov_b32 s71, 14395788
    s_lshl_b32 s27, s25, 2
    s_lshr_b64 s[70:71], s[70:71], s27
    s_and_b32 s27, s70, 15
    s_lshr_b32 s26, s27, 2
    s_cmp_eq_u32 s26, 1
    s_cselect_b64 s[66:67], s[62:63], s[60:61]
    s_cmp_eq_u32 s26, 2
    s_cselect_b64 s[66:67], s[64:65], s[66:67]
    s_mov_b32 s68, s66
    s_and_b32 s69, s67, 65535
    s_mov_b32 s70, 4718592
    s_mov_b32 s71, 131072
    s_and_b32 s26, s27, 3
    s_lshl_b32 s26, s26, 11
    s_add_u32 s26, s26, s24
    buffer_load_dwordx4 v[128:131], v2, s[68:71], s26 offen offset:0
    buffer_load_dwordx4 v[132:135], v2, s[68:71], s26 offen offset:1024
    s_add_u32 s26, s26, 8192
    buffer_load_dwordx4 v[136:139], v2, s[68:71], s26 offen offset:0
    buffer_load_dwordx4 v[140:143], v2, s[68:71], s26 offen offset:1024
    s_add_u32 s26, s26, 8192
    buffer_load_dwordx4 v[144:147], v2, s[68:71], s26 offen offset:0
    buffer_load_dwordx4 v[148:151], v2, s[68:71], s26 offen offset:1024
    s_add_u32 s26, s26, 8192
    buffer_load_dwordx4 v[152:155], v2, s[68:71], s26 offen offset:0
    buffer_load_dwordx4 v[156:159], v2, s[68:71], s26 offen offset:1024
    s_add_u32 s26, s26, 8192
    buffer_load_dwordx4 v[160:163], v2, s[68:71], s26 offen offset:0
    buffer_load_dwordx4 v[164:167], v2, s[68:71], s26 offen offset:1024
    s_add_u32 s26, s26, 8192
    buffer_load_dwordx4 v[168:171], v2, s[68:71], s26 offen offset:0
    buffer_load_dwordx4 v[172:175], v2, s[68:71], s26 offen offset:1024
    s_add_u32 s26, s26, 8192
    s_add_u32 s25, s25, 7
    s_mov_b32 s70, 846615568
    s_mov_b32 s71, 14395788
    s_lshl_b32 s27, s25, 2
    s_lshr_b64 s[70:71], s[70:71], s27
    s_and_b32 s27, s70, 15
    s_cmp_ge_u32 s27, 12
    s_cbranch_scc1 nowarm_m_136
    s_lshr_b32 s26, s27, 2
    s_cmp_eq_u32 s26, 1
    s_cselect_b64 s[66:67], s[62:63], s[60:61]
    s_cmp_eq_u32 s26, 2
    s_cselect_b64 s[66:67], s[64:65], s[66:67]
    s_mov_b32 s68, s66
    s_and_b32 s69, s67, 65535
    s_mov_b32 s70, 4718592
    s_mov_b32 s71, 131072
    s_and_b32 s26, s27, 3
    s_lshl_b32 s26, s26, 11
    s_add_u32 s26, s26, s24
    buffer_load_dwordx4 v[176:179], v2, s[68:71], s26 offen offset:0
    buffer_load_dwordx4 v[180:183], v2, s[68:71], s26 offen offset:1024
    s_add_u32 s26, s26, 8192
    buffer_load_dwordx4 v[184:187], v2, s[68:71], s26 offen offset:0
    buffer_load_dwordx4 v[188:191], v2, s[68:71], s26 offen offset:1024
    s_add_u32 s26, s26, 8192
    buffer_load_dwordx4 v[192:195], v2, s[68:71], s26 offen offset:0
    buffer_load_dwordx4 v[196:199], v2, s[68:71], s26 offen offset:1024
    s_add_u32 s26, s26, 8192
    buffer_load_dwordx4 v[200:203], v2, s[68:71], s26 offen offset:0
    buffer_load_dwordx4 v[204:207], v2, s[68:71], s26 offen offset:1024
    s_add_u32 s26, s26, 8192
    buffer_load_dwordx4 v[208:211], v2, s[68:71], s26 offen offset:0
    buffer_load_dwordx4 v[212:215], v2, s[68:71], s26 offen offset:1024
    s_add_u32 s26, s26, 8192
    buffer_load_dwordx4 v[216:219], v2, s[68:71], s26 offen offset:0
    buffer_load_dwordx4 v[220:223], v2, s[68:71], s26 offen offset:1024
    s_add_u32 s26, s26, 8192
nowarm_m_136:
    s_waitcnt vmcnt(0)
    s_load_dwordx2 s[30:31], s[0:1], 104
    s_waitcnt lgkmcnt(0)
    s_mov_b32 s16, s30
    s_and_b32 s17, s31, 65535
    s_mov_b32 s18, 256
    s_mov_b32 s19, 131072
L_m_137:
    s_sub_u32 s23, s23, 1
    s_cbranch_scc1 abop_m_135
    buffer_load_dword v3, off, s[16:19], 0 offset:64 sc1
    s_waitcnt vmcnt(0)
    v_cmp_eq_u32 vcc, 0, v3
    s_nop 0
    s_cbranch_vccnz L_m_137
    s_and_b32 s27, s20, 31
    s_add_u32 s27, s27, 16
    s_and_b32 s27, s20, 31
    s_cmp_lg_u32 s21, 0
    s_cbranch_scc1 nopoll_m_138
    v_min_u32 v4, 0, v1
    v_mul_u32_u24 v4, 4, v4
    s_lshr_b32 s29, s27, 0
    s_lshl_b32 s29, s29, 8
    s_add_u32 s29, s29, 184288256
    buffer_load_dword v5, v4, s[4:7], s29 offen sc1
    s_waitcnt vmcnt(0)
    v_cmp_gt_u32 vcc, 1, v5
    s_nop 0
    s_cbranch_vccz fok_m_139
L_m_140:
    s_sleep 32
    s_sub_u32 s23, s23, 1
    s_cbranch_scc1 abop_m_135
    buffer_load_dword v5, v4, s[4:7], s29 offen sc1
    s_waitcnt vmcnt(0)
    v_cmp_gt_u32 vcc, 1, v5
    s_nop 0
    s_cbranch_vccnz L_m_140
fok_m_139:
nopoll_m_138:
    s_barrier
    s_mov_b32 s8, s34
    s_and_b32 s9, s35, 65535
    s_mov_b32 s10, 4718592
    s_mov_b32 s11, 131072
    s_lshr_b32 s44, s20, 2
    s_and_b32 s45, s20, 3
    s_lshl_b32 s46, s44, 2
    s_add_u32 s26, s46, s21
    s_mul_i32 s47, s21, 36864
    s_lshl_b32 s49, s21, 12
    s_add_u32 s49, s49, 147456
    s_mul_i32 s48, s26, 147456
    s_mul_i32 s24, s45, 288
    s_add_u32 s48, s48, s24
    v_lshrrev_b32 v8, 4, v1
    v_bfe_u32 v9, v1, 2, 2
    v_and_b32 v10, 3, v1
    v_lshrrev_b32 v6, 2, v1
    v_mul_u32_u24 v4, 1152, v6
    v_lshl_add_u32 v4, v10, 4, v4
    v_lshl_add_u32 v6, v8, 2, v9
    v_lshlrev_b32 v6, 6, v6
    v_lshl_add_u32 v6, v10, 3, v6
    v_add_u32 v5, s47, v6
    v_add_u32 v11, s49, v6
    v_add_u32 v12, s47, v2
    v_lshrrev_b32 v7, 3, v1
    v_mul_u32_u24 v13, 1152, v7
    v_and_b32 v7, 7, v1
    v_lshl_add_u32 v13, v7, 4, v13
    v_lshrrev_b32 v7, 6, v6
    v_lshlrev_b32 v7, 7, v7
    v_lshl_add_u32 v7, v10, 3, v7
    v_add_u32 v14, s47, v7
    s_add_u32 s25, s48, 256
    s_add_u32 m0, s49, 0
    s_nop 0
    buffer_load_dwordx4 v4, s[8:11], s25 offen lds
    s_add_u32 m0, s49, 1024
    s_add_u32 s25, s25, 18432
    buffer_load_dwordx4 v4, s[8:11], s25 offen lds
    s_add_u32 m0, s49, 2048
    s_add_u32 s25, s25, 18432
    buffer_load_dwordx4 v4, s[8:11], s25 offen lds
    s_add_u32 m0, s49, 3072
    s_add_u32 s25, s25, 18432
    buffer_load_dwordx4 v4, s[8:11], s25 offen lds
    s_add_u32 s25, s48, 0
    s_add_u32 m0, s47, 0
    s_nop 0
    buffer_load_dwordx4 v13, s[8:11], s25 offen lds
    s_add_u32 m0, s47, 1024
    s_add_u32 s25, s25, 9216
    buffer_load_dwordx4 v13, s[8:11], s25 offen lds
    s_add_u32 m0, s47, 2048
    s_add_u32 s25, s25, 9216
    buffer_load_dwordx4 v13, s[8:11], s25 offen lds
    s_add_u32 m0, s47, 3072
    s_add_u32 s25, s25, 9216
    buffer_load_dwordx4 v13, s[8:11], s25 offen lds
    s_add_u32 s25, s48, 36864
    s_add_u32 m0, s47, 4096
    s_nop 0
    buffer_load_dwordx4 v13, s[8:11], s25 offen lds
    s_add_u32 m0, s47, 5120
    s_add_u32 s25, s25, 9216
    buffer_load_dwordx4 v13, s[8:11], s25 offen lds
    s_add_u32 m0, s47, 6144
    s_add_u32 s25, s25, 9216
    buffer_load_dwordx4 v13, s[8:11], s25 offen lds
    s_add_u32 m0, s47, 7168
    s_add_u32 s25, s25, 9216
    buffer_load_dwordx4 v13, s[8:11], s25 offen lds
    s_add_u32 s25, s48, 73728
    s_add_u32 m0, s47, 8192
    s_nop 0
    buffer_load_dwordx4 v13, s[8:11], s25 offen lds
    s_add_u32 m0, s47, 9216
    s_add_u32 s25, s25, 9216
    buffer_load_dwordx4 v13, s[8:11], s25 offen lds
    s_add_u32 m0, s47, 10240
    s_add_u32 s25, s25, 9216
    buffer_load_dwordx4 v13, s[8:11], s25 offen lds
    s_add_u32 m0, s47, 11264
    s_add_u32 s25, s25, 9216
    buffer_load_dwordx4 v13, s[8:11], s25 offen lds
    s_add_u32 s25, s48, 110592
    s_add_u32 m0, s47, 12288
    s_nop 0
    buffer_load_dwordx4 v13, s[8:11], s25 offen lds
    s_add_u32 m0, s47, 13312
    s_add_u32 s25, s25, 9216
    buffer_load_dwordx4 v13, s[8:11], s25 offen lds
    s_add_u32 m0, s47, 14336
    s_add_u32 s25, s25, 9216
    buffer_load_dwordx4 v13, s[8:11], s25 offen lds
    s_add_u32 m0, s47, 15360
    s_add_u32 s25, s25, 9216
    buffer_load_dwordx4 v13, s[8:11], s25 offen lds
    s_add_u32 s25, s48, 128
    s_add_u32 m0, s47, 16384
    s_nop 0
    buffer_load_dwordx4 v13, s[8:11], s25 offen lds
    s_add_u32 m0, s47, 17408
    s_add_u32 s25, s25, 9216
    buffer_load_dwordx4 v13, s[8:11], s25 offen lds
    s_add_u32 m0, s47, 18432
    s_add_u32 s25, s25, 9216
    buffer_load_dwordx4 v13, s[8:11], s25 offen lds
    s_add_u32 m0, s47, 19456
    s_add_u32 s25, s25, 9216
    buffer_load_dwordx4 v13, s[8:11], s25 offen lds
    s_add_u32 s25, s48, 36992
    s_add_u32 m0, s47, 20480
    s_nop 0
    buffer_load_dwordx4 v13, s[8:11], s25 offen lds
    s_add_u32 m0, s47, 21504
    s_add_u32 s25, s25, 9216
    buffer_load_dwordx4 v13, s[8:11], s25 offen lds
    s_add_u32 m0, s47, 22528
    s_add_u32 s25, s25, 9216
    buffer_load_dwordx4 v13, s[8:11], s25 offen lds
    s_add_u32 m0, s47, 23552
    s_add_u32 s25, s25, 9216
    buffer_load_dwordx4 v13, s[8:11], s25 offen lds
    s_add_u32 s25, s48, 73856
    s_add_u32 m0, s47, 24576
    s_nop 0
    buffer_load_dwordx4 v13, s[8:11], s25 offen lds
    s_add_u32 m0, s47, 25600
    s_add_u32 s25, s25, 9216
    buffer_load_dwordx4 v13, s[8:11], s25 offen lds
    s_add_u32 m0, s47, 26624
    s_add_u32 s25, s25, 9216
    buffer_load_dwordx4 v13, s[8:11], s25 offen lds
    s_add_u32 m0, s47, 27648
    s_add_u32 s25, s25, 9216
    buffer_load_dwordx4 v13, s[8:11], s25 offen lds
    s_add_u32 s25, s48, 110720
    s_add_u32 m0, s47, 28672
    s_nop 0
    buffer_load_dwordx4 v13, s[8:11], s25 offen lds
    s_add_u32 m0, s47, 29696
    s_add_u32 s25, s25, 9216
    buffer_load_dwordx4 v13, s[8:11], s25 offen lds
    s_add_u32 m0, s47, 30720
    s_add_u32 s25, s25, 9216
    buffer_load_dwordx4 v13, s[8:11], s25 offen lds
    s_add_u32 m0, s47, 31744
    s_add_u32 s25, s25, 9216
    buffer_load_dwordx4 v13, s[8:11], s25 offen lds
    s_waitcnt vmcnt(32)
    ds_read_b64_tr_b16 v[32:33], v11 offset:0
    ds_read_b64_tr_b16 v[34:35], v11 offset:1024
    ds_read_b64_tr_b16 v[36:37], v11 offset:2048
    ds_read_b64_tr_b16 v[38:39], v11 offset:3072
    s_waitcnt lgkmcnt(0)
    ds_write_b128 v12, v[32:35] offset:32768
    ds_write_b128 v12, v[36:39] offset:33792
    s_waitcnt lgkmcnt(0)
    s_add_u32 s25, s48, 73984
    s_add_u32 m0, s49, 0
    s_nop 0
    buffer_load_dwordx4 v4, s[8:11], s25 offen lds
    s_add_u32 m0, s49, 1024
    s_add_u32 s25, s25, 18432
    buffer_load_dwordx4 v4, s[8:11], s25 offen lds
    s_add_u32 m0, s49, 2048
    s_add_u32 s25, s25, 18432
    buffer_load_dwordx4 v4, s[8:11], s25 offen lds
    s_add_u32 m0, s49, 3072
    s_add_u32 s25, s25, 18432
    buffer_load_dwordx4 v4, s[8:11], s25 offen lds
    s_waitcnt vmcnt(32)
    ds_read_b64_tr_b16 v[32:33], v14 offset:0
    ds_read_b64_tr_b16 v[34:35], v14 offset:2048
    ds_read_b64_tr_b16 v[36:37], v14 offset:32
    ds_read_b64_tr_b16 v[38:39], v14 offset:2080
    ds_read_b64_tr_b16 v[40:41], v14 offset:64
    ds_read_b64_tr_b16 v[42:43], v14 offset:2112
    ds_read_b64_tr_b16 v[44:45], v14 offset:96
    ds_read_b64_tr_b16 v[46:47], v14 offset:2144
    s_waitcnt lgkmcnt(0)
    ds_write_b128 v12, v[32:35] offset:0
    ds_write_b128 v12, v[36:39] offset:1024
    ds_write_b128 v12, v[40:43] offset:2048
    ds_write_b128 v12, v[44:47] offset:3072
    s_waitcnt vmcnt(28)
    ds_read_b64_tr_b16 v[32:33], v14 offset:4096
    ds_read_b64_tr_b16 v[34:35], v14 offset:6144
    ds_read_b64_tr_b16 v[36:37], v14 offset:4128
    ds_read_b64_tr_b16 v[38:39], v14 offset:6176
    ds_read_b64_tr_b16 v[40:41], v14 offset:4160
    ds_read_b64_tr_b16 v[42:43], v14 offset:6208
    ds_read_b64_tr_b16 v[44:45], v14 offset:4192
    ds_read_b64_tr_b16 v[46:47], v14 offset:6240
    s_waitcnt lgkmcnt(0)
    ds_write_b128 v12, v[32:35] offset:4096
    ds_write_b128 v12, v[36:39] offset:5120
    ds_write_b128 v12, v[40:43] offset:6144
    ds_write_b128 v12, v[44:47] offset:7168
    s_waitcnt vmcnt(24)
    ds_read_b64_tr_b16 v[32:33], v14 offset:8192
    ds_read_b64_tr_b16 v[34:35], v14 offset:10240
    ds_read_b64_tr_b16 v[36:37], v14 offset:8224
    ds_read_b64_tr_b16 v[38:39], v14 offset:10272
    ds_read_b64_tr_b16 v[40:41], v14 offset:8256
    ds_read_b64_tr_b16 v[42:43], v14 offset:10304
    ds_read_b64_tr_b16 v[44:45], v14 offset:8288
    ds_read_b64_tr_b16 v[46:47], v14 offset:10336
    s_waitcnt lgkmcnt(0)
    ds_write_b128 v12, v[32:35] offset:8192
    ds_write_b128 v12, v[36:39] offset:9216
    ds_write_b128 v12, v[40:43] offset:10240
    ds_write_b128 v12, v[44:47] offset:11264
    s_waitcnt vmcnt(20)
    ds_read_b64_tr_b16 v[32:33], v14 offset:12288
    ds_read_b64_tr_b16 v[34:35], v14 offset:14336
    ds_read_b64_tr_b16 v[36:37], v14 offset:12320
    ds_read_b64_tr_b16 v[38:39], v14 offset:14368
    ds_read_b64_tr_b16 v[40:41], v14 offset:12352
    ds_read_b64_tr_b16 v[42:43], v14 offset:14400
    ds_read_b64_tr_b16 v[44:45], v14 offset:12384
    ds_read_b64_tr_b16 v[46:47], v14 offset:14432
    s_waitcnt lgkmcnt(0)
    ds_write_b128 v12, v[32:35] offset:12288
    ds_write_b128 v12, v[36:39] offset:13312
    ds_write_b128 v12, v[40:43] offset:14336
    ds_write_b128 v12, v[44:47] offset:15360
    s_waitcnt vmcnt(16)
    ds_read_b64_tr_b16 v[32:33], v14 offset:16384
    ds_read_b64_tr_b16 v[34:35], v14 offset:18432
    ds_read_b64_tr_b16 v[36:37], v14 offset:16416
    ds_read_b64_tr_b16 v[38:39], v14 offset:18464
    ds_read_b64_tr_b16 v[40:41], v14 offset:16448
    ds_read_b64_tr_b16 v[42:43], v14 offset:18496
    ds_read_b64_tr_b16 v[44:45], v14 offset:16480
    ds_read_b64_tr_b16 v[46:47], v14 offset:18528
    s_waitcnt lgkmcnt(0)
    ds_write_b128 v12, v[32:35] offset:16384
    ds_write_b128 v12, v[36:39] offset:17408
    ds_write_b128 v12, v[40:43] offset:18432
    ds_write_b128 v12, v[44:47] offset:19456
    s_waitcnt vmcnt(12)
    ds_read_b64_tr_b16 v[32:33], v14 offset:20480
    ds_read_b64_tr_b16 v[34:35], v14 offset:22528
    ds_read_b64_tr_b16 v[36:37], v14 offset:20512
    ds_read_b64_tr_b16 v[38:39], v14 offset:22560
    ds_read_b64_tr_b16 v[40:41], v14 offset:20544
    ds_read_b64_tr_b16 v[42:43], v14 offset:22592
    ds_read_b64_tr_b16 v[44:45], v14 offset:20576
    ds_read_b64_tr_b16 v[46:47], v14 offset:22624
    s_waitcnt lgkmcnt(0)
    ds_write_b128 v12, v[32:35] offset:20480
    ds_write_b128 v12, v[36:39] offset:21504
    ds_write_b128 v12, v[40:43] offset:22528
    ds_write_b128 v12, v[44:47] offset:23552
    s_waitcnt vmcnt(8)
    ds_read_b64_tr_b16 v[32:33], v14 offset:24576
    ds_read_b64_tr_b16 v[34:35], v14 offset:26624
    ds_read_b64_tr_b16 v[36:37], v14 offset:24608
    ds_read_b64_tr_b16 v[38:39], v14 offset:26656
    ds_read_b64_tr_b16 v[40:41], v14 offset:24640
    ds_read_b64_tr_b16 v[42:43], v14 offset:26688
    ds_read_b64_tr_b16 v[44:45], v14 offset:24672
    ds_read_b64_tr_b16 v[46:47], v14 offset:26720
    s_waitcnt lgkmcnt(0)
    ds_write_b128 v12, v[32:35] offset:24576
    ds_write_b128 v12, v[36:39] offset:25600
    ds_write_b128 v12, v[40:43] offset:26624
    ds_write_b128 v12, v[44:47] offset:27648
    s_waitcnt vmcnt(4)
    ds_read_b64_tr_b16 v[32:33], v14 offset:28672
    ds_read_b64_tr_b16 v[34:35], v14 offset:30720
    ds_read_b64_tr_b16 v[36:37], v14 offset:28704
    ds_read_b64_tr_b16 v[38:39], v14 offset:30752
    ds_read_b64_tr_b16 v[40:41], v14 offset:28736
    ds_read_b64_tr_b16 v[42:43], v14 offset:30784
    ds_read_b64_tr_b16 v[44:45], v14 offset:28768
    ds_read_b64_tr_b16 v[46:47], v14 offset:30816
    s_waitcnt lgkmcnt(0)
    ds_write_b128 v12, v[32:35] offset:28672
    ds_write_b128 v12, v[36:39] offset:29696
    ds_write_b128 v12, v[40:43] offset:30720
    ds_write_b128 v12, v[44:47] offset:31744
    s_waitcnt vmcnt(0)
    ds_read_b64_tr_b16 v[32:33], v11 offset:0
    ds_read_b64_tr_b16 v[34:35], v11 offset:1024
    ds_read_b64_tr_b16 v[36:37], v11 offset:2048
    ds_read_b64_tr_b16 v[38:39], v11 offset:3072
    s_waitcnt lgkmcnt(0)
    ds_write_b128 v12, v[32:35] offset:34816
    ds_write_b128 v12, v[36:39] offset:35840
    s_waitcnt lgkmcnt(0)
    v_add_u32 v4, 0, v2
    v_add_u32 v5, 36864, v2
    v_add_u32 v6, 73728, v2
    v_add_u32 v7, 110592, v2
    v_lshrrev_b32 v10, 1, v2
    s_lshr_b32 s22, s21, 1
    s_and_b32 s51, s21, 1
    s_lshl_b32 s50, s21, 6
    s_add_u32 s50, s50, s20
    s_lshl_b32 s24, s51, 10
    v_add_u32 v11, s24, v2
    s_lshl_b32 s24, s51, 9
    v_add_u32 v10, s24, v10
    s_barrier
    s_load_dwordx2 s[30:31], s[0:1], 104
    s_waitcnt lgkmcnt(0)
    s_mov_b32 s16, s30
    s_and_b32 s17, s31, 65535
    s_mov_b32 s18, 256
    s_mov_b32 s19, 131072
L_m_141:
    s_sub_u32 s23, s23, 1
    s_cbranch_scc1 abop_m_135
    buffer_load_dword v3, off, s[16:19], 0 offset:64 sc1
    s_waitcnt vmcnt(0)
    v_cmp_eq_u32 vcc, 0, v3
    s_nop 0
    s_cbranch_vccnz L_m_141
L_m_142:
    s_add_u32 s28, s22, 1
    s_and_b32 s27, s22, 1
    s_mul_i32 s27, s27, 32
    s_add_u32 s27, s27, s46
    v_min_u32 v8, 3, v1
    v_mul_u32_u24 v8, 4, v8
    s_lshr_b32 s29, s27, 2
    s_lshl_b32 s29, s29, 8
    s_and_b32 s92, s27, 3
    s_lshl_b32 s92, s92, 2
    s_add_u32 s29, s29, s92
    s_add_u32 s29, s29, 184296448
    buffer_load_dword v9, v8, s[4:7], s29 offen sc1
    s_waitcnt vmcnt(0)
    v_cmp_gt_u32 vcc, s28, v9
    s_nop 0
    s_cbranch_vccz fok_m_143
L_m_144:
    s_sleep 8
    s_sub_u32 s23, s23, 1
    s_cbranch_scc1 abop_m_135
    buffer_load_dword v9, v8, s[4:7], s29 offen sc1
    s_waitcnt vmcnt(0)
    v_cmp_gt_u32 vcc, s28, v9
    s_nop 0
    s_cbranch_vccnz L_m_144
fok_m_143:
    s_mul_i32 s24, s22, 32
    s_add_u32 s24, s24, s46
    s_lshl_b32 s24, s24, 13
    s_lshl_b32 s25, s51, 12
    s_add_u32 s25, s25, s24
    s_add_u32 s25, s25, 54525952
    buffer_load_dwordx4 v[16:19], v2, s[4:7], s25 offen offset:0
    buffer_load_dwordx4 v[20:23], v2, s[4:7], s25 offen offset:1024
    buffer_load_dwordx4 v[24:27], v2, s[4:7], s25 offen offset:2048
    buffer_load_dwordx4 v[28:31], v2, s[4:7], s25 offen offset:3072
    s_add_u32 s25, s25, 8192
    buffer_load_dwordx4 v[32:35], v2, s[4:7], s25 offen offset:0
    buffer_load_dwordx4 v[36:39], v2, s[4:7], s25 offen offset:1024
    buffer_load_dwordx4 v[40:43], v2, s[4:7], s25 offen offset:2048
    buffer_load_dwordx4 v[44:47], v2, s[4:7], s25 offen offset:3072
    s_add_u32 s25, s25, 8192
    buffer_load_dwordx4 v[48:51], v2, s[4:7], s25 offen offset:0
    buffer_load_dwordx4 v[52:55], v2, s[4:7], s25 offen offset:1024
    buffer_load_dwordx4 v[56:59], v2, s[4:7], s25 offen offset:2048
    buffer_load_dwordx4 v[60:63], v2, s[4:7], s25 offen offset:3072
    s_add_u32 s25, s25, 8192
    buffer_load_dwordx4 v[64:67], v2, s[4:7], s25 offen offset:0
    buffer_load_dwordx4 v[68:71], v2, s[4:7], s25 offen offset:1024
    buffer_load_dwordx4 v[72:75], v2, s[4:7], s25 offen offset:2048
    buffer_load_dwordx4 v[76:79], v2, s[4:7], s25 offen offset:3072
    s_mul_i32 s24, s22, 8
    s_add_u32 s24, s24, s44
    s_mul_i32 s24, s24, 36864
    s_add_u32 s24, s24, 79691776
    s_mul_i32 s25, s45, 9216
    s_add_u32 s24, s24, s25
    ds_read_b128 v[216:219], v4 offset:0
    ds_read_b128 v[220:223], v4 offset:1024
    ds_read_b128 v[224:227], v4 offset:2048
    ds_read_b128 v[228:231], v4 offset:3072
    ds_read_b128 v[232:235], v4 offset:16384
    ds_read_b128 v[236:239], v4 offset:17408
    ds_read_b128 v[240:243], v4 offset:18432
    ds_read_b128 v[244:247], v4 offset:19456
    ds_read_b128 v[248:251], v4 offset:32768
    ds_read_b128 v[252:255], v4 offset:4096
    s_waitcnt vmcnt(15) lgkmcnt(9)
    v_mfma_f32_16x16x32_bf16 v[144:147], v[216:219], v[16:19], 0
    ds_read_b128 v[216:219], v4 offset:5120
    s_waitcnt lgkmcnt(9)
    v_mfma_f32_16x16x32_bf16 v[148:151], v[220:223], v[16:19], 0
    ds_read_b128 v[220:223], v4 offset:6144
    s_waitcnt lgkmcnt(9)
    v_mfma_f32_16x16x32_bf16 v[152:155], v[224:227], v[16:19], 0
    ds_read_b128 v[224:227], v4 offset:7168
    s_waitcnt lgkmcnt(9)
    v_mfma_f32_16x16x32_bf16 v[156:159], v[228:231], v[16:19], 0
    ds_read_b128 v[228:231], v4 offset:20480
    s_waitcnt lgkmcnt(9)
    v_mfma_f32_16x16x32_bf16 v[160:163], v[232:235], v[16:19], 0
    ds_read_b128 v[232:235], v4 offset:21504
    s_waitcnt lgkmcnt(9)
    v_mfma_f32_16x16x32_bf16 v[164:167], v[236:239], v[16:19], 0
    ds_read_b128 v[236:239], v4 offset:22528
    s_waitcnt lgkmcnt(9)
    v_mfma_f32_16x16x32_bf16 v[168:171], v[240:243], v[16:19], 0
    ds_read_b128 v[240:243], v4 offset:23552
    s_waitcnt lgkmcnt(9)
    v_mfma_f32_16x16x32_bf16 v[172:175], v[244:247], v[16:19], 0
    ds_read_b128 v[244:247], v4 offset:33792
    s_waitcnt lgkmcnt(9)
    v_mfma_f32_16x16x32_bf16 v[176:179], v[248:251], v[16:19], 0
    ds_read_b128 v[248:251], v4 offset:8192
    s_waitcnt vmcnt(14) lgkmcnt(9)
    v_mfma_f32_16x16x32_bf16 v[144:147], v[252:255], v[20:23], v[144:147]
    ds_read_b128 v[252:255], v4 offset:9216
    s_waitcnt lgkmcnt(9)
    v_mfma_f32_16x16x32_bf16 v[148:151], v[216:219], v[20:23], v[148:151]
    ds_read_b128 v[216:219], v4 offset:10240
    s_waitcnt lgkmcnt(9)
    v_mfma_f32_16x16x32_bf16 v[152:155], v[220:223], v[20:23], v[152:155]
    ds_read_b128 v[220:223], v4 offset:11264
    s_waitcnt lgkmcnt(9)
    v_mfma_f32_16x16x32_bf16 v[156:159], v[224:227], v[20:23], v[156:159]
    ds_read_b128 v[224:227], v4 offset:24576
    s_waitcnt lgkmcnt(9)
    v_mfma_f32_16x16x32_bf16 v[160:163], v[228:231], v[20:23], v[160:163]
    ds_read_b128 v[228:231], v4 offset:25600
    s_waitcnt lgkmcnt(9)
    v_mfma_f32_16x16x32_bf16 v[164:167], v[232:235], v[20:23], v[164:167]
    ds_read_b128 v[232:235], v4 offset:26624
    s_waitcnt lgkmcnt(9)
    v_mfma_f32_16x16x32_bf16 v[168:171], v[236:239], v[20:23], v[168:171]
    ds_read_b128 v[236:239], v4 offset:27648
    s_waitcnt lgkmcnt(9)
    v_mfma_f32_16x16x32_bf16 v[172:175], v[240:243], v[20:23], v[172:175]
    ds_read_b128 v[240:243], v4 offset:34816
    s_waitcnt lgkmcnt(9)
    v_mfma_f32_16x16x32_bf16 v[176:179], v[244:247], v[20:23], v[176:179]
    ds_read_b128 v[244:247], v4 offset:12288
    s_waitcnt vmcnt(13) lgkmcnt(9)
    v_mfma_f32_16x16x32_bf16 v[144:147], v[248:251], v[24:27], v[144:147]
    ds_read_b128 v[248:251], v4 offset:13312
    s_waitcnt lgkmcnt(9)
    v_mfma_f32_16x16x32_bf16 v[148:151], v[252:255], v[24:27], v[148:151]
    ds_read_b128 v[252:255], v4 offset:14336
    s_waitcnt lgkmcnt(9)
    v_mfma_f32_16x16x32_bf16 v[152:155], v[216:219], v[24:27], v[152:155]
    ds_read_b128 v[216:219], v4 offset:15360
    s_waitcnt lgkmcnt(9)
    v_mfma_f32_16x16x32_bf16 v[156:159], v[220:223], v[24:27], v[156:159]
    ds_read_b128 v[220:223], v4 offset:28672
    s_waitcnt lgkmcnt(9)
    v_mfma_f32_16x16x32_bf16 v[160:163], v[224:227], v[24:27], v[160:163]
    ds_read_b128 v[224:227], v4 offset:29696
    s_waitcnt lgkmcnt(9)
    v_mfma_f32_16x16x32_bf16 v[164:167], v[228:231], v[24:27], v[164:167]
    ds_read_b128 v[228:231], v4 offset:30720
    s_waitcnt lgkmcnt(9)
    v_mfma_f32_16x16x32_bf16 v[168:171], v[232:235], v[24:27], v[168:171]
    ds_read_b128 v[232:235], v4 offset:31744
    s_waitcnt lgkmcnt(9)
    v_mfma_f32_16x16x32_bf16 v[172:175], v[236:239], v[24:27], v[172:175]
    ds_read_b128 v[236:239], v4 offset:35840
    s_waitcnt lgkmcnt(9)
    v_mfma_f32_16x16x32_bf16 v[176:179], v[240:243], v[24:27], v[176:179]
    ds_read_b128 v[240:243], v5 offset:0
    s_waitcnt vmcnt(12) lgkmcnt(9)
    v_mfma_f32_16x16x32_bf16 v[144:147], v[244:247], v[28:31], v[144:147]
    ds_read_b128 v[244:247], v5 offset:1024
    s_waitcnt lgkmcnt(9)
    v_mfma_f32_16x16x32_bf16 v[148:151], v[248:251], v[28:31], v[148:151]
    ds_read_b128 v[248:251], v5 offset:2048
    s_waitcnt lgkmcnt(9)
    v_mfma_f32_16x16x32_bf16 v[152:155], v[252:255], v[28:31], v[152:155]
    ds_read_b128 v[252:255], v5 offset:3072
    s_waitcnt lgkmcnt(9)
    v_mfma_f32_16x16x32_bf16 v[156:159], v[216:219], v[28:31], v[156:159]
    ds_read_b128 v[216:219], v5 offset:16384
    s_waitcnt lgkmcnt(9)
    v_mfma_f32_16x16x32_bf16 v[160:163], v[220:223], v[28:31], v[160:163]
    ds_read_b128 v[220:223], v5 offset:17408
    s_waitcnt lgkmcnt(9)
    v_mfma_f32_16x16x32_bf16 v[164:167], v[224:227], v[28:31], v[164:167]
    ds_read_b128 v[224:227], v5 offset:18432
    s_waitcnt lgkmcnt(9)
    v_mfma_f32_16x16x32_bf16 v[168:171], v[228:231], v[28:31], v[168:171]
    ds_read_b128 v[228:231], v5 offset:19456
    s_waitcnt lgkmcnt(9)
    v_mfma_f32_16x16x32_bf16 v[172:175], v[232:235], v[28:31], v[172:175]
    ds_read_b128 v[232:235], v5 offset:32768
    s_waitcnt lgkmcnt(9)
    v_mfma_f32_16x16x32_bf16 v[176:179], v[236:239], v[28:31], v[176:179]
    ds_read_b128 v[236:239], v5 offset:4096
    s_waitcnt vmcnt(11) lgkmcnt(9)
    v_mfma_f32_16x16x32_bf16 v[144:147], v[240:243], v[32:35], v[144:147]
    ds_read_b128 v[240:243], v5 offset:5120
    s_waitcnt lgkmcnt(9)
    v_mfma_f32_16x16x32_bf16 v[148:151], v[244:247], v[32:35], v[148:151]
    ds_read_b128 v[244:247], v5 offset:6144
    s_waitcnt lgkmcnt(9)
    v_mfma_f32_16x16x32_bf16 v[152:155], v[248:251], v[32:35], v[152:155]
    ds_read_b128 v[248:251], v5 offset:7168
    s_waitcnt lgkmcnt(9)
    v_mfma_f32_16x16x32_bf16 v[156:159], v[252:255], v[32:35], v[156:159]
    ds_read_b128 v[252:255], v5 offset:20480
    s_waitcnt lgkmcnt(9)
    v_mfma_f32_16x16x32_bf16 v[160:163], v[216:219], v[32:35], v[160:163]
    ds_read_b128 v[216:219], v5 offset:21504
    s_waitcnt lgkmcnt(9)
    v_mfma_f32_16x16x32_bf16 v[164:167], v[220:223], v[32:35], v[164:167]
    ds_read_b128 v[220:223], v5 offset:22528
    s_waitcnt lgkmcnt(9)
    v_mfma_f32_16x16x32_bf16 v[168:171], v[224:227], v[32:35], v[168:171]
    ds_read_b128 v[224:227], v5 offset:23552
    s_waitcnt lgkmcnt(9)
    v_mfma_f32_16x16x32_bf16 v[172:175], v[228:231], v[32:35], v[172:175]
    ds_read_b128 v[228:231], v5 offset:33792
    s_waitcnt lgkmcnt(9)
    v_mfma_f32_16x16x32_bf16 v[176:179], v[232:235], v[32:35], v[176:179]
    ds_read_b128 v[232:235], v5 offset:8192
    s_waitcnt vmcnt(10) lgkmcnt(9)
    v_mfma_f32_16x16x32_bf16 v[144:147], v[236:239], v[36:39], v[144:147]
    ds_read_b128 v[236:239], v5 offset:9216
    s_waitcnt lgkmcnt(9)
    v_mfma_f32_16x16x32_bf16 v[148:151], v[240:243], v[36:39], v[148:151]
    ds_read_b128 v[240:243], v5 offset:10240
    s_waitcnt lgkmcnt(9)
    v_mfma_f32_16x16x32_bf16 v[152:155], v[244:247], v[36:39], v[152:155]
    ds_read_b128 v[244:247], v5 offset:11264
    s_waitcnt lgkmcnt(9)
    v_mfma_f32_16x16x32_bf16 v[156:159], v[248:251], v[36:39], v[156:159]
    ds_read_b128 v[248:251], v5 offset:24576
    s_waitcnt lgkmcnt(9)
    v_mfma_f32_16x16x32_bf16 v[160:163], v[252:255], v[36:39], v[160:163]
    ds_read_b128 v[252:255], v5 offset:25600
    s_waitcnt lgkmcnt(9)
    v_mfma_f32_16x16x32_bf16 v[164:167], v[216:219], v[36:39], v[164:167]
    ds_read_b128 v[216:219], v5 offset:26624
    s_waitcnt lgkmcnt(9)
    v_mfma_f32_16x16x32_bf16 v[168:171], v[220:223], v[36:39], v[168:171]
    ds_read_b128 v[220:223], v5 offset:27648
    s_waitcnt lgkmcnt(9)
    v_mfma_f32_16x16x32_bf16 v[172:175], v[224:227], v[36:39], v[172:175]
    ds_read_b128 v[224:227], v5 offset:34816
    s_waitcnt lgkmcnt(9)
    v_mfma_f32_16x16x32_bf16 v[176:179], v[228:231], v[36:39], v[176:179]
    ds_read_b128 v[228:231], v5 offset:12288
    s_waitcnt vmcnt(9) lgkmcnt(9)
    v_mfma_f32_16x16x32_bf16 v[144:147], v[232:235], v[40:43], v[144:147]
    ds_read_b128 v[232:235], v5 offset:13312
    s_waitcnt lgkmcnt(9)
    v_mfma_f32_16x16x32_bf16 v[148:151], v[236:239], v[40:43], v[148:151]
    ds_read_b128 v[236:239], v5 offset:14336
    s_waitcnt lgkmcnt(9)
    v_mfma_f32_16x16x32_bf16 v[152:155], v[240:243], v[40:43], v[152:155]
    ds_read_b128 v[240:243], v5 offset:15360
    s_waitcnt lgkmcnt(9)
    v_mfma_f32_16x16x32_bf16 v[156:159], v[244:247], v[40:43], v[156:159]
    ds_read_b128 v[244:247], v5 offset:28672
    s_waitcnt lgkmcnt(9)
    v_mfma_f32_16x16x32_bf16 v[160:163], v[248:251], v[40:43], v[160:163]
    ds_read_b128 v[248:251], v5 offset:29696
    s_waitcnt lgkmcnt(9)
    v_mfma_f32_16x16x32_bf16 v[164:167], v[252:255], v[40:43], v[164:167]
    ds_read_b128 v[252:255], v5 offset:30720
    s_waitcnt lgkmcnt(9)
    v_mfma_f32_16x16x32_bf16 v[168:171], v[216:219], v[40:43], v[168:171]
    ds_read_b128 v[216:219], v5 offset:31744
    s_waitcnt lgkmcnt(9)
    v_mfma_f32_16x16x32_bf16 v[172:175], v[220:223], v[40:43], v[172:175]
    ds_read_b128 v[220:223], v5 offset:35840
    s_waitcnt lgkmcnt(9)
    v_mfma_f32_16x16x32_bf16 v[176:179], v[224:227], v[40:43], v[176:179]
    ds_read_b128 v[224:227], v6 offset:0
    s_waitcnt vmcnt(8) lgkmcnt(9)
    v_mfma_f32_16x16x32_bf16 v[144:147], v[228:231], v[44:47], v[144:147]
    ds_read_b128 v[228:231], v6 offset:1024
    s_waitcnt lgkmcnt(9)
    v_mfma_f32_16x16x32_bf16 v[148:151], v[232:235], v[44:47], v[148:151]
    ds_read_b128 v[232:235], v6 offset:2048
    s_waitcnt lgkmcnt(9)
    v_mfma_f32_16x16x32_bf16 v[152:155], v[236:239], v[44:47], v[152:155]
    ds_read_b128 v[236:239], v6 offset:3072
    s_waitcnt lgkmcnt(9)
    v_mfma_f32_16x16x32_bf16 v[156:159], v[240:243], v[44:47], v[156:159]
    ds_read_b128 v[240:243], v6 offset:16384
    s_waitcnt lgkmcnt(9)
    v_mfma_f32_16x16x32_bf16 v[160:163], v[244:247], v[44:47], v[160:163]
    ds_read_b128 v[244:247], v6 offset:17408
    s_waitcnt lgkmcnt(9)
    v_mfma_f32_16x16x32_bf16 v[164:167], v[248:251], v[44:47], v[164:167]
    ds_read_b128 v[248:251], v6 offset:18432
    s_waitcnt lgkmcnt(9)
    v_mfma_f32_16x16x32_bf16 v[168:171], v[252:255], v[44:47], v[168:171]
    ds_read_b128 v[252:255], v6 offset:19456
    s_waitcnt lgkmcnt(9)
    v_mfma_f32_16x16x32_bf16 v[172:175], v[216:219], v[44:47], v[172:175]
    ds_read_b128 v[216:219], v6 offset:32768
    s_waitcnt lgkmcnt(9)
    v_mfma_f32_16x16x32_bf16 v[176:179], v[220:223], v[44:47], v[176:179]
    ds_read_b128 v[220:223], v6 offset:4096
    s_waitcnt vmcnt(7) lgkmcnt(9)
    v_mfma_f32_16x16x32_bf16 v[144:147], v[224:227], v[48:51], v[144:147]
    ds_read_b128 v[224:227], v6 offset:5120
    s_waitcnt lgkmcnt(9)
    v_mfma_f32_16x16x32_bf16 v[148:151], v[228:231], v[48:51], v[148:151]
    ds_read_b128 v[228:231], v6 offset:6144
    s_waitcnt lgkmcnt(9)
    v_mfma_f32_16x16x32_bf16 v[152:155], v[232:235], v[48:51], v[152:155]
    ds_read_b128 v[232:235], v6 offset:7168
    s_waitcnt lgkmcnt(9)
    v_mfma_f32_16x16x32_bf16 v[156:159], v[236:239], v[48:51], v[156:159]
    ds_read_b128 v[236:239], v6 offset:20480
    s_waitcnt lgkmcnt(9)
    v_mfma_f32_16x16x32_bf16 v[160:163], v[240:243], v[48:51], v[160:163]
    ds_read_b128 v[240:243], v6 offset:21504
    s_waitcnt lgkmcnt(9)
    v_mfma_f32_16x16x32_bf16 v[164:167], v[244:247], v[48:51], v[164:167]
    ds_read_b128 v[244:247], v6 offset:22528
    s_waitcnt lgkmcnt(9)
    v_mfma_f32_16x16x32_bf16 v[168:171], v[248:251], v[48:51], v[168:171]
    ds_read_b128 v[248:251], v6 offset:23552
    s_waitcnt lgkmcnt(9)
    v_mfma_f32_16x16x32_bf16 v[172:175], v[252:255], v[48:51], v[172:175]
    ds_read_b128 v[252:255], v6 offset:33792
    s_waitcnt lgkmcnt(9)
    v_mfma_f32_16x16x32_bf16 v[176:179], v[216:219], v[48:51], v[176:179]
    ds_read_b128 v[216:219], v6 offset:8192
    s_waitcnt vmcnt(6) lgkmcnt(9)
    v_mfma_f32_16x16x32_bf16 v[144:147], v[220:223], v[52:55], v[144:147]
    ds_read_b128 v[220:223], v6 offset:9216
    s_waitcnt lgkmcnt(9)
    v_mfma_f32_16x16x32_bf16 v[148:151], v[224:227], v[52:55], v[148:151]
    ds_read_b128 v[224:227], v6 offset:10240
    s_waitcnt lgkmcnt(9)
    v_mfma_f32_16x16x32_bf16 v[152:155], v[228:231], v[52:55], v[152:155]
    ds_read_b128 v[228:231], v6 offset:11264
    s_waitcnt lgkmcnt(9)
    v_mfma_f32_16x16x32_bf16 v[156:159], v[232:235], v[52:55], v[156:159]
    ds_read_b128 v[232:235], v6 offset:24576
    s_waitcnt lgkmcnt(9)
    v_mfma_f32_16x16x32_bf16 v[160:163], v[236:239], v[52:55], v[160:163]
    ds_read_b128 v[236:239], v6 offset:25600
    s_waitcnt lgkmcnt(9)
    v_mfma_f32_16x16x32_bf16 v[164:167], v[240:243], v[52:55], v[164:167]
    ds_read_b128 v[240:243], v6 offset:26624
    s_waitcnt lgkmcnt(9)
    v_mfma_f32_16x16x32_bf16 v[168:171], v[244:247], v[52:55], v[168:171]
    ds_read_b128 v[244:247], v6 offset:27648
    s_waitcnt lgkmcnt(9)
    v_mfma_f32_16x16x32_bf16 v[172:175], v[248:251], v[52:55], v[172:175]
    ds_read_b128 v[248:251], v6 offset:34816
    s_waitcnt lgkmcnt(9)
    v_mfma_f32_16x16x32_bf16 v[176:179], v[252:255], v[52:55], v[176:179]
    ds_read_b128 v[252:255], v6 offset:12288
    s_waitcnt vmcnt(5) lgkmcnt(9)
    v_mfma_f32_16x16x32_bf16 v[144:147], v[216:219], v[56:59], v[144:147]
    ds_read_b128 v[216:219], v6 offset:13312
    s_waitcnt lgkmcnt(9)
    v_mfma_f32_16x16x32_bf16 v[148:151], v[220:223], v[56:59], v[148:151]
    ds_read_b128 v[220:223], v6 offset:14336
    s_waitcnt lgkmcnt(9)
    v_mfma_f32_16x16x32_bf16 v[152:155], v[224:227], v[56:59], v[152:155]
    ds_read_b128 v[224:227], v6 offset:15360
    s_waitcnt lgkmcnt(9)
    v_mfma_f32_16x16x32_bf16 v[156:159], v[228:231], v[56:59], v[156:159]
    ds_read_b128 v[228:231], v6 offset:28672
    s_waitcnt lgkmcnt(9)
    v_mfma_f32_16x16x32_bf16 v[160:163], v[232:235], v[56:59], v[160:163]
    ds_read_b128 v[232:235], v6 offset:29696
    s_waitcnt lgkmcnt(9)
    v_mfma_f32_16x16x32_bf16 v[164:167], v[236:239], v[56:59], v[164:167]
    ds_read_b128 v[236:239], v6 offset:30720
    s_waitcnt lgkmcnt(9)
    v_mfma_f32_16x16x32_bf16 v[168:171], v[240:243], v[56:59], v[168:171]
    ds_read_b128 v[240:243], v6 offset:31744
    s_waitcnt lgkmcnt(9)
    v_mfma_f32_16x16x32_bf16 v[172:175], v[244:247], v[56:59], v[172:175]
    ds_read_b128 v[244:247], v6 offset:35840
    s_waitcnt lgkmcnt(9)
    v_mfma_f32_16x16x32_bf16 v[176:179], v[248:251], v[56:59], v[176:179]
    ds_read_b128 v[248:251], v7 offset:0
    s_waitcnt vmcnt(4) lgkmcnt(9)
    v_mfma_f32_16x16x32_bf16 v[144:147], v[252:255], v[60:63], v[144:147]
    ds_read_b128 v[252:255], v7 offset:1024
    s_waitcnt lgkmcnt(9)
    v_mfma_f32_16x16x32_bf16 v[148:151], v[216:219], v[60:63], v[148:151]
    ds_read_b128 v[216:219], v7 offset:2048
    s_waitcnt lgkmcnt(9)
    v_mfma_f32_16x16x32_bf16 v[152:155], v[220:223], v[60:63], v[152:155]
    ds_read_b128 v[220:223], v7 offset:3072
    s_waitcnt lgkmcnt(9)
    v_mfma_f32_16x16x32_bf16 v[156:159], v[224:227], v[60:63], v[156:159]
    ds_read_b128 v[224:227], v7 offset:16384
    s_waitcnt lgkmcnt(9)
    v_mfma_f32_16x16x32_bf16 v[160:163], v[228:231], v[60:63], v[160:163]
    ds_read_b128 v[228:231], v7 offset:17408
    s_waitcnt lgkmcnt(9)
    v_mfma_f32_16x16x32_bf16 v[164:167], v[232:235], v[60:63], v[164:167]
    ds_read_b128 v[232:235], v7 offset:18432
    s_waitcnt lgkmcnt(9)
    v_mfma_f32_16x16x32_bf16 v[168:171], v[236:239], v[60:63], v[168:171]
    ds_read_b128 v[236:239], v7 offset:19456
    s_waitcnt lgkmcnt(9)
    v_mfma_f32_16x16x32_bf16 v[172:175], v[240:243], v[60:63], v[172:175]
    ds_read_b128 v[240:243], v7 offset:32768
    s_waitcnt lgkmcnt(9)
    v_mfma_f32_16x16x32_bf16 v[176:179], v[244:247], v[60:63], v[176:179]
    ds_read_b128 v[244:247], v7 offset:4096
    s_waitcnt vmcnt(3) lgkmcnt(9)
    v_mfma_f32_16x16x32_bf16 v[144:147], v[248:251], v[64:67], v[144:147]
    ds_read_b128 v[248:251], v7 offset:5120
    s_waitcnt lgkmcnt(9)
    v_mfma_f32_16x16x32_bf16 v[148:151], v[252:255], v[64:67], v[148:151]
    ds_read_b128 v[252:255], v7 offset:6144
    s_waitcnt lgkmcnt(9)
    v_mfma_f32_16x16x32_bf16 v[152:155], v[216:219], v[64:67], v[152:155]
    ds_read_b128 v[216:219], v7 offset:7168
    s_waitcnt lgkmcnt(9)
    v_mfma_f32_16x16x32_bf16 v[156:159], v[220:223], v[64:67], v[156:159]
    ds_read_b128 v[220:223], v7 offset:20480
    s_waitcnt lgkmcnt(9)
    v_mfma_f32_16x16x32_bf16 v[160:163], v[224:227], v[64:67], v[160:163]
    ds_read_b128 v[224:227], v7 offset:21504
    s_waitcnt lgkmcnt(9)
    v_mfma_f32_16x16x32_bf16 v[164:167], v[228:231], v[64:67], v[164:167]
    ds_read_b128 v[228:231], v7 offset:22528
    s_waitcnt lgkmcnt(9)
    v_mfma_f32_16x16x32_bf16 v[168:171], v[232:235], v[64:67], v[168:171]
    ds_read_b128 v[232:235], v7 offset:23552
    s_waitcnt lgkmcnt(9)
    v_mfma_f32_16x16x32_bf16 v[172:175], v[236:239], v[64:67], v[172:175]
    ds_read_b128 v[236:239], v7 offset:33792
    s_waitcnt lgkmcnt(9)
    v_mfma_f32_16x16x32_bf16 v[176:179], v[240:243], v[64:67], v[176:179]
    ds_read_b128 v[240:243], v7 offset:8192
    s_waitcnt vmcnt(2) lgkmcnt(9)
    v_mfma_f32_16x16x32_bf16 v[144:147], v[244:247], v[68:71], v[144:147]
    ds_read_b128 v[244:247], v7 offset:9216
    s_waitcnt lgkmcnt(9)
    v_mfma_f32_16x16x32_bf16 v[148:151], v[248:251], v[68:71], v[148:151]
    ds_read_b128 v[248:251], v7 offset:10240
    s_waitcnt lgkmcnt(9)
    v_mfma_f32_16x16x32_bf16 v[152:155], v[252:255], v[68:71], v[152:155]
    ds_read_b128 v[252:255], v7 offset:11264
    s_waitcnt lgkmcnt(9)
    v_mfma_f32_16x16x32_bf16 v[156:159], v[216:219], v[68:71], v[156:159]
    ds_read_b128 v[216:219], v7 offset:24576
    s_waitcnt lgkmcnt(9)
    v_mfma_f32_16x16x32_bf16 v[160:163], v[220:223], v[68:71], v[160:163]
    ds_read_b128 v[220:223], v7 offset:25600
    s_waitcnt lgkmcnt(9)
    v_mfma_f32_16x16x32_bf16 v[164:167], v[224:227], v[68:71], v[164:167]
    ds_read_b128 v[224:227], v7 offset:26624
    s_waitcnt lgkmcnt(9)
    v_mfma_f32_16x16x32_bf16 v[168:171], v[228:231], v[68:71], v[168:171]
    ds_read_b128 v[228:231], v7 offset:27648
    s_waitcnt lgkmcnt(9)
    v_mfma_f32_16x16x32_bf16 v[172:175], v[232:235], v[68:71], v[172:175]
    ds_read_b128 v[232:235], v7 offset:34816
    s_waitcnt lgkmcnt(9)
    v_mfma_f32_16x16x32_bf16 v[176:179], v[236:239], v[68:71], v[176:179]
    ds_read_b128 v[236:239], v7 offset:12288
    s_waitcnt vmcnt(1) lgkmcnt(9)
    v_mfma_f32_16x16x32_bf16 v[144:147], v[240:243], v[72:75], v[144:147]
    ds_read_b128 v[240:243], v7 offset:13312
    s_waitcnt lgkmcnt(9)
    v_mfma_f32_16x16x32_bf16 v[148:151], v[244:247], v[72:75], v[148:151]
    ds_read_b128 v[244:247], v7 offset:14336
    s_waitcnt lgkmcnt(9)
    v_mfma_f32_16x16x32_bf16 v[152:155], v[248:251], v[72:75], v[152:155]
    ds_read_b128 v[248:251], v7 offset:15360
    s_waitcnt lgkmcnt(9)
    v_mfma_f32_16x16x32_bf16 v[156:159], v[252:255], v[72:75], v[156:159]
    ds_read_b128 v[252:255], v7 offset:28672
    s_waitcnt lgkmcnt(9)
    v_mfma_f32_16x16x32_bf16 v[160:163], v[216:219], v[72:75], v[160:163]
    ds_read_b128 v[216:219], v7 offset:29696
    s_waitcnt lgkmcnt(9)
    v_mfma_f32_16x16x32_bf16 v[164:167], v[220:223], v[72:75], v[164:167]
    ds_read_b128 v[220:223], v7 offset:30720
    s_waitcnt lgkmcnt(9)
    v_mfma_f32_16x16x32_bf16 v[168:171], v[224:227], v[72:75], v[168:171]
    ds_read_b128 v[224:227], v7 offset:31744
    s_waitcnt lgkmcnt(9)
    v_mfma_f32_16x16x32_bf16 v[172:175], v[228:231], v[72:75], v[172:175]
    ds_read_b128 v[228:231], v7 offset:35840
    s_waitcnt lgkmcnt(9)
    v_mfma_f32_16x16x32_bf16 v[176:179], v[232:235], v[72:75], v[176:179]
    s_waitcnt vmcnt(0) lgkmcnt(8)
    v_mfma_f32_16x16x32_bf16 v[144:147], v[236:239], v[76:79], v[144:147]
    s_waitcnt lgkmcnt(7)
    v_mfma_f32_16x16x32_bf16 v[148:151], v[240:243], v[76:79], v[148:151]
    s_waitcnt lgkmcnt(6)
    v_mfma_f32_16x16x32_bf16 v[152:155], v[244:247], v[76:79], v[152:155]
    v_cvt_pk_bf16_f32 v144, v144, v145
    s_waitcnt lgkmcnt(5)
    v_mfma_f32_16x16x32_bf16 v[156:159], v[248:251], v[76:79], v[156:159]
    v_cvt_pk_bf16_f32 v145, v146, v147
    s_waitcnt lgkmcnt(4)
    v_mfma_f32_16x16x32_bf16 v[160:163], v[252:255], v[76:79], v[160:163]
    v_cvt_pk_bf16_f32 v152, v152, v153
    s_waitcnt lgkmcnt(3)
    v_mfma_f32_16x16x32_bf16 v[164:167], v[216:219], v[76:79], v[164:167]
    v_cvt_pk_bf16_f32 v146, v148, v149
    s_waitcnt lgkmcnt(2)
    v_mfma_f32_16x16x32_bf16 v[168:171], v[220:223], v[76:79], v[168:171]
    v_cvt_pk_bf16_f32 v147, v150, v151
    s_waitcnt lgkmcnt(1)
    v_mfma_f32_16x16x32_bf16 v[172:175], v[224:227], v[76:79], v[172:175]
    buffer_store_dwordx4 v[144:147], v11, s[4:7], s24 offen offset:0 sc1
    s_waitcnt lgkmcnt(0)
    v_mfma_f32_16x16x32_bf16 v[176:179], v[228:231], v[76:79], v[176:179]
    v_cvt_pk_bf16_f32 v153, v154, v155
    v_cvt_pk_bf16_f32 v154, v156, v157
    v_cvt_pk_bf16_f32 v155, v158, v159
    v_cvt_pk_bf16_f32 v160, v160, v161
    buffer_store_dwordx4 v[152:155], v11, s[4:7], s24 offen offset:2048 sc1
    v_cvt_pk_bf16_f32 v161, v162, v163
    v_cvt_pk_bf16_f32 v168, v168, v169
    s_add_u32 s24, s24, 4096
    v_cvt_pk_bf16_f32 v162, v164, v165
    v_cvt_pk_bf16_f32 v163, v166, v167
    v_cvt_pk_bf16_f32 v169, v170, v171
    buffer_store_dwordx4 v[160:163], v11, s[4:7], s24 offen offset:0 sc1
    v_cvt_pk_bf16_f32 v170, v172, v173
    v_cvt_pk_bf16_f32 v171, v174, v175
    buffer_store_dwordx4 v[168:171], v11, s[4:7], s24 offen offset:2048 sc1
    v_cvt_pk_bf16_f32 v176, v176, v177
    s_add_u32 s24, s24, 4096
    v_cvt_pk_bf16_f32 v177, v178, v179
    buffer_store_dwordx2 v[176:177], v10, s[4:7], s24 offen sc1
    s_waitcnt vmcnt(0)
    s_add_u32 s28, s22, 1
    s_lshr_b32 s29, s50, 6
    s_lshl_b32 s29, s29, 8
    s_and_b32 s92, s50, 63
    s_lshl_b32 s92, s92, 2
    s_add_u32 s29, s29, s92
    s_add_u32 s29, s29, 184300544
    v_mov_b32 v9, s28
    buffer_store_dword v9, off, s[4:7], s29 sc1
    s_add_u32 s22, s22, 2
    s_cmp_lt_u32 s22, 64
    s_cbranch_scc1 L_m_142
    s_endpgm
abop_m_135:
    s_endpgm
nop_m_134:
    s_sub_u32 s20, s20, 32
    s_cmp_ge_u32 s20, 8
    s_cbranch_scc1 nred1_m_145
    s_load_dwordx2 s[32:33], s[0:1], 112
    s_load_dwordx2 s[34:35], s[0:1], 0
    v_lshrrev_b32 v3, 6, v0
    s_nop 0
    v_readfirstlane_b32 s21, v3
    v_and_b32 v1, 63, v0
    v_lshlrev_b32 v2, 4, v1
    s_mov_b32 s23, 4194304
    s_waitcnt lgkmcnt(0)
    s_mov_b32 s4, s32
    s_and_b32 s5, s33, 65535
    s_mov_b32 s6, 268435456
    s_mov_b32 s7, 131072
    s_lshr_b32 s24, s2, 5
    s_cmp_lt_u32 s24, 2
    s_cbranch_scc1 nowarm_m_147
    s_load_dwordx4 s[60:63], s[0:1], 16
    s_load_dwordx2 s[64:65], s[0:1], 32
    s_sub_u32 s24, s24, 2
    s_lshl_b32 s24, s24, 2
    s_bfe_u32 s25, s2, 131075
    s_add_u32 s24, s24, s25
    s_lshl_b32 s24, s24, 2
    s_add_u32 s24, s24, s21
    s_mul_i32 s24, s24, 49152
    s_and_b32 s25, s2, 7
    s_sub_u32 s25, s25, 1
    s_waitcnt lgkmcnt(0)
    s_mov_b32 s70, 846615568
    s_mov_b32 s71, 14395788
    s_lshl_b32 s27, s25, 2
    s_lshr_b64 s[70:71], s[70:71], s27
    s_and_b32 s27, s70, 15
    s_lshr_b32 s26, s27, 2
    s_cmp_eq_u32 s26, 1
    s_cselect_b64 s[66:67], s[62:63], s[60:61]
    s_cmp_eq_u32 s26, 2
    s_cselect_b64 s[66:67], s[64:65], s[66:67]
    s_mov_b32 s68, s66
    s_and_b32 s69, s67, 65535
    s_mov_b32 s70, 4718592
    s_mov_b32 s71, 131072
    s_and_b32 s26, s27, 3
    s_lshl_b32 s26, s26, 11
    s_add_u32 s26, s26, s24
    buffer_load_dwordx4 v[128:131], v2, s[68:71], s26 offen offset:0
    buffer_load_dwordx4 v[132:135], v2, s[68:71], s26 offen offset:1024
    s_add_u32 s26, s26, 8192
    buffer_load_dwordx4 v[136:139], v2, s[68:71], s26 offen offset:0
    buffer_load_dwordx4 v[140:143], v2, s[68:71], s26 offen offset:1024
    s_add_u32 s26, s26, 8192
    buffer_load_dwordx4 v[144:147], v2, s[68:71], s26 offen offset:0
    buffer_load_dwordx4 v[148:151], v2, s[68:71], s26 offen offset:1024
    s_add_u32 s26, s26, 8192
    buffer_load_dwordx4 v[152:155], v2, s[68:71], s26 offen offset:0
    buffer_load_dwordx4 v[156:159], v2, s[68:71], s26 offen offset:1024
    s_add_u32 s26, s26, 8192
    buffer_load_dwordx4 v[160:163], v2, s[68:71], s26 offen offset:0
    buffer_load_dwordx4 v[164:167], v2, s[68:71], s26 offen offset:1024
    s_add_u32 s26, s26, 8192
    buffer_load_dwordx4 v[168:171], v2, s[68:71], s26 offen offset:0
    buffer_load_dwordx4 v[172:175], v2, s[68:71], s26 offen offset:1024
    s_add_u32 s26, s26, 8192
    s_add_u32 s25, s25, 7
    s_mov_b32 s70, 846615568
    s_mov_b32 s71, 14395788
    s_lshl_b32 s27, s25, 2
    s_lshr_b64 s[70:71], s[70:71], s27
    s_and_b32 s27, s70, 15
    s_cmp_ge_u32 s27, 12
    s_cbranch_scc1 nowarm_m_147
    s_lshr_b32 s26, s27, 2
    s_cmp_eq_u32 s26, 1
    s_cselect_b64 s[66:67], s[62:63], s[60:61]
    s_cmp_eq_u32 s26, 2
    s_cselect_b64 s[66:67], s[64:65], s[66:67]
    s_mov_b32 s68, s66
    s_and_b32 s69, s67, 65535
    s_mov_b32 s70, 4718592
    s_mov_b32 s71, 131072
    s_and_b32 s26, s27, 3
    s_lshl_b32 s26, s26, 11
    s_add_u32 s26, s26, s24
    buffer_load_dwordx4 v[176:179], v2, s[68:71], s26 offen offset:0
    buffer_load_dwordx4 v[180:183], v2, s[68:71], s26 offen offset:1024
    s_add_u32 s26, s26, 8192
    buffer_load_dwordx4 v[184:187], v2, s[68:71], s26 offen offset:0
    buffer_load_dwordx4 v[188:191], v2, s[68:71], s26 offen offset:1024
    s_add_u32 s26, s26, 8192
    buffer_load_dwordx4 v[192:195], v2, s[68:71], s26 offen offset:0
    buffer_load_dwordx4 v[196:199], v2, s[68:71], s26 offen offset:1024
    s_add_u32 s26, s26, 8192
    buffer_load_dwordx4 v[200:203], v2, s[68:71], s26 offen offset:0
    buffer_load_dwordx4 v[204:207], v2, s[68:71], s26 offen offset:1024
    s_add_u32 s26, s26, 8192
    buffer_load_dwordx4 v[208:211], v2, s[68:71], s26 offen offset:0
    buffer_load_dwordx4 v[212:215], v2, s[68:71], s26 offen offset:1024
    s_add_u32 s26, s26, 8192
    buffer_load_dwordx4 v[216:219], v2, s[68:71], s26 offen offset:0
    buffer_load_dwordx4 v[220:223], v2, s[68:71], s26 offen offset:1024
    s_add_u32 s26, s26, 8192
nowarm_m_147:
    s_waitcnt vmcnt(0)
    s_lshl_b32 s44, s20, 2
    s_add_u32 s44, s44, s21
    s_and_b32 s45, s44, 7
    s_lshr_b32 s22, s44, 3
    s_mov_b32 s50, 16256
    s_mov_b32 s51, 1065353216
    v_lshrrev_b32 v14, 4, v1
    v_bfe_u32 v15, v1, 2, 2
    v_and_b32 v3, 3, v1
    v_lshlrev_b32 v12, 11, v14
    v_lshl_add_u32 v12, v15, 8, v12
    v_lshl_add_u32 v4, v3, 4, v12
    v_mul_u32_u24 v12, 9216, v14
    v_lshl_add_u32 v12, v15, 7, v12
    v_lshl_add_u32 v5, v3, 3, v12
    v_mul_u32_u24 v13, 1152, v3
    v_lshl_add_u32 v12, v14, 3, v15
    v_lshl_add_u32 v6, v12, 3, v13
    v_mul_u32_u24 v12, 36, v14
    v_add_u32 v12, v12, v15
    v_add_u32 v12, 32, v12
    v_lshl_add_u32 v7, v12, 3, v13
    s_lshr_b32 s24, s45, 2
    s_and_b32 s25, s45, 3
    s_lshl_b32 s46, s24, 10
    s_lshl_b32 s26, s25, 6
    s_add_u32 s46, s46, s26
    s_lshl_b32 s49, s24, 9
    s_lshl_b32 s26, s25, 5
    s_add_u32 s49, s49, s26
    s_add_u32 s49, s49, 8192
    s_mov_b32 s8, s34
    s_and_b32 s9, s35, 65535
    s_mov_b32 s10, 2359296
    s_mov_b32 s11, 131072
    v_lshrrev_b32 v12, 1, v15
    v_lshlrev_b32 v12, 9, v12
    v_and_b32 v13, 1, v15
    v_lshl_add_u32 v12, v13, 3, v12
    v_lshl_add_u32 v12, v3, 4, v12
    s_lshl_b32 s24, s45, 6
    v_add_u32 v12, s24, v12
    v_lshl_add_u32 v8, v14, 11, v12
    v_mul_u32_u24 v13, 9216, v14
    v_add_u32 v9, v13, v12
    v_add_u32 v9, 8192, v9
    s_load_dwordx2 s[30:31], s[0:1], 104
    s_waitcnt lgkmcnt(0)
    s_mov_b32 s16, s30
    s_and_b32 s17, s31, 65535
    s_mov_b32 s18, 256
    s_mov_b32 s19, 131072
L_m_148:
    s_sub_u32 s23, s23, 1
    s_cbranch_scc1 abred1_m_146
    buffer_load_dword v3, off, s[16:19], 0 offset:64 sc1
    s_waitcnt vmcnt(0)
    v_cmp_eq_u32 vcc, 0, v3
    s_nop 0
    s_cbranch_vccnz L_m_148
L_m_149:
    s_lshl_b32 s47, s22, 3
    s_add_u32 s47, s47, s45
    s_mul_i32 s48, s47, 9216
    s_add_u32 s48, s48, 117440512
    s_mul_i32 s47, s47, 4608
    s_waitcnt vmcnt(0)
    s_max_u32 s28, s22, 3
    s_sub_u32 s28, s28, 3
    s_lshr_b32 s29, s44, 3
    s_lshl_b32 s29, s29, 8
    s_and_b32 s92, s44, 7
    s_lshl_b32 s92, s92, 2
    s_add_u32 s29, s29, s92
    s_add_u32 s29, s29, 184301568
    v_mov_b32 v11, s28
    v_and_b32 v10, 3, v1
    v_lshlrev_b32 v10, 10, v10
    buffer_store_dword v11, v10, s[4:7], s29 offen sc1
    buffer_load_dwordx2 v[52:53], v6, s[8:11], s47 offen offset:0
    buffer_load_dwordx2 v[54:55], v6, s[8:11], s47 offen offset:32
    buffer_load_dwordx2 v[56:57], v6, s[8:11], s47 offen offset:288
    buffer_load_dwordx2 v[58:59], v6, s[8:11], s47 offen offset:320
    buffer_load_dwordx2 v[60:61], v6, s[8:11], s47 offen offset:576
    buffer_load_dwordx2 v[62:63], v6, s[8:11], s47 offen offset:608
    buffer_load_dwordx2 v[64:65], v6, s[8:11], s47 offen offset:864
    buffer_load_dwordx2 v[66:67], v6, s[8:11], s47 offen offset:896
    buffer_load_dwordx2 v[68:69], v7, s[8:11], s47 offen offset:0
    s_add_u32 s28, s22, 1
    s_and_b32 s27, s22, 1
    s_lshl_b32 s27, s27, 1
    s_lshr_b32 s26, s45, 2
    s_add_u32 s27, s27, s26
    s_lshl_b32 s27, s27, 6
    v_min_u32 v10, 31, v1
    v_mul_u32_u24 v10, 4, v10
    s_lshr_b32 s29, s27, 6
    s_lshl_b32 s29, s29, 8
    s_and_b32 s92, s27, 63
    s_lshl_b32 s92, s92, 2
    s_add_u32 s29, s29, s92
    s_add_u32 s29, s29, 184300544
    buffer_load_dword v11, v10, s[4:7], s29 offen sc1
    s_waitcnt vmcnt(0)
    v_cmp_gt_u32 vcc, s28, v11
    s_nop 0
    s_cbranch_vccz fok_m_150
L_m_151:
    s_sleep 8
    s_sub_u32 s23, s23, 1
    s_cbranch_scc1 abred1_m_146
    buffer_load_dword v11, v10, s[4:7], s29 offen sc1
    s_waitcnt vmcnt(0)
    v_cmp_gt_u32 vcc, s28, v11
    s_nop 0
    s_cbranch_vccnz L_m_151
fok_m_150:
    s_mul_i32 s24, s22, 294912
    s_add_u32 s24, s24, 79691776
    s_add_u32 s27, s24, s49
    s_add_u32 s24, s24, s46
    buffer_load_dwordx4 v[72:75], v4, s[4:7], s24 offen
    s_add_u32 s24, s24, 9216
    buffer_load_dwordx4 v[76:79], v4, s[4:7], s24 offen
    s_add_u32 s24, s24, 9216
    buffer_load_dwordx4 v[80:83], v4, s[4:7], s24 offen
    s_add_u32 s24, s24, 9216
    buffer_load_dwordx4 v[84:87], v4, s[4:7], s24 offen
    s_add_u32 s24, s24, 9216
    buffer_load_dwordx2 v[216:217], v5, s[4:7], s27 offen
    s_add_u32 s27, s27, 36864
    buffer_load_dwordx4 v[88:91], v4, s[4:7], s24 offen
    s_add_u32 s24, s24, 9216
    buffer_load_dwordx4 v[92:95], v4, s[4:7], s24 offen
    s_add_u32 s24, s24, 9216
    buffer_load_dwordx4 v[96:99], v4, s[4:7], s24 offen
    s_add_u32 s24, s24, 9216
    buffer_load_dwordx4 v[100:103], v4, s[4:7], s24 offen
    s_add_u32 s24, s24, 9216
    buffer_load_dwordx2 v[218:219], v5, s[4:7], s27 offen
    s_add_u32 s27, s27, 36864
    buffer_load_dwordx4 v[104:107], v4, s[4:7], s24 offen
    s_add_u32 s24, s24, 9216
    buffer_load_dwordx4 v[108:111], v4, s[4:7], s24 offen
    s_add_u32 s24, s24, 9216
    buffer_load_dwordx4 v[112:115], v4, s[4:7], s24 offen
    s_add_u32 s24, s24, 9216
    buffer_load_dwordx4 v[116:119], v4, s[4:7], s24 offen
    s_add_u32 s24, s24, 9216
    buffer_load_dwordx2 v[220:221], v5, s[4:7], s27 offen
    s_add_u32 s27, s27, 36864
    buffer_load_dwordx4 v[120:123], v4, s[4:7], s24 offen
    s_add_u32 s24, s24, 9216
    buffer_load_dwordx4 v[124:127], v4, s[4:7], s24 offen
    s_add_u32 s24, s24, 9216
    buffer_load_dwordx4 v[128:131], v4, s[4:7], s24 offen
    s_add_u32 s24, s24, 9216
    buffer_load_dwordx4 v[132:135], v4, s[4:7], s24 offen
    s_add_u32 s24, s24, 9216
    buffer_load_dwordx2 v[222:223], v5, s[4:7], s27 offen
    s_add_u32 s27, s27, 36864
    buffer_load_dwordx4 v[136:139], v4, s[4:7], s24 offen
    s_add_u32 s24, s24, 9216
    buffer_load_dwordx4 v[140:143], v4, s[4:7], s24 offen
    s_add_u32 s24, s24, 9216
    buffer_load_dwordx4 v[144:147], v4, s[4:7], s24 offen
    s_add_u32 s24, s24, 9216
    buffer_load_dwordx4 v[148:151], v4, s[4:7], s24 offen
    s_add_u32 s24, s24, 9216
    buffer_load_dwordx2 v[224:225], v5, s[4:7], s27 offen
    s_add_u32 s27, s27, 36864
    buffer_load_dwordx4 v[152:155], v4, s[4:7], s24 offen
    s_add_u32 s24, s24, 9216
    buffer_load_dwordx4 v[156:159], v4, s[4:7], s24 offen
    s_add_u32 s24, s24, 9216
    buffer_load_dwordx4 v[160:163], v4, s[4:7], s24 offen
    s_add_u32 s24, s24, 9216
    buffer_load_dwordx4 v[164:167], v4, s[4:7], s24 offen
    s_add_u32 s24, s24, 9216
    buffer_load_dwordx2 v[226:227], v5, s[4:7], s27 offen
    s_add_u32 s27, s27, 36864
    buffer_load_dwordx4 v[168:171], v4, s[4:7], s24 offen
    s_add_u32 s24, s24, 9216
    buffer_load_dwordx4 v[172:175], v4, s[4:7], s24 offen
    s_add_u32 s24, s24, 9216
    buffer_load_dwordx4 v[176:179], v4, s[4:7], s24 offen
    s_add_u32 s24, s24, 9216
    buffer_load_dwordx4 v[180:183], v4, s[4:7], s24 offen
    s_add_u32 s24, s24, 9216
    buffer_load_dwordx2 v[228:229], v5, s[4:7], s27 offen
    s_add_u32 s27, s27, 36864
    buffer_load_dwordx4 v[184:187], v4, s[4:7], s24 offen
    s_add_u32 s24, s24, 9216
    buffer_load_dwordx4 v[188:191], v4, s[4:7], s24 offen
    s_add_u32 s24, s24, 9216
    buffer_load_dwordx4 v[192:195], v4, s[4:7], s24 offen
    s_add_u32 s24, s24, 9216
    buffer_load_dwordx4 v[196:199], v4, s[4:7], s24 offen
    s_add_u32 s24, s24, 9216
    buffer_load_dwordx2 v[230:231], v5, s[4:7], s27 offen
    s_add_u32 s27, s27, 36864
    v_lshlrev_b32 v16, 16, v52
    v_and_b32 v17, 4294901760, v52
    v_lshlrev_b32 v18, 16, v53
    v_and_b32 v19, 4294901760, v53
    v_lshlrev_b32 v20, 16, v54
    v_and_b32 v21, 4294901760, v54
    v_lshlrev_b32 v22, 16, v55
    v_and_b32 v23, 4294901760, v55
    v_lshlrev_b32 v24, 16, v56
    v_and_b32 v25, 4294901760, v56
    v_lshlrev_b32 v26, 16, v57
    v_and_b32 v27, 4294901760, v57
    v_lshlrev_b32 v28, 16, v58
    v_and_b32 v29, 4294901760, v58
    v_lshlrev_b32 v30, 16, v59
    v_and_b32 v31, 4294901760, v59
    v_lshlrev_b32 v32, 16, v60
    v_and_b32 v33, 4294901760, v60
    v_lshlrev_b32 v34, 16, v61
    v_and_b32 v35, 4294901760, v61
    v_lshlrev_b32 v36, 16, v62
    v_and_b32 v37, 4294901760, v62
    v_lshlrev_b32 v38, 16, v63
    v_and_b32 v39, 4294901760, v63
    v_lshlrev_b32 v40, 16, v64
    v_and_b32 v41, 4294901760, v64
    v_lshlrev_b32 v42, 16, v65
    v_and_b32 v43, 4294901760, v65
    v_lshlrev_b32 v44, 16, v66
    v_and_b32 v45, 4294901760, v66
    v_lshlrev_b32 v46, 16, v67
    v_and_b32 v47, 4294901760, v67
    v_lshlrev_b32 v48, 16, v68
    v_and_b32 v49, 4294901760, v68
    v_lshlrev_b32 v50, 16, v69
    v_and_b32 v51, 4294901760, v69
    s_waitcnt vmcnt(39)
    v_dot2c_f32_bf16 v16, s50, v72
    v_dot2c_f32_bf16 v17, s51, v72
    v_dot2c_f32_bf16 v18, s50, v73
    v_dot2c_f32_bf16 v19, s51, v73
    v_dot2c_f32_bf16 v20, s50, v74
    v_dot2c_f32_bf16 v21, s51, v74
    v_dot2c_f32_bf16 v22, s50, v75
    v_dot2c_f32_bf16 v23, s51, v75
    s_waitcnt vmcnt(38)
    v_dot2c_f32_bf16 v24, s50, v76
    v_dot2c_f32_bf16 v25, s51, v76
    v_dot2c_f32_bf16 v26, s50, v77
    v_dot2c_f32_bf16 v27, s51, v77
    v_dot2c_f32_bf16 v28, s50, v78
    v_dot2c_f32_bf16 v29, s51, v78
    v_dot2c_f32_bf16 v30, s50, v79
    v_dot2c_f32_bf16 v31, s51, v79
    s_waitcnt vmcnt(37)
    v_dot2c_f32_bf16 v32, s50, v80
    v_dot2c_f32_bf16 v33, s51, v80
    v_dot2c_f32_bf16 v34, s50, v81
    v_dot2c_f32_bf16 v35, s51, v81
    v_dot2c_f32_bf16 v36, s50, v82
    v_dot2c_f32_bf16 v37, s51, v82
    v_dot2c_f32_bf16 v38, s50, v83
    v_dot2c_f32_bf16 v39, s51, v83
    s_waitcnt vmcnt(36)
    v_dot2c_f32_bf16 v40, s50, v84
    v_dot2c_f32_bf16 v41, s51, v84
    v_dot2c_f32_bf16 v42, s50, v85
    v_dot2c_f32_bf16 v43, s51, v85
    v_dot2c_f32_bf16 v44, s50, v86
    v_dot2c_f32_bf16 v45, s51, v86
    v_dot2c_f32_bf16 v46, s50, v87
    v_dot2c_f32_bf16 v47, s51, v87
    s_waitcnt vmcnt(35)
    v_dot2c_f32_bf16 v48, s50, v216
    v_dot2c_f32_bf16 v49, s51, v216
    v_dot2c_f32_bf16 v50, s50, v217
    v_dot2c_f32_bf16 v51, s51, v217
    s_waitcnt vmcnt(34)
    v_dot2c_f32_bf16 v16, s50, v88
    v_dot2c_f32_bf16 v17, s51, v88
    v_dot2c_f32_bf16 v18, s50, v89
    v_dot2c_f32_bf16 v19, s51, v89
    v_dot2c_f32_bf16 v20, s50, v90
    v_dot2c_f32_bf16 v21, s51, v90
    v_dot2c_f32_bf16 v22, s50, v91
    v_dot2c_f32_bf16 v23, s51, v91
    s_waitcnt vmcnt(33)
    v_dot2c_f32_bf16 v24, s50, v92
    v_dot2c_f32_bf16 v25, s51, v92
    v_dot2c_f32_bf16 v26, s50, v93
    v_dot2c_f32_bf16 v27, s51, v93
    v_dot2c_f32_bf16 v28, s50, v94
    v_dot2c_f32_bf16 v29, s51, v94
    v_dot2c_f32_bf16 v30, s50, v95
    v_dot2c_f32_bf16 v31, s51, v95
    s_waitcnt vmcnt(32)
    v_dot2c_f32_bf16 v32, s50, v96
    v_dot2c_f32_bf16 v33, s51, v96
    v_dot2c_f32_bf16 v34, s50, v97
    v_dot2c_f32_bf16 v35, s51, v97
    v_dot2c_f32_bf16 v36, s50, v98
    v_dot2c_f32_bf16 v37, s51, v98
    v_dot2c_f32_bf16 v38, s50, v99
    v_dot2c_f32_bf16 v39, s51, v99
    s_waitcnt vmcnt(31)
    v_dot2c_f32_bf16 v40, s50, v100
    v_dot2c_f32_bf16 v41, s51, v100
    v_dot2c_f32_bf16 v42, s50, v101
    v_dot2c_f32_bf16 v43, s51, v101
    v_dot2c_f32_bf16 v44, s50, v102
    v_dot2c_f32_bf16 v45, s51, v102
    v_dot2c_f32_bf16 v46, s50, v103
    v_dot2c_f32_bf16 v47, s51, v103
    s_waitcnt vmcnt(30)
    v_dot2c_f32_bf16 v48, s50, v218
    v_dot2c_f32_bf16 v49, s51, v218
    v_dot2c_f32_bf16 v50, s50, v219
    v_dot2c_f32_bf16 v51, s51, v219
    s_waitcnt vmcnt(29)
    v_dot2c_f32_bf16 v16, s50, v104
    v_dot2c_f32_bf16 v17, s51, v104
    v_dot2c_f32_bf16 v18, s50, v105
    v_dot2c_f32_bf16 v19, s51, v105
    v_dot2c_f32_bf16 v20, s50, v106
    v_dot2c_f32_bf16 v21, s51, v106
    v_dot2c_f32_bf16 v22, s50, v107
    v_dot2c_f32_bf16 v23, s51, v107
    s_waitcnt vmcnt(28)
    v_dot2c_f32_bf16 v24, s50, v108
    v_dot2c_f32_bf16 v25, s51, v108
    v_dot2c_f32_bf16 v26, s50, v109
    v_dot2c_f32_bf16 v27, s51, v109
    v_dot2c_f32_bf16 v28, s50, v110
    v_dot2c_f32_bf16 v29, s51, v110
    v_dot2c_f32_bf16 v30, s50, v111
    v_dot2c_f32_bf16 v31, s51, v111
    s_waitcnt vmcnt(27)
    v_dot2c_f32_bf16 v32, s50, v112
    v_dot2c_f32_bf16 v33, s51, v112
    v_dot2c_f32_bf16 v34, s50, v113
    v_dot2c_f32_bf16 v35, s51, v113
    v_dot2c_f32_bf16 v36, s50, v114
    v_dot2c_f32_bf16 v37, s51, v114
    v_dot2c_f32_bf16 v38, s50, v115
    v_dot2c_f32_bf16 v39, s51, v115
    s_waitcnt vmcnt(26)
    v_dot2c_f32_bf16 v40, s50, v116
    v_dot2c_f32_bf16 v41, s51, v116
    v_dot2c_f32_bf16 v42, s50, v117
    v_dot2c_f32_bf16 v43, s51, v117
    v_dot2c_f32_bf16 v44, s50, v118
    v_dot2c_f32_bf16 v45, s51, v118
    v_dot2c_f32_bf16 v46, s50, v119
    v_dot2c_f32_bf16 v47, s51, v119
    s_waitcnt vmcnt(25)
    v_dot2c_f32_bf16 v48, s50, v220
    v_dot2c_f32_bf16 v49, s51, v220
    v_dot2c_f32_bf16 v50, s50, v221
    v_dot2c_f32_bf16 v51, s51, v221
    s_waitcnt vmcnt(24)
    v_dot2c_f32_bf16 v16, s50, v120
    v_dot2c_f32_bf16 v17, s51, v120
    v_dot2c_f32_bf16 v18, s50, v121
    v_dot2c_f32_bf16 v19, s51, v121
    v_dot2c_f32_bf16 v20, s50, v122
    v_dot2c_f32_bf16 v21, s51, v122
    v_dot2c_f32_bf16 v22, s50, v123
    v_dot2c_f32_bf16 v23, s51, v123
    s_waitcnt vmcnt(23)
    v_dot2c_f32_bf16 v24, s50, v124
    v_dot2c_f32_bf16 v25, s51, v124
    v_dot2c_f32_bf16 v26, s50, v125
    v_dot2c_f32_bf16 v27, s51, v125
    v_dot2c_f32_bf16 v28, s50, v126
    v_dot2c_f32_bf16 v29, s51, v126
    v_dot2c_f32_bf16 v30, s50, v127
    v_dot2c_f32_bf16 v31, s51, v127
    s_waitcnt vmcnt(22)
    v_dot2c_f32_bf16 v32, s50, v128
    v_dot2c_f32_bf16 v33, s51, v128
    v_dot2c_f32_bf16 v34, s50, v129
    v_dot2c_f32_bf16 v35, s51, v129
    v_dot2c_f32_bf16 v36, s50, v130
    v_dot2c_f32_bf16 v37, s51, v130
    v_dot2c_f32_bf16 v38, s50, v131
    v_dot2c_f32_bf16 v39, s51, v131
    s_waitcnt vmcnt(21)
    v_dot2c_f32_bf16 v40, s50, v132
    v_dot2c_f32_bf16 v41, s51, v132
    v_dot2c_f32_bf16 v42, s50, v133
    v_dot2c_f32_bf16 v43, s51, v133
    v_dot2c_f32_bf16 v44, s50, v134
    v_dot2c_f32_bf16 v45, s51, v134
    v_dot2c_f32_bf16 v46, s50, v135
    v_dot2c_f32_bf16 v47, s51, v135
    s_waitcnt vmcnt(20)
    v_dot2c_f32_bf16 v48, s50, v222
    v_dot2c_f32_bf16 v49, s51, v222
    v_dot2c_f32_bf16 v50, s50, v223
    v_dot2c_f32_bf16 v51, s51, v223
    s_waitcnt vmcnt(19)
    v_dot2c_f32_bf16 v16, s50, v136
    v_dot2c_f32_bf16 v17, s51, v136
    v_dot2c_f32_bf16 v18, s50, v137
    v_dot2c_f32_bf16 v19, s51, v137
    v_dot2c_f32_bf16 v20, s50, v138
    v_dot2c_f32_bf16 v21, s51, v138
    v_dot2c_f32_bf16 v22, s50, v139
    v_dot2c_f32_bf16 v23, s51, v139
    s_waitcnt vmcnt(18)
    v_dot2c_f32_bf16 v24, s50, v140
    v_dot2c_f32_bf16 v25, s51, v140
    v_dot2c_f32_bf16 v26, s50, v141
    v_dot2c_f32_bf16 v27, s51, v141
    v_dot2c_f32_bf16 v28, s50, v142
    v_dot2c_f32_bf16 v29, s51, v142
    v_dot2c_f32_bf16 v30, s50, v143
    v_dot2c_f32_bf16 v31, s51, v143
    s_waitcnt vmcnt(17)
    v_dot2c_f32_bf16 v32, s50, v144
    v_dot2c_f32_bf16 v33, s51, v144
    v_dot2c_f32_bf16 v34, s50, v145
    v_dot2c_f32_bf16 v35, s51, v145
    v_dot2c_f32_bf16 v36, s50, v146
    v_dot2c_f32_bf16 v37, s51, v146
    v_dot2c_f32_bf16 v38, s50, v147
    v_dot2c_f32_bf16 v39, s51, v147
    s_waitcnt vmcnt(16)
    v_dot2c_f32_bf16 v40, s50, v148
    v_dot2c_f32_bf16 v41, s51, v148
    v_dot2c_f32_bf16 v42, s50, v149
    v_dot2c_f32_bf16 v43, s51, v149
    v_dot2c_f32_bf16 v44, s50, v150
    v_dot2c_f32_bf16 v45, s51, v150
    v_dot2c_f32_bf16 v46, s50, v151
    v_dot2c_f32_bf16 v47, s51, v151
    s_waitcnt vmcnt(15)
    v_dot2c_f32_bf16 v48, s50, v224
    v_dot2c_f32_bf16 v49, s51, v224
    v_dot2c_f32_bf16 v50, s50, v225
    v_dot2c_f32_bf16 v51, s51, v225
    s_waitcnt vmcnt(14)
    v_dot2c_f32_bf16 v16, s50, v152
    v_dot2c_f32_bf16 v17, s51, v152
    v_dot2c_f32_bf16 v18, s50, v153
    v_dot2c_f32_bf16 v19, s51, v153
    v_dot2c_f32_bf16 v20, s50, v154
    v_dot2c_f32_bf16 v21, s51, v154
    v_dot2c_f32_bf16 v22, s50, v155
    v_dot2c_f32_bf16 v23, s51, v155
    s_waitcnt vmcnt(13)
    v_dot2c_f32_bf16 v24, s50, v156
    v_dot2c_f32_bf16 v25, s51, v156
    v_dot2c_f32_bf16 v26, s50, v157
    v_dot2c_f32_bf16 v27, s51, v157
    v_dot2c_f32_bf16 v28, s50, v158
    v_dot2c_f32_bf16 v29, s51, v158
    v_dot2c_f32_bf16 v30, s50, v159
    v_dot2c_f32_bf16 v31, s51, v159
    s_waitcnt vmcnt(12)
    v_dot2c_f32_bf16 v32, s50, v160
    v_dot2c_f32_bf16 v33, s51, v160
    v_dot2c_f32_bf16 v34, s50, v161
    v_dot2c_f32_bf16 v35, s51, v161
    v_dot2c_f32_bf16 v36, s50, v162
    v_dot2c_f32_bf16 v37, s51, v162
    v_dot2c_f32_bf16 v38, s50, v163
    v_dot2c_f32_bf16 v39, s51, v163
    s_waitcnt vmcnt(11)
    v_dot2c_f32_bf16 v40, s50, v164
    v_dot2c_f32_bf16 v41, s51, v164
    v_dot2c_f32_bf16 v42, s50, v165
    v_dot2c_f32_bf16 v43, s51, v165
    v_dot2c_f32_bf16 v44, s50, v166
    v_dot2c_f32_bf16 v45, s51, v166
    v_dot2c_f32_bf16 v46, s50, v167
    v_dot2c_f32_bf16 v47, s51, v167
    s_waitcnt vmcnt(10)
    v_dot2c_f32_bf16 v48, s50, v226
    v_dot2c_f32_bf16 v49, s51, v226
    v_dot2c_f32_bf16 v50, s50, v227
    v_dot2c_f32_bf16 v51, s51, v227
    s_waitcnt vmcnt(9)
    v_dot2c_f32_bf16 v16, s50, v168
    v_dot2c_f32_bf16 v17, s51, v168
    v_dot2c_f32_bf16 v18, s50, v169
    v_dot2c_f32_bf16 v19, s51, v169
    v_dot2c_f32_bf16 v20, s50, v170
    v_dot2c_f32_bf16 v21, s51, v170
    v_dot2c_f32_bf16 v22, s50, v171
    v_dot2c_f32_bf16 v23, s51, v171
    s_waitcnt vmcnt(8)
    v_dot2c_f32_bf16 v24, s50, v172
    v_dot2c_f32_bf16 v25, s51, v172
    v_dot2c_f32_bf16 v26, s50, v173
    v_dot2c_f32_bf16 v27, s51, v173
    v_dot2c_f32_bf16 v28, s50, v174
    v_dot2c_f32_bf16 v29, s51, v174
    v_dot2c_f32_bf16 v30, s50, v175
    v_dot2c_f32_bf16 v31, s51, v175
    s_waitcnt vmcnt(7)
    v_dot2c_f32_bf16 v32, s50, v176
    v_dot2c_f32_bf16 v33, s51, v176
    v_dot2c_f32_bf16 v34, s50, v177
    v_dot2c_f32_bf16 v35, s51, v177
    v_dot2c_f32_bf16 v36, s50, v178
    v_dot2c_f32_bf16 v37, s51, v178
    v_dot2c_f32_bf16 v38, s50, v179
    v_dot2c_f32_bf16 v39, s51, v179
    s_waitcnt vmcnt(6)
    v_dot2c_f32_bf16 v40, s50, v180
    v_dot2c_f32_bf16 v41, s51, v180
    v_dot2c_f32_bf16 v42, s50, v181
    v_dot2c_f32_bf16 v43, s51, v181
    v_dot2c_f32_bf16 v44, s50, v182
    v_dot2c_f32_bf16 v45, s51, v182
    v_dot2c_f32_bf16 v46, s50, v183
    v_dot2c_f32_bf16 v47, s51, v183
    s_waitcnt vmcnt(5)
    v_dot2c_f32_bf16 v48, s50, v228
    v_dot2c_f32_bf16 v49, s51, v228
    v_dot2c_f32_bf16 v50, s50, v229
    v_dot2c_f32_bf16 v51, s51, v229
    s_waitcnt vmcnt(4)
    v_dot2c_f32_bf16 v16, s50, v184
    v_dot2c_f32_bf16 v17, s51, v184
    v_dot2c_f32_bf16 v18, s50, v185
    v_dot2c_f32_bf16 v19, s51, v185
    v_dot2c_f32_bf16 v20, s50, v186
    v_dot2c_f32_bf16 v21, s51, v186
    v_dot2c_f32_bf16 v22, s50, v187
    v_dot2c_f32_bf16 v23, s51, v187
    s_waitcnt vmcnt(3)
    v_dot2c_f32_bf16 v24, s50, v188
    v_dot2c_f32_bf16 v25, s51, v188
    v_dot2c_f32_bf16 v26, s50, v189
    v_dot2c_f32_bf16 v27, s51, v189
    v_dot2c_f32_bf16 v28, s50, v190
    v_dot2c_f32_bf16 v29, s51, v190
    v_dot2c_f32_bf16 v30, s50, v191
    v_dot2c_f32_bf16 v31, s51, v191
    s_waitcnt vmcnt(2)
    v_dot2c_f32_bf16 v32, s50, v192
    v_dot2c_f32_bf16 v33, s51, v192
    v_dot2c_f32_bf16 v34, s50, v193
    v_dot2c_f32_bf16 v35, s51, v193
    v_dot2c_f32_bf16 v36, s50, v194
    v_dot2c_f32_bf16 v37, s51, v194
    v_dot2c_f32_bf16 v38, s50, v195
    v_dot2c_f32_bf16 v39, s51, v195
    s_waitcnt vmcnt(1)
    v_dot2c_f32_bf16 v40, s50, v196
    v_dot2c_f32_bf16 v41, s51, v196
    v_dot2c_f32_bf16 v42, s50, v197
    v_dot2c_f32_bf16 v43, s51, v197
    v_dot2c_f32_bf16 v44, s50, v198
    v_dot2c_f32_bf16 v45, s51, v198
    v_dot2c_f32_bf16 v46, s50, v199
    v_dot2c_f32_bf16 v47, s51, v199
    s_waitcnt vmcnt(0)
    v_dot2c_f32_bf16 v48, s50, v230
    v_dot2c_f32_bf16 v49, s51, v230
    v_dot2c_f32_bf16 v50, s50, v231
    v_dot2c_f32_bf16 v51, s51, v231
    v_pk_add_f32 v[14:15], v[16:17], v[18:19]
    v_pk_add_f32 v[14:15], v[14:15], v[20:21]
    v_pk_add_f32 v[14:15], v[14:15], v[22:23]
    v_pk_add_f32 v[14:15], v[14:15], v[24:25]
    v_pk_add_f32 v[14:15], v[14:15], v[26:27]
    v_pk_add_f32 v[14:15], v[14:15], v[28:29]
    v_pk_add_f32 v[14:15], v[14:15], v[30:31]
    v_pk_add_f32 v[14:15], v[14:15], v[32:33]
    v_pk_add_f32 v[14:15], v[14:15], v[34:35]
    v_pk_add_f32 v[14:15], v[14:15], v[36:37]
    v_pk_add_f32 v[14:15], v[14:15], v[38:39]
    v_pk_add_f32 v[14:15], v[14:15], v[40:41]
    v_pk_add_f32 v[14:15], v[14:15], v[42:43]
    v_pk_add_f32 v[14:15], v[14:15], v[44:45]
    v_pk_add_f32 v[14:15], v[14:15], v[46:47]
    v_pk_add_f32 v[14:15], v[14:15], v[48:49]
    v_pk_add_f32 v[14:15], v[14:15], v[50:51]
    v_add_f32 v14, v14, v15
    s_nop 1
    v_add_f32_dpp v14, v14, v14 row_ror:4 row_mask:0xf bank_mask:0xf
    s_nop 1
    v_add_f32_dpp v14, v14, v14 row_ror:8 row_mask:0xf bank_mask:0xf
    v_mov_b32 v3, v14
    s_nop 1
    v_permlane16_swap_b32 v14, v3
    v_add_f32 v14, v14, v3
    v_mov_b32 v3, v14
    s_nop 1
    v_permlane32_swap_b32 v14, v3
    v_add_f32 v14, v14, v3
    v_mul_f32 v12, 987991609, v14
    v_mov_b64 v[10:11], 0
    v_pk_add_f32 v[72:73], v[16:17], v[12:13] op_sel_hi:[1,0] neg_lo:[0,1] neg_hi:[0,1]
    v_pk_fma_f32 v[10:11], v[72:73], v[72:73], v[10:11]
    v_pk_add_f32 v[74:75], v[18:19], v[12:13] op_sel_hi:[1,0] neg_lo:[0,1] neg_hi:[0,1]
    v_pk_fma_f32 v[10:11], v[74:75], v[74:75], v[10:11]
    v_pk_add_f32 v[76:77], v[20:21], v[12:13] op_sel_hi:[1,0] neg_lo:[0,1] neg_hi:[0,1]
    v_pk_fma_f32 v[10:11], v[76:77], v[76:77], v[10:11]
    v_pk_add_f32 v[78:79], v[22:23], v[12:13] op_sel_hi:[1,0] neg_lo:[0,1] neg_hi:[0,1]
    v_pk_fma_f32 v[10:11], v[78:79], v[78:79], v[10:11]
    v_pk_add_f32 v[80:81], v[24:25], v[12:13] op_sel_hi:[1,0] neg_lo:[0,1] neg_hi:[0,1]
    v_pk_fma_f32 v[10:11], v[80:81], v[80:81], v[10:11]
    v_pk_add_f32 v[82:83], v[26:27], v[12:13] op_sel_hi:[1,0] neg_lo:[0,1] neg_hi:[0,1]
    v_pk_fma_f32 v[10:11], v[82:83], v[82:83], v[10:11]
    v_pk_add_f32 v[84:85], v[28:29], v[12:13] op_sel_hi:[1,0] neg_lo:[0,1] neg_hi:[0,1]
    v_pk_fma_f32 v[10:11], v[84:85], v[84:85], v[10:11]
    v_pk_add_f32 v[86:87], v[30:31], v[12:13] op_sel_hi:[1,0] neg_lo:[0,1] neg_hi:[0,1]
    v_pk_fma_f32 v[10:11], v[86:87], v[86:87], v[10:11]
    v_pk_add_f32 v[88:89], v[32:33], v[12:13] op_sel_hi:[1,0] neg_lo:[0,1] neg_hi:[0,1]
    v_pk_fma_f32 v[10:11], v[88:89], v[88:89], v[10:11]
    v_pk_add_f32 v[90:91], v[34:35], v[12:13] op_sel_hi:[1,0] neg_lo:[0,1] neg_hi:[0,1]
    v_pk_fma_f32 v[10:11], v[90:91], v[90:91], v[10:11]
    v_pk_add_f32 v[92:93], v[36:37], v[12:13] op_sel_hi:[1,0] neg_lo:[0,1] neg_hi:[0,1]
    v_pk_fma_f32 v[10:11], v[92:93], v[92:93], v[10:11]
    v_pk_add_f32 v[94:95], v[38:39], v[12:13] op_sel_hi:[1,0] neg_lo:[0,1] neg_hi:[0,1]
    v_pk_fma_f32 v[10:11], v[94:95], v[94:95], v[10:11]
    v_pk_add_f32 v[96:97], v[40:41], v[12:13] op_sel_hi:[1,0] neg_lo:[0,1] neg_hi:[0,1]
    v_pk_fma_f32 v[10:11], v[96:97], v[96:97], v[10:11]
    v_pk_add_f32 v[98:99], v[42:43], v[12:13] op_sel_hi:[1,0] neg_lo:[0,1] neg_hi:[0,1]
    v_pk_fma_f32 v[10:11], v[98:99], v[98:99], v[10:11]
    v_pk_add_f32 v[100:101], v[44:45], v[12:13] op_sel_hi:[1,0] neg_lo:[0,1] neg_hi:[0,1]
    v_pk_fma_f32 v[10:11], v[100:101], v[100:101], v[10:11]
    v_pk_add_f32 v[102:103], v[46:47], v[12:13] op_sel_hi:[1,0] neg_lo:[0,1] neg_hi:[0,1]
    v_pk_fma_f32 v[10:11], v[102:103], v[102:103], v[10:11]
    v_pk_add_f32 v[104:105], v[48:49], v[12:13] op_sel_hi:[1,0] neg_lo:[0,1] neg_hi:[0,1]
    v_pk_fma_f32 v[10:11], v[104:105], v[104:105], v[10:11]
    v_pk_add_f32 v[106:107], v[50:51], v[12:13] op_sel_hi:[1,0] neg_lo:[0,1] neg_hi:[0,1]
    v_pk_fma_f32 v[10:11], v[106:107], v[106:107], v[10:11]
    v_add_f32 v10, v10, v11
    s_nop 1
    v_add_f32_dpp v10, v10, v10 row_ror:4 row_mask:0xf bank_mask:0xf
    s_nop 1
    v_add_f32_dpp v10, v10, v10 row_ror:8 row_mask:0xf bank_mask:0xf
    v_mov_b32 v3, v10
    s_nop 1
    v_permlane16_swap_b32 v10, v3
    v_add_f32 v10, v10, v3
    v_mov_b32 v3, v10
    s_nop 1
    v_permlane32_swap_b32 v10, v3
    v_add_f32 v10, v10, v3
    v_mov_b32 v12, 925353388
    v_fmac_f32 v12, 987991609, v10
    v_rsq_f32 v12, v12
    s_mul_i32 s27, s22, 36864
    s_add_u32 s27, s27, 122683392
    s_mov_b32 s24, s27
    v_pk_mul_f32 v[72:73], v[72:73], v[12:13] op_sel_hi:[1,0]
    v_cvt_pk_bf16_f32 v52, v72, v73
    v_pk_mul_f32 v[74:75], v[74:75], v[12:13] op_sel_hi:[1,0]
    v_cvt_pk_bf16_f32 v53, v74, v75
    buffer_store_dwordx2 v[52:53], v8, s[4:7], s27 offen offset:0 sc1
    v_pk_mul_f32 v[76:77], v[76:77], v[12:13] op_sel_hi:[1,0]
    v_cvt_pk_bf16_f32 v54, v76, v77
    v_pk_mul_f32 v[78:79], v[78:79], v[12:13] op_sel_hi:[1,0]
    v_cvt_pk_bf16_f32 v55, v78, v79
    buffer_store_dwordx2 v[54:55], v8, s[4:7], s27 offen offset:1024 sc1
    s_add_u32 s27, s27, 9216
    v_pk_mul_f32 v[80:81], v[80:81], v[12:13] op_sel_hi:[1,0]
    v_cvt_pk_bf16_f32 v56, v80, v81
    v_pk_mul_f32 v[82:83], v[82:83], v[12:13] op_sel_hi:[1,0]
    v_cvt_pk_bf16_f32 v57, v82, v83
    buffer_store_dwordx2 v[56:57], v8, s[4:7], s27 offen offset:0 sc1
    v_pk_mul_f32 v[84:85], v[84:85], v[12:13] op_sel_hi:[1,0]
    v_cvt_pk_bf16_f32 v58, v84, v85
    v_pk_mul_f32 v[86:87], v[86:87], v[12:13] op_sel_hi:[1,0]
    v_cvt_pk_bf16_f32 v59, v86, v87
    buffer_store_dwordx2 v[58:59], v8, s[4:7], s27 offen offset:1024 sc1
    s_add_u32 s27, s27, 9216
    v_pk_mul_f32 v[88:89], v[88:89], v[12:13] op_sel_hi:[1,0]
    v_cvt_pk_bf16_f32 v60, v88, v89
    v_pk_mul_f32 v[90:91], v[90:91], v[12:13] op_sel_hi:[1,0]
    v_cvt_pk_bf16_f32 v61, v90, v91
    buffer_store_dwordx2 v[60:61], v8, s[4:7], s27 offen offset:0 sc1
    v_pk_mul_f32 v[92:93], v[92:93], v[12:13] op_sel_hi:[1,0]
    v_cvt_pk_bf16_f32 v62, v92, v93
    v_pk_mul_f32 v[94:95], v[94:95], v[12:13] op_sel_hi:[1,0]
    v_cvt_pk_bf16_f32 v63, v94, v95
    buffer_store_dwordx2 v[62:63], v8, s[4:7], s27 offen offset:1024 sc1
    s_add_u32 s27, s27, 9216
    v_pk_mul_f32 v[96:97], v[96:97], v[12:13] op_sel_hi:[1,0]
    v_cvt_pk_bf16_f32 v64, v96, v97
    v_pk_mul_f32 v[98:99], v[98:99], v[12:13] op_sel_hi:[1,0]
    v_cvt_pk_bf16_f32 v65, v98, v99
    buffer_store_dwordx2 v[64:65], v8, s[4:7], s27 offen offset:0 sc1
    v_pk_mul_f32 v[100:101], v[100:101], v[12:13] op_sel_hi:[1,0]
    v_cvt_pk_bf16_f32 v66, v100, v101
    v_pk_mul_f32 v[102:103], v[102:103], v[12:13] op_sel_hi:[1,0]
    v_cvt_pk_bf16_f32 v67, v102, v103
    buffer_store_dwordx2 v[66:67], v8, s[4:7], s27 offen offset:1024 sc1
    s_add_u32 s27, s27, 9216
    v_pk_mul_f32 v[104:105], v[104:105], v[12:13] op_sel_hi:[1,0]
    v_cvt_pk_bf16_f32 v68, v104, v105
    v_pk_mul_f32 v[106:107], v[106:107], v[12:13] op_sel_hi:[1,0]
    v_cvt_pk_bf16_f32 v69, v106, v107
    buffer_store_dwordx2 v[68:69], v9, s[4:7], s24 offen sc1
    s_add_u32 s25, s48, 4096
    s_add_u32 s26, s48, 8192
    buffer_store_dwordx4 v[16:19], v2, s[4:7], s48 offen offset:0 sc1
    buffer_store_dwordx4 v[20:23], v2, s[4:7], s48 offen offset:1024 sc1
    buffer_store_dwordx4 v[24:27], v2, s[4:7], s48 offen offset:2048 sc1
    buffer_store_dwordx4 v[28:31], v2, s[4:7], s48 offen offset:3072 sc1
    buffer_store_dwordx4 v[32:35], v2, s[4:7], s25 offen offset:0 sc1
    buffer_store_dwordx4 v[36:39], v2, s[4:7], s25 offen offset:1024 sc1
    buffer_store_dwordx4 v[40:43], v2, s[4:7], s25 offen offset:2048 sc1
    buffer_store_dwordx4 v[44:47], v2, s[4:7], s25 offen offset:3072 sc1
    buffer_store_dwordx4 v[48:51], v2, s[4:7], s26 offen offset:0 sc1
    s_add_u32 s22, s22, 4
    s_cmp_lt_u32 s22, 52
    s_cbranch_scc1 L_m_149
    s_waitcnt vmcnt(0)
    s_sub_u32 s28, s22, 3
    s_lshr_b32 s29, s44, 3
    s_lshl_b32 s29, s29, 8
    s_and_b32 s92, s44, 7
    s_lshl_b32 s92, s92, 2
    s_add_u32 s29, s29, s92
    s_add_u32 s29, s29, 184301568
    v_mov_b32 v11, s28
    v_and_b32 v10, 3, v1
    v_lshlrev_b32 v10, 10, v10
    buffer_store_dword v11, v10, s[4:7], s29 offen sc1
    s_endpgm
abred1_m_146:
    s_endpgm
nred1_m_145:
    s_sub_u32 s20, s20, 8
    s_cmp_ge_u32 s20, 72
    s_cbranch_scc1 nf1_m_152
    s_load_dwordx2 s[32:33], s[0:1], 112
    s_load_dwordx2 s[34:35], s[0:1], 64
    s_load_dwordx2 s[36:37], s[0:1], 72
    s_load_dwordx2 s[38:39], s[0:1], 0
    v_lshrrev_b32 v3, 6, v0
    s_nop 0
    v_readfirstlane_b32 s21, v3
    v_and_b32 v1, 63, v0
    v_lshlrev_b32 v2, 4, v1
    s_mov_b32 s23, 4194304
    s_waitcnt lgkmcnt(0)
    s_mov_b32 s4, s32
    s_and_b32 s5, s33, 65535
    s_mov_b32 s6, 268435456
    s_mov_b32 s7, 131072
    s_cmp_ge_u32 s20, 64
    s_cbranch_scc1 noln_m_154
    s_mov_b64 s[40:41], s[34:35]
    s_mov_b64 s[34:35], s[38:39]
    s_mov_b32 s8, s34
    s_and_b32 s9, s35, 65535
    s_mov_b32 s10, 2359296
    s_mov_b32 s11, 131072
    v_lshrrev_b32 v4, 3, v1
    v_mul_u32_u24 v5, 1152, v4
    v_and_b32 v7, 7, v1
    v_lshl_add_u32 v5, v7, 4, v5
    s_lshl_b32 s24, s20, 5
    s_lshl_b32 s25, s21, 3
    s_add_u32 s24, s24, s25
    s_mul_i32 s24, s24, 1152
    buffer_load_dwordx4 v[16:19], v5, s[8:11], s24 offen offset:0
    buffer_load_dwordx4 v[20:23], v5, s[8:11], s24 offen offset:128
    buffer_load_dwordx4 v[24:27], v5, s[8:11], s24 offen offset:256
    buffer_load_dwordx4 v[28:31], v5, s[8:11], s24 offen offset:384
    buffer_load_dwordx4 v[32:35], v5, s[8:11], s24 offen offset:512
    buffer_load_dwordx4 v[36:39], v5, s[8:11], s24 offen offset:640
    buffer_load_dwordx4 v[40:43], v5, s[8:11], s24 offen offset:768
    buffer_load_dwordx4 v[44:47], v5, s[8:11], s24 offen offset:896
    buffer_load_dwordx4 v[48:51], v5, s[8:11], s24 offen offset:1024
    v_lshrrev_b32 v6, 1, v7
    v_lshlrev_b32 v6, 10, v6
    v_and_b32 v7, 1, v7
    v_lshl_add_u32 v6, v7, 9, v6
    v_add_u32 v4, s25, v4
    v_lshl_add_u32 v5, v4, 4, v6
    s_waitcnt vmcnt(8)
    v_lshlrev_b32 v64, 16, v16
    v_and_b32 v65, 4294901760, v16
    v_lshlrev_b32 v66, 16, v17
    v_and_b32 v67, 4294901760, v17
    v_lshlrev_b32 v68, 16, v18
    v_and_b32 v69, 4294901760, v18
    v_lshlrev_b32 v70, 16, v19
    v_and_b32 v71, 4294901760, v19
    s_waitcnt vmcnt(7)
    v_lshlrev_b32 v72, 16, v20
    v_and_b32 v73, 4294901760, v20
    v_lshlrev_b32 v74, 16, v21
    v_and_b32 v75, 4294901760, v21
    v_lshlrev_b32 v76, 16, v22
    v_and_b32 v77, 4294901760, v22
    v_lshlrev_b32 v78, 16, v23
    v_and_b32 v79, 4294901760, v23
    s_waitcnt vmcnt(6)
    v_lshlrev_b32 v80, 16, v24
    v_and_b32 v81, 4294901760, v24
    v_lshlrev_b32 v82, 16, v25
    v_and_b32 v83, 4294901760, v25
    v_lshlrev_b32 v84, 16, v26
    v_and_b32 v85, 4294901760, v26
    v_lshlrev_b32 v86, 16, v27
    v_and_b32 v87, 4294901760, v27
    s_waitcnt vmcnt(5)
    v_lshlrev_b32 v88, 16, v28
    v_and_b32 v89, 4294901760, v28
    v_lshlrev_b32 v90, 16, v29
    v_and_b32 v91, 4294901760, v29
    v_lshlrev_b32 v92, 16, v30
    v_and_b32 v93, 4294901760, v30
    v_lshlrev_b32 v94, 16, v31
    v_and_b32 v95, 4294901760, v31
    s_waitcnt vmcnt(4)
    v_lshlrev_b32 v96, 16, v32
    v_and_b32 v97, 4294901760, v32
    v_lshlrev_b32 v98, 16, v33
    v_and_b32 v99, 4294901760, v33
    v_lshlrev_b32 v100, 16, v34
    v_and_b32 v101, 4294901760, v34
    v_lshlrev_b32 v102, 16, v35
    v_and_b32 v103, 4294901760, v35
    s_waitcnt vmcnt(3)
    v_lshlrev_b32 v104, 16, v36
    v_and_b32 v105, 4294901760, v36
    v_lshlrev_b32 v106, 16, v37
    v_and_b32 v107, 4294901760, v37
    v_lshlrev_b32 v108, 16, v38
    v_and_b32 v109, 4294901760, v38
    v_lshlrev_b32 v110, 16, v39
    v_and_b32 v111, 4294901760, v39
    s_waitcnt vmcnt(2)
    v_lshlrev_b32 v112, 16, v40
    v_and_b32 v113, 4294901760, v40
    v_lshlrev_b32 v114, 16, v41
    v_and_b32 v115, 4294901760, v41
    v_lshlrev_b32 v116, 16, v42
    v_and_b32 v117, 4294901760, v42
    v_lshlrev_b32 v118, 16, v43
    v_and_b32 v119, 4294901760, v43
    s_waitcnt vmcnt(1)
    v_lshlrev_b32 v120, 16, v44
    v_and_b32 v121, 4294901760, v44
    v_lshlrev_b32 v122, 16, v45
    v_and_b32 v123, 4294901760, v45
    v_lshlrev_b32 v124, 16, v46
    v_and_b32 v125, 4294901760, v46
    v_lshlrev_b32 v126, 16, v47
    v_and_b32 v127, 4294901760, v47
    s_waitcnt vmcnt(0)
    v_lshlrev_b32 v128, 16, v48
    v_and_b32 v129, 4294901760, v48
    v_lshlrev_b32 v130, 16, v49
    v_and_b32 v131, 4294901760, v49
    v_lshlrev_b32 v132, 16, v50
    v_and_b32 v133, 4294901760, v50
    v_lshlrev_b32 v134, 16, v51
    v_and_b32 v135, 4294901760, v51
    v_mov_b32 v6, 0
    v_mov_b32 v7, 0
    v_add_f32 v6, v6, v64
    v_add_f32 v7, v7, v65
    v_add_f32 v6, v6, v66
    v_add_f32 v7, v7, v67
    v_add_f32 v6, v6, v68
    v_add_f32 v7, v7, v69
    v_add_f32 v6, v6, v70
    v_add_f32 v7, v7, v71
    v_add_f32 v6, v6, v72
    v_add_f32 v7, v7, v73
    v_add_f32 v6, v6, v74
    v_add_f32 v7, v7, v75
    v_add_f32 v6, v6, v76
    v_add_f32 v7, v7, v77
    v_add_f32 v6, v6, v78
    v_add_f32 v7, v7, v79
    v_add_f32 v6, v6, v80
    v_add_f32 v7, v7, v81
    v_add_f32 v6, v6, v82
    v_add_f32 v7, v7, v83
    v_add_f32 v6, v6, v84
    v_add_f32 v7, v7, v85
    v_add_f32 v6, v6, v86
    v_add_f32 v7, v7, v87
    v_add_f32 v6, v6, v88
    v_add_f32 v7, v7, v89
    v_add_f32 v6, v6, v90
    v_add_f32 v7, v7, v91
    v_add_f32 v6, v6, v92
    v_add_f32 v7, v7, v93
    v_add_f32 v6, v6, v94
    v_add_f32 v7, v7, v95
    v_add_f32 v6, v6, v96
    v_add_f32 v7, v7, v97
    v_add_f32 v6, v6, v98
    v_add_f32 v7, v7, v99
    v_add_f32 v6, v6, v100
    v_add_f32 v7, v7, v101
    v_add_f32 v6, v6, v102
    v_add_f32 v7, v7, v103
    v_add_f32 v6, v6, v104
    v_add_f32 v7, v7, v105
    v_add_f32 v6, v6, v106
    v_add_f32 v7, v7, v107
    v_add_f32 v6, v6, v108
    v_add_f32 v7, v7, v109
    v_add_f32 v6, v6, v110
    v_add_f32 v7, v7, v111
    v_add_f32 v6, v6, v112
    v_add_f32 v7, v7, v113
    v_add_f32 v6, v6, v114
    v_add_f32 v7, v7, v115
    v_add_f32 v6, v6, v116
    v_add_f32 v7, v7, v117
    v_add_f32 v6, v6, v118
    v_add_f32 v7, v7, v119
    v_add_f32 v6, v6, v120
    v_add_f32 v7, v7, v121
    v_add_f32 v6, v6, v122
    v_add_f32 v7, v7, v123
    v_add_f32 v6, v6, v124
    v_add_f32 v7, v7, v125
    v_add_f32 v6, v6, v126
    v_add_f32 v7, v7, v127
    v_add_f32 v6, v6, v128
    v_add_f32 v7, v7, v129
    v_add_f32 v6, v6, v130
    v_add_f32 v7, v7, v131
    v_add_f32 v6, v6, v132
    v_add_f32 v7, v7, v133
    v_add_f32 v6, v6, v134
    v_add_f32 v7, v7, v135
    v_add_f32 v6, v6, v7
    s_nop 1
    v_add_f32_dpp v6, v6, v6 quad_perm:[1,0,3,2] row_mask:0xf bank_mask:0xf
    s_nop 1
    v_add_f32_dpp v6, v6, v6 quad_perm:[2,3,0,1] row_mask:0xf bank_mask:0xf
    s_nop 1
    v_add_f32_dpp v6, v6, v6 row_half_mirror row_mask:0xf bank_mask:0xf
    v_mul_f32 v6, 987991609, v6
    v_mov_b32 v7, 0
    v_mov_b32 v4, 0
    v_sub_f32 v64, v64, v6
    v_sub_f32 v65, v65, v6
    v_fmac_f32 v7, v64, v64
    v_fmac_f32 v4, v65, v65
    v_sub_f32 v66, v66, v6
    v_sub_f32 v67, v67, v6
    v_fmac_f32 v7, v66, v66
    v_fmac_f32 v4, v67, v67
    v_sub_f32 v68, v68, v6
    v_sub_f32 v69, v69, v6
    v_fmac_f32 v7, v68, v68
    v_fmac_f32 v4, v69, v69
    v_sub_f32 v70, v70, v6
    v_sub_f32 v71, v71, v6
    v_fmac_f32 v7, v70, v70
    v_fmac_f32 v4, v71, v71
    v_sub_f32 v72, v72, v6
    v_sub_f32 v73, v73, v6
    v_fmac_f32 v7, v72, v72
    v_fmac_f32 v4, v73, v73
    v_sub_f32 v74, v74, v6
    v_sub_f32 v75, v75, v6
    v_fmac_f32 v7, v74, v74
    v_fmac_f32 v4, v75, v75
    v_sub_f32 v76, v76, v6
    v_sub_f32 v77, v77, v6
    v_fmac_f32 v7, v76, v76
    v_fmac_f32 v4, v77, v77
    v_sub_f32 v78, v78, v6
    v_sub_f32 v79, v79, v6
    v_fmac_f32 v7, v78, v78
    v_fmac_f32 v4, v79, v79
    v_sub_f32 v80, v80, v6
    v_sub_f32 v81, v81, v6
    v_fmac_f32 v7, v80, v80
    v_fmac_f32 v4, v81, v81
    v_sub_f32 v82, v82, v6
    v_sub_f32 v83, v83, v6
    v_fmac_f32 v7, v82, v82
    v_fmac_f32 v4, v83, v83
    v_sub_f32 v84, v84, v6
    v_sub_f32 v85, v85, v6
    v_fmac_f32 v7, v84, v84
    v_fmac_f32 v4, v85, v85
    v_sub_f32 v86, v86, v6
    v_sub_f32 v87, v87, v6
    v_fmac_f32 v7, v86, v86
    v_fmac_f32 v4, v87, v87
    v_sub_f32 v88, v88, v6
    v_sub_f32 v89, v89, v6
    v_fmac_f32 v7, v88, v88
    v_fmac_f32 v4, v89, v89
    v_sub_f32 v90, v90, v6
    v_sub_f32 v91, v91, v6
    v_fmac_f32 v7, v90, v90
    v_fmac_f32 v4, v91, v91
    v_sub_f32 v92, v92, v6
    v_sub_f32 v93, v93, v6
    v_fmac_f32 v7, v92, v92
    v_fmac_f32 v4, v93, v93
    v_sub_f32 v94, v94, v6
    v_sub_f32 v95, v95, v6
    v_fmac_f32 v7, v94, v94
    v_fmac_f32 v4, v95, v95
    v_sub_f32 v96, v96, v6
    v_sub_f32 v97, v97, v6
    v_fmac_f32 v7, v96, v96
    v_fmac_f32 v4, v97, v97
    v_sub_f32 v98, v98, v6
    v_sub_f32 v99, v99, v6
    v_fmac_f32 v7, v98, v98
    v_fmac_f32 v4, v99, v99
    v_sub_f32 v100, v100, v6
    v_sub_f32 v101, v101, v6
    v_fmac_f32 v7, v100, v100
    v_fmac_f32 v4, v101, v101
    v_sub_f32 v102, v102, v6
    v_sub_f32 v103, v103, v6
    v_fmac_f32 v7, v102, v102
    v_fmac_f32 v4, v103, v103
    v_sub_f32 v104, v104, v6
    v_sub_f32 v105, v105, v6
    v_fmac_f32 v7, v104, v104
    v_fmac_f32 v4, v105, v105
    v_sub_f32 v106, v106, v6
    v_sub_f32 v107, v107, v6
    v_fmac_f32 v7, v106, v106
    v_fmac_f32 v4, v107, v107
    v_sub_f32 v108, v108, v6
    v_sub_f32 v109, v109, v6
    v_fmac_f32 v7, v108, v108
    v_fmac_f32 v4, v109, v109
    v_sub_f32 v110, v110, v6
    v_sub_f32 v111, v111, v6
    v_fmac_f32 v7, v110, v110
    v_fmac_f32 v4, v111, v111
    v_sub_f32 v112, v112, v6
    v_sub_f32 v113, v113, v6
    v_fmac_f32 v7, v112, v112
    v_fmac_f32 v4, v113, v113
    v_sub_f32 v114, v114, v6
    v_sub_f32 v115, v115, v6
    v_fmac_f32 v7, v114, v114
    v_fmac_f32 v4, v115, v115
    v_sub_f32 v116, v116, v6
    v_sub_f32 v117, v117, v6
    v_fmac_f32 v7, v116, v116
    v_fmac_f32 v4, v117, v117
    v_sub_f32 v118, v118, v6
    v_sub_f32 v119, v119, v6
    v_fmac_f32 v7, v118, v118
    v_fmac_f32 v4, v119, v119
    v_sub_f32 v120, v120, v6
    v_sub_f32 v121, v121, v6
    v_fmac_f32 v7, v120, v120
    v_fmac_f32 v4, v121, v121
    v_sub_f32 v122, v122, v6
    v_sub_f32 v123, v123, v6
    v_fmac_f32 v7, v122, v122
    v_fmac_f32 v4, v123, v123
    v_sub_f32 v124, v124, v6
    v_sub_f32 v125, v125, v6
    v_fmac_f32 v7, v124, v124
    v_fmac_f32 v4, v125, v125
    v_sub_f32 v126, v126, v6
    v_sub_f32 v127, v127, v6
    v_fmac_f32 v7, v126, v126
    v_fmac_f32 v4, v127, v127
    v_sub_f32 v128, v128, v6
    v_sub_f32 v129, v129, v6
    v_fmac_f32 v7, v128, v128
    v_fmac_f32 v4, v129, v129
    v_sub_f32 v130, v130, v6
    v_sub_f32 v131, v131, v6
    v_fmac_f32 v7, v130, v130
    v_fmac_f32 v4, v131, v131
    v_sub_f32 v132, v132, v6
    v_sub_f32 v133, v133, v6
    v_fmac_f32 v7, v132, v132
    v_fmac_f32 v4, v133, v133
    v_sub_f32 v134, v134, v6
    v_sub_f32 v135, v135, v6
    v_fmac_f32 v7, v134, v134
    v_fmac_f32 v4, v135, v135
    v_add_f32 v7, v7, v4
    s_nop 1
    v_add_f32_dpp v7, v7, v7 quad_perm:[1,0,3,2] row_mask:0xf bank_mask:0xf
    s_nop 1
    v_add_f32_dpp v7, v7, v7 quad_perm:[2,3,0,1] row_mask:0xf bank_mask:0xf
    s_nop 1
    v_add_f32_dpp v7, v7, v7 row_half_mirror row_mask:0xf bank_mask:0xf
    v_mov_b32 v4, 925353388
    v_fmac_f32 v4, 987991609, v7
    v_rsq_f32 v4, v4
    s_nop 0
    v_mul_f32 v64, v64, v4
    v_mul_f32 v65, v65, v4
    v_cvt_pk_bf16_f32 v16, v64, v65
    v_mul_f32 v66, v66, v4
    v_mul_f32 v67, v67, v4
    v_cvt_pk_bf16_f32 v17, v66, v67
    v_mul_f32 v68, v68, v4
    v_mul_f32 v69, v69, v4
    v_cvt_pk_bf16_f32 v18, v68, v69
    v_mul_f32 v70, v70, v4
    v_mul_f32 v71, v71, v4
    v_cvt_pk_bf16_f32 v19, v70, v71
    v_mul_f32 v72, v72, v4
    v_mul_f32 v73, v73, v4
    v_cvt_pk_bf16_f32 v20, v72, v73
    v_mul_f32 v74, v74, v4
    v_mul_f32 v75, v75, v4
    v_cvt_pk_bf16_f32 v21, v74, v75
    v_mul_f32 v76, v76, v4
    v_mul_f32 v77, v77, v4
    v_cvt_pk_bf16_f32 v22, v76, v77
    v_mul_f32 v78, v78, v4
    v_mul_f32 v79, v79, v4
    v_cvt_pk_bf16_f32 v23, v78, v79
    v_mul_f32 v80, v80, v4
    v_mul_f32 v81, v81, v4
    v_cvt_pk_bf16_f32 v24, v80, v81
    v_mul_f32 v82, v82, v4
    v_mul_f32 v83, v83, v4
    v_cvt_pk_bf16_f32 v25, v82, v83
    v_mul_f32 v84, v84, v4
    v_mul_f32 v85, v85, v4
    v_cvt_pk_bf16_f32 v26, v84, v85
    v_mul_f32 v86, v86, v4
    v_mul_f32 v87, v87, v4
    v_cvt_pk_bf16_f32 v27, v86, v87
    v_mul_f32 v88, v88, v4
    v_mul_f32 v89, v89, v4
    v_cvt_pk_bf16_f32 v28, v88, v89
    v_mul_f32 v90, v90, v4
    v_mul_f32 v91, v91, v4
    v_cvt_pk_bf16_f32 v29, v90, v91
    v_mul_f32 v92, v92, v4
    v_mul_f32 v93, v93, v4
    v_cvt_pk_bf16_f32 v30, v92, v93
    v_mul_f32 v94, v94, v4
    v_mul_f32 v95, v95, v4
    v_cvt_pk_bf16_f32 v31, v94, v95
    v_mul_f32 v96, v96, v4
    v_mul_f32 v97, v97, v4
    v_cvt_pk_bf16_f32 v32, v96, v97
    v_mul_f32 v98, v98, v4
    v_mul_f32 v99, v99, v4
    v_cvt_pk_bf16_f32 v33, v98, v99
    v_mul_f32 v100, v100, v4
    v_mul_f32 v101, v101, v4
    v_cvt_pk_bf16_f32 v34, v100, v101
    v_mul_f32 v102, v102, v4
    v_mul_f32 v103, v103, v4
    v_cvt_pk_bf16_f32 v35, v102, v103
    v_mul_f32 v104, v104, v4
    v_mul_f32 v105, v105, v4
    v_cvt_pk_bf16_f32 v36, v104, v105
    v_mul_f32 v106, v106, v4
    v_mul_f32 v107, v107, v4
    v_cvt_pk_bf16_f32 v37, v106, v107
    v_mul_f32 v108, v108, v4
    v_mul_f32 v109, v109, v4
    v_cvt_pk_bf16_f32 v38, v108, v109
    v_mul_f32 v110, v110, v4
    v_mul_f32 v111, v111, v4
    v_cvt_pk_bf16_f32 v39, v110, v111
    v_mul_f32 v112, v112, v4
    v_mul_f32 v113, v113, v4
    v_cvt_pk_bf16_f32 v40, v112, v113
    v_mul_f32 v114, v114, v4
    v_mul_f32 v115, v115, v4
    v_cvt_pk_bf16_f32 v41, v114, v115
    v_mul_f32 v116, v116, v4
    v_mul_f32 v117, v117, v4
    v_cvt_pk_bf16_f32 v42, v116, v117
    v_mul_f32 v118, v118, v4
    v_mul_f32 v119, v119, v4
    v_cvt_pk_bf16_f32 v43, v118, v119
    v_mul_f32 v120, v120, v4
    v_mul_f32 v121, v121, v4
    v_cvt_pk_bf16_f32 v44, v120, v121
    v_mul_f32 v122, v122, v4
    v_mul_f32 v123, v123, v4
    v_cvt_pk_bf16_f32 v45, v122, v123
    v_mul_f32 v124, v124, v4
    v_mul_f32 v125, v125, v4
    v_cvt_pk_bf16_f32 v46, v124, v125
    v_mul_f32 v126, v126, v4
    v_mul_f32 v127, v127, v4
    v_cvt_pk_bf16_f32 v47, v126, v127
    v_mul_f32 v128, v128, v4
    v_mul_f32 v129, v129, v4
    v_cvt_pk_bf16_f32 v48, v128, v129
    v_mul_f32 v130, v130, v4
    v_mul_f32 v131, v131, v4
    v_cvt_pk_bf16_f32 v49, v130, v131
    v_mul_f32 v132, v132, v4
    v_mul_f32 v133, v133, v4
    v_cvt_pk_bf16_f32 v50, v132, v133
    v_mul_f32 v134, v134, v4
    v_mul_f32 v135, v135, v4
    v_cvt_pk_bf16_f32 v51, v134, v135
    s_mul_i32 s24, s20, 36864
    s_add_u32 s24, s24, 0
    buffer_store_dwordx4 v[16:19], v5, s[4:7], s24 offen sc1
    s_add_u32 s24, s24, 4096
    buffer_store_dwordx4 v[20:23], v5, s[4:7], s24 offen sc1
    s_add_u32 s24, s24, 4096
    buffer_store_dwordx4 v[24:27], v5, s[4:7], s24 offen sc1
    s_add_u32 s24, s24, 4096
    buffer_store_dwordx4 v[28:31], v5, s[4:7], s24 offen sc1
    s_add_u32 s24, s24, 4096
    buffer_store_dwordx4 v[32:35], v5, s[4:7], s24 offen sc1
    s_add_u32 s24, s24, 4096
    buffer_store_dwordx4 v[36:39], v5, s[4:7], s24 offen sc1
    s_add_u32 s24, s24, 4096
    buffer_store_dwordx4 v[40:43], v5, s[4:7], s24 offen sc1
    s_add_u32 s24, s24, 4096
    buffer_store_dwordx4 v[44:47], v5, s[4:7], s24 offen sc1
    s_add_u32 s24, s24, 4096
    buffer_store_dwordx4 v[48:51], v5, s[4:7], s24 offen sc1
    s_cmp_lt_u32 s20, 60
    s_cbranch_scc1 nomark_m_155
    v_mov_b32 v8, -1
    v_mov_b32 v9, -1
    v_mov_b32 v10, -1
    v_mov_b32 v11, -1
    s_lshl_b32 s24, s20, 16
    s_lshl_b32 s25, s21, 14
    s_add_u32 s24, s24, s25
    s_add_u32 s25, s24, 75497472
    s_add_u32 s24, s24, 201326592
    buffer_store_dwordx4 v[8:11], v2, s[4:7], s24 offen offset:0 sc1
    buffer_store_dwordx4 v[8:11], v2, s[4:7], s24 offen offset:1024 sc1
    buffer_store_dwordx4 v[8:11], v2, s[4:7], s24 offen offset:2048 sc1
    buffer_store_dwordx4 v[8:11], v2, s[4:7], s24 offen offset:3072 sc1
    s_add_u32 s24, s24, 4096
    buffer_store_dwordx4 v[8:11], v2, s[4:7], s25 offen offset:0 sc1
    buffer_store_dwordx4 v[8:11], v2, s[4:7], s25 offen offset:1024 sc1
    buffer_store_dwordx4 v[8:11], v2, s[4:7], s25 offen offset:2048 sc1
    buffer_store_dwordx4 v[8:11], v2, s[4:7], s25 offen offset:3072 sc1
    s_add_u32 s25, s25, 4096
    buffer_store_dwordx4 v[8:11], v2, s[4:7], s24 offen offset:0 sc1
    buffer_store_dwordx4 v[8:11], v2, s[4:7], s24 offen offset:1024 sc1
    buffer_store_dwordx4 v[8:11], v2, s[4:7], s24 offen offset:2048 sc1
    buffer_store_dwordx4 v[8:11], v2, s[4:7], s24 offen offset:3072 sc1
    s_add_u32 s24, s24, 4096
    buffer_store_dwordx4 v[8:11], v2, s[4:7], s25 offen offset:0 sc1
    buffer_store_dwordx4 v[8:11], v2, s[4:7], s25 offen offset:1024 sc1
    buffer_store_dwordx4 v[8:11], v2, s[4:7], s25 offen offset:2048 sc1
    buffer_store_dwordx4 v[8:11], v2, s[4:7], s25 offen offset:3072 sc1
    s_add_u32 s25, s25, 4096
    buffer_store_dwordx4 v[8:11], v2, s[4:7], s24 offen offset:0 sc1
    buffer_store_dwordx4 v[8:11], v2, s[4:7], s24 offen offset:1024 sc1
    buffer_store_dwordx4 v[8:11], v2, s[4:7], s24 offen offset:2048 sc1
    buffer_store_dwordx4 v[8:11], v2, s[4:7], s24 offen offset:3072 sc1
    s_add_u32 s24, s24, 4096
    buffer_store_dwordx4 v[8:11], v2, s[4:7], s25 offen offset:0 sc1
    buffer_store_dwordx4 v[8:11], v2, s[4:7], s25 offen offset:1024 sc1
    buffer_store_dwordx4 v[8:11], v2, s[4:7], s25 offen offset:2048 sc1
    buffer_store_dwordx4 v[8:11], v2, s[4:7], s25 offen offset:3072 sc1
    s_add_u32 s25, s25, 4096
    buffer_store_dwordx4 v[8:11], v2, s[4:7], s24 offen offset:0 sc1
    buffer_store_dwordx4 v[8:11], v2, s[4:7], s24 offen offset:1024 sc1
    buffer_store_dwordx4 v[8:11], v2, s[4:7], s24 offen offset:2048 sc1
    buffer_store_dwordx4 v[8:11], v2, s[4:7], s24 offen offset:3072 sc1
    buffer_store_dwordx4 v[8:11], v2, s[4:7], s25 offen offset:0 sc1
    buffer_store_dwordx4 v[8:11], v2, s[4:7], s25 offen offset:1024 sc1
    buffer_store_dwordx4 v[8:11], v2, s[4:7], s25 offen offset:2048 sc1
    buffer_store_dwordx4 v[8:11], v2, s[4:7], s25 offen offset:3072 sc1
    s_nop 1
nomark_m_155:
    s_load_dwordx2 s[30:31], s[0:1], 104
    s_waitcnt lgkmcnt(0)
    s_mov_b32 s16, s30
    s_and_b32 s17, s31, 65535
    s_mov_b32 s18, 256
    s_mov_b32 s19, 131072
L_m_156:
    s_sub_u32 s23, s23, 1
    s_cbranch_scc1 abf1_m_153
    buffer_load_dword v3, off, s[16:19], 0 offset:64 sc1
    s_waitcnt vmcnt(0)
    v_cmp_eq_u32 vcc, 0, v3
    s_nop 0
    s_cbranch_vccnz L_m_156
    s_waitcnt vmcnt(0)
    s_barrier
    s_cmp_lg_u32 s21, 0
    s_cbranch_scc1 noset_m_157
    s_lshr_b32 s29, s20, 6
    s_lshl_b32 s29, s29, 8
    s_and_b32 s92, s20, 63
    s_lshl_b32 s92, s92, 2
    s_add_u32 s29, s29, s92
    s_add_u32 s29, s29, 184287232
    v_mov_b32 v5, 1
    buffer_store_dword v5, off, s[4:7], s29 sc1
    s_nop 0
noset_m_157:
    s_mov_b64 s[34:35], s[40:41]
noln_m_154:
    s_lshr_b32 s24, s2, 5
    s_cmp_lt_u32 s24, 2
    s_cbranch_scc1 nowarm_m_158
    s_load_dwordx4 s[60:63], s[0:1], 16
    s_load_dwordx2 s[64:65], s[0:1], 32
    s_sub_u32 s24, s24, 2
    s_lshl_b32 s24, s24, 2
    s_bfe_u32 s25, s2, 131075
    s_add_u32 s24, s24, s25
    s_lshl_b32 s24, s24, 2
    s_add_u32 s24, s24, s21
    s_mul_i32 s24, s24, 49152
    s_and_b32 s25, s2, 7
    s_sub_u32 s25, s25, 1
    s_waitcnt lgkmcnt(0)
    s_mov_b32 s70, 846615568
    s_mov_b32 s71, 14395788
    s_lshl_b32 s27, s25, 2
    s_lshr_b64 s[70:71], s[70:71], s27
    s_and_b32 s27, s70, 15
    s_lshr_b32 s26, s27, 2
    s_cmp_eq_u32 s26, 1
    s_cselect_b64 s[66:67], s[62:63], s[60:61]
    s_cmp_eq_u32 s26, 2
    s_cselect_b64 s[66:67], s[64:65], s[66:67]
    s_mov_b32 s68, s66
    s_and_b32 s69, s67, 65535
    s_mov_b32 s70, 4718592
    s_mov_b32 s71, 131072
    s_and_b32 s26, s27, 3
    s_lshl_b32 s26, s26, 11
    s_add_u32 s26, s26, s24
    buffer_load_dwordx4 v[128:131], v2, s[68:71], s26 offen offset:0
    buffer_load_dwordx4 v[132:135], v2, s[68:71], s26 offen offset:1024
    s_add_u32 s26, s26, 8192
    buffer_load_dwordx4 v[136:139], v2, s[68:71], s26 offen offset:0
    buffer_load_dwordx4 v[140:143], v2, s[68:71], s26 offen offset:1024
    s_add_u32 s26, s26, 8192
    buffer_load_dwordx4 v[144:147], v2, s[68:71], s26 offen offset:0
    buffer_load_dwordx4 v[148:151], v2, s[68:71], s26 offen offset:1024
    s_add_u32 s26, s26, 8192
    buffer_load_dwordx4 v[152:155], v2, s[68:71], s26 offen offset:0
    buffer_load_dwordx4 v[156:159], v2, s[68:71], s26 offen offset:1024
    s_add_u32 s26, s26, 8192
    buffer_load_dwordx4 v[160:163], v2, s[68:71], s26 offen offset:0
    buffer_load_dwordx4 v[164:167], v2, s[68:71], s26 offen offset:1024
    s_add_u32 s26, s26, 8192
    buffer_load_dwordx4 v[168:171], v2, s[68:71], s26 offen offset:0
    buffer_load_dwordx4 v[172:175], v2, s[68:71], s26 offen offset:1024
    s_add_u32 s26, s26, 8192
    s_add_u32 s25, s25, 7
    s_mov_b32 s70, 846615568
    s_mov_b32 s71, 14395788
    s_lshl_b32 s27, s25, 2
    s_lshr_b64 s[70:71], s[70:71], s27
    s_and_b32 s27, s70, 15
    s_cmp_ge_u32 s27, 12
    s_cbranch_scc1 nowarm_m_158
    s_lshr_b32 s26, s27, 2
    s_cmp_eq_u32 s26, 1
    s_cselect_b64 s[66:67], s[62:63], s[60:61]
    s_cmp_eq_u32 s26, 2
    s_cselect_b64 s[66:67], s[64:65], s[66:67]
    s_mov_b32 s68, s66
    s_and_b32 s69, s67, 65535
    s_mov_b32 s70, 4718592
    s_mov_b32 s71, 131072
    s_and_b32 s26, s27, 3
    s_lshl_b32 s26, s26, 11
    s_add_u32 s26, s26, s24
    buffer_load_dwordx4 v[176:179], v2, s[68:71], s26 offen offset:0
    buffer_load_dwordx4 v[180:183], v2, s[68:71], s26 offen offset:1024
    s_add_u32 s26, s26, 8192
    buffer_load_dwordx4 v[184:187], v2, s[68:71], s26 offen offset:0
    buffer_load_dwordx4 v[188:191], v2, s[68:71], s26 offen offset:1024
    s_add_u32 s26, s26, 8192
    buffer_load_dwordx4 v[192:195], v2, s[68:71], s26 offen offset:0
    buffer_load_dwordx4 v[196:199], v2, s[68:71], s26 offen offset:1024
    s_add_u32 s26, s26, 8192
    buffer_load_dwordx4 v[200:203], v2, s[68:71], s26 offen offset:0
    buffer_load_dwordx4 v[204:207], v2, s[68:71], s26 offen offset:1024
    s_add_u32 s26, s26, 8192
    buffer_load_dwordx4 v[208:211], v2, s[68:71], s26 offen offset:0
    buffer_load_dwordx4 v[212:215], v2, s[68:71], s26 offen offset:1024
    s_add_u32 s26, s26, 8192
    buffer_load_dwordx4 v[216:219], v2, s[68:71], s26 offen offset:0
    buffer_load_dwordx4 v[220:223], v2, s[68:71], s26 offen offset:1024
    s_add_u32 s26, s26, 8192
nowarm_m_158:
    s_waitcnt vmcnt(0)
    s_load_dwordx2 s[30:31], s[0:1], 104
    s_waitcnt lgkmcnt(0)
    s_mov_b32 s16, s30
    s_and_b32 s17, s31, 65535
    s_mov_b32 s18, 256
    s_mov_b32 s19, 131072
L_m_159:
    s_sub_u32 s23, s23, 1
    s_cbranch_scc1 abf1_m_153
    buffer_load_dword v3, off, s[16:19], 0 offset:64 sc1
    s_waitcnt vmcnt(0)
    v_cmp_eq_u32 vcc, 0, v3
    s_nop 0
    s_cbranch_vccnz L_m_159
    s_and_b32 s27, s20, 31
    s_add_u32 s27, s27, 16
    s_and_b32 s27, s20, 31
    s_cmp_lg_u32 s21, 0
    s_cbranch_scc1 nopoll_m_160
    v_min_u32 v4, 0, v1
    v_mul_u32_u24 v4, 4, v4
    s_lshr_b32 s29, s27, 0
    s_lshl_b32 s29, s29, 8
    s_add_u32 s29, s29, 184288256
    buffer_load_dword v5, v4, s[4:7], s29 offen sc1
    s_waitcnt vmcnt(0)
    v_cmp_gt_u32 vcc, 4, v5
    s_nop 0
    s_cbranch_vccz fok_m_161
L_m_162:
    s_sleep 32
    s_sub_u32 s23, s23, 1
    s_cbranch_scc1 abf1_m_153
    buffer_load_dword v5, v4, s[4:7], s29 offen sc1
    s_waitcnt vmcnt(0)
    v_cmp_gt_u32 vcc, 4, v5
    s_nop 0
    s_cbranch_vccnz L_m_162
fok_m_161:
nopoll_m_160:
    s_barrier
    s_mov_b32 s8, s34
    s_and_b32 s9, s35, 65535
    s_mov_b32 s10, 5308416
    s_mov_b32 s11, 131072
    s_mov_b32 s12, s36
    s_and_b32 s13, s37, 65535
    s_mov_b32 s14, 9216
    s_mov_b32 s15, 131072
    s_cmp_ge_u32 s20, 36
    s_cselect_b32 s22, 1, 0
    s_mul_i32 s24, s22, 36
    s_sub_u32 s44, s20, s24
    s_lshl_b32 s45, s44, 8
    s_lshl_b32 s25, s21, 6
    s_add_u32 s45, s45, s25
    s_lshl_b32 s46, s21, 15
    v_lshrrev_b32 v9, 5, v1
    v_lshlrev_b32 v9, 3, v9
    buffer_load_dwordx2 v[112:113], v9, s[12:15], s45 offen offset:0
    buffer_load_dwordx2 v[114:115], v9, s[12:15], s45 offen offset:16
    buffer_load_dwordx2 v[116:117], v9, s[12:15], s45 offen offset:32
    buffer_load_dwordx2 v[118:119], v9, s[12:15], s45 offen offset:48
    s_waitcnt vmcnt(3)
    v_lshlrev_b32 v96, 16, v112
    v_and_b32 v97, 4294901760, v112
    v_lshlrev_b32 v98, 16, v113
    v_and_b32 v99, 4294901760, v113
    s_waitcnt vmcnt(2)
    v_lshlrev_b32 v100, 16, v114
    v_and_b32 v101, 4294901760, v114
    v_lshlrev_b32 v102, 16, v115
    v_and_b32 v103, 4294901760, v115
    s_waitcnt vmcnt(1)
    v_lshlrev_b32 v104, 16, v116
    v_and_b32 v105, 4294901760, v116
    v_lshlrev_b32 v106, 16, v117
    v_and_b32 v107, 4294901760, v117
    s_waitcnt vmcnt(0)
    v_lshlrev_b32 v108, 16, v118
    v_and_b32 v109, 4294901760, v118
    v_lshlrev_b32 v110, 16, v119
    v_and_b32 v111, 4294901760, v119
    v_lshrrev_b32 v6, 4, v1
    v_mul_u32_u24 v4, 9216, v6
    v_and_b32 v6, 15, v1
    v_lshl_add_u32 v4, v6, 4, v4
    v_lshrrev_b32 v6, 5, v1
    v_lshlrev_b32 v6, 3, v6
    v_bfe_u32 v7, v1, 2, 2
    v_add_u32 v6, v6, v7
    v_lshlrev_b32 v5, 8, v6
    v_bfe_u32 v6, v1, 4, 1
    v_lshl_add_u32 v5, v6, 5, v5
    v_and_b32 v6, 3, v1
    v_lshl_add_u32 v5, v6, 3, v5
    s_lshl_b32 s24, s21, 6
    v_add_u32 v5, s24, v5
    s_lshl_b32 s25, s44, 8
    s_mul_i32 s24, s21, 147456
    s_add_u32 s25, s25, s24
    s_lshl_b32 s46, s21, 12
    s_add_u32 m0, s46, 0
    s_add_u32 s24, s25, 0
    buffer_load_dwordx4 v4, s[8:11], s24 offen lds
    s_add_u32 m0, s46, 1024
    s_add_u32 s24, s25, 36864
    buffer_load_dwordx4 v4, s[8:11], s24 offen lds
    s_add_u32 m0, s46, 2048
    s_add_u32 s24, s25, 73728
    buffer_load_dwordx4 v4, s[8:11], s24 offen lds
    s_add_u32 m0, s46, 3072
    s_add_u32 s24, s25, 110592
    buffer_load_dwordx4 v4, s[8:11], s24 offen lds
    s_add_u32 m0, s46, 16384
    s_add_u32 s24, s25, 589824
    buffer_load_dwordx4 v4, s[8:11], s24 offen lds
    s_add_u32 m0, s46, 17408
    s_add_u32 s24, s25, 626688
    buffer_load_dwordx4 v4, s[8:11], s24 offen lds
    s_add_u32 m0, s46, 18432
    s_add_u32 s24, s25, 663552
    buffer_load_dwordx4 v4, s[8:11], s24 offen lds
    s_add_u32 m0, s46, 19456
    s_add_u32 s24, s25, 700416
    buffer_load_dwordx4 v4, s[8:11], s24 offen lds
    s_add_u32 m0, s46, 32768
    s_add_u32 s24, s25, 1179648
    buffer_load_dwordx4 v4, s[8:11], s24 offen lds
    s_add_u32 m0, s46, 33792
    s_add_u32 s24, s25, 1216512
    buffer_load_dwordx4 v4, s[8:11], s24 offen lds
    s_add_u32 m0, s46, 34816
    s_add_u32 s24, s25, 1253376
    buffer_load_dwordx4 v4, s[8:11], s24 offen lds
    s_add_u32 m0, s46, 35840
    s_add_u32 s24, s25, 1290240
    buffer_load_dwordx4 v4, s[8:11], s24 offen lds
    s_add_u32 m0, s46, 49152
    s_add_u32 s24, s25, 1769472
    buffer_load_dwordx4 v4, s[8:11], s24 offen lds
    s_add_u32 m0, s46, 50176
    s_add_u32 s24, s25, 1806336
    buffer_load_dwordx4 v4, s[8:11], s24 offen lds
    s_add_u32 m0, s46, 51200
    s_add_u32 s24, s25, 1843200
    buffer_load_dwordx4 v4, s[8:11], s24 offen lds
    s_add_u32 m0, s46, 52224
    s_add_u32 s24, s25, 1880064
    buffer_load_dwordx4 v4, s[8:11], s24 offen lds
    s_add_u32 m0, s46, 65536
    s_add_u32 s24, s25, 2359296
    buffer_load_dwordx4 v4, s[8:11], s24 offen lds
    s_add_u32 m0, s46, 66560
    s_add_u32 s24, s25, 2396160
    buffer_load_dwordx4 v4, s[8:11], s24 offen lds
    s_add_u32 m0, s46, 67584
    s_add_u32 s24, s25, 2433024
    buffer_load_dwordx4 v4, s[8:11], s24 offen lds
    s_add_u32 m0, s46, 68608
    s_add_u32 s24, s25, 2469888
    buffer_load_dwordx4 v4, s[8:11], s24 offen lds
    s_add_u32 m0, s46, 81920
    s_add_u32 s24, s25, 2949120
    buffer_load_dwordx4 v4, s[8:11], s24 offen lds
    s_add_u32 m0, s46, 82944
    s_add_u32 s24, s25, 2985984
    buffer_load_dwordx4 v4, s[8:11], s24 offen lds
    s_add_u32 m0, s46, 83968
    s_add_u32 s24, s25, 3022848
    buffer_load_dwordx4 v4, s[8:11], s24 offen lds
    s_add_u32 m0, s46, 84992
    s_add_u32 s24, s25, 3059712
    buffer_load_dwordx4 v4, s[8:11], s24 offen lds
    s_add_u32 m0, s46, 98304
    s_add_u32 s24, s25, 3538944
    buffer_load_dwordx4 v4, s[8:11], s24 offen lds
    s_add_u32 m0, s46, 99328
    s_add_u32 s24, s25, 3575808
    buffer_load_dwordx4 v4, s[8:11], s24 offen lds
    s_add_u32 m0, s46, 100352
    s_add_u32 s24, s25, 3612672
    buffer_load_dwordx4 v4, s[8:11], s24 offen lds
    s_add_u32 m0, s46, 101376
    s_add_u32 s24, s25, 3649536
    buffer_load_dwordx4 v4, s[8:11], s24 offen lds
    s_add_u32 m0, s46, 114688
    s_add_u32 s24, s25, 4128768
    buffer_load_dwordx4 v4, s[8:11], s24 offen lds
    s_add_u32 m0, s46, 115712
    s_add_u32 s24, s25, 4165632
    buffer_load_dwordx4 v4, s[8:11], s24 offen lds
    s_add_u32 m0, s46, 116736
    s_add_u32 s24, s25, 4202496
    buffer_load_dwordx4 v4, s[8:11], s24 offen lds
    s_add_u32 m0, s46, 117760
    s_add_u32 s24, s25, 4239360
    buffer_load_dwordx4 v4, s[8:11], s24 offen lds
    s_add_u32 m0, s46, 131072
    s_add_u32 s24, s25, 4718592
    buffer_load_dwordx4 v4, s[8:11], s24 offen lds
    s_add_u32 m0, s46, 132096
    s_add_u32 s24, s25, 4755456
    buffer_load_dwordx4 v4, s[8:11], s24 offen lds
    s_add_u32 m0, s46, 133120
    s_add_u32 s24, s25, 4792320
    buffer_load_dwordx4 v4, s[8:11], s24 offen lds
    s_add_u32 m0, s46, 134144
    s_add_u32 s24, s25, 4829184
    buffer_load_dwordx4 v4, s[8:11], s24 offen lds
    s_waitcnt vmcnt(32)
    s_barrier
    ds_read_b64_tr_b16 a[0:1], v5 offset:0
    ds_read_b64_tr_b16 a[2:3], v5 offset:1024
    ds_read_b64_tr_b16 a[4:5], v5 offset:4096
    ds_read_b64_tr_b16 a[6:7], v5 offset:5120
    ds_read_b64_tr_b16 a[8:9], v5 offset:8192
    ds_read_b64_tr_b16 a[10:11], v5 offset:9216
    ds_read_b64_tr_b16 a[12:13], v5 offset:12288
    ds_read_b64_tr_b16 a[14:15], v5 offset:13312
    s_waitcnt vmcnt(28)
    s_barrier
    ds_read_b64_tr_b16 a[16:17], v5 offset:16384
    ds_read_b64_tr_b16 a[18:19], v5 offset:17408
    ds_read_b64_tr_b16 a[20:21], v5 offset:20480
    ds_read_b64_tr_b16 a[22:23], v5 offset:21504
    ds_read_b64_tr_b16 a[24:25], v5 offset:24576
    ds_read_b64_tr_b16 a[26:27], v5 offset:25600
    ds_read_b64_tr_b16 a[28:29], v5 offset:28672
    ds_read_b64_tr_b16 a[30:31], v5 offset:29696
    s_waitcnt vmcnt(24)
    s_barrier
    ds_read_b64_tr_b16 a[32:33], v5 offset:32768
    ds_read_b64_tr_b16 a[34:35], v5 offset:33792
    ds_read_b64_tr_b16 a[36:37], v5 offset:36864
    ds_read_b64_tr_b16 a[38:39], v5 offset:37888
    ds_read_b64_tr_b16 a[40:41], v5 offset:40960
    ds_read_b64_tr_b16 a[42:43], v5 offset:41984
    ds_read_b64_tr_b16 a[44:45], v5 offset:45056
    ds_read_b64_tr_b16 a[46:47], v5 offset:46080
    s_waitcnt vmcnt(20)
    s_barrier
    ds_read_b64_tr_b16 a[48:49], v5 offset:49152
    ds_read_b64_tr_b16 a[50:51], v5 offset:50176
    ds_read_b64_tr_b16 a[52:53], v5 offset:53248
    ds_read_b64_tr_b16 a[54:55], v5 offset:54272
    ds_read_b64_tr_b16 a[56:57], v5 offset:57344
    ds_read_b64_tr_b16 a[58:59], v5 offset:58368
    ds_read_b64_tr_b16 a[60:61], v5 offset:61440
    ds_read_b64_tr_b16 a[62:63], v5 offset:62464
    v_add_u32 v5, 65536, v5
    s_waitcnt vmcnt(16)
    s_barrier
    ds_read_b64_tr_b16 a[64:65], v5 offset:0
    ds_read_b64_tr_b16 a[66:67], v5 offset:1024
    ds_read_b64_tr_b16 a[68:69], v5 offset:4096
    ds_read_b64_tr_b16 a[70:71], v5 offset:5120
    ds_read_b64_tr_b16 a[72:73], v5 offset:8192
    ds_read_b64_tr_b16 a[74:75], v5 offset:9216
    ds_read_b64_tr_b16 a[76:77], v5 offset:12288
    ds_read_b64_tr_b16 a[78:79], v5 offset:13312
    s_waitcnt vmcnt(12)
    s_barrier
    ds_read_b64_tr_b16 a[80:81], v5 offset:16384
    ds_read_b64_tr_b16 a[82:83], v5 offset:17408
    ds_read_b64_tr_b16 a[84:85], v5 offset:20480
    ds_read_b64_tr_b16 a[86:87], v5 offset:21504
    ds_read_b64_tr_b16 a[88:89], v5 offset:24576
    ds_read_b64_tr_b16 a[90:91], v5 offset:25600
    ds_read_b64_tr_b16 a[92:93], v5 offset:28672
    ds_read_b64_tr_b16 a[94:95], v5 offset:29696
    s_waitcnt vmcnt(8)
    s_barrier
    ds_read_b64_tr_b16 a[96:97], v5 offset:32768
    ds_read_b64_tr_b16 a[98:99], v5 offset:33792
    ds_read_b64_tr_b16 a[100:101], v5 offset:36864
    ds_read_b64_tr_b16 a[102:103], v5 offset:37888
    ds_read_b64_tr_b16 a[104:105], v5 offset:40960
    ds_read_b64_tr_b16 a[106:107], v5 offset:41984
    ds_read_b64_tr_b16 a[108:109], v5 offset:45056
    ds_read_b64_tr_b16 a[110:111], v5 offset:46080
    s_waitcnt vmcnt(4)
    s_barrier
    ds_read_b64_tr_b16 a[112:113], v5 offset:49152
    ds_read_b64_tr_b16 a[114:115], v5 offset:50176
    ds_read_b64_tr_b16 a[116:117], v5 offset:53248
    ds_read_b64_tr_b16 a[118:119], v5 offset:54272
    ds_read_b64_tr_b16 a[120:121], v5 offset:57344
    ds_read_b64_tr_b16 a[122:123], v5 offset:58368
    ds_read_b64_tr_b16 a[124:125], v5 offset:61440
    ds_read_b64_tr_b16 a[126:127], v5 offset:62464
    v_add_u32 v5, 65536, v5
    s_waitcnt vmcnt(0)
    s_barrier
    ds_read_b64_tr_b16 a[128:129], v5 offset:0
    ds_read_b64_tr_b16 a[130:131], v5 offset:1024
    ds_read_b64_tr_b16 a[132:133], v5 offset:4096
    ds_read_b64_tr_b16 a[134:135], v5 offset:5120
    ds_read_b64_tr_b16 a[136:137], v5 offset:8192
    ds_read_b64_tr_b16 a[138:139], v5 offset:9216
    ds_read_b64_tr_b16 a[140:141], v5 offset:12288
    ds_read_b64_tr_b16 a[142:143], v5 offset:13312
    s_waitcnt lgkmcnt(0)
    s_mov_b32 s48, 3222493025
    s_mov_b32 s50, 3184710632
    s_mov_b32 s52, 1065353216
    s_mov_b32 s49, 3222493025
    s_mov_b32 s51, 3184710632
    s_mov_b32 s53, 1065353216
    v_mov_b64 v[120:121], s[48:49]
    v_bfe_u32 v4, v1, 4, 1
    v_lshlrev_b32 v4, 12, v4
    v_and_b32 v5, 15, v1
    v_lshl_add_u32 v10, v5, 4, v4
    v_lshrrev_b32 v4, 5, v1
    v_lshl_add_u32 v10, v4, 8, v10
    s_lshl_b32 s24, s21, 10
    v_add_u32 v10, s24, v10
    s_mul_i32 s47, s21, 9216
    s_barrier
    s_load_dwordx2 s[30:31], s[0:1], 104
    s_waitcnt lgkmcnt(0)
    s_mov_b32 s16, s30
    s_and_b32 s17, s31, 65535
    s_mov_b32 s18, 256
    s_mov_b32 s19, 131072
L_m_163:
    s_sub_u32 s23, s23, 1
    s_cbranch_scc1 abf1_m_153
    buffer_load_dword v3, off, s[16:19], 0 offset:64 sc1
    s_waitcnt vmcnt(0)
    v_cmp_eq_u32 vcc, 0, v3
    s_nop 0
    s_cbranch_vccnz L_m_163
L_m_164:
    s_add_u32 s28, s22, 1
    s_cmp_ge_u32 s22, 52
    s_cselect_b32 s25, 10240, 0
    s_and_b32 s27, s22, 3
    s_lshl_b32 s27, s27, 3
    s_and_b32 s26, s44, 3
    s_lshl_b32 s26, s26, 10
    s_add_u32 s26, s26, s25
    s_cmp_lg_u32 s21, 0
    s_cbranch_scc1 nopoll_m_165
    v_min_u32 v4, 7, v1
    v_mul_u32_u24 v4, 4, v4
    s_lshr_b32 s29, s27, 3
    s_lshl_b32 s29, s29, 8
    s_and_b32 s92, s27, 7
    s_lshl_b32 s92, s92, 2
    s_add_u32 s29, s29, s92
    s_add_u32 s29, s29, 184301568
    s_add_u32 s29, s29, s26
    buffer_load_dword v5, v4, s[4:7], s29 offen sc1
    s_waitcnt vmcnt(0)
    v_cmp_gt_u32 vcc, s28, v5
    s_nop 0
    s_cbranch_vccz fok_m_166
L_m_167:
    s_sleep 8
    s_sub_u32 s23, s23, 1
    s_cbranch_scc1 abf1_m_153
    buffer_load_dword v5, v4, s[4:7], s29 offen sc1
    s_waitcnt vmcnt(0)
    v_cmp_gt_u32 vcc, s28, v5
    s_nop 0
    s_cbranch_vccnz L_m_167
fok_m_166:
nopoll_m_165:
    s_barrier
    s_mul_i32 s24, s22, 36864
    s_add_u32 s24, s24, s47
    s_add_u32 s24, s24, 122683392
    s_add_u32 m0, s47, 0
    s_nop 0
    buffer_load_dwordx4 v2, s[4:7], s24 offen lds
    s_add_u32 m0, s47, 1024
    s_add_u32 s24, s24, 1024
    buffer_load_dwordx4 v2, s[4:7], s24 offen lds
    s_add_u32 m0, s47, 2048
    s_add_u32 s24, s24, 1024
    buffer_load_dwordx4 v2, s[4:7], s24 offen lds
    s_add_u32 m0, s47, 3072
    s_add_u32 s24, s24, 1024
    buffer_load_dwordx4 v2, s[4:7], s24 offen lds
    s_add_u32 m0, s47, 4096
    s_add_u32 s24, s24, 1024
    buffer_load_dwordx4 v2, s[4:7], s24 offen lds
    s_add_u32 m0, s47, 5120
    s_add_u32 s24, s24, 1024
    buffer_load_dwordx4 v2, s[4:7], s24 offen lds
    s_add_u32 m0, s47, 6144
    s_add_u32 s24, s24, 1024
    buffer_load_dwordx4 v2, s[4:7], s24 offen lds
    s_add_u32 m0, s47, 7168
    s_add_u32 s24, s24, 1024
    buffer_load_dwordx4 v2, s[4:7], s24 offen lds
    s_add_u32 m0, s47, 8192
    s_add_u32 s24, s24, 1024
    buffer_load_dwordx4 v2, s[4:7], s24 offen lds
    s_waitcnt vmcnt(0)
    s_barrier
    ds_read_b128 v[64:67], v2 offset:0
    ds_read_b128 v[68:71], v2 offset:1024
    ds_read_b128 v[72:75], v2 offset:2048
    ds_read_b128 v[76:79], v2 offset:3072
    ds_read_b128 v[80:83], v2 offset:4096
    ds_read_b128 v[84:87], v2 offset:5120
    s_waitcnt lgkmcnt(5)
    v_mfma_f32_32x32x16_bf16 v[16:31], a[0:3], v[64:67], 0
    ds_read_b128 v[64:67], v2 offset:6144
    s_waitcnt lgkmcnt(5)
    v_mfma_f32_32x32x16_bf16 v[16:31], a[4:7], v[68:71], v[16:31]
    ds_read_b128 v[68:71], v2 offset:7168
    s_waitcnt lgkmcnt(5)
    v_mfma_f32_32x32x16_bf16 v[16:31], a[8:11], v[72:75], v[16:31]
    ds_read_b128 v[72:75], v2 offset:8192
    s_waitcnt lgkmcnt(5)
    v_mfma_f32_32x32x16_bf16 v[16:31], a[12:15], v[76:79], v[16:31]
    ds_read_b128 v[76:79], v2 offset:9216
    s_waitcnt lgkmcnt(5)
    v_mfma_f32_32x32x16_bf16 v[16:31], a[16:19], v[80:83], v[16:31]
    ds_read_b128 v[80:83], v2 offset:10240
    s_waitcnt lgkmcnt(5)
    v_mfma_f32_32x32x16_bf16 v[16:31], a[20:23], v[84:87], v[16:31]
    ds_read_b128 v[84:87], v2 offset:11264
    s_waitcnt lgkmcnt(5)
    v_mfma_f32_32x32x16_bf16 v[16:31], a[24:27], v[64:67], v[16:31]
    ds_read_b128 v[64:67], v2 offset:12288
    s_waitcnt lgkmcnt(5)
    v_mfma_f32_32x32x16_bf16 v[16:31], a[28:31], v[68:71], v[16:31]
    ds_read_b128 v[68:71], v2 offset:13312
    s_waitcnt lgkmcnt(5)
    v_mfma_f32_32x32x16_bf16 v[16:31], a[32:35], v[72:75], v[16:31]
    ds_read_b128 v[72:75], v2 offset:14336
    s_waitcnt lgkmcnt(5)
    v_mfma_f32_32x32x16_bf16 v[16:31], a[36:39], v[76:79], v[16:31]
    ds_read_b128 v[76:79], v2 offset:15360
    s_waitcnt lgkmcnt(5)
    v_mfma_f32_32x32x16_bf16 v[16:31], a[40:43], v[80:83], v[16:31]
    ds_read_b128 v[80:83], v2 offset:16384
    s_waitcnt lgkmcnt(5)
    v_mfma_f32_32x32x16_bf16 v[16:31], a[44:47], v[84:87], v[16:31]
    ds_read_b128 v[84:87], v2 offset:17408
    s_waitcnt lgkmcnt(5)
    v_mfma_f32_32x32x16_bf16 v[16:31], a[48:51], v[64:67], v[16:31]
    ds_read_b128 v[64:67], v2 offset:18432
    s_waitcnt lgkmcnt(5)
    v_mfma_f32_32x32x16_bf16 v[16:31], a[52:55], v[68:71], v[16:31]
    ds_read_b128 v[68:71], v2 offset:19456
    s_waitcnt lgkmcnt(5)
    v_mfma_f32_32x32x16_bf16 v[16:31], a[56:59], v[72:75], v[16:31]
    ds_read_b128 v[72:75], v2 offset:20480
    s_waitcnt lgkmcnt(5)
    v_mfma_f32_32x32x16_bf16 v[16:31], a[60:63], v[76:79], v[16:31]
    ds_read_b128 v[76:79], v2 offset:21504
    s_waitcnt lgkmcnt(5)
    v_mfma_f32_32x32x16_bf16 v[16:31], a[64:67], v[80:83], v[16:31]
    ds_read_b128 v[80:83], v2 offset:22528
    s_waitcnt lgkmcnt(5)
    v_mfma_f32_32x32x16_bf16 v[16:31], a[68:71], v[84:87], v[16:31]
    ds_read_b128 v[84:87], v2 offset:23552
    s_waitcnt lgkmcnt(5)
    v_mfma_f32_32x32x16_bf16 v[16:31], a[72:75], v[64:67], v[16:31]
    ds_read_b128 v[64:67], v2 offset:24576
    s_waitcnt lgkmcnt(5)
    v_mfma_f32_32x32x16_bf16 v[16:31], a[76:79], v[68:71], v[16:31]
    ds_read_b128 v[68:71], v2 offset:25600
    s_waitcnt lgkmcnt(5)
    v_mfma_f32_32x32x16_bf16 v[16:31], a[80:83], v[72:75], v[16:31]
    ds_read_b128 v[72:75], v2 offset:26624
    s_waitcnt lgkmcnt(5)
    v_mfma_f32_32x32x16_bf16 v[16:31], a[84:87], v[76:79], v[16:31]
    ds_read_b128 v[76:79], v2 offset:27648
    s_waitcnt lgkmcnt(5)
    v_mfma_f32_32x32x16_bf16 v[16:31], a[88:91], v[80:83], v[16:31]
    ds_read_b128 v[80:83], v2 offset:28672
    s_waitcnt lgkmcnt(5)
    v_mfma_f32_32x32x16_bf16 v[16:31], a[92:95], v[84:87], v[16:31]
    ds_read_b128 v[84:87], v2 offset:29696
    s_waitcnt lgkmcnt(5)
    v_mfma_f32_32x32x16_bf16 v[16:31], a[96:99], v[64:67], v[16:31]
    ds_read_b128 v[64:67], v2 offset:30720
    s_waitcnt lgkmcnt(5)
    v_mfma_f32_32x32x16_bf16 v[16:31], a[100:103], v[68:71], v[16:31]
    ds_read_b128 v[68:71], v2 offset:31744
    s_waitcnt lgkmcnt(5)
    v_mfma_f32_32x32x16_bf16 v[16:31], a[104:107], v[72:75], v[16:31]
    ds_read_b128 v[72:75], v2 offset:32768
    s_waitcnt lgkmcnt(5)
    v_mfma_f32_32x32x16_bf16 v[16:31], a[108:111], v[76:79], v[16:31]
    ds_read_b128 v[76:79], v2 offset:33792
    s_waitcnt lgkmcnt(5)
    v_mfma_f32_32x32x16_bf16 v[16:31], a[112:115], v[80:83], v[16:31]
    ds_read_b128 v[80:83], v2 offset:34816
    s_waitcnt lgkmcnt(5)
    v_mfma_f32_32x32x16_bf16 v[16:31], a[116:119], v[84:87], v[16:31]
    ds_read_b128 v[84:87], v2 offset:35840
    s_waitcnt lgkmcnt(5)
    v_mfma_f32_32x32x16_bf16 v[16:31], a[120:123], v[64:67], v[16:31]
    s_waitcnt lgkmcnt(4)
    v_mfma_f32_32x32x16_bf16 v[16:31], a[124:127], v[68:71], v[16:31]
    s_waitcnt lgkmcnt(3)
    v_mfma_f32_32x32x16_bf16 v[16:31], a[128:131], v[72:75], v[16:31]
    s_waitcnt lgkmcnt(2)
    v_mfma_f32_32x32x16_bf16 v[16:31], a[132:135], v[76:79], v[16:31]
    s_waitcnt lgkmcnt(1)
    v_mfma_f32_32x32x16_bf16 v[16:31], a[136:139], v[80:83], v[16:31]
    s_waitcnt lgkmcnt(0)
    v_mfma_f32_32x32x16_bf16 v[16:31], a[140:143], v[84:87], v[16:31]
    s_mul_i32 s24, s22, 36
    s_add_u32 s24, s24, s44
    s_lshl_b32 s24, s24, 13
    s_add_u32 s24, s24, 125829120
    s_nop 7
    v_pk_add_f32 v[16:17], v[16:17], v[96:97]
    v_pk_add_f32 v[18:19], v[18:19], v[98:99]
    v_pk_add_f32 v[20:21], v[20:21], v[100:101]
    v_pk_add_f32 v[22:23], v[22:23], v[102:103]
    v_pk_mul_f32 v[32:33], v[16:17], v[16:17]
    v_pk_mul_f32 v[34:35], v[18:19], v[18:19]
    v_pk_mul_f32 v[36:37], v[20:21], v[20:21]
    v_pk_mul_f32 v[38:39], v[22:23], v[22:23]
    v_pk_add_f32 v[24:25], v[24:25], v[104:105]
    v_pk_add_f32 v[26:27], v[26:27], v[106:107]
    v_pk_add_f32 v[28:29], v[28:29], v[108:109]
    v_pk_add_f32 v[30:31], v[30:31], v[110:111]
    v_pk_fma_f32 v[32:33], v[32:33], s[50:51], v[120:121]
    v_pk_fma_f32 v[34:35], v[34:35], s[50:51], v[120:121]
    v_pk_fma_f32 v[36:37], v[36:37], s[50:51], v[120:121]
    v_pk_fma_f32 v[38:39], v[38:39], s[50:51], v[120:121]
    v_pk_mul_f32 v[40:41], v[24:25], v[24:25]
    v_pk_mul_f32 v[42:43], v[26:27], v[26:27]
    v_pk_mul_f32 v[44:45], v[28:29], v[28:29]
    v_pk_mul_f32 v[46:47], v[30:31], v[30:31]
    v_pk_mul_f32 v[32:33], v[32:33], v[16:17]
    v_pk_mul_f32 v[34:35], v[34:35], v[18:19]
    v_pk_mul_f32 v[36:37], v[36:37], v[20:21]
    v_pk_mul_f32 v[38:39], v[38:39], v[22:23]
    v_pk_fma_f32 v[40:41], v[40:41], s[50:51], v[120:121]
    v_pk_fma_f32 v[42:43], v[42:43], s[50:51], v[120:121]
    v_pk_fma_f32 v[44:45], v[44:45], s[50:51], v[120:121]
    v_pk_fma_f32 v[46:47], v[46:47], s[50:51], v[120:121]
    v_exp_f32 v32, v32
    v_exp_f32 v33, v33
    v_exp_f32 v34, v34
    v_exp_f32 v35, v35
    v_exp_f32 v36, v36
    v_exp_f32 v37, v37
    v_exp_f32 v38, v38
    v_exp_f32 v39, v39
    v_pk_mul_f32 v[40:41], v[40:41], v[24:25]
    v_pk_mul_f32 v[42:43], v[42:43], v[26:27]
    v_pk_mul_f32 v[44:45], v[44:45], v[28:29]
    v_pk_mul_f32 v[46:47], v[46:47], v[30:31]
    v_exp_f32 v40, v40
    v_exp_f32 v41, v41
    v_exp_f32 v42, v42
    v_exp_f32 v43, v43
    v_exp_f32 v44, v44
    v_exp_f32 v45, v45
    v_exp_f32 v46, v46
    v_exp_f32 v47, v47
    v_pk_add_f32 v[32:33], v[32:33], s[52:53]
    v_pk_add_f32 v[34:35], v[34:35], s[52:53]
    v_pk_add_f32 v[36:37], v[36:37], s[52:53]
    v_pk_add_f32 v[38:39], v[38:39], s[52:53]
    v_rcp_f32 v32, v32
    v_rcp_f32 v33, v33
    v_rcp_f32 v34, v34
    v_rcp_f32 v35, v35
    v_rcp_f32 v36, v36
    v_rcp_f32 v37, v37
    v_rcp_f32 v38, v38
    v_rcp_f32 v39, v39
    v_pk_add_f32 v[40:41], v[40:41], s[52:53]
    v_pk_add_f32 v[42:43], v[42:43], s[52:53]
    v_pk_add_f32 v[44:45], v[44:45], s[52:53]
    v_pk_add_f32 v[46:47], v[46:47], s[52:53]
    v_rcp_f32 v40, v40
    v_rcp_f32 v41, v41
    v_rcp_f32 v42, v42
    v_rcp_f32 v43, v43
    v_rcp_f32 v44, v44
    v_rcp_f32 v45, v45
    v_rcp_f32 v46, v46
    v_rcp_f32 v47, v47
    v_pk_mul_f32 v[16:17], v[16:17], v[32:33]
    v_pk_mul_f32 v[18:19], v[18:19], v[34:35]
    v_pk_mul_f32 v[20:21], v[20:21], v[36:37]
    v_pk_mul_f32 v[22:23], v[22:23], v[38:39]
    v_cvt_pk_bf16_f32 v48, v16, v17
    v_cvt_pk_bf16_f32 v49, v18, v19
    v_cvt_pk_bf16_f32 v50, v20, v21
    v_cvt_pk_bf16_f32 v51, v22, v23
    v_pk_mul_f32 v[24:25], v[24:25], v[40:41]
    v_pk_mul_f32 v[26:27], v[26:27], v[42:43]
    v_pk_mul_f32 v[28:29], v[28:29], v[44:45]
    v_pk_mul_f32 v[30:31], v[30:31], v[46:47]
    v_cvt_pk_bf16_f32 v52, v24, v25
    v_cvt_pk_bf16_f32 v53, v26, v27
    v_cvt_pk_bf16_f32 v54, v28, v29
    v_cvt_pk_bf16_f32 v55, v30, v31
    buffer_store_dwordx4 v[48:51], v10, s[4:7], s24 offen offset:0 sc1
    buffer_store_dwordx4 v[52:55], v10, s[4:7], s24 offen offset:512 sc1
    s_waitcnt vmcnt(0)
    s_barrier
    s_add_u32 s28, s22, 1
    s_cmp_lg_u32 s21, 0
    s_cbranch_scc1 noset_m_168
    s_lshr_b32 s29, s20, 2
    s_lshl_b32 s29, s29, 8
    s_and_b32 s92, s20, 3
    s_lshl_b32 s92, s92, 2
    s_add_u32 s29, s29, s92
    s_add_u32 s29, s29, 184305664
    v_mov_b32 v5, s28
    buffer_store_dword v5, off, s[4:7], s29 sc1
    s_nop 0
noset_m_168:
    s_add_u32 s22, s22, 2
    s_cmp_lt_u32 s22, 64
    s_cbranch_scc1 L_m_164
    s_endpgm
abf1_m_153:
    s_endpgm
nf1_m_152:
    s_sub_u32 s20, s20, 72
    s_cmp_ge_u32 s20, 36
    s_cbranch_scc1 nf2_m_169
    s_load_dwordx2 s[32:33], s[0:1], 112
    s_load_dwordx2 s[34:35], s[0:1], 80
    v_lshrrev_b32 v3, 6, v0
    s_nop 0
    v_readfirstlane_b32 s21, v3
    v_and_b32 v1, 63, v0
    v_lshlrev_b32 v2, 4, v1
    s_mov_b32 s23, 4194304
    s_waitcnt lgkmcnt(0)
    s_mov_b32 s4, s32
    s_and_b32 s5, s33, 65535
    s_mov_b32 s6, 268435456
    s_mov_b32 s7, 131072
    s_lshr_b32 s24, s2, 5
    s_cmp_lt_u32 s24, 2
    s_cbranch_scc1 nowarm_m_171
    s_load_dwordx4 s[60:63], s[0:1], 16
    s_load_dwordx2 s[64:65], s[0:1], 32
    s_sub_u32 s24, s24, 2
    s_lshl_b32 s24, s24, 2
    s_bfe_u32 s25, s2, 131075
    s_add_u32 s24, s24, s25
    s_lshl_b32 s24, s24, 2
    s_add_u32 s24, s24, s21
    s_mul_i32 s24, s24, 49152
    s_and_b32 s25, s2, 7
    s_sub_u32 s25, s25, 1
    s_waitcnt lgkmcnt(0)
    s_mov_b32 s70, 846615568
    s_mov_b32 s71, 14395788
    s_lshl_b32 s27, s25, 2
    s_lshr_b64 s[70:71], s[70:71], s27
    s_and_b32 s27, s70, 15
    s_lshr_b32 s26, s27, 2
    s_cmp_eq_u32 s26, 1
    s_cselect_b64 s[66:67], s[62:63], s[60:61]
    s_cmp_eq_u32 s26, 2
    s_cselect_b64 s[66:67], s[64:65], s[66:67]
    s_mov_b32 s68, s66
    s_and_b32 s69, s67, 65535
    s_mov_b32 s70, 4718592
    s_mov_b32 s71, 131072
    s_and_b32 s26, s27, 3
    s_lshl_b32 s26, s26, 11
    s_add_u32 s26, s26, s24
    buffer_load_dwordx4 v[128:131], v2, s[68:71], s26 offen offset:0
    buffer_load_dwordx4 v[132:135], v2, s[68:71], s26 offen offset:1024
    s_add_u32 s26, s26, 8192
    buffer_load_dwordx4 v[136:139], v2, s[68:71], s26 offen offset:0
    buffer_load_dwordx4 v[140:143], v2, s[68:71], s26 offen offset:1024
    s_add_u32 s26, s26, 8192
    buffer_load_dwordx4 v[144:147], v2, s[68:71], s26 offen offset:0
    buffer_load_dwordx4 v[148:151], v2, s[68:71], s26 offen offset:1024
    s_add_u32 s26, s26, 8192
    buffer_load_dwordx4 v[152:155], v2, s[68:71], s26 offen offset:0
    buffer_load_dwordx4 v[156:159], v2, s[68:71], s26 offen offset:1024
    s_add_u32 s26, s26, 8192
    buffer_load_dwordx4 v[160:163], v2, s[68:71], s26 offen offset:0
    buffer_load_dwordx4 v[164:167], v2, s[68:71], s26 offen offset:1024
    s_add_u32 s26, s26, 8192
    buffer_load_dwordx4 v[168:171], v2, s[68:71], s26 offen offset:0
    buffer_load_dwordx4 v[172:175], v2, s[68:71], s26 offen offset:1024
    s_add_u32 s26, s26, 8192
    s_add_u32 s25, s25, 7
    s_mov_b32 s70, 846615568
    s_mov_b32 s71, 14395788
    s_lshl_b32 s27, s25, 2
    s_lshr_b64 s[70:71], s[70:71], s27
    s_and_b32 s27, s70, 15
    s_cmp_ge_u32 s27, 12
    s_cbranch_scc1 nowarm_m_171
    s_lshr_b32 s26, s27, 2
    s_cmp_eq_u32 s26, 1
    s_cselect_b64 s[66:67], s[62:63], s[60:61]
    s_cmp_eq_u32 s26, 2
    s_cselect_b64 s[66:67], s[64:65], s[66:67]
    s_mov_b32 s68, s66
    s_and_b32 s69, s67, 65535
    s_mov_b32 s70, 4718592
    s_mov_b32 s71, 131072
    s_and_b32 s26, s27, 3
    s_lshl_b32 s26, s26, 11
    s_add_u32 s26, s26, s24
    buffer_load_dwordx4 v[176:179], v2, s[68:71], s26 offen offset:0
    buffer_load_dwordx4 v[180:183], v2, s[68:71], s26 offen offset:1024
    s_add_u32 s26, s26, 8192
    buffer_load_dwordx4 v[184:187], v2, s[68:71], s26 offen offset:0
    buffer_load_dwordx4 v[188:191], v2, s[68:71], s26 offen offset:1024
    s_add_u32 s26, s26, 8192
    buffer_load_dwordx4 v[192:195], v2, s[68:71], s26 offen offset:0
    buffer_load_dwordx4 v[196:199], v2, s[68:71], s26 offen offset:1024
    s_add_u32 s26, s26, 8192
    buffer_load_dwordx4 v[200:203], v2, s[68:71], s26 offen offset:0
    buffer_load_dwordx4 v[204:207], v2, s[68:71], s26 offen offset:1024
    s_add_u32 s26, s26, 8192
    buffer_load_dwordx4 v[208:211], v2, s[68:71], s26 offen offset:0
    buffer_load_dwordx4 v[212:215], v2, s[68:71], s26 offen offset:1024
    s_add_u32 s26, s26, 8192
    buffer_load_dwordx4 v[216:219], v2, s[68:71], s26 offen offset:0
    buffer_load_dwordx4 v[220:223], v2, s[68:71], s26 offen offset:1024
    s_add_u32 s26, s26, 8192
nowarm_m_171:
    s_waitcnt vmcnt(0)
    s_load_dwordx2 s[30:31], s[0:1], 104
    s_waitcnt lgkmcnt(0)
    s_mov_b32 s16, s30
    s_and_b32 s17, s31, 65535
    s_mov_b32 s18, 256
    s_mov_b32 s19, 131072
L_m_172:
    s_sub_u32 s23, s23, 1
    s_cbranch_scc1 abf2_m_170
    buffer_load_dword v3, off, s[16:19], 0 offset:64 sc1
    s_waitcnt vmcnt(0)
    v_cmp_eq_u32 vcc, 0, v3
    s_nop 0
    s_cbranch_vccnz L_m_172
    s_and_b32 s27, s20, 31
    s_add_u32 s27, s27, 16
    s_and_b32 s27, s20, 31
    s_cmp_lg_u32 s21, 0
    s_cbranch_scc1 nopoll_m_173
    v_min_u32 v4, 0, v1
    v_mul_u32_u24 v4, 4, v4
    s_lshr_b32 s29, s27, 0
    s_lshl_b32 s29, s29, 8
    s_add_u32 s29, s29, 184288256
    buffer_load_dword v5, v4, s[4:7], s29 offen sc1
    s_waitcnt vmcnt(0)
    v_cmp_gt_u32 vcc, 6, v5
    s_nop 0
    s_cbranch_vccz fok_m_174
L_m_175:
    s_sleep 32
    s_sub_u32 s23, s23, 1
    s_cbranch_scc1 abf2_m_170
    buffer_load_dword v5, v4, s[4:7], s29 offen sc1
    s_waitcnt vmcnt(0)
    v_cmp_gt_u32 vcc, 6, v5
    s_nop 0
    s_cbranch_vccnz L_m_175
fok_m_174:
nopoll_m_173:
    s_barrier
    s_mov_b32 s8, s34
    s_and_b32 s9, s35, 65535
    s_mov_b32 s10, 5308416
    s_mov_b32 s11, 131072
    s_lshr_b32 s44, s20, 2
    s_and_b32 s45, s20, 3
    s_lshl_b32 s46, s44, 2
    s_add_u32 s26, s46, s21
    s_mul_i32 s47, s21, 36864
    s_lshl_b32 s49, s21, 12
    s_add_u32 s49, s49, 147456
    s_mul_i32 s48, s26, 147456
    s_mul_i32 s24, s45, 288
    s_add_u32 s48, s48, s24
    v_lshrrev_b32 v8, 4, v1
    v_bfe_u32 v9, v1, 2, 2
    v_and_b32 v10, 3, v1
    v_lshrrev_b32 v6, 2, v1
    v_mul_u32_u24 v4, 1152, v6
    v_lshl_add_u32 v4, v10, 4, v4
    v_lshrrev_b32 v6, 1, v8
    v_lshlrev_b32 v6, 4, v6
    v_and_b32 v7, 1, v8
    v_lshl_add_u32 v6, v7, 2, v6
    v_add_u32 v6, v6, v9
    v_lshlrev_b32 v6, 6, v6
    v_lshl_add_u32 v6, v10, 3, v6
    v_add_u32 v5, s47, v6
    v_add_u32 v11, s49, v6
    v_add_u32 v12, s47, v2
    v_lshrrev_b32 v7, 3, v1
    v_mul_u32_u24 v13, 1152, v7
    v_and_b32 v7, 7, v1
    v_lshl_add_u32 v13, v7, 4, v13
    v_lshrrev_b32 v7, 6, v6
    v_lshlrev_b32 v7, 7, v7
    v_lshl_add_u32 v7, v10, 3, v7
    v_add_u32 v14, s47, v7
    s_add_u32 s25, s48, 256
    s_add_u32 m0, s49, 0
    s_nop 0
    buffer_load_dwordx4 v4, s[8:11], s25 offen lds
    s_add_u32 m0, s49, 1024
    s_add_u32 s25, s25, 18432
    buffer_load_dwordx4 v4, s[8:11], s25 offen lds
    s_add_u32 m0, s49, 2048
    s_add_u32 s25, s25, 18432
    buffer_load_dwordx4 v4, s[8:11], s25 offen lds
    s_add_u32 m0, s49, 3072
    s_add_u32 s25, s25, 18432
    buffer_load_dwordx4 v4, s[8:11], s25 offen lds
    s_add_u32 s25, s48, 0
    s_add_u32 m0, s47, 0
    s_nop 0
    buffer_load_dwordx4 v13, s[8:11], s25 offen lds
    s_add_u32 m0, s47, 1024
    s_add_u32 s25, s25, 9216
    buffer_load_dwordx4 v13, s[8:11], s25 offen lds
    s_add_u32 m0, s47, 2048
    s_add_u32 s25, s25, 9216
    buffer_load_dwordx4 v13, s[8:11], s25 offen lds
    s_add_u32 m0, s47, 3072
    s_add_u32 s25, s25, 9216
    buffer_load_dwordx4 v13, s[8:11], s25 offen lds
    s_add_u32 s25, s48, 36864
    s_add_u32 m0, s47, 4096
    s_nop 0
    buffer_load_dwordx4 v13, s[8:11], s25 offen lds
    s_add_u32 m0, s47, 5120
    s_add_u32 s25, s25, 9216
    buffer_load_dwordx4 v13, s[8:11], s25 offen lds
    s_add_u32 m0, s47, 6144
    s_add_u32 s25, s25, 9216
    buffer_load_dwordx4 v13, s[8:11], s25 offen lds
    s_add_u32 m0, s47, 7168
    s_add_u32 s25, s25, 9216
    buffer_load_dwordx4 v13, s[8:11], s25 offen lds
    s_add_u32 s25, s48, 73728
    s_add_u32 m0, s47, 8192
    s_nop 0
    buffer_load_dwordx4 v13, s[8:11], s25 offen lds
    s_add_u32 m0, s47, 9216
    s_add_u32 s25, s25, 9216
    buffer_load_dwordx4 v13, s[8:11], s25 offen lds
    s_add_u32 m0, s47, 10240
    s_add_u32 s25, s25, 9216
    buffer_load_dwordx4 v13, s[8:11], s25 offen lds
    s_add_u32 m0, s47, 11264
    s_add_u32 s25, s25, 9216
    buffer_load_dwordx4 v13, s[8:11], s25 offen lds
    s_add_u32 s25, s48, 110592
    s_add_u32 m0, s47, 12288
    s_nop 0
    buffer_load_dwordx4 v13, s[8:11], s25 offen lds
    s_add_u32 m0, s47, 13312
    s_add_u32 s25, s25, 9216
    buffer_load_dwordx4 v13, s[8:11], s25 offen lds
    s_add_u32 m0, s47, 14336
    s_add_u32 s25, s25, 9216
    buffer_load_dwordx4 v13, s[8:11], s25 offen lds
    s_add_u32 m0, s47, 15360
    s_add_u32 s25, s25, 9216
    buffer_load_dwordx4 v13, s[8:11], s25 offen lds
    s_add_u32 s25, s48, 128
    s_add_u32 m0, s47, 16384
    s_nop 0
    buffer_load_dwordx4 v13, s[8:11], s25 offen lds
    s_add_u32 m0, s47, 17408
    s_add_u32 s25, s25, 9216
    buffer_load_dwordx4 v13, s[8:11], s25 offen lds
    s_add_u32 m0, s47, 18432
    s_add_u32 s25, s25, 9216
    buffer_load_dwordx4 v13, s[8:11], s25 offen lds
    s_add_u32 m0, s47, 19456
    s_add_u32 s25, s25, 9216
    buffer_load_dwordx4 v13, s[8:11], s25 offen lds
    s_add_u32 s25, s48, 36992
    s_add_u32 m0, s47, 20480
    s_nop 0
    buffer_load_dwordx4 v13, s[8:11], s25 offen lds
    s_add_u32 m0, s47, 21504
    s_add_u32 s25, s25, 9216
    buffer_load_dwordx4 v13, s[8:11], s25 offen lds
    s_add_u32 m0, s47, 22528
    s_add_u32 s25, s25, 9216
    buffer_load_dwordx4 v13, s[8:11], s25 offen lds
    s_add_u32 m0, s47, 23552
    s_add_u32 s25, s25, 9216
    buffer_load_dwordx4 v13, s[8:11], s25 offen lds
    s_add_u32 s25, s48, 73856
    s_add_u32 m0, s47, 24576
    s_nop 0
    buffer_load_dwordx4 v13, s[8:11], s25 offen lds
    s_add_u32 m0, s47, 25600
    s_add_u32 s25, s25, 9216
    buffer_load_dwordx4 v13, s[8:11], s25 offen lds
    s_add_u32 m0, s47, 26624
    s_add_u32 s25, s25, 9216
    buffer_load_dwordx4 v13, s[8:11], s25 offen lds
    s_add_u32 m0, s47, 27648
    s_add_u32 s25, s25, 9216
    buffer_load_dwordx4 v13, s[8:11], s25 offen lds
    s_add_u32 s25, s48, 110720
    s_add_u32 m0, s47, 28672
    s_nop 0
    buffer_load_dwordx4 v13, s[8:11], s25 offen lds
    s_add_u32 m0, s47, 29696
    s_add_u32 s25, s25, 9216
    buffer_load_dwordx4 v13, s[8:11], s25 offen lds
    s_add_u32 m0, s47, 30720
    s_add_u32 s25, s25, 9216
    buffer_load_dwordx4 v13, s[8:11], s25 offen lds
    s_add_u32 m0, s47, 31744
    s_add_u32 s25, s25, 9216
    buffer_load_dwordx4 v13, s[8:11], s25 offen lds
    s_waitcnt vmcnt(32)
    ds_read_b64_tr_b16 v[32:33], v11 offset:0
    ds_read_b64_tr_b16 v[34:35], v11 offset:512
    ds_read_b64_tr_b16 v[36:37], v11 offset:2048
    ds_read_b64_tr_b16 v[38:39], v11 offset:2560
    s_waitcnt lgkmcnt(0)
    ds_write_b128 v12, v[32:35] offset:32768
    ds_write_b128 v12, v[36:39] offset:33792
    s_waitcnt lgkmcnt(0)
    s_add_u32 s25, s48, 73984
    s_add_u32 m0, s49, 0
    s_nop 0
    buffer_load_dwordx4 v4, s[8:11], s25 offen lds
    s_add_u32 m0, s49, 1024
    s_add_u32 s25, s25, 18432
    buffer_load_dwordx4 v4, s[8:11], s25 offen lds
    s_add_u32 m0, s49, 2048
    s_add_u32 s25, s25, 18432
    buffer_load_dwordx4 v4, s[8:11], s25 offen lds
    s_add_u32 m0, s49, 3072
    s_add_u32 s25, s25, 18432
    buffer_load_dwordx4 v4, s[8:11], s25 offen lds
    s_waitcnt vmcnt(32)
    ds_read_b64_tr_b16 v[32:33], v14 offset:0
    ds_read_b64_tr_b16 v[34:35], v14 offset:1024
    ds_read_b64_tr_b16 v[36:37], v14 offset:32
    ds_read_b64_tr_b16 v[38:39], v14 offset:1056
    ds_read_b64_tr_b16 v[40:41], v14 offset:64
    ds_read_b64_tr_b16 v[42:43], v14 offset:1088
    ds_read_b64_tr_b16 v[44:45], v14 offset:96
    ds_read_b64_tr_b16 v[46:47], v14 offset:1120
    s_waitcnt lgkmcnt(0)
    ds_write_b128 v12, v[32:35] offset:0
    ds_write_b128 v12, v[36:39] offset:1024
    ds_write_b128 v12, v[40:43] offset:2048
    ds_write_b128 v12, v[44:47] offset:3072
    s_waitcnt vmcnt(28)
    ds_read_b64_tr_b16 v[32:33], v14 offset:4096
    ds_read_b64_tr_b16 v[34:35], v14 offset:5120
    ds_read_b64_tr_b16 v[36:37], v14 offset:4128
    ds_read_b64_tr_b16 v[38:39], v14 offset:5152
    ds_read_b64_tr_b16 v[40:41], v14 offset:4160
    ds_read_b64_tr_b16 v[42:43], v14 offset:5184
    ds_read_b64_tr_b16 v[44:45], v14 offset:4192
    ds_read_b64_tr_b16 v[46:47], v14 offset:5216
    s_waitcnt lgkmcnt(0)
    ds_write_b128 v12, v[32:35] offset:4096
    ds_write_b128 v12, v[36:39] offset:5120
    ds_write_b128 v12, v[40:43] offset:6144
    ds_write_b128 v12, v[44:47] offset:7168
    s_waitcnt vmcnt(24)
    ds_read_b64_tr_b16 v[32:33], v14 offset:8192
    ds_read_b64_tr_b16 v[34:35], v14 offset:9216
    ds_read_b64_tr_b16 v[36:37], v14 offset:8224
    ds_read_b64_tr_b16 v[38:39], v14 offset:9248
    ds_read_b64_tr_b16 v[40:41], v14 offset:8256
    ds_read_b64_tr_b16 v[42:43], v14 offset:9280
    ds_read_b64_tr_b16 v[44:45], v14 offset:8288
    ds_read_b64_tr_b16 v[46:47], v14 offset:9312
    s_waitcnt lgkmcnt(0)
    ds_write_b128 v12, v[32:35] offset:8192
    ds_write_b128 v12, v[36:39] offset:9216
    ds_write_b128 v12, v[40:43] offset:10240
    ds_write_b128 v12, v[44:47] offset:11264
    s_waitcnt vmcnt(20)
    ds_read_b64_tr_b16 v[32:33], v14 offset:12288
    ds_read_b64_tr_b16 v[34:35], v14 offset:13312
    ds_read_b64_tr_b16 v[36:37], v14 offset:12320
    ds_read_b64_tr_b16 v[38:39], v14 offset:13344
    ds_read_b64_tr_b16 v[40:41], v14 offset:12352
    ds_read_b64_tr_b16 v[42:43], v14 offset:13376
    ds_read_b64_tr_b16 v[44:45], v14 offset:12384
    ds_read_b64_tr_b16 v[46:47], v14 offset:13408
    s_waitcnt lgkmcnt(0)
    ds_write_b128 v12, v[32:35] offset:12288
    ds_write_b128 v12, v[36:39] offset:13312
    ds_write_b128 v12, v[40:43] offset:14336
    ds_write_b128 v12, v[44:47] offset:15360
    s_waitcnt vmcnt(16)
    ds_read_b64_tr_b16 v[32:33], v14 offset:16384
    ds_read_b64_tr_b16 v[34:35], v14 offset:17408
    ds_read_b64_tr_b16 v[36:37], v14 offset:16416
    ds_read_b64_tr_b16 v[38:39], v14 offset:17440
    ds_read_b64_tr_b16 v[40:41], v14 offset:16448
    ds_read_b64_tr_b16 v[42:43], v14 offset:17472
    ds_read_b64_tr_b16 v[44:45], v14 offset:16480
    ds_read_b64_tr_b16 v[46:47], v14 offset:17504
    s_waitcnt lgkmcnt(0)
    ds_write_b128 v12, v[32:35] offset:16384
    ds_write_b128 v12, v[36:39] offset:17408
    ds_write_b128 v12, v[40:43] offset:18432
    ds_write_b128 v12, v[44:47] offset:19456
    s_waitcnt vmcnt(12)
    ds_read_b64_tr_b16 v[32:33], v14 offset:20480
    ds_read_b64_tr_b16 v[34:35], v14 offset:21504
    ds_read_b64_tr_b16 v[36:37], v14 offset:20512
    ds_read_b64_tr_b16 v[38:39], v14 offset:21536
    ds_read_b64_tr_b16 v[40:41], v14 offset:20544
    ds_read_b64_tr_b16 v[42:43], v14 offset:21568
    ds_read_b64_tr_b16 v[44:45], v14 offset:20576
    ds_read_b64_tr_b16 v[46:47], v14 offset:21600
    s_waitcnt lgkmcnt(0)
    ds_write_b128 v12, v[32:35] offset:20480
    ds_write_b128 v12, v[36:39] offset:21504
    ds_write_b128 v12, v[40:43] offset:22528
    ds_write_b128 v12, v[44:47] offset:23552
    s_waitcnt vmcnt(8)
    ds_read_b64_tr_b16 v[32:33], v14 offset:24576
    ds_read_b64_tr_b16 v[34:35], v14 offset:25600
    ds_read_b64_tr_b16 v[36:37], v14 offset:24608
    ds_read_b64_tr_b16 v[38:39], v14 offset:25632
    ds_read_b64_tr_b16 v[40:41], v14 offset:24640
    ds_read_b64_tr_b16 v[42:43], v14 offset:25664
    ds_read_b64_tr_b16 v[44:45], v14 offset:24672
    ds_read_b64_tr_b16 v[46:47], v14 offset:25696
    s_waitcnt lgkmcnt(0)
    ds_write_b128 v12, v[32:35] offset:24576
    ds_write_b128 v12, v[36:39] offset:25600
    ds_write_b128 v12, v[40:43] offset:26624
    ds_write_b128 v12, v[44:47] offset:27648
    s_waitcnt vmcnt(4)
    ds_read_b64_tr_b16 v[32:33], v14 offset:28672
    ds_read_b64_tr_b16 v[34:35], v14 offset:29696
    ds_read_b64_tr_b16 v[36:37], v14 offset:28704
    ds_read_b64_tr_b16 v[38:39], v14 offset:29728
    ds_read_b64_tr_b16 v[40:41], v14 offset:28736
    ds_read_b64_tr_b16 v[42:43], v14 offset:29760
    ds_read_b64_tr_b16 v[44:45], v14 offset:28768
    ds_read_b64_tr_b16 v[46:47], v14 offset:29792
    s_waitcnt lgkmcnt(0)
    ds_write_b128 v12, v[32:35] offset:28672
    ds_write_b128 v12, v[36:39] offset:29696
    ds_write_b128 v12, v[40:43] offset:30720
    ds_write_b128 v12, v[44:47] offset:31744
    s_waitcnt vmcnt(0)
    ds_read_b64_tr_b16 v[32:33], v11 offset:0
    ds_read_b64_tr_b16 v[34:35], v11 offset:512
    ds_read_b64_tr_b16 v[36:37], v11 offset:2048
    ds_read_b64_tr_b16 v[38:39], v11 offset:2560
    s_waitcnt lgkmcnt(0)
    ds_write_b128 v12, v[32:35] offset:34816
    ds_write_b128 v12, v[36:39] offset:35840
    s_waitcnt lgkmcnt(0)
    v_add_u32 v4, 0, v2
    v_add_u32 v5, 36864, v2
    v_add_u32 v6, 73728, v2
    v_add_u32 v7, 110592, v2
    v_lshrrev_b32 v10, 1, v2
    s_lshr_b32 s22, s21, 1
    s_and_b32 s51, s21, 1
    s_lshl_b32 s50, s21, 6
    s_add_u32 s50, s50, s20
    s_lshl_b32 s24, s51, 10
    v_add_u32 v11, s24, v2
    s_lshl_b32 s24, s51, 9
    v_add_u32 v10, s24, v10
    s_barrier
    s_load_dwordx2 s[30:31], s[0:1], 104
    s_waitcnt lgkmcnt(0)
    s_mov_b32 s16, s30
    s_and_b32 s17, s31, 65535
    s_mov_b32 s18, 256
    s_mov_b32 s19, 131072
L_m_176:
    s_sub_u32 s23, s23, 1
    s_cbranch_scc1 abf2_m_170
    buffer_load_dword v3, off, s[16:19], 0 offset:64 sc1
    s_waitcnt vmcnt(0)
    v_cmp_eq_u32 vcc, 0, v3
    s_nop 0
    s_cbranch_vccnz L_m_176
L_m_177:
    s_add_u32 s28, s22, 1
    s_and_b32 s27, s22, 1
    s_mul_i32 s27, s27, 36
    s_add_u32 s27, s27, s46
    v_min_u32 v8, 3, v1
    v_mul_u32_u24 v8, 4, v8
    s_lshr_b32 s29, s27, 2
    s_lshl_b32 s29, s29, 8
    s_and_b32 s92, s27, 3
    s_lshl_b32 s92, s92, 2
    s_add_u32 s29, s29, s92
    s_add_u32 s29, s29, 184305664
    buffer_load_dword v9, v8, s[4:7], s29 offen sc1
    s_waitcnt vmcnt(0)
    v_cmp_gt_u32 vcc, s28, v9
    s_nop 0
    s_cbranch_vccz fok_m_178
L_m_179:
    s_sleep 8
    s_sub_u32 s23, s23, 1
    s_cbranch_scc1 abf2_m_170
    buffer_load_dword v9, v8, s[4:7], s29 offen sc1
    s_waitcnt vmcnt(0)
    v_cmp_gt_u32 vcc, s28, v9
    s_nop 0
    s_cbranch_vccnz L_m_179
fok_m_178:
    s_mul_i32 s24, s22, 36
    s_add_u32 s24, s24, s46
    s_lshl_b32 s24, s24, 13
    s_lshl_b32 s25, s51, 12
    s_add_u32 s25, s25, s24
    s_add_u32 s25, s25, 125829120
    buffer_load_dwordx4 v[16:19], v2, s[4:7], s25 offen offset:0
    buffer_load_dwordx4 v[20:23], v2, s[4:7], s25 offen offset:1024
    buffer_load_dwordx4 v[24:27], v2, s[4:7], s25 offen offset:2048
    buffer_load_dwordx4 v[28:31], v2, s[4:7], s25 offen offset:3072
    s_add_u32 s25, s25, 8192
    buffer_load_dwordx4 v[32:35], v2, s[4:7], s25 offen offset:0
    buffer_load_dwordx4 v[36:39], v2, s[4:7], s25 offen offset:1024
    buffer_load_dwordx4 v[40:43], v2, s[4:7], s25 offen offset:2048
    buffer_load_dwordx4 v[44:47], v2, s[4:7], s25 offen offset:3072
    s_add_u32 s25, s25, 8192
    buffer_load_dwordx4 v[48:51], v2, s[4:7], s25 offen offset:0
    buffer_load_dwordx4 v[52:55], v2, s[4:7], s25 offen offset:1024
    buffer_load_dwordx4 v[56:59], v2, s[4:7], s25 offen offset:2048
    buffer_load_dwordx4 v[60:63], v2, s[4:7], s25 offen offset:3072
    s_add_u32 s25, s25, 8192
    buffer_load_dwordx4 v[64:67], v2, s[4:7], s25 offen offset:0
    buffer_load_dwordx4 v[68:71], v2, s[4:7], s25 offen offset:1024
    buffer_load_dwordx4 v[72:75], v2, s[4:7], s25 offen offset:2048
    buffer_load_dwordx4 v[76:79], v2, s[4:7], s25 offen offset:3072
    s_mul_i32 s24, s22, 9
    s_add_u32 s24, s24, s44
    s_mul_i32 s24, s24, 36864
    s_add_u32 s24, s24, 218103808
    s_mul_i32 s25, s45, 9216
    s_add_u32 s24, s24, s25
    ds_read_b128 v[216:219], v4 offset:0
    ds_read_b128 v[220:223], v4 offset:1024
    ds_read_b128 v[224:227], v4 offset:2048
    ds_read_b128 v[228:231], v4 offset:3072
    ds_read_b128 v[232:235], v4 offset:16384
    ds_read_b128 v[236:239], v4 offset:17408
    ds_read_b128 v[240:243], v4 offset:18432
    ds_read_b128 v[244:247], v4 offset:19456
    ds_read_b128 v[248:251], v4 offset:32768
    ds_read_b128 v[252:255], v4 offset:4096
    s_waitcnt vmcnt(15) lgkmcnt(9)
    v_mfma_f32_16x16x32_bf16 v[144:147], v[216:219], v[16:19], 0
    ds_read_b128 v[216:219], v4 offset:5120
    s_waitcnt lgkmcnt(9)
    v_mfma_f32_16x16x32_bf16 v[148:151], v[220:223], v[16:19], 0
    ds_read_b128 v[220:223], v4 offset:6144
    s_waitcnt lgkmcnt(9)
    v_mfma_f32_16x16x32_bf16 v[152:155], v[224:227], v[16:19], 0
    ds_read_b128 v[224:227], v4 offset:7168
    s_waitcnt lgkmcnt(9)
    v_mfma_f32_16x16x32_bf16 v[156:159], v[228:231], v[16:19], 0
    ds_read_b128 v[228:231], v4 offset:20480
    s_waitcnt lgkmcnt(9)
    v_mfma_f32_16x16x32_bf16 v[160:163], v[232:235], v[16:19], 0
    ds_read_b128 v[232:235], v4 offset:21504
    s_waitcnt lgkmcnt(9)
    v_mfma_f32_16x16x32_bf16 v[164:167], v[236:239], v[16:19], 0
    ds_read_b128 v[236:239], v4 offset:22528
    s_waitcnt lgkmcnt(9)
    v_mfma_f32_16x16x32_bf16 v[168:171], v[240:243], v[16:19], 0
    ds_read_b128 v[240:243], v4 offset:23552
    s_waitcnt lgkmcnt(9)
    v_mfma_f32_16x16x32_bf16 v[172:175], v[244:247], v[16:19], 0
    ds_read_b128 v[244:247], v4 offset:33792
    s_waitcnt lgkmcnt(9)
    v_mfma_f32_16x16x32_bf16 v[176:179], v[248:251], v[16:19], 0
    ds_read_b128 v[248:251], v4 offset:8192
    s_waitcnt vmcnt(14) lgkmcnt(9)
    v_mfma_f32_16x16x32_bf16 v[144:147], v[252:255], v[20:23], v[144:147]
    ds_read_b128 v[252:255], v4 offset:9216
    s_waitcnt lgkmcnt(9)
    v_mfma_f32_16x16x32_bf16 v[148:151], v[216:219], v[20:23], v[148:151]
    ds_read_b128 v[216:219], v4 offset:10240
    s_waitcnt lgkmcnt(9)
    v_mfma_f32_16x16x32_bf16 v[152:155], v[220:223], v[20:23], v[152:155]
    ds_read_b128 v[220:223], v4 offset:11264
    s_waitcnt lgkmcnt(9)
    v_mfma_f32_16x16x32_bf16 v[156:159], v[224:227], v[20:23], v[156:159]
    ds_read_b128 v[224:227], v4 offset:24576
    s_waitcnt lgkmcnt(9)
    v_mfma_f32_16x16x32_bf16 v[160:163], v[228:231], v[20:23], v[160:163]
    ds_read_b128 v[228:231], v4 offset:25600
    s_waitcnt lgkmcnt(9)
    v_mfma_f32_16x16x32_bf16 v[164:167], v[232:235], v[20:23], v[164:167]
    ds_read_b128 v[232:235], v4 offset:26624
    s_waitcnt lgkmcnt(9)
    v_mfma_f32_16x16x32_bf16 v[168:171], v[236:239], v[20:23], v[168:171]
    ds_read_b128 v[236:239], v4 offset:27648
    s_waitcnt lgkmcnt(9)
    v_mfma_f32_16x16x32_bf16 v[172:175], v[240:243], v[20:23], v[172:175]
    ds_read_b128 v[240:243], v4 offset:34816
    s_waitcnt lgkmcnt(9)
    v_mfma_f32_16x16x32_bf16 v[176:179], v[244:247], v[20:23], v[176:179]
    ds_read_b128 v[244:247], v4 offset:12288
    s_waitcnt vmcnt(13) lgkmcnt(9)
    v_mfma_f32_16x16x32_bf16 v[144:147], v[248:251], v[24:27], v[144:147]
    ds_read_b128 v[248:251], v4 offset:13312
    s_waitcnt lgkmcnt(9)
    v_mfma_f32_16x16x32_bf16 v[148:151], v[252:255], v[24:27], v[148:151]
    ds_read_b128 v[252:255], v4 offset:14336
    s_waitcnt lgkmcnt(9)
    v_mfma_f32_16x16x32_bf16 v[152:155], v[216:219], v[24:27], v[152:155]
    ds_read_b128 v[216:219], v4 offset:15360
    s_waitcnt lgkmcnt(9)
    v_mfma_f32_16x16x32_bf16 v[156:159], v[220:223], v[24:27], v[156:159]
    ds_read_b128 v[220:223], v4 offset:28672
    s_waitcnt lgkmcnt(9)
    v_mfma_f32_16x16x32_bf16 v[160:163], v[224:227], v[24:27], v[160:163]
    ds_read_b128 v[224:227], v4 offset:29696
    s_waitcnt lgkmcnt(9)
    v_mfma_f32_16x16x32_bf16 v[164:167], v[228:231], v[24:27], v[164:167]
    ds_read_b128 v[228:231], v4 offset:30720
    s_waitcnt lgkmcnt(9)
    v_mfma_f32_16x16x32_bf16 v[168:171], v[232:235], v[24:27], v[168:171]
    ds_read_b128 v[232:235], v4 offset:31744
    s_waitcnt lgkmcnt(9)
    v_mfma_f32_16x16x32_bf16 v[172:175], v[236:239], v[24:27], v[172:175]
    ds_read_b128 v[236:239], v4 offset:35840
    s_waitcnt lgkmcnt(9)
    v_mfma_f32_16x16x32_bf16 v[176:179], v[240:243], v[24:27], v[176:179]
    ds_read_b128 v[240:243], v5 offset:0
    s_waitcnt vmcnt(12) lgkmcnt(9)
    v_mfma_f32_16x16x32_bf16 v[144:147], v[244:247], v[28:31], v[144:147]
    ds_read_b128 v[244:247], v5 offset:1024
    s_waitcnt lgkmcnt(9)
    v_mfma_f32_16x16x32_bf16 v[148:151], v[248:251], v[28:31], v[148:151]
    ds_read_b128 v[248:251], v5 offset:2048
    s_waitcnt lgkmcnt(9)
    v_mfma_f32_16x16x32_bf16 v[152:155], v[252:255], v[28:31], v[152:155]
    ds_read_b128 v[252:255], v5 offset:3072
    s_waitcnt lgkmcnt(9)
    v_mfma_f32_16x16x32_bf16 v[156:159], v[216:219], v[28:31], v[156:159]
    ds_read_b128 v[216:219], v5 offset:16384
    s_waitcnt lgkmcnt(9)
    v_mfma_f32_16x16x32_bf16 v[160:163], v[220:223], v[28:31], v[160:163]
    ds_read_b128 v[220:223], v5 offset:17408
    s_waitcnt lgkmcnt(9)
    v_mfma_f32_16x16x32_bf16 v[164:167], v[224:227], v[28:31], v[164:167]
    ds_read_b128 v[224:227], v5 offset:18432
    s_waitcnt lgkmcnt(9)
    v_mfma_f32_16x16x32_bf16 v[168:171], v[228:231], v[28:31], v[168:171]
    ds_read_b128 v[228:231], v5 offset:19456
    s_waitcnt lgkmcnt(9)
    v_mfma_f32_16x16x32_bf16 v[172:175], v[232:235], v[28:31], v[172:175]
    ds_read_b128 v[232:235], v5 offset:32768
    s_waitcnt lgkmcnt(9)
    v_mfma_f32_16x16x32_bf16 v[176:179], v[236:239], v[28:31], v[176:179]
    ds_read_b128 v[236:239], v5 offset:4096
    s_waitcnt vmcnt(11) lgkmcnt(9)
    v_mfma_f32_16x16x32_bf16 v[144:147], v[240:243], v[32:35], v[144:147]
    ds_read_b128 v[240:243], v5 offset:5120
    s_waitcnt lgkmcnt(9)
    v_mfma_f32_16x16x32_bf16 v[148:151], v[244:247], v[32:35], v[148:151]
    ds_read_b128 v[244:247], v5 offset:6144
    s_waitcnt lgkmcnt(9)
    v_mfma_f32_16x16x32_bf16 v[152:155], v[248:251], v[32:35], v[152:155]
    ds_read_b128 v[248:251], v5 offset:7168
    s_waitcnt lgkmcnt(9)
    v_mfma_f32_16x16x32_bf16 v[156:159], v[252:255], v[32:35], v[156:159]
    ds_read_b128 v[252:255], v5 offset:20480
    s_waitcnt lgkmcnt(9)
    v_mfma_f32_16x16x32_bf16 v[160:163], v[216:219], v[32:35], v[160:163]
    ds_read_b128 v[216:219], v5 offset:21504
    s_waitcnt lgkmcnt(9)
    v_mfma_f32_16x16x32_bf16 v[164:167], v[220:223], v[32:35], v[164:167]
    ds_read_b128 v[220:223], v5 offset:22528
    s_waitcnt lgkmcnt(9)
    v_mfma_f32_16x16x32_bf16 v[168:171], v[224:227], v[32:35], v[168:171]
    ds_read_b128 v[224:227], v5 offset:23552
    s_waitcnt lgkmcnt(9)
    v_mfma_f32_16x16x32_bf16 v[172:175], v[228:231], v[32:35], v[172:175]
    ds_read_b128 v[228:231], v5 offset:33792
    s_waitcnt lgkmcnt(9)
    v_mfma_f32_16x16x32_bf16 v[176:179], v[232:235], v[32:35], v[176:179]
    ds_read_b128 v[232:235], v5 offset:8192
    s_waitcnt vmcnt(10) lgkmcnt(9)
    v_mfma_f32_16x16x32_bf16 v[144:147], v[236:239], v[36:39], v[144:147]
    ds_read_b128 v[236:239], v5 offset:9216
    s_waitcnt lgkmcnt(9)
    v_mfma_f32_16x16x32_bf16 v[148:151], v[240:243], v[36:39], v[148:151]
    ds_read_b128 v[240:243], v5 offset:10240
    s_waitcnt lgkmcnt(9)
    v_mfma_f32_16x16x32_bf16 v[152:155], v[244:247], v[36:39], v[152:155]
    ds_read_b128 v[244:247], v5 offset:11264
    s_waitcnt lgkmcnt(9)
    v_mfma_f32_16x16x32_bf16 v[156:159], v[248:251], v[36:39], v[156:159]
    ds_read_b128 v[248:251], v5 offset:24576
    s_waitcnt lgkmcnt(9)
    v_mfma_f32_16x16x32_bf16 v[160:163], v[252:255], v[36:39], v[160:163]
    ds_read_b128 v[252:255], v5 offset:25600
    s_waitcnt lgkmcnt(9)
    v_mfma_f32_16x16x32_bf16 v[164:167], v[216:219], v[36:39], v[164:167]
    ds_read_b128 v[216:219], v5 offset:26624
    s_waitcnt lgkmcnt(9)
    v_mfma_f32_16x16x32_bf16 v[168:171], v[220:223], v[36:39], v[168:171]
    ds_read_b128 v[220:223], v5 offset:27648
    s_waitcnt lgkmcnt(9)
    v_mfma_f32_16x16x32_bf16 v[172:175], v[224:227], v[36:39], v[172:175]
    ds_read_b128 v[224:227], v5 offset:34816
    s_waitcnt lgkmcnt(9)
    v_mfma_f32_16x16x32_bf16 v[176:179], v[228:231], v[36:39], v[176:179]
    ds_read_b128 v[228:231], v5 offset:12288
    s_waitcnt vmcnt(9) lgkmcnt(9)
    v_mfma_f32_16x16x32_bf16 v[144:147], v[232:235], v[40:43], v[144:147]
    ds_read_b128 v[232:235], v5 offset:13312
    s_waitcnt lgkmcnt(9)
    v_mfma_f32_16x16x32_bf16 v[148:151], v[236:239], v[40:43], v[148:151]
    ds_read_b128 v[236:239], v5 offset:14336
    s_waitcnt lgkmcnt(9)
    v_mfma_f32_16x16x32_bf16 v[152:155], v[240:243], v[40:43], v[152:155]
    ds_read_b128 v[240:243], v5 offset:15360
    s_waitcnt lgkmcnt(9)
    v_mfma_f32_16x16x32_bf16 v[156:159], v[244:247], v[40:43], v[156:159]
    ds_read_b128 v[244:247], v5 offset:28672
    s_waitcnt lgkmcnt(9)
    v_mfma_f32_16x16x32_bf16 v[160:163], v[248:251], v[40:43], v[160:163]
    ds_read_b128 v[248:251], v5 offset:29696
    s_waitcnt lgkmcnt(9)
    v_mfma_f32_16x16x32_bf16 v[164:167], v[252:255], v[40:43], v[164:167]
    ds_read_b128 v[252:255], v5 offset:30720
    s_waitcnt lgkmcnt(9)
    v_mfma_f32_16x16x32_bf16 v[168:171], v[216:219], v[40:43], v[168:171]
    ds_read_b128 v[216:219], v5 offset:31744
    s_waitcnt lgkmcnt(9)
    v_mfma_f32_16x16x32_bf16 v[172:175], v[220:223], v[40:43], v[172:175]
    ds_read_b128 v[220:223], v5 offset:35840
    s_waitcnt lgkmcnt(9)
    v_mfma_f32_16x16x32_bf16 v[176:179], v[224:227], v[40:43], v[176:179]
    ds_read_b128 v[224:227], v6 offset:0
    s_waitcnt vmcnt(8) lgkmcnt(9)
    v_mfma_f32_16x16x32_bf16 v[144:147], v[228:231], v[44:47], v[144:147]
    ds_read_b128 v[228:231], v6 offset:1024
    s_waitcnt lgkmcnt(9)
    v_mfma_f32_16x16x32_bf16 v[148:151], v[232:235], v[44:47], v[148:151]
    ds_read_b128 v[232:235], v6 offset:2048
    s_waitcnt lgkmcnt(9)
    v_mfma_f32_16x16x32_bf16 v[152:155], v[236:239], v[44:47], v[152:155]
    ds_read_b128 v[236:239], v6 offset:3072
    s_waitcnt lgkmcnt(9)
    v_mfma_f32_16x16x32_bf16 v[156:159], v[240:243], v[44:47], v[156:159]
    ds_read_b128 v[240:243], v6 offset:16384
    s_waitcnt lgkmcnt(9)
    v_mfma_f32_16x16x32_bf16 v[160:163], v[244:247], v[44:47], v[160:163]
    ds_read_b128 v[244:247], v6 offset:17408
    s_waitcnt lgkmcnt(9)
    v_mfma_f32_16x16x32_bf16 v[164:167], v[248:251], v[44:47], v[164:167]
    ds_read_b128 v[248:251], v6 offset:18432
    s_waitcnt lgkmcnt(9)
    v_mfma_f32_16x16x32_bf16 v[168:171], v[252:255], v[44:47], v[168:171]
    ds_read_b128 v[252:255], v6 offset:19456
    s_waitcnt lgkmcnt(9)
    v_mfma_f32_16x16x32_bf16 v[172:175], v[216:219], v[44:47], v[172:175]
    ds_read_b128 v[216:219], v6 offset:32768
    s_waitcnt lgkmcnt(9)
    v_mfma_f32_16x16x32_bf16 v[176:179], v[220:223], v[44:47], v[176:179]
    ds_read_b128 v[220:223], v6 offset:4096
    s_waitcnt vmcnt(7) lgkmcnt(9)
    v_mfma_f32_16x16x32_bf16 v[144:147], v[224:227], v[48:51], v[144:147]
    ds_read_b128 v[224:227], v6 offset:5120
    s_waitcnt lgkmcnt(9)
    v_mfma_f32_16x16x32_bf16 v[148:151], v[228:231], v[48:51], v[148:151]
    ds_read_b128 v[228:231], v6 offset:6144
    s_waitcnt lgkmcnt(9)
    v_mfma_f32_16x16x32_bf16 v[152:155], v[232:235], v[48:51], v[152:155]
    ds_read_b128 v[232:235], v6 offset:7168
    s_waitcnt lgkmcnt(9)
    v_mfma_f32_16x16x32_bf16 v[156:159], v[236:239], v[48:51], v[156:159]
    ds_read_b128 v[236:239], v6 offset:20480
    s_waitcnt lgkmcnt(9)
    v_mfma_f32_16x16x32_bf16 v[160:163], v[240:243], v[48:51], v[160:163]
    ds_read_b128 v[240:243], v6 offset:21504
    s_waitcnt lgkmcnt(9)
    v_mfma_f32_16x16x32_bf16 v[164:167], v[244:247], v[48:51], v[164:167]
    ds_read_b128 v[244:247], v6 offset:22528
    s_waitcnt lgkmcnt(9)
    v_mfma_f32_16x16x32_bf16 v[168:171], v[248:251], v[48:51], v[168:171]
    ds_read_b128 v[248:251], v6 offset:23552
    s_waitcnt lgkmcnt(9)
    v_mfma_f32_16x16x32_bf16 v[172:175], v[252:255], v[48:51], v[172:175]
    ds_read_b128 v[252:255], v6 offset:33792
    s_waitcnt lgkmcnt(9)
    v_mfma_f32_16x16x32_bf16 v[176:179], v[216:219], v[48:51], v[176:179]
    ds_read_b128 v[216:219], v6 offset:8192
    s_waitcnt vmcnt(6) lgkmcnt(9)
    v_mfma_f32_16x16x32_bf16 v[144:147], v[220:223], v[52:55], v[144:147]
    ds_read_b128 v[220:223], v6 offset:9216
    s_waitcnt lgkmcnt(9)
    v_mfma_f32_16x16x32_bf16 v[148:151], v[224:227], v[52:55], v[148:151]
    ds_read_b128 v[224:227], v6 offset:10240
    s_waitcnt lgkmcnt(9)
    v_mfma_f32_16x16x32_bf16 v[152:155], v[228:231], v[52:55], v[152:155]
    ds_read_b128 v[228:231], v6 offset:11264
    s_waitcnt lgkmcnt(9)
    v_mfma_f32_16x16x32_bf16 v[156:159], v[232:235], v[52:55], v[156:159]
    ds_read_b128 v[232:235], v6 offset:24576
    s_waitcnt lgkmcnt(9)
    v_mfma_f32_16x16x32_bf16 v[160:163], v[236:239], v[52:55], v[160:163]
    ds_read_b128 v[236:239], v6 offset:25600
    s_waitcnt lgkmcnt(9)
    v_mfma_f32_16x16x32_bf16 v[164:167], v[240:243], v[52:55], v[164:167]
    ds_read_b128 v[240:243], v6 offset:26624
    s_waitcnt lgkmcnt(9)
    v_mfma_f32_16x16x32_bf16 v[168:171], v[244:247], v[52:55], v[168:171]
    ds_read_b128 v[244:247], v6 offset:27648
    s_waitcnt lgkmcnt(9)
    v_mfma_f32_16x16x32_bf16 v[172:175], v[248:251], v[52:55], v[172:175]
    ds_read_b128 v[248:251], v6 offset:34816
    s_waitcnt lgkmcnt(9)
    v_mfma_f32_16x16x32_bf16 v[176:179], v[252:255], v[52:55], v[176:179]
    ds_read_b128 v[252:255], v6 offset:12288
    s_waitcnt vmcnt(5) lgkmcnt(9)
    v_mfma_f32_16x16x32_bf16 v[144:147], v[216:219], v[56:59], v[144:147]
    ds_read_b128 v[216:219], v6 offset:13312
    s_waitcnt lgkmcnt(9)
    v_mfma_f32_16x16x32_bf16 v[148:151], v[220:223], v[56:59], v[148:151]
    ds_read_b128 v[220:223], v6 offset:14336
    s_waitcnt lgkmcnt(9)
    v_mfma_f32_16x16x32_bf16 v[152:155], v[224:227], v[56:59], v[152:155]
    ds_read_b128 v[224:227], v6 offset:15360
    s_waitcnt lgkmcnt(9)
    v_mfma_f32_16x16x32_bf16 v[156:159], v[228:231], v[56:59], v[156:159]
    ds_read_b128 v[228:231], v6 offset:28672
    s_waitcnt lgkmcnt(9)
    v_mfma_f32_16x16x32_bf16 v[160:163], v[232:235], v[56:59], v[160:163]
    ds_read_b128 v[232:235], v6 offset:29696
    s_waitcnt lgkmcnt(9)
    v_mfma_f32_16x16x32_bf16 v[164:167], v[236:239], v[56:59], v[164:167]
    ds_read_b128 v[236:239], v6 offset:30720
    s_waitcnt lgkmcnt(9)
    v_mfma_f32_16x16x32_bf16 v[168:171], v[240:243], v[56:59], v[168:171]
    ds_read_b128 v[240:243], v6 offset:31744
    s_waitcnt lgkmcnt(9)
    v_mfma_f32_16x16x32_bf16 v[172:175], v[244:247], v[56:59], v[172:175]
    ds_read_b128 v[244:247], v6 offset:35840
    s_waitcnt lgkmcnt(9)
    v_mfma_f32_16x16x32_bf16 v[176:179], v[248:251], v[56:59], v[176:179]
    ds_read_b128 v[248:251], v7 offset:0
    s_waitcnt vmcnt(4) lgkmcnt(9)
    v_mfma_f32_16x16x32_bf16 v[144:147], v[252:255], v[60:63], v[144:147]
    ds_read_b128 v[252:255], v7 offset:1024
    s_waitcnt lgkmcnt(9)
    v_mfma_f32_16x16x32_bf16 v[148:151], v[216:219], v[60:63], v[148:151]
    ds_read_b128 v[216:219], v7 offset:2048
    s_waitcnt lgkmcnt(9)
    v_mfma_f32_16x16x32_bf16 v[152:155], v[220:223], v[60:63], v[152:155]
    ds_read_b128 v[220:223], v7 offset:3072
    s_waitcnt lgkmcnt(9)
    v_mfma_f32_16x16x32_bf16 v[156:159], v[224:227], v[60:63], v[156:159]
    ds_read_b128 v[224:227], v7 offset:16384
    s_waitcnt lgkmcnt(9)
    v_mfma_f32_16x16x32_bf16 v[160:163], v[228:231], v[60:63], v[160:163]
    ds_read_b128 v[228:231], v7 offset:17408
    s_waitcnt lgkmcnt(9)
    v_mfma_f32_16x16x32_bf16 v[164:167], v[232:235], v[60:63], v[164:167]
    ds_read_b128 v[232:235], v7 offset:18432
    s_waitcnt lgkmcnt(9)
    v_mfma_f32_16x16x32_bf16 v[168:171], v[236:239], v[60:63], v[168:171]
    ds_read_b128 v[236:239], v7 offset:19456
    s_waitcnt lgkmcnt(9)
    v_mfma_f32_16x16x32_bf16 v[172:175], v[240:243], v[60:63], v[172:175]
    ds_read_b128 v[240:243], v7 offset:32768
    s_waitcnt lgkmcnt(9)
    v_mfma_f32_16x16x32_bf16 v[176:179], v[244:247], v[60:63], v[176:179]
    ds_read_b128 v[244:247], v7 offset:4096
    s_waitcnt vmcnt(3) lgkmcnt(9)
    v_mfma_f32_16x16x32_bf16 v[144:147], v[248:251], v[64:67], v[144:147]
    ds_read_b128 v[248:251], v7 offset:5120
    s_waitcnt lgkmcnt(9)
    v_mfma_f32_16x16x32_bf16 v[148:151], v[252:255], v[64:67], v[148:151]
    ds_read_b128 v[252:255], v7 offset:6144
    s_waitcnt lgkmcnt(9)
    v_mfma_f32_16x16x32_bf16 v[152:155], v[216:219], v[64:67], v[152:155]
    ds_read_b128 v[216:219], v7 offset:7168
    s_waitcnt lgkmcnt(9)
    v_mfma_f32_16x16x32_bf16 v[156:159], v[220:223], v[64:67], v[156:159]
    ds_read_b128 v[220:223], v7 offset:20480
    s_waitcnt lgkmcnt(9)
    v_mfma_f32_16x16x32_bf16 v[160:163], v[224:227], v[64:67], v[160:163]
    ds_read_b128 v[224:227], v7 offset:21504
    s_waitcnt lgkmcnt(9)
    v_mfma_f32_16x16x32_bf16 v[164:167], v[228:231], v[64:67], v[164:167]
    ds_read_b128 v[228:231], v7 offset:22528
    s_waitcnt lgkmcnt(9)
    v_mfma_f32_16x16x32_bf16 v[168:171], v[232:235], v[64:67], v[168:171]
    ds_read_b128 v[232:235], v7 offset:23552
    s_waitcnt lgkmcnt(9)
    v_mfma_f32_16x16x32_bf16 v[172:175], v[236:239], v[64:67], v[172:175]
    ds_read_b128 v[236:239], v7 offset:33792
    s_waitcnt lgkmcnt(9)
    v_mfma_f32_16x16x32_bf16 v[176:179], v[240:243], v[64:67], v[176:179]
    ds_read_b128 v[240:243], v7 offset:8192
    s_waitcnt vmcnt(2) lgkmcnt(9)
    v_mfma_f32_16x16x32_bf16 v[144:147], v[244:247], v[68:71], v[144:147]
    ds_read_b128 v[244:247], v7 offset:9216
    s_waitcnt lgkmcnt(9)
    v_mfma_f32_16x16x32_bf16 v[148:151], v[248:251], v[68:71], v[148:151]
    ds_read_b128 v[248:251], v7 offset:10240
    s_waitcnt lgkmcnt(9)
    v_mfma_f32_16x16x32_bf16 v[152:155], v[252:255], v[68:71], v[152:155]
    ds_read_b128 v[252:255], v7 offset:11264
    s_waitcnt lgkmcnt(9)
    v_mfma_f32_16x16x32_bf16 v[156:159], v[216:219], v[68:71], v[156:159]
    ds_read_b128 v[216:219], v7 offset:24576
    s_waitcnt lgkmcnt(9)
    v_mfma_f32_16x16x32_bf16 v[160:163], v[220:223], v[68:71], v[160:163]
    ds_read_b128 v[220:223], v7 offset:25600
    s_waitcnt lgkmcnt(9)
    v_mfma_f32_16x16x32_bf16 v[164:167], v[224:227], v[68:71], v[164:167]
    ds_read_b128 v[224:227], v7 offset:26624
    s_waitcnt lgkmcnt(9)
    v_mfma_f32_16x16x32_bf16 v[168:171], v[228:231], v[68:71], v[168:171]
    ds_read_b128 v[228:231], v7 offset:27648
    s_waitcnt lgkmcnt(9)
    v_mfma_f32_16x16x32_bf16 v[172:175], v[232:235], v[68:71], v[172:175]
    ds_read_b128 v[232:235], v7 offset:34816
    s_waitcnt lgkmcnt(9)
    v_mfma_f32_16x16x32_bf16 v[176:179], v[236:239], v[68:71], v[176:179]
    ds_read_b128 v[236:239], v7 offset:12288
    s_waitcnt vmcnt(1) lgkmcnt(9)
    v_mfma_f32_16x16x32_bf16 v[144:147], v[240:243], v[72:75], v[144:147]
    ds_read_b128 v[240:243], v7 offset:13312
    s_waitcnt lgkmcnt(9)
    v_mfma_f32_16x16x32_bf16 v[148:151], v[244:247], v[72:75], v[148:151]
    ds_read_b128 v[244:247], v7 offset:14336
    s_waitcnt lgkmcnt(9)
    v_mfma_f32_16x16x32_bf16 v[152:155], v[248:251], v[72:75], v[152:155]
    ds_read_b128 v[248:251], v7 offset:15360
    s_waitcnt lgkmcnt(9)
    v_mfma_f32_16x16x32_bf16 v[156:159], v[252:255], v[72:75], v[156:159]
    ds_read_b128 v[252:255], v7 offset:28672
    s_waitcnt lgkmcnt(9)
    v_mfma_f32_16x16x32_bf16 v[160:163], v[216:219], v[72:75], v[160:163]
    ds_read_b128 v[216:219], v7 offset:29696
    s_waitcnt lgkmcnt(9)
    v_mfma_f32_16x16x32_bf16 v[164:167], v[220:223], v[72:75], v[164:167]
    ds_read_b128 v[220:223], v7 offset:30720
    s_waitcnt lgkmcnt(9)
    v_mfma_f32_16x16x32_bf16 v[168:171], v[224:227], v[72:75], v[168:171]
    ds_read_b128 v[224:227], v7 offset:31744
    s_waitcnt lgkmcnt(9)
    v_mfma_f32_16x16x32_bf16 v[172:175], v[228:231], v[72:75], v[172:175]
    ds_read_b128 v[228:231], v7 offset:35840
    s_waitcnt lgkmcnt(9)
    v_mfma_f32_16x16x32_bf16 v[176:179], v[232:235], v[72:75], v[176:179]
    s_waitcnt vmcnt(0) lgkmcnt(8)
    v_mfma_f32_16x16x32_bf16 v[144:147], v[236:239], v[76:79], v[144:147]
    s_waitcnt lgkmcnt(7)
    v_mfma_f32_16x16x32_bf16 v[148:151], v[240:243], v[76:79], v[148:151]
    s_waitcnt lgkmcnt(6)
    v_mfma_f32_16x16x32_bf16 v[152:155], v[244:247], v[76:79], v[152:155]
    v_cvt_pk_bf16_f32 v144, v144, v145
    s_waitcnt lgkmcnt(5)
    v_mfma_f32_16x16x32_bf16 v[156:159], v[248:251], v[76:79], v[156:159]
    v_cvt_pk_bf16_f32 v145, v146, v147
    s_waitcnt lgkmcnt(4)
    v_mfma_f32_16x16x32_bf16 v[160:163], v[252:255], v[76:79], v[160:163]
    v_cvt_pk_bf16_f32 v152, v152, v153
    s_waitcnt lgkmcnt(3)
    v_mfma_f32_16x16x32_bf16 v[164:167], v[216:219], v[76:79], v[164:167]
    v_cvt_pk_bf16_f32 v146, v148, v149
    s_waitcnt lgkmcnt(2)
    v_mfma_f32_16x16x32_bf16 v[168:171], v[220:223], v[76:79], v[168:171]
    v_cvt_pk_bf16_f32 v147, v150, v151
    s_waitcnt lgkmcnt(1)
    v_mfma_f32_16x16x32_bf16 v[172:175], v[224:227], v[76:79], v[172:175]
    buffer_store_dwordx4 v[144:147], v11, s[4:7], s24 offen offset:0 sc1
    s_waitcnt lgkmcnt(0)
    v_mfma_f32_16x16x32_bf16 v[176:179], v[228:231], v[76:79], v[176:179]
    v_cvt_pk_bf16_f32 v153, v154, v155
    v_cvt_pk_bf16_f32 v154, v156, v157
    v_cvt_pk_bf16_f32 v155, v158, v159
    v_cvt_pk_bf16_f32 v160, v160, v161
    buffer_store_dwordx4 v[152:155], v11, s[4:7], s24 offen offset:2048 sc1
    v_cvt_pk_bf16_f32 v161, v162, v163
    v_cvt_pk_bf16_f32 v168, v168, v169
    s_add_u32 s24, s24, 4096
    v_cvt_pk_bf16_f32 v162, v164, v165
    v_cvt_pk_bf16_f32 v163, v166, v167
    v_cvt_pk_bf16_f32 v169, v170, v171
    buffer_store_dwordx4 v[160:163], v11, s[4:7], s24 offen offset:0 sc1
    v_cvt_pk_bf16_f32 v170, v172, v173
    v_cvt_pk_bf16_f32 v171, v174, v175
    buffer_store_dwordx4 v[168:171], v11, s[4:7], s24 offen offset:2048 sc1
    v_cvt_pk_bf16_f32 v176, v176, v177
    s_add_u32 s24, s24, 4096
    v_cvt_pk_bf16_f32 v177, v178, v179
    buffer_store_dwordx2 v[176:177], v10, s[4:7], s24 offen sc1
    s_waitcnt vmcnt(0)
    s_add_u32 s28, s22, 1
    s_lshr_b32 s29, s50, 6
    s_lshl_b32 s29, s29, 8
    s_and_b32 s92, s50, 63
    s_lshl_b32 s92, s92, 2
    s_add_u32 s29, s29, s92
    s_add_u32 s29, s29, 184310784
    v_mov_b32 v9, s28
    buffer_store_dword v9, off, s[4:7], s29 sc1
    s_add_u32 s22, s22, 2
    s_cmp_lt_u32 s22, 64
    s_cbranch_scc1 L_m_177
    s_endpgm
abf2_m_170:
    s_endpgm
nf2_m_169:
    s_sub_u32 s20, s20, 36
    s_cmp_ge_u32 s20, 8
    s_cbranch_scc1 nred2_m_180
    s_load_dwordx2 s[32:33], s[0:1], 112
    s_load_dwordx2 s[34:35], s[0:1], 88
    s_load_dwordx2 s[36:37], s[0:1], 96
    v_lshrrev_b32 v3, 6, v0
    s_nop 0
    v_readfirstlane_b32 s21, v3
    v_and_b32 v1, 63, v0
    v_lshlrev_b32 v2, 4, v1
    s_mov_b32 s23, 4194304
    s_waitcnt lgkmcnt(0)
    s_mov_b32 s4, s32
    s_and_b32 s5, s33, 65535
    s_mov_b32 s6, 268435456
    s_mov_b32 s7, 131072
    s_lshr_b32 s24, s2, 5
    s_cmp_lt_u32 s24, 2
    s_cbranch_scc1 nowarm_m_182
    s_load_dwordx4 s[60:63], s[0:1], 16
    s_load_dwordx2 s[64:65], s[0:1], 32
    s_sub_u32 s24, s24, 2
    s_lshl_b32 s24, s24, 2
    s_bfe_u32 s25, s2, 131075
    s_add_u32 s24, s24, s25
    s_lshl_b32 s24, s24, 2
    s_add_u32 s24, s24, s21
    s_mul_i32 s24, s24, 49152
    s_and_b32 s25, s2, 7
    s_sub_u32 s25, s25, 1
    s_waitcnt lgkmcnt(0)
    s_mov_b32 s70, 846615568
    s_mov_b32 s71, 14395788
    s_lshl_b32 s27, s25, 2
    s_lshr_b64 s[70:71], s[70:71], s27
    s_and_b32 s27, s70, 15
    s_lshr_b32 s26, s27, 2
    s_cmp_eq_u32 s26, 1
    s_cselect_b64 s[66:67], s[62:63], s[60:61]
    s_cmp_eq_u32 s26, 2
    s_cselect_b64 s[66:67], s[64:65], s[66:67]
    s_mov_b32 s68, s66
    s_and_b32 s69, s67, 65535
    s_mov_b32 s70, 4718592
    s_mov_b32 s71, 131072
    s_and_b32 s26, s27, 3
    s_lshl_b32 s26, s26, 11
    s_add_u32 s26, s26, s24
    buffer_load_dwordx4 v[128:131], v2, s[68:71], s26 offen offset:0
    buffer_load_dwordx4 v[132:135], v2, s[68:71], s26 offen offset:1024
    s_add_u32 s26, s26, 8192
    buffer_load_dwordx4 v[136:139], v2, s[68:71], s26 offen offset:0
    buffer_load_dwordx4 v[140:143], v2, s[68:71], s26 offen offset:1024
    s_add_u32 s26, s26, 8192
    buffer_load_dwordx4 v[144:147], v2, s[68:71], s26 offen offset:0
    buffer_load_dwordx4 v[148:151], v2, s[68:71], s26 offen offset:1024
    s_add_u32 s26, s26, 8192
    buffer_load_dwordx4 v[152:155], v2, s[68:71], s26 offen offset:0
    buffer_load_dwordx4 v[156:159], v2, s[68:71], s26 offen offset:1024
    s_add_u32 s26, s26, 8192
    buffer_load_dwordx4 v[160:163], v2, s[68:71], s26 offen offset:0
    buffer_load_dwordx4 v[164:167], v2, s[68:71], s26 offen offset:1024
    s_add_u32 s26, s26, 8192
    buffer_load_dwordx4 v[168:171], v2, s[68:71], s26 offen offset:0
    buffer_load_dwordx4 v[172:175], v2, s[68:71], s26 offen offset:1024
    s_add_u32 s26, s26, 8192
    s_add_u32 s25, s25, 7
    s_mov_b32 s70, 846615568
    s_mov_b32 s71, 14395788
    s_lshl_b32 s27, s25, 2
    s_lshr_b64 s[70:71], s[70:71], s27
    s_and_b32 s27, s70, 15
    s_cmp_ge_u32 s27, 12
    s_cbranch_scc1 nowarm_m_182
    s_lshr_b32 s26, s27, 2
    s_cmp_eq_u32 s26, 1
    s_cselect_b64 s[66:67], s[62:63], s[60:61]
    s_cmp_eq_u32 s26, 2
    s_cselect_b64 s[66:67], s[64:65], s[66:67]
    s_mov_b32 s68, s66
    s_and_b32 s69, s67, 65535
    s_mov_b32 s70, 4718592
    s_mov_b32 s71, 131072
    s_and_b32 s26, s27, 3
    s_lshl_b32 s26, s26, 11
    s_add_u32 s26, s26, s24
    buffer_load_dwordx4 v[176:179], v2, s[68:71], s26 offen offset:0
    buffer_load_dwordx4 v[180:183], v2, s[68:71], s26 offen offset:1024
    s_add_u32 s26, s26, 8192
    buffer_load_dwordx4 v[184:187], v2, s[68:71], s26 offen offset:0
    buffer_load_dwordx4 v[188:191], v2, s[68:71], s26 offen offset:1024
    s_add_u32 s26, s26, 8192
    buffer_load_dwordx4 v[192:195], v2, s[68:71], s26 offen offset:0
    buffer_load_dwordx4 v[196:199], v2, s[68:71], s26 offen offset:1024
    s_add_u32 s26, s26, 8192
    buffer_load_dwordx4 v[200:203], v2, s[68:71], s26 offen offset:0
    buffer_load_dwordx4 v[204:207], v2, s[68:71], s26 offen offset:1024
    s_add_u32 s26, s26, 8192
    buffer_load_dwordx4 v[208:211], v2, s[68:71], s26 offen offset:0
    buffer_load_dwordx4 v[212:215], v2, s[68:71], s26 offen offset:1024
    s_add_u32 s26, s26, 8192
    buffer_load_dwordx4 v[216:219], v2, s[68:71], s26 offen offset:0
    buffer_load_dwordx4 v[220:223], v2, s[68:71], s26 offen offset:1024
    s_add_u32 s26, s26, 8192
nowarm_m_182:
    s_waitcnt vmcnt(0)
    s_lshl_b32 s44, s20, 2
    s_add_u32 s44, s44, s21
    s_and_b32 s45, s44, 7
    s_lshr_b32 s22, s44, 3
    s_mov_b32 s50, 16256
    s_mov_b32 s51, 1065353216
    v_lshrrev_b32 v14, 4, v1
    v_bfe_u32 v15, v1, 2, 2
    v_and_b32 v3, 3, v1
    v_lshlrev_b32 v12, 11, v14
    v_lshl_add_u32 v12, v15, 8, v12
    v_lshl_add_u32 v4, v3, 4, v12
    v_mul_u32_u24 v12, 9216, v14
    v_lshl_add_u32 v12, v15, 7, v12
    v_lshl_add_u32 v5, v3, 3, v12
    v_mul_u32_u24 v13, 1152, v3
    v_lshl_add_u32 v12, v14, 3, v15
    v_lshl_add_u32 v6, v12, 3, v13
    v_mul_u32_u24 v12, 36, v14
    v_add_u32 v12, v12, v15
    v_add_u32 v12, 32, v12
    v_lshl_add_u32 v7, v12, 3, v13
    s_lshr_b32 s24, s45, 2
    s_and_b32 s25, s45, 3
    s_lshl_b32 s46, s24, 10
    s_lshl_b32 s26, s25, 6
    s_add_u32 s46, s46, s26
    s_lshl_b32 s49, s24, 9
    s_lshl_b32 s26, s25, 5
    s_add_u32 s49, s49, s26
    s_add_u32 s49, s49, 8192
    s_mov_b32 s8, s34
    s_and_b32 s9, s35, 65535
    s_mov_b32 s10, 1152
    s_mov_b32 s11, 131072
    s_mov_b32 s12, s36
    s_and_b32 s13, s37, 65535
    s_mov_b32 s14, 2359296
    s_mov_b32 s15, 131072
    v_sub_u32 v12, v6, v13
    v_sub_u32 v13, v7, v13
    buffer_load_dwordx2 v[52:53], v12, s[8:11], 0 offen offset:0
    buffer_load_dwordx2 v[54:55], v12, s[8:11], 0 offen offset:32
    buffer_load_dwordx2 v[56:57], v12, s[8:11], 0 offen offset:288
    buffer_load_dwordx2 v[58:59], v12, s[8:11], 0 offen offset:320
    buffer_load_dwordx2 v[60:61], v12, s[8:11], 0 offen offset:576
    buffer_load_dwordx2 v[62:63], v12, s[8:11], 0 offen offset:608
    buffer_load_dwordx2 v[64:65], v12, s[8:11], 0 offen offset:864
    buffer_load_dwordx2 v[66:67], v12, s[8:11], 0 offen offset:896
    buffer_load_dwordx2 v[68:69], v13, s[8:11], 0 offen offset:0
    s_waitcnt vmcnt(8)
    v_lshlrev_b32 v220, 16, v52
    v_and_b32 v221, 4294901760, v52
    v_lshlrev_b32 v222, 16, v53
    v_and_b32 v223, 4294901760, v53
    s_waitcnt vmcnt(7)
    v_lshlrev_b32 v224, 16, v54
    v_and_b32 v225, 4294901760, v54
    v_lshlrev_b32 v226, 16, v55
    v_and_b32 v227, 4294901760, v55
    s_waitcnt vmcnt(6)
    v_lshlrev_b32 v228, 16, v56
    v_and_b32 v229, 4294901760, v56
    v_lshlrev_b32 v230, 16, v57
    v_and_b32 v231, 4294901760, v57
    s_waitcnt vmcnt(5)
    v_lshlrev_b32 v232, 16, v58
    v_and_b32 v233, 4294901760, v58
    v_lshlrev_b32 v234, 16, v59
    v_and_b32 v235, 4294901760, v59
    s_waitcnt vmcnt(4)
    v_lshlrev_b32 v236, 16, v60
    v_and_b32 v237, 4294901760, v60
    v_lshlrev_b32 v238, 16, v61
    v_and_b32 v239, 4294901760, v61
    s_waitcnt vmcnt(3)
    v_lshlrev_b32 v240, 16, v62
    v_and_b32 v241, 4294901760, v62
    v_lshlrev_b32 v242, 16, v63
    v_and_b32 v243, 4294901760, v63
    s_waitcnt vmcnt(2)
    v_lshlrev_b32 v244, 16, v64
    v_and_b32 v245, 4294901760, v64
    v_lshlrev_b32 v246, 16, v65
    v_and_b32 v247, 4294901760, v65
    s_waitcnt vmcnt(1)
    v_lshlrev_b32 v248, 16, v66
    v_and_b32 v249, 4294901760, v66
    v_lshlrev_b32 v250, 16, v67
    v_and_b32 v251, 4294901760, v67
    s_waitcnt vmcnt(0)
    v_lshlrev_b32 v252, 16, v68
    v_and_b32 v253, 4294901760, v68
    v_lshlrev_b32 v254, 16, v69
    v_and_b32 v255, 4294901760, v69
    s_load_dwordx2 s[30:31], s[0:1], 104
    s_waitcnt lgkmcnt(0)
    s_mov_b32 s16, s30
    s_and_b32 s17, s31, 65535
    s_mov_b32 s18, 256
    s_mov_b32 s19, 131072
L_m_183:
    s_sub_u32 s23, s23, 1
    s_cbranch_scc1 abred2_m_181
    buffer_load_dword v3, off, s[16:19], 0 offset:64 sc1
    s_waitcnt vmcnt(0)
    v_cmp_eq_u32 vcc, 0, v3
    s_nop 0
    s_cbranch_vccnz L_m_183
L_m_184:
    s_lshl_b32 s47, s22, 3
    s_add_u32 s47, s47, s45
    s_mul_i32 s48, s47, 9216
    s_add_u32 s48, s48, 117440512
    s_mul_i32 s47, s47, 4608
    s_waitcnt vmcnt(0)
    s_max_u32 s28, s22, 3
    s_sub_u32 s28, s28, 3
    s_add_u32 s28, s22, 1
    s_and_b32 s27, s22, 1
    s_lshl_b32 s27, s27, 1
    s_lshr_b32 s26, s45, 2
    s_add_u32 s27, s27, s26
    s_lshl_b32 s27, s27, 6
    v_min_u32 v10, 35, v1
    v_mul_u32_u24 v10, 4, v10
    s_lshr_b32 s29, s27, 6
    s_lshl_b32 s29, s29, 8
    s_and_b32 s92, s27, 63
    s_lshl_b32 s92, s92, 2
    s_add_u32 s29, s29, s92
    s_add_u32 s29, s29, 184310784
    buffer_load_dword v11, v10, s[4:7], s29 offen sc1
    s_waitcnt vmcnt(0)
    v_cmp_gt_u32 vcc, s28, v11
    s_nop 0
    s_cbranch_vccz fok_m_185
L_m_186:
    s_sleep 8
    s_sub_u32 s23, s23, 1
    s_cbranch_scc1 abred2_m_181
    buffer_load_dword v11, v10, s[4:7], s29 offen sc1
    s_waitcnt vmcnt(0)
    v_cmp_gt_u32 vcc, s28, v11
    s_nop 0
    s_cbranch_vccnz L_m_186
fok_m_185:
    s_mul_i32 s24, s22, 331776
    s_add_u32 s24, s24, 218103808
    s_add_u32 s27, s24, s49
    s_add_u32 s24, s24, s46
    s_add_u32 s25, s48, 4096
    s_add_u32 s26, s48, 8192
    buffer_load_dwordx4 v[16:19], v2, s[4:7], s48 offen offset:0
    buffer_load_dwordx4 v[20:23], v2, s[4:7], s48 offen offset:1024
    buffer_load_dwordx4 v[24:27], v2, s[4:7], s48 offen offset:2048
    buffer_load_dwordx4 v[28:31], v2, s[4:7], s48 offen offset:3072
    buffer_load_dwordx4 v[32:35], v2, s[4:7], s25 offen offset:0
    buffer_load_dwordx4 v[36:39], v2, s[4:7], s25 offen offset:1024
    buffer_load_dwordx4 v[40:43], v2, s[4:7], s25 offen offset:2048
    buffer_load_dwordx4 v[44:47], v2, s[4:7], s25 offen offset:3072
    buffer_load_dwordx4 v[48:51], v2, s[4:7], s26 offen offset:0
    buffer_load_dwordx4 v[72:75], v4, s[4:7], s24 offen
    s_add_u32 s24, s24, 9216
    buffer_load_dwordx4 v[76:79], v4, s[4:7], s24 offen
    s_add_u32 s24, s24, 9216
    buffer_load_dwordx4 v[80:83], v4, s[4:7], s24 offen
    s_add_u32 s24, s24, 9216
    buffer_load_dwordx4 v[84:87], v4, s[4:7], s24 offen
    s_add_u32 s24, s24, 9216
    buffer_load_dwordx2 v[52:53], v5, s[4:7], s27 offen
    s_add_u32 s27, s27, 36864
    buffer_load_dwordx4 v[88:91], v4, s[4:7], s24 offen
    s_add_u32 s24, s24, 9216
    buffer_load_dwordx4 v[92:95], v4, s[4:7], s24 offen
    s_add_u32 s24, s24, 9216
    buffer_load_dwordx4 v[96:99], v4, s[4:7], s24 offen
    s_add_u32 s24, s24, 9216
    buffer_load_dwordx4 v[100:103], v4, s[4:7], s24 offen
    s_add_u32 s24, s24, 9216
    buffer_load_dwordx2 v[54:55], v5, s[4:7], s27 offen
    s_add_u32 s27, s27, 36864
    buffer_load_dwordx4 v[104:107], v4, s[4:7], s24 offen
    s_add_u32 s24, s24, 9216
    buffer_load_dwordx4 v[108:111], v4, s[4:7], s24 offen
    s_add_u32 s24, s24, 9216
    buffer_load_dwordx4 v[112:115], v4, s[4:7], s24 offen
    s_add_u32 s24, s24, 9216
    buffer_load_dwordx4 v[116:119], v4, s[4:7], s24 offen
    s_add_u32 s24, s24, 9216
    buffer_load_dwordx2 v[56:57], v5, s[4:7], s27 offen
    s_add_u32 s27, s27, 36864
    buffer_load_dwordx4 v[120:123], v4, s[4:7], s24 offen
    s_add_u32 s24, s24, 9216
    buffer_load_dwordx4 v[124:127], v4, s[4:7], s24 offen
    s_add_u32 s24, s24, 9216
    buffer_load_dwordx4 v[128:131], v4, s[4:7], s24 offen
    s_add_u32 s24, s24, 9216
    buffer_load_dwordx4 v[132:135], v4, s[4:7], s24 offen
    s_add_u32 s24, s24, 9216
    buffer_load_dwordx2 v[58:59], v5, s[4:7], s27 offen
    s_add_u32 s27, s27, 36864
    buffer_load_dwordx4 v[136:139], v4, s[4:7], s24 offen
    s_add_u32 s24, s24, 9216
    buffer_load_dwordx4 v[140:143], v4, s[4:7], s24 offen
    s_add_u32 s24, s24, 9216
    buffer_load_dwordx4 v[144:147], v4, s[4:7], s24 offen
    s_add_u32 s24, s24, 9216
    buffer_load_dwordx4 v[148:151], v4, s[4:7], s24 offen
    s_add_u32 s24, s24, 9216
    buffer_load_dwordx2 v[60:61], v5, s[4:7], s27 offen
    s_add_u32 s27, s27, 36864
    buffer_load_dwordx4 v[152:155], v4, s[4:7], s24 offen
    s_add_u32 s24, s24, 9216
    buffer_load_dwordx4 v[156:159], v4, s[4:7], s24 offen
    s_add_u32 s24, s24, 9216
    buffer_load_dwordx4 v[160:163], v4, s[4:7], s24 offen
    s_add_u32 s24, s24, 9216
    buffer_load_dwordx4 v[164:167], v4, s[4:7], s24 offen
    s_add_u32 s24, s24, 9216
    buffer_load_dwordx2 v[62:63], v5, s[4:7], s27 offen
    s_add_u32 s27, s27, 36864
    buffer_load_dwordx4 v[168:171], v4, s[4:7], s24 offen
    s_add_u32 s24, s24, 9216
    buffer_load_dwordx4 v[172:175], v4, s[4:7], s24 offen
    s_add_u32 s24, s24, 9216
    buffer_load_dwordx4 v[176:179], v4, s[4:7], s24 offen
    s_add_u32 s24, s24, 9216
    buffer_load_dwordx4 v[180:183], v4, s[4:7], s24 offen
    s_add_u32 s24, s24, 9216
    buffer_load_dwordx2 v[64:65], v5, s[4:7], s27 offen
    s_add_u32 s27, s27, 36864
    buffer_load_dwordx4 v[184:187], v4, s[4:7], s24 offen
    s_add_u32 s24, s24, 9216
    buffer_load_dwordx4 v[188:191], v4, s[4:7], s24 offen
    s_add_u32 s24, s24, 9216
    buffer_load_dwordx4 v[192:195], v4, s[4:7], s24 offen
    s_add_u32 s24, s24, 9216
    buffer_load_dwordx4 v[196:199], v4, s[4:7], s24 offen
    s_add_u32 s24, s24, 9216
    buffer_load_dwordx2 v[66:67], v5, s[4:7], s27 offen
    s_add_u32 s27, s27, 36864
    buffer_load_dwordx4 v[200:203], v4, s[4:7], s24 offen
    s_add_u32 s24, s24, 9216
    buffer_load_dwordx4 v[204:207], v4, s[4:7], s24 offen
    s_add_u32 s24, s24, 9216
    buffer_load_dwordx4 v[208:211], v4, s[4:7], s24 offen
    s_add_u32 s24, s24, 9216
    buffer_load_dwordx4 v[212:215], v4, s[4:7], s24 offen
    s_add_u32 s24, s24, 9216
    buffer_load_dwordx2 v[68:69], v5, s[4:7], s27 offen
    s_add_u32 s27, s27, 36864
    s_waitcnt vmcnt(53)
    v_pk_add_f32 v[16:17], v[16:17], v[220:221]
    v_pk_add_f32 v[18:19], v[18:19], v[222:223]
    s_waitcnt vmcnt(52)
    v_pk_add_f32 v[20:21], v[20:21], v[224:225]
    v_pk_add_f32 v[22:23], v[22:23], v[226:227]
    s_waitcnt vmcnt(51)
    v_pk_add_f32 v[24:25], v[24:25], v[228:229]
    v_pk_add_f32 v[26:27], v[26:27], v[230:231]
    s_waitcnt vmcnt(50)
    v_pk_add_f32 v[28:29], v[28:29], v[232:233]
    v_pk_add_f32 v[30:31], v[30:31], v[234:235]
    s_waitcnt vmcnt(49)
    v_pk_add_f32 v[32:33], v[32:33], v[236:237]
    v_pk_add_f32 v[34:35], v[34:35], v[238:239]
    s_waitcnt vmcnt(48)
    v_pk_add_f32 v[36:37], v[36:37], v[240:241]
    v_pk_add_f32 v[38:39], v[38:39], v[242:243]
    s_waitcnt vmcnt(47)
    v_pk_add_f32 v[40:41], v[40:41], v[244:245]
    v_pk_add_f32 v[42:43], v[42:43], v[246:247]
    s_waitcnt vmcnt(46)
    v_pk_add_f32 v[44:45], v[44:45], v[248:249]
    v_pk_add_f32 v[46:47], v[46:47], v[250:251]
    s_waitcnt vmcnt(45)
    v_pk_add_f32 v[48:49], v[48:49], v[252:253]
    v_pk_add_f32 v[50:51], v[50:51], v[254:255]
    s_waitcnt vmcnt(44)
    v_dot2c_f32_bf16 v16, s50, v72
    v_dot2c_f32_bf16 v17, s51, v72
    v_dot2c_f32_bf16 v18, s50, v73
    v_dot2c_f32_bf16 v19, s51, v73
    v_dot2c_f32_bf16 v20, s50, v74
    v_dot2c_f32_bf16 v21, s51, v74
    v_dot2c_f32_bf16 v22, s50, v75
    v_dot2c_f32_bf16 v23, s51, v75
    s_waitcnt vmcnt(43)
    v_dot2c_f32_bf16 v24, s50, v76
    v_dot2c_f32_bf16 v25, s51, v76
    v_dot2c_f32_bf16 v26, s50, v77
    v_dot2c_f32_bf16 v27, s51, v77
    v_dot2c_f32_bf16 v28, s50, v78
    v_dot2c_f32_bf16 v29, s51, v78
    v_dot2c_f32_bf16 v30, s50, v79
    v_dot2c_f32_bf16 v31, s51, v79
    s_waitcnt vmcnt(42)
    v_dot2c_f32_bf16 v32, s50, v80
    v_dot2c_f32_bf16 v33, s51, v80
    v_dot2c_f32_bf16 v34, s50, v81
    v_dot2c_f32_bf16 v35, s51, v81
    v_dot2c_f32_bf16 v36, s50, v82
    v_dot2c_f32_bf16 v37, s51, v82
    v_dot2c_f32_bf16 v38, s50, v83
    v_dot2c_f32_bf16 v39, s51, v83
    s_waitcnt vmcnt(41)
    v_dot2c_f32_bf16 v40, s50, v84
    v_dot2c_f32_bf16 v41, s51, v84
    v_dot2c_f32_bf16 v42, s50, v85
    v_dot2c_f32_bf16 v43, s51, v85
    v_dot2c_f32_bf16 v44, s50, v86
    v_dot2c_f32_bf16 v45, s51, v86
    v_dot2c_f32_bf16 v46, s50, v87
    v_dot2c_f32_bf16 v47, s51, v87
    s_waitcnt vmcnt(40)
    v_dot2c_f32_bf16 v48, s50, v52
    v_dot2c_f32_bf16 v49, s51, v52
    v_dot2c_f32_bf16 v50, s50, v53
    v_dot2c_f32_bf16 v51, s51, v53
    s_waitcnt vmcnt(39)
    v_dot2c_f32_bf16 v16, s50, v88
    v_dot2c_f32_bf16 v17, s51, v88
    v_dot2c_f32_bf16 v18, s50, v89
    v_dot2c_f32_bf16 v19, s51, v89
    v_dot2c_f32_bf16 v20, s50, v90
    v_dot2c_f32_bf16 v21, s51, v90
    v_dot2c_f32_bf16 v22, s50, v91
    v_dot2c_f32_bf16 v23, s51, v91
    s_waitcnt vmcnt(38)
    v_dot2c_f32_bf16 v24, s50, v92
    v_dot2c_f32_bf16 v25, s51, v92
    v_dot2c_f32_bf16 v26, s50, v93
    v_dot2c_f32_bf16 v27, s51, v93
    v_dot2c_f32_bf16 v28, s50, v94
    v_dot2c_f32_bf16 v29, s51, v94
    v_dot2c_f32_bf16 v30, s50, v95
    v_dot2c_f32_bf16 v31, s51, v95
    s_waitcnt vmcnt(37)
    v_dot2c_f32_bf16 v32, s50, v96
    v_dot2c_f32_bf16 v33, s51, v96
    v_dot2c_f32_bf16 v34, s50, v97
    v_dot2c_f32_bf16 v35, s51, v97
    v_dot2c_f32_bf16 v36, s50, v98
    v_dot2c_f32_bf16 v37, s51, v98
    v_dot2c_f32_bf16 v38, s50, v99
    v_dot2c_f32_bf16 v39, s51, v99
    s_waitcnt vmcnt(36)
    v_dot2c_f32_bf16 v40, s50, v100
    v_dot2c_f32_bf16 v41, s51, v100
    v_dot2c_f32_bf16 v42, s50, v101
    v_dot2c_f32_bf16 v43, s51, v101
    v_dot2c_f32_bf16 v44, s50, v102
    v_dot2c_f32_bf16 v45, s51, v102
    v_dot2c_f32_bf16 v46, s50, v103
    v_dot2c_f32_bf16 v47, s51, v103
    s_waitcnt vmcnt(35)
    v_dot2c_f32_bf16 v48, s50, v54
    v_dot2c_f32_bf16 v49, s51, v54
    v_dot2c_f32_bf16 v50, s50, v55
    v_dot2c_f32_bf16 v51, s51, v55
    s_waitcnt vmcnt(34)
    v_dot2c_f32_bf16 v16, s50, v104
    v_dot2c_f32_bf16 v17, s51, v104
    v_dot2c_f32_bf16 v18, s50, v105
    v_dot2c_f32_bf16 v19, s51, v105
    v_dot2c_f32_bf16 v20, s50, v106
    v_dot2c_f32_bf16 v21, s51, v106
    v_dot2c_f32_bf16 v22, s50, v107
    v_dot2c_f32_bf16 v23, s51, v107
    s_waitcnt vmcnt(33)
    v_dot2c_f32_bf16 v24, s50, v108
    v_dot2c_f32_bf16 v25, s51, v108
    v_dot2c_f32_bf16 v26, s50, v109
    v_dot2c_f32_bf16 v27, s51, v109
    v_dot2c_f32_bf16 v28, s50, v110
    v_dot2c_f32_bf16 v29, s51, v110
    v_dot2c_f32_bf16 v30, s50, v111
    v_dot2c_f32_bf16 v31, s51, v111
    s_waitcnt vmcnt(32)
    v_dot2c_f32_bf16 v32, s50, v112
    v_dot2c_f32_bf16 v33, s51, v112
    v_dot2c_f32_bf16 v34, s50, v113
    v_dot2c_f32_bf16 v35, s51, v113
    v_dot2c_f32_bf16 v36, s50, v114
    v_dot2c_f32_bf16 v37, s51, v114
    v_dot2c_f32_bf16 v38, s50, v115
    v_dot2c_f32_bf16 v39, s51, v115
    s_waitcnt vmcnt(31)
    v_dot2c_f32_bf16 v40, s50, v116
    v_dot2c_f32_bf16 v41, s51, v116
    v_dot2c_f32_bf16 v42, s50, v117
    v_dot2c_f32_bf16 v43, s51, v117
    v_dot2c_f32_bf16 v44, s50, v118
    v_dot2c_f32_bf16 v45, s51, v118
    v_dot2c_f32_bf16 v46, s50, v119
    v_dot2c_f32_bf16 v47, s51, v119
    s_waitcnt vmcnt(30)
    v_dot2c_f32_bf16 v48, s50, v56
    v_dot2c_f32_bf16 v49, s51, v56
    v_dot2c_f32_bf16 v50, s50, v57
    v_dot2c_f32_bf16 v51, s51, v57
    s_waitcnt vmcnt(29)
    v_dot2c_f32_bf16 v16, s50, v120
    v_dot2c_f32_bf16 v17, s51, v120
    v_dot2c_f32_bf16 v18, s50, v121
    v_dot2c_f32_bf16 v19, s51, v121
    v_dot2c_f32_bf16 v20, s50, v122
    v_dot2c_f32_bf16 v21, s51, v122
    v_dot2c_f32_bf16 v22, s50, v123
    v_dot2c_f32_bf16 v23, s51, v123
    s_waitcnt vmcnt(28)
    v_dot2c_f32_bf16 v24, s50, v124
    v_dot2c_f32_bf16 v25, s51, v124
    v_dot2c_f32_bf16 v26, s50, v125
    v_dot2c_f32_bf16 v27, s51, v125
    v_dot2c_f32_bf16 v28, s50, v126
    v_dot2c_f32_bf16 v29, s51, v126
    v_dot2c_f32_bf16 v30, s50, v127
    v_dot2c_f32_bf16 v31, s51, v127
    s_waitcnt vmcnt(27)
    v_dot2c_f32_bf16 v32, s50, v128
    v_dot2c_f32_bf16 v33, s51, v128
    v_dot2c_f32_bf16 v34, s50, v129
    v_dot2c_f32_bf16 v35, s51, v129
    v_dot2c_f32_bf16 v36, s50, v130
    v_dot2c_f32_bf16 v37, s51, v130
    v_dot2c_f32_bf16 v38, s50, v131
    v_dot2c_f32_bf16 v39, s51, v131
    s_waitcnt vmcnt(26)
    v_dot2c_f32_bf16 v40, s50, v132
    v_dot2c_f32_bf16 v41, s51, v132
    v_dot2c_f32_bf16 v42, s50, v133
    v_dot2c_f32_bf16 v43, s51, v133
    v_dot2c_f32_bf16 v44, s50, v134
    v_dot2c_f32_bf16 v45, s51, v134
    v_dot2c_f32_bf16 v46, s50, v135
    v_dot2c_f32_bf16 v47, s51, v135
    s_waitcnt vmcnt(25)
    v_dot2c_f32_bf16 v48, s50, v58
    v_dot2c_f32_bf16 v49, s51, v58
    v_dot2c_f32_bf16 v50, s50, v59
    v_dot2c_f32_bf16 v51, s51, v59
    s_waitcnt vmcnt(24)
    v_dot2c_f32_bf16 v16, s50, v136
    v_dot2c_f32_bf16 v17, s51, v136
    v_dot2c_f32_bf16 v18, s50, v137
    v_dot2c_f32_bf16 v19, s51, v137
    v_dot2c_f32_bf16 v20, s50, v138
    v_dot2c_f32_bf16 v21, s51, v138
    v_dot2c_f32_bf16 v22, s50, v139
    v_dot2c_f32_bf16 v23, s51, v139
    s_waitcnt vmcnt(23)
    v_dot2c_f32_bf16 v24, s50, v140
    v_dot2c_f32_bf16 v25, s51, v140
    v_dot2c_f32_bf16 v26, s50, v141
    v_dot2c_f32_bf16 v27, s51, v141
    v_dot2c_f32_bf16 v28, s50, v142
    v_dot2c_f32_bf16 v29, s51, v142
    v_dot2c_f32_bf16 v30, s50, v143
    v_dot2c_f32_bf16 v31, s51, v143
    s_waitcnt vmcnt(22)
    v_dot2c_f32_bf16 v32, s50, v144
    v_dot2c_f32_bf16 v33, s51, v144
    v_dot2c_f32_bf16 v34, s50, v145
    v_dot2c_f32_bf16 v35, s51, v145
    v_dot2c_f32_bf16 v36, s50, v146
    v_dot2c_f32_bf16 v37, s51, v146
    v_dot2c_f32_bf16 v38, s50, v147
    v_dot2c_f32_bf16 v39, s51, v147
    s_waitcnt vmcnt(21)
    v_dot2c_f32_bf16 v40, s50, v148
    v_dot2c_f32_bf16 v41, s51, v148
    v_dot2c_f32_bf16 v42, s50, v149
    v_dot2c_f32_bf16 v43, s51, v149
    v_dot2c_f32_bf16 v44, s50, v150
    v_dot2c_f32_bf16 v45, s51, v150
    v_dot2c_f32_bf16 v46, s50, v151
    v_dot2c_f32_bf16 v47, s51, v151
    s_waitcnt vmcnt(20)
    v_dot2c_f32_bf16 v48, s50, v60
    v_dot2c_f32_bf16 v49, s51, v60
    v_dot2c_f32_bf16 v50, s50, v61
    v_dot2c_f32_bf16 v51, s51, v61
    s_waitcnt vmcnt(19)
    v_dot2c_f32_bf16 v16, s50, v152
    v_dot2c_f32_bf16 v17, s51, v152
    v_dot2c_f32_bf16 v18, s50, v153
    v_dot2c_f32_bf16 v19, s51, v153
    v_dot2c_f32_bf16 v20, s50, v154
    v_dot2c_f32_bf16 v21, s51, v154
    v_dot2c_f32_bf16 v22, s50, v155
    v_dot2c_f32_bf16 v23, s51, v155
    s_waitcnt vmcnt(18)
    v_dot2c_f32_bf16 v24, s50, v156
    v_dot2c_f32_bf16 v25, s51, v156
    v_dot2c_f32_bf16 v26, s50, v157
    v_dot2c_f32_bf16 v27, s51, v157
    v_dot2c_f32_bf16 v28, s50, v158
    v_dot2c_f32_bf16 v29, s51, v158
    v_dot2c_f32_bf16 v30, s50, v159
    v_dot2c_f32_bf16 v31, s51, v159
    s_waitcnt vmcnt(17)
    v_dot2c_f32_bf16 v32, s50, v160
    v_dot2c_f32_bf16 v33, s51, v160
    v_dot2c_f32_bf16 v34, s50, v161
    v_dot2c_f32_bf16 v35, s51, v161
    v_dot2c_f32_bf16 v36, s50, v162
    v_dot2c_f32_bf16 v37, s51, v162
    v_dot2c_f32_bf16 v38, s50, v163
    v_dot2c_f32_bf16 v39, s51, v163
    s_waitcnt vmcnt(16)
    v_dot2c_f32_bf16 v40, s50, v164
    v_dot2c_f32_bf16 v41, s51, v164
    v_dot2c_f32_bf16 v42, s50, v165
    v_dot2c_f32_bf16 v43, s51, v165
    v_dot2c_f32_bf16 v44, s50, v166
    v_dot2c_f32_bf16 v45, s51, v166
    v_dot2c_f32_bf16 v46, s50, v167
    v_dot2c_f32_bf16 v47, s51, v167
    s_waitcnt vmcnt(15)
    v_dot2c_f32_bf16 v48, s50, v62
    v_dot2c_f32_bf16 v49, s51, v62
    v_dot2c_f32_bf16 v50, s50, v63
    v_dot2c_f32_bf16 v51, s51, v63
    s_waitcnt vmcnt(14)
    v_dot2c_f32_bf16 v16, s50, v168
    v_dot2c_f32_bf16 v17, s51, v168
    v_dot2c_f32_bf16 v18, s50, v169
    v_dot2c_f32_bf16 v19, s51, v169
    v_dot2c_f32_bf16 v20, s50, v170
    v_dot2c_f32_bf16 v21, s51, v170
    v_dot2c_f32_bf16 v22, s50, v171
    v_dot2c_f32_bf16 v23, s51, v171
    s_waitcnt vmcnt(13)
    v_dot2c_f32_bf16 v24, s50, v172
    v_dot2c_f32_bf16 v25, s51, v172
    v_dot2c_f32_bf16 v26, s50, v173
    v_dot2c_f32_bf16 v27, s51, v173
    v_dot2c_f32_bf16 v28, s50, v174
    v_dot2c_f32_bf16 v29, s51, v174
    v_dot2c_f32_bf16 v30, s50, v175
    v_dot2c_f32_bf16 v31, s51, v175
    s_waitcnt vmcnt(12)
    v_dot2c_f32_bf16 v32, s50, v176
    v_dot2c_f32_bf16 v33, s51, v176
    v_dot2c_f32_bf16 v34, s50, v177
    v_dot2c_f32_bf16 v35, s51, v177
    v_dot2c_f32_bf16 v36, s50, v178
    v_dot2c_f32_bf16 v37, s51, v178
    v_dot2c_f32_bf16 v38, s50, v179
    v_dot2c_f32_bf16 v39, s51, v179
    s_waitcnt vmcnt(11)
    v_dot2c_f32_bf16 v40, s50, v180
    v_dot2c_f32_bf16 v41, s51, v180
    v_dot2c_f32_bf16 v42, s50, v181
    v_dot2c_f32_bf16 v43, s51, v181
    v_dot2c_f32_bf16 v44, s50, v182
    v_dot2c_f32_bf16 v45, s51, v182
    v_dot2c_f32_bf16 v46, s50, v183
    v_dot2c_f32_bf16 v47, s51, v183
    s_waitcnt vmcnt(10)
    v_dot2c_f32_bf16 v48, s50, v64
    v_dot2c_f32_bf16 v49, s51, v64
    v_dot2c_f32_bf16 v50, s50, v65
    v_dot2c_f32_bf16 v51, s51, v65
    s_waitcnt vmcnt(9)
    v_dot2c_f32_bf16 v16, s50, v184
    v_dot2c_f32_bf16 v17, s51, v184
    v_dot2c_f32_bf16 v18, s50, v185
    v_dot2c_f32_bf16 v19, s51, v185
    v_dot2c_f32_bf16 v20, s50, v186
    v_dot2c_f32_bf16 v21, s51, v186
    v_dot2c_f32_bf16 v22, s50, v187
    v_dot2c_f32_bf16 v23, s51, v187
    s_waitcnt vmcnt(8)
    v_dot2c_f32_bf16 v24, s50, v188
    v_dot2c_f32_bf16 v25, s51, v188
    v_dot2c_f32_bf16 v26, s50, v189
    v_dot2c_f32_bf16 v27, s51, v189
    v_dot2c_f32_bf16 v28, s50, v190
    v_dot2c_f32_bf16 v29, s51, v190
    v_dot2c_f32_bf16 v30, s50, v191
    v_dot2c_f32_bf16 v31, s51, v191
    s_waitcnt vmcnt(7)
    v_dot2c_f32_bf16 v32, s50, v192
    v_dot2c_f32_bf16 v33, s51, v192
    v_dot2c_f32_bf16 v34, s50, v193
    v_dot2c_f32_bf16 v35, s51, v193
    v_dot2c_f32_bf16 v36, s50, v194
    v_dot2c_f32_bf16 v37, s51, v194
    v_dot2c_f32_bf16 v38, s50, v195
    v_dot2c_f32_bf16 v39, s51, v195
    s_waitcnt vmcnt(6)
    v_dot2c_f32_bf16 v40, s50, v196
    v_dot2c_f32_bf16 v41, s51, v196
    v_dot2c_f32_bf16 v42, s50, v197
    v_dot2c_f32_bf16 v43, s51, v197
    v_dot2c_f32_bf16 v44, s50, v198
    v_dot2c_f32_bf16 v45, s51, v198
    v_dot2c_f32_bf16 v46, s50, v199
    v_dot2c_f32_bf16 v47, s51, v199
    s_waitcnt vmcnt(5)
    v_dot2c_f32_bf16 v48, s50, v66
    v_dot2c_f32_bf16 v49, s51, v66
    v_dot2c_f32_bf16 v50, s50, v67
    v_dot2c_f32_bf16 v51, s51, v67
    s_waitcnt vmcnt(4)
    v_dot2c_f32_bf16 v16, s50, v200
    v_dot2c_f32_bf16 v17, s51, v200
    v_dot2c_f32_bf16 v18, s50, v201
    v_dot2c_f32_bf16 v19, s51, v201
    v_dot2c_f32_bf16 v20, s50, v202
    v_dot2c_f32_bf16 v21, s51, v202
    v_dot2c_f32_bf16 v22, s50, v203
    v_dot2c_f32_bf16 v23, s51, v203
    s_waitcnt vmcnt(3)
    v_dot2c_f32_bf16 v24, s50, v204
    v_dot2c_f32_bf16 v25, s51, v204
    v_dot2c_f32_bf16 v26, s50, v205
    v_dot2c_f32_bf16 v27, s51, v205
    v_dot2c_f32_bf16 v28, s50, v206
    v_dot2c_f32_bf16 v29, s51, v206
    v_dot2c_f32_bf16 v30, s50, v207
    v_dot2c_f32_bf16 v31, s51, v207
    s_waitcnt vmcnt(2)
    v_dot2c_f32_bf16 v32, s50, v208
    v_dot2c_f32_bf16 v33, s51, v208
    v_dot2c_f32_bf16 v34, s50, v209
    v_dot2c_f32_bf16 v35, s51, v209
    v_dot2c_f32_bf16 v36, s50, v210
    v_dot2c_f32_bf16 v37, s51, v210
    v_dot2c_f32_bf16 v38, s50, v211
    v_dot2c_f32_bf16 v39, s51, v211
    s_waitcnt vmcnt(1)
    v_dot2c_f32_bf16 v40, s50, v212
    v_dot2c_f32_bf16 v41, s51, v212
    v_dot2c_f32_bf16 v42, s50, v213
    v_dot2c_f32_bf16 v43, s51, v213
    v_dot2c_f32_bf16 v44, s50, v214
    v_dot2c_f32_bf16 v45, s51, v214
    v_dot2c_f32_bf16 v46, s50, v215
    v_dot2c_f32_bf16 v47, s51, v215
    s_waitcnt vmcnt(0)
    v_dot2c_f32_bf16 v48, s50, v68
    v_dot2c_f32_bf16 v49, s51, v68
    v_dot2c_f32_bf16 v50, s50, v69
    v_dot2c_f32_bf16 v51, s51, v69
    v_cvt_pk_bf16_f32 v52, v16, v17
    v_cvt_pk_bf16_f32 v53, v18, v19
    buffer_store_dwordx2 v[52:53], v6, s[12:15], s47 offen offset:0
    v_cvt_pk_bf16_f32 v54, v20, v21
    v_cvt_pk_bf16_f32 v55, v22, v23
    buffer_store_dwordx2 v[54:55], v6, s[12:15], s47 offen offset:32
    v_cvt_pk_bf16_f32 v56, v24, v25
    v_cvt_pk_bf16_f32 v57, v26, v27
    buffer_store_dwordx2 v[56:57], v6, s[12:15], s47 offen offset:288
    v_cvt_pk_bf16_f32 v58, v28, v29
    v_cvt_pk_bf16_f32 v59, v30, v31
    buffer_store_dwordx2 v[58:59], v6, s[12:15], s47 offen offset:320
    v_cvt_pk_bf16_f32 v60, v32, v33
    v_cvt_pk_bf16_f32 v61, v34, v35
    buffer_store_dwordx2 v[60:61], v6, s[12:15], s47 offen offset:576
    v_cvt_pk_bf16_f32 v62, v36, v37
    v_cvt_pk_bf16_f32 v63, v38, v39
    buffer_store_dwordx2 v[62:63], v6, s[12:15], s47 offen offset:608
    v_cvt_pk_bf16_f32 v64, v40, v41
    v_cvt_pk_bf16_f32 v65, v42, v43
    buffer_store_dwordx2 v[64:65], v6, s[12:15], s47 offen offset:864
    v_cvt_pk_bf16_f32 v66, v44, v45
    v_cvt_pk_bf16_f32 v67, v46, v47
    buffer_store_dwordx2 v[66:67], v6, s[12:15], s47 offen offset:896
    v_cvt_pk_bf16_f32 v68, v48, v49
    v_cvt_pk_bf16_f32 v69, v50, v51
    buffer_store_dwordx2 v[68:69], v7, s[12:15], s47 offen offset:0
    s_add_u32 s22, s22, 4
    s_cmp_lt_u32 s22, 52
    s_cbranch_scc1 L_m_184
    s_waitcnt vmcnt(0)
    s_sub_u32 s28, s22, 3
    s_endpgm
abred2_m_181:
    s_endpgm
nred2_m_180:
    s_sub_u32 s20, s20, 8
    s_cmp_ge_u32 s20, 1
    s_cbranch_scc1 ninit_m_187
    s_load_dwordx2 s[32:33], s[0:1], 112
    v_lshrrev_b32 v3, 6, v0
    s_nop 0
    v_readfirstlane_b32 s21, v3
    v_and_b32 v1, 63, v0
    v_lshlrev_b32 v2, 4, v1
    s_mov_b32 s23, 4194304
    s_waitcnt lgkmcnt(0)
    s_mov_b32 s4, s32
    s_and_b32 s5, s33, 65535
    s_mov_b32 s6, 268435456
    s_mov_b32 s7, 131072
    s_cmp_lg_u32 s21, 0
    s_cbranch_scc1 abinit_m_188
    s_load_dwordx2 s[30:31], s[0:1], 104
    v_mov_b32 v4, 0
    v_mov_b32 v5, 0
    v_mov_b32 v6, 0
    v_mov_b32 v7, 0
    s_mov_b32 s24, 184287232
    buffer_store_dwordx4 v[4:7], v2, s[4:7], s24 offen offset:0 sc1
    buffer_store_dwordx4 v[4:7], v2, s[4:7], s24 offen offset:1024 sc1
    buffer_store_dwordx4 v[4:7], v2, s[4:7], s24 offen offset:2048 sc1
    buffer_store_dwordx4 v[4:7], v2, s[4:7], s24 offen offset:3072 sc1
    s_add_u32 s24, s24, 4096
    buffer_store_dwordx4 v[4:7], v2, s[4:7], s24 offen offset:0 sc1
    buffer_store_dwordx4 v[4:7], v2, s[4:7], s24 offen offset:1024 sc1
    buffer_store_dwordx4 v[4:7], v2, s[4:7], s24 offen offset:2048 sc1
    buffer_store_dwordx4 v[4:7], v2, s[4:7], s24 offen offset:3072 sc1
    s_add_u32 s24, s24, 4096
    buffer_store_dwordx4 v[4:7], v2, s[4:7], s24 offen offset:0 sc1
    buffer_store_dwordx4 v[4:7], v2, s[4:7], s24 offen offset:1024 sc1
    buffer_store_dwordx4 v[4:7], v2, s[4:7], s24 offen offset:2048 sc1
    buffer_store_dwordx4 v[4:7], v2, s[4:7], s24 offen offset:3072 sc1
    s_add_u32 s24, s24, 4096
    buffer_store_dwordx4 v[4:7], v2, s[4:7], s24 offen offset:0 sc1
    buffer_store_dwordx4 v[4:7], v2, s[4:7], s24 offen offset:1024 sc1
    buffer_store_dwordx4 v[4:7], v2, s[4:7], s24 offen offset:2048 sc1
    buffer_store_dwordx4 v[4:7], v2, s[4:7], s24 offen offset:3072 sc1
    s_add_u32 s24, s24, 4096
    buffer_store_dwordx4 v[4:7], v2, s[4:7], s24 offen offset:0 sc1
    buffer_store_dwordx4 v[4:7], v2, s[4:7], s24 offen offset:1024 sc1
    buffer_store_dwordx4 v[4:7], v2, s[4:7], s24 offen offset:2048 sc1
    buffer_store_dwordx4 v[4:7], v2, s[4:7], s24 offen offset:3072 sc1
    s_add_u32 s24, s24, 4096
    buffer_store_dwordx4 v[4:7], v2, s[4:7], s24 offen offset:0 sc1
    buffer_store_dwordx4 v[4:7], v2, s[4:7], s24 offen offset:1024 sc1
    buffer_store_dwordx4 v[4:7], v2, s[4:7], s24 offen offset:2048 sc1
    buffer_store_dwordx4 v[4:7], v2, s[4:7], s24 offen offset:3072 sc1
    s_add_u32 s24, s24, 4096
    buffer_store_dwordx4 v[4:7], v2, s[4:7], s24 offen offset:0 sc1
    buffer_store_dwordx4 v[4:7], v2, s[4:7], s24 offen offset:1024 sc1
    buffer_store_dwordx4 v[4:7], v2, s[4:7], s24 offen offset:2048 sc1
    buffer_store_dwordx4 v[4:7], v2, s[4:7], s24 offen offset:3072 sc1
    s_waitcnt vmcnt(0) lgkmcnt(0)
    s_mov_b32 s16, s30
    s_and_b32 s17, s31, 65535
    s_mov_b32 s18, 256
    s_mov_b32 s19, 131072
    v_mov_b32 v3, 1
    buffer_store_dword v3, off, s[16:19], 0 offset:64 sc1
    s_endpgm
abinit_m_188:
    s_endpgm
ninit_m_187:
    s_sub_u32 s20, s20, 1
    s_endpgm
.section .rodata,"a"
.p2align 6
.amdhsa_kernel sequential_preLN__memory_aug_recurrent_mem_tr__dense_activation_gelu__prompt_kernel
  .amdhsa_next_free_vgpr 512
  .amdhsa_next_free_sgpr 102
  .amdhsa_accum_offset 256
  .amdhsa_group_segment_fixed_size 0
  .amdhsa_kernarg_size 120
  .amdhsa_user_sgpr_count 2
  .amdhsa_user_sgpr_kernarg_segment_ptr 1
  .amdhsa_system_sgpr_workgroup_id_x 1
.end_amdhsa_kernel
```
